```python
import torch

def _softmax(x, axis=-1):
    return torch.softmax(x, dim=axis)

def _gelu(x):
    return torch.nn.functional.gelu(x, approximate='tanh')

def _silu(x):
    return torch.nn.functional.silu(x)

def _sigmoid(x):
    return torch.sigmoid(x)

def _layernorm(x, axis=-1, eps=1e-05):
    m = x.mean(dim=axis, keepdim=True)
    v = x.var(dim=axis, keepdim=True, unbiased=False)
    return (x - m) / torch.sqrt(v + eps)

def _scatter_add(tgt, idx, src, axis=0):
    return tgt.clone().index_add_(axis, idx, src)

def _segment_sum(src, seg, n):
    out = torch.zeros((n,) + src.shape[1:], dtype=src.dtype)
    return out.index_add_(0, seg, src)

def _pad(x, pw):
    flat = tuple((v for pair in reversed(pw) for v in pair))
    return torch.nn.functional.pad(x, flat)
kernel_name = 'recurrent_scan__memory_aug_recurrent_mem_tr__dense_activation_silu__prompt'

def setup_inputs():

    _w = lambda a: (lambda t: t.to(torch.bfloat16) if t.is_floating_point() else t)(torch.as_tensor(a))

    def _A_setup():
        B, S, Dm = (1, 2048, 640)
        H, Dh = (32, 128)
        M, seg = (8, 32)
        seg = min(seg, S)
        S = S // seg * seg
        return {'x': _w((lambda *s: torch.randn(*s, dtype=torch.bfloat16) * 0.1)(B, S, Dm)), 'mem0': _w((lambda *s: torch.randn(*s, dtype=torch.bfloat16) * 1.6)(B, M, Dm)), 'Wq': _w((lambda *s: torch.randn(*s, dtype=torch.bfloat16) * 0.8)(Dm, H, Dh) * Dm ** (-0.5)), 'Wk': _w((lambda *s: torch.randn(*s, dtype=torch.bfloat16) * 0.8)(Dm, H, Dh) * Dm ** (-0.5)), 'Wv': _w((lambda *s: torch.randn(*s, dtype=torch.bfloat16) * 1.6)(Dm, H, Dh) * Dm ** (-0.5)), 'Wo': _w((lambda *s: torch.randn(*s, dtype=torch.bfloat16) * 1.6)(H, Dh, Dm) * (H * Dh) ** (-0.5)), 'seg_len': seg}
    _A_in = _A_setup()

    def _B_setup():
        B, S, D, F = (1, 2048, 640, 1728)
        return {'x': _w((lambda *s: torch.randn(*s, dtype=torch.bfloat16) * 0.1)(B, S, D)), 'w1': _w((lambda *s: torch.randn(*s, dtype=torch.bfloat16) * 0.4)(D, F) * D ** (-0.5)), 'w2': _w((lambda *s: torch.randn(*s, dtype=torch.bfloat16) * 0.4)(F, D) * F ** (-0.5))}
    _B_in = _B_setup()
    return {'A_x': _A_in['x'], 'A_mem0': _A_in['mem0'], 'A_Wq': _A_in['Wq'], 'A_Wk': _A_in['Wk'], 'A_Wv': _A_in['Wv'], 'A_Wo': _A_in['Wo'], 'A_seg_len': _A_in['seg_len'], 'B_x': _B_in['x'], 'B_w1': _B_in['w1'], 'B_w2': _B_in['w2']}

def reference(A_x, A_mem0, A_Wq, A_Wk, A_Wv, A_Wo, A_seg_len, B_x, B_w1, B_w2):

    def _A_ref(x, mem0, Wq, Wk, Wv, Wo, seg_len):
        B, S, Dm = x.shape
        H, Dh = (Wq.shape[1], Wq.shape[2])
        M = mem0.shape[1]
        scale = Dh ** (-0.5)
        n_seg = S // seg_len
        L = M + seg_len
        idx = torch.arange(L)
        mask = (idx[:, None] < M) | (idx[:, None] >= idx[None, :])
        mem = mem0
        outs = []
        for s in range(n_seg):
            xs = x[:, s * seg_len:(s + 1) * seg_len, :].clone()
            h = torch.concatenate([mem, xs], axis=1)
            q = torch.einsum('btd,dhe->bhte', h, Wq)
            k = torch.einsum('btd,dhe->bhte', h, Wk)
            v = torch.einsum('btd,dhe->bhte', h, Wv)
            scores = torch.einsum('bhqe,bhke->bhqk', q, k) * scale
            scores = torch.where(mask[None, None], scores, -1000000000.0)
            p = _softmax(scores, axis=-1)
            o = torch.einsum('bhqk,bhke->bhqe', p, v)
            o = torch.einsum('bhte,hed->btd', o, Wo)
            mem = o[:, :M, :].clone()
            outs.append(o[:, M:, :])
        return torch.concatenate(outs, axis=1)

    def _B_ref(x, w1, w2):
        h = torch.einsum('bsd,df->bsf', x, w1)
        h = _silu(h)
        out = torch.einsum('bsf,fd->bsd', h, w2)
        return out
    x = A_x
    xn = _layernorm(x, axis=-1)
    s = _A_ref(xn, A_mem0, A_Wq, A_Wk, A_Wv, A_Wo, A_seg_len)
    g = _silu(_B_ref(xn, B_w1, B_w2))
    return x + s * g
```

```asm
; @launch grid=(256,1,1) block=(256,1,1) lds=122880
.amdgcn_target "amdgcn-amd-amdhsa--gfx950"
.text
.globl recurrent_scan__memory_aug_recurrent_mem_tr__dense_activation_silu__prompt_kernel
.p2align 8
.type recurrent_scan__memory_aug_recurrent_mem_tr__dense_activation_silu__prompt_kernel,@function
recurrent_scan__memory_aug_recurrent_mem_tr__dense_activation_silu__prompt_kernel:
    s_load_dwordx2 s[4:5], s[0:1], 96
    s_mov_b32 s6, 0xfe00000
    s_mov_b32 s7, 0x20000
    s_mov_b32 s10, 0x200000
    s_mov_b32 s11, 0x20000
    s_load_dwordx2 s[88:89], s[0:1], 88
    s_mov_b32 s90, 256
    s_mov_b32 s91, 0x20000
    s_waitcnt lgkmcnt(0)
    s_add_u32 s8, s4, 0x1fffff
    s_addc_u32 s9, s5, 0
    s_and_b32 s8, s8, 0xffe00000
    s_add_u32 s4, s4, 0x1fffff
    s_addc_u32 s5, s5, 0
    s_and_b32 s4, s4, 0xffe00000
    s_cmp_lt_u32 s2, 256
    s_cbranch_scc1 L_in
    s_endpgm
L_in:
    s_getpc_b64 s[12:13]
L_pc:
    s_mov_b32 s14, L_last-L_pc-4
    s_lshr_b32 s20, s2, 3
    s_mul_i32 s21, s20, 86
    s_lshr_b32 s21, s21, 8
    s_mul_i32 s21, s21, 3
    s_sub_u32 s20, s20, s21
    s_lshl_b32 s20, s20, 15
    v_lshl_add_u32 v116, v0, 7, s20
    v_min_u32 v116, s14, v116
    v_mov_b32 v117, s13
    v_add_co_u32 v116, vcc, s12, v116
    s_nop 1
    v_addc_co_u32 v117, vcc, 0, v117, vcc
    global_load_dword v118, v[116:117], off
    s_and_b32 s20, s2, 0x184
    s_cmp_eq_u32 s20, 0x80
    s_cbranch_scc0 L_noinit
    s_lshr_b32 s17, s2, 3
    s_and_b32 s17, s17, 15
    s_lshl_b32 s17, s17, 2
    s_and_b32 s20, s2, 3
    s_add_u32 s17, s17, s20
    v_and_b32 v1, 63, v0
    v_lshrrev_b32 v2, 6, v0
    s_nop 0
    v_readfirstlane_b32 s18, v2
    v_and_b32 v12, 15, v1
    v_lshrrev_b32 v13, 4, v1
    v_lshlrev_b32 v4, 4, v1
    v_mov_b32 v11, -1
    s_mov_b32 s31, 0x05040100
    s_mov_b32 s32, 0x07060302
    s_load_dwordx2 s[12:13], s[0:1], 0
    s_mov_b32 s14, 2621440
    s_mov_b32 s15, 0x20000
    s_waitcnt lgkmcnt(0)
    s_lshl_b32 s22, s17, 1
    s_add_u32 s23, s22, 1
    v_mul_u32_u24 v5, 1280, v12
    v_lshl_add_u32 v5, v13, 4, v5
    s_mul_i32 s20, s22, 20480
    s_mul_i32 s21, s18, 320
    s_add_u32 s20, s20, s21
    buffer_load_dwordx4 v[20:23], v5, s[12:15], s20 offen offset:0
    buffer_load_dwordx4 v[24:27], v5, s[12:15], s20 offen offset:64
    buffer_load_dwordx4 v[28:31], v5, s[12:15], s20 offen offset:128
    buffer_load_dwordx4 v[32:35], v5, s[12:15], s20 offen offset:192
    buffer_load_dwordx4 v[36:39], v5, s[12:15], s20 offen offset:256
    v_mul_u32_u24 v5, 1280, v12
    v_lshl_add_u32 v5, v13, 4, v5
    s_mul_i32 s20, s23, 20480
    s_mul_i32 s21, s18, 320
    s_add_u32 s20, s20, s21
    buffer_load_dwordx4 v[80:83], v5, s[12:15], s20 offen offset:0
    buffer_load_dwordx4 v[84:87], v5, s[12:15], s20 offen offset:64
    buffer_load_dwordx4 v[88:91], v5, s[12:15], s20 offen offset:128
    buffer_load_dwordx4 v[92:95], v5, s[12:15], s20 offen offset:192
    buffer_load_dwordx4 v[96:99], v5, s[12:15], s20 offen offset:256
    s_add_u32 s24, s17, 64
    v_lshlrev_b32 v110, 4, v0
    s_lshl_b32 s20, s24, 14
    v_mov_b32 v112, -1
    v_mov_b32 v113, -1
    v_mov_b32 v114, -1
    v_mov_b32 v115, -1
    buffer_store_dwordx4 v[112:115], v110, s[8:11], s20 offen sc1
    s_add_u32 s20, s20, 4096
    buffer_store_dwordx4 v[112:115], v110, s[8:11], s20 offen sc1
    s_add_u32 s20, s20, 4096
    buffer_store_dwordx4 v[112:115], v110, s[8:11], s20 offen sc1
    s_add_u32 s20, s20, 4096
    buffer_store_dwordx4 v[112:115], v110, s[8:11], s20 offen sc1
    s_add_u32 s20, s20, 4096
    s_mov_b32 s24, s17
    v_lshlrev_b32 v110, 4, v0
    s_lshl_b32 s20, s24, 14
    v_mov_b32 v112, -1
    v_mov_b32 v113, -1
    v_mov_b32 v114, -1
    v_mov_b32 v115, -1
    buffer_store_dwordx4 v[112:115], v110, s[8:11], s20 offen sc1
    s_add_u32 s20, s20, 4096
    buffer_store_dwordx4 v[112:115], v110, s[8:11], s20 offen sc1
    s_add_u32 s20, s20, 4096
    buffer_store_dwordx4 v[112:115], v110, s[8:11], s20 offen sc1
    s_add_u32 s20, s20, 4096
    buffer_store_dwordx4 v[112:115], v110, s[8:11], s20 offen sc1
    s_add_u32 s20, s20, 4096
    s_waitcnt vmcnt(8)
    v_lshlrev_b32 v6, 2, v12
    s_lshl_b32 s21, s18, 6
    v_add_u32 v7, s21, v6
    v_lshlrev_b32 v40, 16, v20
    v_and_b32 v41, 0xffff0000, v20
    v_lshlrev_b32 v42, 16, v21
    v_and_b32 v43, 0xffff0000, v21
    v_lshlrev_b32 v44, 16, v22
    v_and_b32 v45, 0xffff0000, v22
    v_lshlrev_b32 v46, 16, v23
    v_and_b32 v47, 0xffff0000, v23
    v_lshlrev_b32 v48, 16, v24
    v_and_b32 v49, 0xffff0000, v24
    v_lshlrev_b32 v50, 16, v25
    v_and_b32 v51, 0xffff0000, v25
    v_lshlrev_b32 v52, 16, v26
    v_and_b32 v53, 0xffff0000, v26
    v_lshlrev_b32 v54, 16, v27
    v_and_b32 v55, 0xffff0000, v27
    v_lshlrev_b32 v56, 16, v28
    v_and_b32 v57, 0xffff0000, v28
    v_lshlrev_b32 v58, 16, v29
    v_and_b32 v59, 0xffff0000, v29
    v_lshlrev_b32 v60, 16, v30
    v_and_b32 v61, 0xffff0000, v30
    v_lshlrev_b32 v62, 16, v31
    v_and_b32 v63, 0xffff0000, v31
    v_lshlrev_b32 v64, 16, v32
    v_and_b32 v65, 0xffff0000, v32
    v_lshlrev_b32 v66, 16, v33
    v_and_b32 v67, 0xffff0000, v33
    v_lshlrev_b32 v68, 16, v34
    v_and_b32 v69, 0xffff0000, v34
    v_lshlrev_b32 v70, 16, v35
    v_and_b32 v71, 0xffff0000, v35
    v_lshlrev_b32 v72, 16, v36
    v_and_b32 v73, 0xffff0000, v36
    v_lshlrev_b32 v74, 16, v37
    v_and_b32 v75, 0xffff0000, v37
    v_lshlrev_b32 v76, 16, v38
    v_and_b32 v77, 0xffff0000, v38
    v_lshlrev_b32 v78, 16, v39
    v_and_b32 v79, 0xffff0000, v39
    v_add_f32 v8, v40, v41
    v_add_f32 v9, v42, v43
    v_add_f32 v8, v8, v44
    v_add_f32 v9, v9, v45
    v_add_f32 v8, v8, v46
    v_add_f32 v9, v9, v47
    v_add_f32 v8, v8, v48
    v_add_f32 v9, v9, v49
    v_add_f32 v8, v8, v50
    v_add_f32 v9, v9, v51
    v_add_f32 v8, v8, v52
    v_add_f32 v9, v9, v53
    v_add_f32 v8, v8, v54
    v_add_f32 v9, v9, v55
    v_add_f32 v8, v8, v56
    v_add_f32 v9, v9, v57
    v_add_f32 v8, v8, v58
    v_add_f32 v9, v9, v59
    v_add_f32 v8, v8, v60
    v_add_f32 v9, v9, v61
    v_add_f32 v8, v8, v62
    v_add_f32 v9, v9, v63
    v_add_f32 v8, v8, v64
    v_add_f32 v9, v9, v65
    v_add_f32 v8, v8, v66
    v_add_f32 v9, v9, v67
    v_add_f32 v8, v8, v68
    v_add_f32 v9, v9, v69
    v_add_f32 v8, v8, v70
    v_add_f32 v9, v9, v71
    v_add_f32 v8, v8, v72
    v_add_f32 v9, v9, v73
    v_add_f32 v8, v8, v74
    v_add_f32 v9, v9, v75
    v_add_f32 v8, v8, v76
    v_add_f32 v9, v9, v77
    v_add_f32 v8, v8, v78
    v_add_f32 v9, v9, v79
    v_add_f32 v8, v8, v9
    v_mov_b32 v9, v8
    s_nop 1
    v_permlane32_swap_b32 v8, v9
    v_add_f32 v8, v8, v9
    v_mov_b32 v9, v8
    s_nop 1
    v_permlane16_swap_b32 v8, v9
    v_add_f32 v8, v8, v9
    ds_write_b32 v7, v8 offset:0
    s_waitcnt lgkmcnt(0)
    s_barrier
    ds_read_b32 v8, v6 offset:0
    ds_read_b32 v9, v6 offset:64
    ds_read_b32 v10, v6 offset:128
    ds_read_b32 v14, v6 offset:192
    s_waitcnt lgkmcnt(0)
    v_add_f32 v8, v8, v9
    v_add_f32 v10, v10, v14
    v_add_f32 v8, v8, v10
    v_mul_f32 v8, 0x3acccccd, v8
    v_sub_f32 v40, v40, v8
    v_sub_f32 v41, v41, v8
    v_sub_f32 v42, v42, v8
    v_sub_f32 v43, v43, v8
    v_sub_f32 v44, v44, v8
    v_sub_f32 v45, v45, v8
    v_sub_f32 v46, v46, v8
    v_sub_f32 v47, v47, v8
    v_sub_f32 v48, v48, v8
    v_sub_f32 v49, v49, v8
    v_sub_f32 v50, v50, v8
    v_sub_f32 v51, v51, v8
    v_sub_f32 v52, v52, v8
    v_sub_f32 v53, v53, v8
    v_sub_f32 v54, v54, v8
    v_sub_f32 v55, v55, v8
    v_sub_f32 v56, v56, v8
    v_sub_f32 v57, v57, v8
    v_sub_f32 v58, v58, v8
    v_sub_f32 v59, v59, v8
    v_sub_f32 v60, v60, v8
    v_sub_f32 v61, v61, v8
    v_sub_f32 v62, v62, v8
    v_sub_f32 v63, v63, v8
    v_sub_f32 v64, v64, v8
    v_sub_f32 v65, v65, v8
    v_sub_f32 v66, v66, v8
    v_sub_f32 v67, v67, v8
    v_sub_f32 v68, v68, v8
    v_sub_f32 v69, v69, v8
    v_sub_f32 v70, v70, v8
    v_sub_f32 v71, v71, v8
    v_sub_f32 v72, v72, v8
    v_sub_f32 v73, v73, v8
    v_sub_f32 v74, v74, v8
    v_sub_f32 v75, v75, v8
    v_sub_f32 v76, v76, v8
    v_sub_f32 v77, v77, v8
    v_sub_f32 v78, v78, v8
    v_sub_f32 v79, v79, v8
    v_mul_f32 v8, v40, v40
    v_mul_f32 v9, v41, v41
    v_fmac_f32 v8, v42, v42
    v_fmac_f32 v9, v43, v43
    v_fmac_f32 v8, v44, v44
    v_fmac_f32 v9, v45, v45
    v_fmac_f32 v8, v46, v46
    v_fmac_f32 v9, v47, v47
    v_fmac_f32 v8, v48, v48
    v_fmac_f32 v9, v49, v49
    v_fmac_f32 v8, v50, v50
    v_fmac_f32 v9, v51, v51
    v_fmac_f32 v8, v52, v52
    v_fmac_f32 v9, v53, v53
    v_fmac_f32 v8, v54, v54
    v_fmac_f32 v9, v55, v55
    v_fmac_f32 v8, v56, v56
    v_fmac_f32 v9, v57, v57
    v_fmac_f32 v8, v58, v58
    v_fmac_f32 v9, v59, v59
    v_fmac_f32 v8, v60, v60
    v_fmac_f32 v9, v61, v61
    v_fmac_f32 v8, v62, v62
    v_fmac_f32 v9, v63, v63
    v_fmac_f32 v8, v64, v64
    v_fmac_f32 v9, v65, v65
    v_fmac_f32 v8, v66, v66
    v_fmac_f32 v9, v67, v67
    v_fmac_f32 v8, v68, v68
    v_fmac_f32 v9, v69, v69
    v_fmac_f32 v8, v70, v70
    v_fmac_f32 v9, v71, v71
    v_fmac_f32 v8, v72, v72
    v_fmac_f32 v9, v73, v73
    v_fmac_f32 v8, v74, v74
    v_fmac_f32 v9, v75, v75
    v_fmac_f32 v8, v76, v76
    v_fmac_f32 v9, v77, v77
    v_fmac_f32 v8, v78, v78
    v_fmac_f32 v9, v79, v79
    v_add_f32 v8, v8, v9
    v_mov_b32 v9, v8
    s_nop 1
    v_permlane32_swap_b32 v8, v9
    v_add_f32 v8, v8, v9
    v_mov_b32 v9, v8
    s_nop 1
    v_permlane16_swap_b32 v8, v9
    v_add_f32 v8, v8, v9
    ds_write_b32 v7, v8 offset:256
    s_waitcnt lgkmcnt(0)
    s_barrier
    ds_read_b32 v8, v6 offset:256
    ds_read_b32 v9, v6 offset:320
    ds_read_b32 v10, v6 offset:384
    ds_read_b32 v14, v6 offset:448
    s_waitcnt lgkmcnt(0)
    v_add_f32 v8, v8, v9
    v_add_f32 v10, v10, v14
    v_add_f32 v8, v8, v10
    v_mov_b32 v9, 0x3727c5ac
    v_fmac_f32 v9, 0x3acccccd, v8
    v_rsq_f32 v8, v9
    s_nop 0
    v_mul_f32 v40, v40, v8
    v_mul_f32 v41, v41, v8
    v_mul_f32 v42, v42, v8
    v_mul_f32 v43, v43, v8
    v_mul_f32 v44, v44, v8
    v_mul_f32 v45, v45, v8
    v_mul_f32 v46, v46, v8
    v_mul_f32 v47, v47, v8
    v_mul_f32 v48, v48, v8
    v_mul_f32 v49, v49, v8
    v_mul_f32 v50, v50, v8
    v_mul_f32 v51, v51, v8
    v_mul_f32 v52, v52, v8
    v_mul_f32 v53, v53, v8
    v_mul_f32 v54, v54, v8
    v_mul_f32 v55, v55, v8
    v_mul_f32 v56, v56, v8
    v_mul_f32 v57, v57, v8
    v_mul_f32 v58, v58, v8
    v_mul_f32 v59, v59, v8
    v_mul_f32 v60, v60, v8
    v_mul_f32 v61, v61, v8
    v_mul_f32 v62, v62, v8
    v_mul_f32 v63, v63, v8
    v_mul_f32 v64, v64, v8
    v_mul_f32 v65, v65, v8
    v_mul_f32 v66, v66, v8
    v_mul_f32 v67, v67, v8
    v_mul_f32 v68, v68, v8
    v_mul_f32 v69, v69, v8
    v_mul_f32 v70, v70, v8
    v_mul_f32 v71, v71, v8
    v_mul_f32 v72, v72, v8
    v_mul_f32 v73, v73, v8
    v_mul_f32 v74, v74, v8
    v_mul_f32 v75, v75, v8
    v_mul_f32 v76, v76, v8
    v_mul_f32 v77, v77, v8
    v_mul_f32 v78, v78, v8
    v_mul_f32 v79, v79, v8
    v_cvt_pk_bf16_f32 v20, v40, v41
    v_cvt_pk_bf16_f32 v21, v42, v43
    v_cvt_pk_bf16_f32 v22, v44, v45
    v_cvt_pk_bf16_f32 v23, v46, v47
    v_cvt_pk_bf16_f32 v24, v48, v49
    v_cvt_pk_bf16_f32 v25, v50, v51
    v_cvt_pk_bf16_f32 v26, v52, v53
    v_cvt_pk_bf16_f32 v27, v54, v55
    v_cvt_pk_bf16_f32 v28, v56, v57
    v_cvt_pk_bf16_f32 v29, v58, v59
    v_cvt_pk_bf16_f32 v30, v60, v61
    v_cvt_pk_bf16_f32 v31, v62, v63
    v_cvt_pk_bf16_f32 v32, v64, v65
    v_cvt_pk_bf16_f32 v33, v66, v67
    v_cvt_pk_bf16_f32 v34, v68, v69
    v_cvt_pk_bf16_f32 v35, v70, v71
    v_cvt_pk_bf16_f32 v36, v72, v73
    v_cvt_pk_bf16_f32 v37, v74, v75
    v_cvt_pk_bf16_f32 v38, v76, v77
    v_cvt_pk_bf16_f32 v39, v78, v79
    s_mul_i32 s20, s22, 20480
    s_mul_i32 s21, s18, 5120
    s_add_u32 s20, s20, s21
    s_add_u32 s20, s20, 2097152
    s_add_u32 s21, s20, 4096
    buffer_store_dwordx4 v[20:23], v4, s[4:7], s20 offen offset:0 sc1
    buffer_store_dwordx4 v[24:27], v4, s[4:7], s20 offen offset:1024 sc1
    buffer_store_dwordx4 v[28:31], v4, s[4:7], s20 offen offset:2048 sc1
    buffer_store_dwordx4 v[32:35], v4, s[4:7], s20 offen offset:3072 sc1
    buffer_store_dwordx4 v[36:39], v4, s[4:7], s21 offen offset:0 sc1
    v_lshlrev_b32 v6, 2, v12
    s_lshl_b32 s21, s18, 6
    v_add_u32 v7, s21, v6
    v_lshlrev_b32 v40, 16, v80
    v_and_b32 v41, 0xffff0000, v80
    v_lshlrev_b32 v42, 16, v81
    v_and_b32 v43, 0xffff0000, v81
    v_lshlrev_b32 v44, 16, v82
    v_and_b32 v45, 0xffff0000, v82
    v_lshlrev_b32 v46, 16, v83
    v_and_b32 v47, 0xffff0000, v83
    v_lshlrev_b32 v48, 16, v84
    v_and_b32 v49, 0xffff0000, v84
    v_lshlrev_b32 v50, 16, v85
    v_and_b32 v51, 0xffff0000, v85
    v_lshlrev_b32 v52, 16, v86
    v_and_b32 v53, 0xffff0000, v86
    v_lshlrev_b32 v54, 16, v87
    v_and_b32 v55, 0xffff0000, v87
    v_lshlrev_b32 v56, 16, v88
    v_and_b32 v57, 0xffff0000, v88
    v_lshlrev_b32 v58, 16, v89
    v_and_b32 v59, 0xffff0000, v89
    v_lshlrev_b32 v60, 16, v90
    v_and_b32 v61, 0xffff0000, v90
    v_lshlrev_b32 v62, 16, v91
    v_and_b32 v63, 0xffff0000, v91
    v_lshlrev_b32 v64, 16, v92
    v_and_b32 v65, 0xffff0000, v92
    v_lshlrev_b32 v66, 16, v93
    v_and_b32 v67, 0xffff0000, v93
    v_lshlrev_b32 v68, 16, v94
    v_and_b32 v69, 0xffff0000, v94
    v_lshlrev_b32 v70, 16, v95
    v_and_b32 v71, 0xffff0000, v95
    v_lshlrev_b32 v72, 16, v96
    v_and_b32 v73, 0xffff0000, v96
    v_lshlrev_b32 v74, 16, v97
    v_and_b32 v75, 0xffff0000, v97
    v_lshlrev_b32 v76, 16, v98
    v_and_b32 v77, 0xffff0000, v98
    v_lshlrev_b32 v78, 16, v99
    v_and_b32 v79, 0xffff0000, v99
    v_add_f32 v8, v40, v41
    v_add_f32 v9, v42, v43
    v_add_f32 v8, v8, v44
    v_add_f32 v9, v9, v45
    v_add_f32 v8, v8, v46
    v_add_f32 v9, v9, v47
    v_add_f32 v8, v8, v48
    v_add_f32 v9, v9, v49
    v_add_f32 v8, v8, v50
    v_add_f32 v9, v9, v51
    v_add_f32 v8, v8, v52
    v_add_f32 v9, v9, v53
    v_add_f32 v8, v8, v54
    v_add_f32 v9, v9, v55
    v_add_f32 v8, v8, v56
    v_add_f32 v9, v9, v57
    v_add_f32 v8, v8, v58
    v_add_f32 v9, v9, v59
    v_add_f32 v8, v8, v60
    v_add_f32 v9, v9, v61
    v_add_f32 v8, v8, v62
    v_add_f32 v9, v9, v63
    v_add_f32 v8, v8, v64
    v_add_f32 v9, v9, v65
    v_add_f32 v8, v8, v66
    v_add_f32 v9, v9, v67
    v_add_f32 v8, v8, v68
    v_add_f32 v9, v9, v69
    v_add_f32 v8, v8, v70
    v_add_f32 v9, v9, v71
    v_add_f32 v8, v8, v72
    v_add_f32 v9, v9, v73
    v_add_f32 v8, v8, v74
    v_add_f32 v9, v9, v75
    v_add_f32 v8, v8, v76
    v_add_f32 v9, v9, v77
    v_add_f32 v8, v8, v78
    v_add_f32 v9, v9, v79
    v_add_f32 v8, v8, v9
    v_mov_b32 v9, v8
    s_nop 1
    v_permlane32_swap_b32 v8, v9
    v_add_f32 v8, v8, v9
    v_mov_b32 v9, v8
    s_nop 1
    v_permlane16_swap_b32 v8, v9
    v_add_f32 v8, v8, v9
    ds_write_b32 v7, v8 offset:0
    s_waitcnt lgkmcnt(0)
    s_barrier
    ds_read_b32 v8, v6 offset:0
    ds_read_b32 v9, v6 offset:64
    ds_read_b32 v10, v6 offset:128
    ds_read_b32 v14, v6 offset:192
    s_waitcnt lgkmcnt(0)
    v_add_f32 v8, v8, v9
    v_add_f32 v10, v10, v14
    v_add_f32 v8, v8, v10
    v_mul_f32 v8, 0x3acccccd, v8
    v_sub_f32 v40, v40, v8
    v_sub_f32 v41, v41, v8
    v_sub_f32 v42, v42, v8
    v_sub_f32 v43, v43, v8
    v_sub_f32 v44, v44, v8
    v_sub_f32 v45, v45, v8
    v_sub_f32 v46, v46, v8
    v_sub_f32 v47, v47, v8
    v_sub_f32 v48, v48, v8
    v_sub_f32 v49, v49, v8
    v_sub_f32 v50, v50, v8
    v_sub_f32 v51, v51, v8
    v_sub_f32 v52, v52, v8
    v_sub_f32 v53, v53, v8
    v_sub_f32 v54, v54, v8
    v_sub_f32 v55, v55, v8
    v_sub_f32 v56, v56, v8
    v_sub_f32 v57, v57, v8
    v_sub_f32 v58, v58, v8
    v_sub_f32 v59, v59, v8
    v_sub_f32 v60, v60, v8
    v_sub_f32 v61, v61, v8
    v_sub_f32 v62, v62, v8
    v_sub_f32 v63, v63, v8
    v_sub_f32 v64, v64, v8
    v_sub_f32 v65, v65, v8
    v_sub_f32 v66, v66, v8
    v_sub_f32 v67, v67, v8
    v_sub_f32 v68, v68, v8
    v_sub_f32 v69, v69, v8
    v_sub_f32 v70, v70, v8
    v_sub_f32 v71, v71, v8
    v_sub_f32 v72, v72, v8
    v_sub_f32 v73, v73, v8
    v_sub_f32 v74, v74, v8
    v_sub_f32 v75, v75, v8
    v_sub_f32 v76, v76, v8
    v_sub_f32 v77, v77, v8
    v_sub_f32 v78, v78, v8
    v_sub_f32 v79, v79, v8
    v_mul_f32 v8, v40, v40
    v_mul_f32 v9, v41, v41
    v_fmac_f32 v8, v42, v42
    v_fmac_f32 v9, v43, v43
    v_fmac_f32 v8, v44, v44
    v_fmac_f32 v9, v45, v45
    v_fmac_f32 v8, v46, v46
    v_fmac_f32 v9, v47, v47
    v_fmac_f32 v8, v48, v48
    v_fmac_f32 v9, v49, v49
    v_fmac_f32 v8, v50, v50
    v_fmac_f32 v9, v51, v51
    v_fmac_f32 v8, v52, v52
    v_fmac_f32 v9, v53, v53
    v_fmac_f32 v8, v54, v54
    v_fmac_f32 v9, v55, v55
    v_fmac_f32 v8, v56, v56
    v_fmac_f32 v9, v57, v57
    v_fmac_f32 v8, v58, v58
    v_fmac_f32 v9, v59, v59
    v_fmac_f32 v8, v60, v60
    v_fmac_f32 v9, v61, v61
    v_fmac_f32 v8, v62, v62
    v_fmac_f32 v9, v63, v63
    v_fmac_f32 v8, v64, v64
    v_fmac_f32 v9, v65, v65
    v_fmac_f32 v8, v66, v66
    v_fmac_f32 v9, v67, v67
    v_fmac_f32 v8, v68, v68
    v_fmac_f32 v9, v69, v69
    v_fmac_f32 v8, v70, v70
    v_fmac_f32 v9, v71, v71
    v_fmac_f32 v8, v72, v72
    v_fmac_f32 v9, v73, v73
    v_fmac_f32 v8, v74, v74
    v_fmac_f32 v9, v75, v75
    v_fmac_f32 v8, v76, v76
    v_fmac_f32 v9, v77, v77
    v_fmac_f32 v8, v78, v78
    v_fmac_f32 v9, v79, v79
    v_add_f32 v8, v8, v9
    v_mov_b32 v9, v8
    s_nop 1
    v_permlane32_swap_b32 v8, v9
    v_add_f32 v8, v8, v9
    v_mov_b32 v9, v8
    s_nop 1
    v_permlane16_swap_b32 v8, v9
    v_add_f32 v8, v8, v9
    ds_write_b32 v7, v8 offset:256
    s_waitcnt lgkmcnt(0)
    s_barrier
    ds_read_b32 v8, v6 offset:256
    ds_read_b32 v9, v6 offset:320
    ds_read_b32 v10, v6 offset:384
    ds_read_b32 v14, v6 offset:448
    s_waitcnt lgkmcnt(0)
    v_add_f32 v8, v8, v9
    v_add_f32 v10, v10, v14
    v_add_f32 v8, v8, v10
    v_mov_b32 v9, 0x3727c5ac
    v_fmac_f32 v9, 0x3acccccd, v8
    v_rsq_f32 v8, v9
    s_nop 0
    v_mul_f32 v40, v40, v8
    v_mul_f32 v41, v41, v8
    v_mul_f32 v42, v42, v8
    v_mul_f32 v43, v43, v8
    v_mul_f32 v44, v44, v8
    v_mul_f32 v45, v45, v8
    v_mul_f32 v46, v46, v8
    v_mul_f32 v47, v47, v8
    v_mul_f32 v48, v48, v8
    v_mul_f32 v49, v49, v8
    v_mul_f32 v50, v50, v8
    v_mul_f32 v51, v51, v8
    v_mul_f32 v52, v52, v8
    v_mul_f32 v53, v53, v8
    v_mul_f32 v54, v54, v8
    v_mul_f32 v55, v55, v8
    v_mul_f32 v56, v56, v8
    v_mul_f32 v57, v57, v8
    v_mul_f32 v58, v58, v8
    v_mul_f32 v59, v59, v8
    v_mul_f32 v60, v60, v8
    v_mul_f32 v61, v61, v8
    v_mul_f32 v62, v62, v8
    v_mul_f32 v63, v63, v8
    v_mul_f32 v64, v64, v8
    v_mul_f32 v65, v65, v8
    v_mul_f32 v66, v66, v8
    v_mul_f32 v67, v67, v8
    v_mul_f32 v68, v68, v8
    v_mul_f32 v69, v69, v8
    v_mul_f32 v70, v70, v8
    v_mul_f32 v71, v71, v8
    v_mul_f32 v72, v72, v8
    v_mul_f32 v73, v73, v8
    v_mul_f32 v74, v74, v8
    v_mul_f32 v75, v75, v8
    v_mul_f32 v76, v76, v8
    v_mul_f32 v77, v77, v8
    v_mul_f32 v78, v78, v8
    v_mul_f32 v79, v79, v8
    v_cvt_pk_bf16_f32 v80, v40, v41
    v_cvt_pk_bf16_f32 v81, v42, v43
    v_cvt_pk_bf16_f32 v82, v44, v45
    v_cvt_pk_bf16_f32 v83, v46, v47
    v_cvt_pk_bf16_f32 v84, v48, v49
    v_cvt_pk_bf16_f32 v85, v50, v51
    v_cvt_pk_bf16_f32 v86, v52, v53
    v_cvt_pk_bf16_f32 v87, v54, v55
    v_cvt_pk_bf16_f32 v88, v56, v57
    v_cvt_pk_bf16_f32 v89, v58, v59
    v_cvt_pk_bf16_f32 v90, v60, v61
    v_cvt_pk_bf16_f32 v91, v62, v63
    v_cvt_pk_bf16_f32 v92, v64, v65
    v_cvt_pk_bf16_f32 v93, v66, v67
    v_cvt_pk_bf16_f32 v94, v68, v69
    v_cvt_pk_bf16_f32 v95, v70, v71
    v_cvt_pk_bf16_f32 v96, v72, v73
    v_cvt_pk_bf16_f32 v97, v74, v75
    v_cvt_pk_bf16_f32 v98, v76, v77
    v_cvt_pk_bf16_f32 v99, v78, v79
    s_mul_i32 s20, s23, 20480
    s_mul_i32 s21, s18, 5120
    s_add_u32 s20, s20, s21
    s_add_u32 s20, s20, 2097152
    s_add_u32 s21, s20, 4096
    buffer_store_dwordx4 v[80:83], v4, s[4:7], s20 offen offset:0 sc1
    buffer_store_dwordx4 v[84:87], v4, s[4:7], s20 offen offset:1024 sc1
    buffer_store_dwordx4 v[88:91], v4, s[4:7], s20 offen offset:2048 sc1
    buffer_store_dwordx4 v[92:95], v4, s[4:7], s20 offen offset:3072 sc1
    buffer_store_dwordx4 v[96:99], v4, s[4:7], s21 offen offset:0 sc1
    s_waitcnt vmcnt(0)
    s_lshl_b32 s24, s24, 14
    s_add_u32 s24, s24, 4096
    s_lshl_b32 s20, s18, 10
    s_add_u32 s24, s24, s20
    s_and_b32 s20, s18, 1
    s_lshl_b32 s20, s20, 13
    s_add_u32 s24, s24, s20
    s_memtime s[26:27]
    s_waitcnt lgkmcnt(0)
    buffer_load_dword v6, off, s[8:11], s24 sc1
    s_waitcnt vmcnt(0)
    s_memtime s[28:29]
    s_waitcnt lgkmcnt(0)
    s_sub_u32 s35, s28, s26
    s_xor_b32 s24, s24, 0x2000
    s_memtime s[26:27]
    s_waitcnt lgkmcnt(0)
    buffer_load_dword v6, off, s[8:11], s24 sc1
    s_waitcnt vmcnt(0)
    s_memtime s[28:29]
    s_waitcnt lgkmcnt(0)
    s_sub_u32 s36, s28, s26
    s_xor_b32 s24, s24, 0x2000
    s_cmp_lt_u32 s36, s35
    s_cselect_b32 s25, 0x2000, 0
    s_xor_b32 s25, s25, s20
    s_lshr_b32 s25, s25, 5
    s_add_u32 s25, s25, 1
L_i_nov:
    s_lshl_b32 s20, s18, 2
    v_mov_b32 v6, s20
    v_mov_b32 v7, s25
    ds_write_b32 v6, v7 offset:1024
    s_waitcnt lgkmcnt(0)
    v_cmp_eq_u32 vcc, 0, v0
    v_mov_b32 v5, 0x40000000
    s_nop 0
    v_cndmask_b32 v5, v5, v0, vcc
    v_mov_b32 v6, s25
    s_waitcnt vmcnt(0)
    s_barrier
    s_cmp_eq_u32 s18, 0
    s_cbranch_scc0 L_i_sig
    v_mov_b32 v6, 0
    ds_read_b128 v[16:19], v6 offset:1024
    s_waitcnt lgkmcnt(0)
    v_add3_u32 v6, v16, v17, v18
    v_add3_u32 v6, v6, v19, -3
    s_nop 0
    v_readfirstlane_b32 s25, v6
    buffer_atomic_add v6, v5, s[88:91], 0 offen sc0 sc1
    s_waitcnt vmcnt(0)
    v_readfirstlane_b32 s20, v6
    s_add_u32 s20, s20, s25
    s_and_b32 s21, s20, 255
    s_cmp_eq_u32 s21, 64
    s_cbranch_scc0 L_i_sig
    v_mov_b32 v6, s20
    buffer_store_dword v6, v5, s[88:91], 0 offen offset:128 sc1
L_i_sig:
L_noinit:
    s_and_b32 s20, s2, 7
    s_lshr_b32 s21, s2, 3
    s_cmp_lt_u32 s20, 4
    s_cbranch_scc0 L_notchain
    s_and_b32 s17, s21, 7
    s_lshl_b32 s16, s20, 3
    s_add_u32 s17, s17, s16
    s_cmp_lt_u32 s21, 8
    s_cbranch_scc1 L_qk_j
    s_cmp_lt_u32 s21, 16
    s_cbranch_scc1 L_vo_j
    s_sub_u32 s17, s21, 16
    s_lshl_b32 s17, s17, 2
    s_add_u32 s17, s17, s20
    s_cmp_lt_u32 s21, 26
    s_cbranch_scc1 L_own_j
    s_branch L_notchain
L_qk_j:
    s_branch L_qk
L_vo_j:
    s_branch L_vo
L_own_j:
    s_branch L_own
L_notchain:
    s_cmp_lt_u32 s21, 32
    s_cbranch_scc0 L_exit
    s_cmp_lt_u32 s20, 4
    s_cbranch_scc0 L_far
    s_sub_u32 s42, s21, 26
    s_lshl_b32 s42, s42, 2
    s_add_u32 s42, s42, s20
    s_cmp_lt_u32 s42, 7
    s_cbranch_scc0 L_touch
    s_mul_i32 s16, s42, 37
    s_lshr_b32 s16, s16, 8
    s_mul_i32 s20, s16, 7
    s_sub_u32 s17, s42, s20
    s_mov_b32 s41, 1
    s_branch L_x_ffn
L_touch:
    s_mov_b32 s21, 0
    v_mov_b32 v172, 40960
    s_cmp_eq_u32 s18, 0
    s_cbranch_scc0 wi_1_w
wi_1:
    buffer_load_dword v171, off, s[88:91], 0 offset:132 sc1
    s_waitcnt vmcnt(0)
wi_1_chk:
    v_readfirstlane_b32 s19, v171
    s_and_b32 s20, s19, 255
    s_cmp_eq_u32 s20, 40
    s_cbranch_scc1 wi_1_ok
    s_sleep 2
    s_add_u32 s21, s21, 1
    s_cmp_lt_u32 s21, 200000
    s_cbranch_scc1 wi_1
wi_1_ok:
    ds_write_b32 v172, v171
wi_1_w:
    s_waitcnt vmcnt(0) lgkmcnt(0)
    s_barrier
    ds_read_b32 v171, v172
    s_waitcnt lgkmcnt(0)
    v_readfirstlane_b32 s19, v171
    s_and_b32 s46, s19, 0x7000
    s_and_b32 s45, s19, 0x800
    s_and_b32 s19, s19, 0x2000
    s_xor_b32 s34, s19, 0x2000
    s_sub_u32 s42, s42, 7
    s_lshl_b32 s42, s42, 15
    v_lshl_add_u32 v5, v0, 7, s42
    s_load_dwordx2 s[12:13], s[0:1], 64
    s_mov_b32 s14, 2211840
    s_mov_b32 s15, 0x20000
    s_waitcnt lgkmcnt(0)
    s_load_dwordx2 s[92:93], s[0:1], 72
    s_mov_b32 s94, 2211840
    s_mov_b32 s95, 0x20000
    s_waitcnt lgkmcnt(0)
    v_add_u32 v8, 557056, v5
    buffer_load_dword v8, v8, s[12:15], 0 offen
    v_add_u32 v9, 1114112, v5
    buffer_load_dword v9, v9, s[12:15], 0 offen
    v_add_u32 v10, 1671168, v5
    buffer_load_dword v10, v10, s[12:15], 0 offen
    v_add_u32 v11, 0, v5
    buffer_load_dword v11, v11, s[92:95], 0 offen
    v_add_u32 v12, 557056, v5
    buffer_load_dword v12, v12, s[92:95], 0 offen
    v_add_u32 v13, 1114112, v5
    buffer_load_dword v13, v13, s[92:95], 0 offen
    v_add_u32 v14, 1671168, v5
    buffer_load_dword v14, v14, s[92:95], 0 offen
    s_waitcnt vmcnt(0)
L_exit:
    s_endpgm
L_far:
    s_and_b32 s20, s20, 3
    s_lshr_b32 s17, s21, 1
    s_and_b32 s17, s17, 7
    s_lshl_b32 s20, s20, 3
    s_add_u32 s17, s17, s20
    s_and_b32 s16, s21, 1
    s_lshl_b32 s42, s17, 1
    s_add_u32 s42, s42, s16
    s_mov_b32 s41, 2
    s_mul_i32 s41, s16, 63
    s_add_u32 s41, s41, 1
    s_cmp_lt_u32 s21, 16
    s_cbranch_scc0 L_x_vox
    v_and_b32 v1, 63, v0
    v_lshrrev_b32 v2, 6, v0
    s_nop 0
    v_readfirstlane_b32 s18, v2
    v_and_b32 v12, 15, v1
    v_lshrrev_b32 v13, 4, v1
    v_lshlrev_b32 v4, 4, v1
    v_mov_b32 v11, -1
    s_mov_b32 s31, 0x05040100
    s_mov_b32 s32, 0x07060302
    v_lshlrev_b32 v10, 16, v13
    v_lshl_add_u32 v10, v12, 2, v10
    s_lshl_b32 s20, s17, 8
    s_lshl_b32 s21, s18, 6
    s_add_u32 s20, s20, s21
    v_add_u32 v10, s20, v10
    s_load_dwordx2 s[12:13], s[0:1], 24
    s_mov_b32 s14, 5242880
    s_mov_b32 s15, 0x20000
    s_waitcnt lgkmcnt(0)
    s_load_dwordx2 s[92:93], s[0:1], 16
    s_mov_b32 s94, 5242880
    s_mov_b32 s95, 0x20000
    s_waitcnt lgkmcnt(0)
    s_mov_b32 s40, 0
    s_and_b32 s20, s17, 3
    s_lshr_b32 s21, s20, 1
    s_sub_u32 s21, s20, s21
    s_lshl_b32 s21, s21, 1
    s_and_b32 s22, s16, 1
    s_add_u32 s21, s21, s22
    s_lshl_b32 s21, s21, 2
    s_add_u32 s21, s21, s18
    s_mul_i32 s21, s21, 131072
    s_and_b32 s22, s17, 28
    s_lshl_b32 s22, s22, 8
    s_add_u32 s21, s21, s22
    s_add_u32 s21, s21, 2097408
    s_cmp_eq_u32 s20, 1
    s_cselect_b32 s21, 0x40000000, s21
    v_lshrrev_b32 v184, 1, v1
    v_lshlrev_b32 v184, 13, v184
    v_and_b32 v185, 1, v1
    v_lshl_add_u32 v184, v185, 7, v184
    v_add_u32 v184, s21, v184
    v_cmp_gt_u32 vcc, 32, v1
    v_mov_b32 v185, 0x40000000
    s_nop 0
    v_cndmask_b32 v184, v185, v184, vcc
    s_bitcmp1_b32 s16, 0
    s_cbranch_scc0 rev_2_a
    v_bfe_u32 v160, v1, 2, 2
    v_lshlrev_b32 v160, 6, v160
    v_and_b32 v161, 3, v1
    v_lshl_add_u32 v160, v161, 4, v160
    v_bfe_u32 v161, v1, 4, 1
    v_lshrrev_b32 v162, 5, v1
    ds_bpermute_b32 v164, v160, v10
    v_mul_u32_u24 v163, 8192, v161
    v_mul_u32_u24 v170, 16384, v162
    s_waitcnt lgkmcnt(0)
    v_add3_u32 v164, v164, v163, v170
    ds_bpermute_b32 v165, v160, v10
    v_mul_u32_u24 v163, 8192, v161
    v_mul_u32_u24 v170, 16384, v162
    s_waitcnt lgkmcnt(0)
    v_add3_u32 v165, v165, v163, v170
    s_mul_i32 s29, s18, 20480
    s_add_u32 s29, s29, 40960
    v_lshl_add_u32 v170, v1, 2, s29
    s_add_u32 m0, s29, 0
    s_mov_b32 s30, 1310720
    buffer_load_dwordx4 v164, s[12:15], s30 offen lds
    s_add_u32 m0, s29, 1024
    s_mov_b32 s30, 1343488
    buffer_load_dwordx4 v164, s[12:15], s30 offen lds
    s_add_u32 m0, s29, 2048
    s_mov_b32 s30, 1572864
    buffer_load_dwordx4 v164, s[12:15], s30 offen lds
    s_add_u32 m0, s29, 3072
    s_mov_b32 s30, 1605632
    buffer_load_dwordx4 v164, s[12:15], s30 offen lds
    s_add_u32 m0, s29, 4096
    s_mov_b32 s30, 1835008
    buffer_load_dwordx4 v164, s[12:15], s30 offen lds
    s_add_u32 m0, s29, 5120
    s_mov_b32 s30, 1867776
    buffer_load_dwordx4 v164, s[12:15], s30 offen lds
    s_add_u32 m0, s29, 6144
    s_mov_b32 s30, 2097152
    buffer_load_dwordx4 v164, s[12:15], s30 offen lds
    s_add_u32 m0, s29, 7168
    s_mov_b32 s30, 2129920
    buffer_load_dwordx4 v164, s[12:15], s30 offen lds
    s_add_u32 m0, s29, 8192
    s_mov_b32 s30, 2359296
    buffer_load_dwordx4 v164, s[12:15], s30 offen lds
    s_add_u32 m0, s29, 9216
    s_mov_b32 s30, 2392064
    buffer_load_dwordx4 v164, s[12:15], s30 offen lds
    s_add_u32 m0, s29, 10240
    s_mov_b32 s30, 0
    buffer_load_dwordx4 v164, s[12:15], s30 offen lds
    s_add_u32 m0, s29, 11264
    s_mov_b32 s30, 32768
    buffer_load_dwordx4 v164, s[12:15], s30 offen lds
    s_add_u32 m0, s29, 12288
    s_mov_b32 s30, 262144
    buffer_load_dwordx4 v164, s[12:15], s30 offen lds
    s_add_u32 m0, s29, 13312
    s_mov_b32 s30, 294912
    buffer_load_dwordx4 v164, s[12:15], s30 offen lds
    s_add_u32 m0, s29, 14336
    s_mov_b32 s30, 524288
    buffer_load_dwordx4 v164, s[12:15], s30 offen lds
    s_add_u32 m0, s29, 15360
    s_mov_b32 s30, 557056
    buffer_load_dwordx4 v164, s[12:15], s30 offen lds
    s_add_u32 m0, s29, 16384
    s_mov_b32 s30, 786432
    buffer_load_dwordx4 v164, s[12:15], s30 offen lds
    s_add_u32 m0, s29, 17408
    s_mov_b32 s30, 819200
    buffer_load_dwordx4 v164, s[12:15], s30 offen lds
    s_add_u32 m0, s29, 18432
    s_mov_b32 s30, 1048576
    buffer_load_dwordx4 v164, s[12:15], s30 offen lds
    s_add_u32 m0, s29, 19456
    s_mov_b32 s30, 1081344
    buffer_load_dwordx4 v164, s[12:15], s30 offen lds
    s_waitcnt vmcnt(16)
    ds_read2st64_b32 v[128:129], v170 offset0:0 offset1:1
    ds_read2st64_b32 v[130:131], v170 offset0:2 offset1:3
    ds_read2st64_b32 v[132:133], v170 offset0:4 offset1:5
    ds_read2st64_b32 v[134:135], v170 offset0:6 offset1:7
    ds_read2st64_b32 v[136:137], v170 offset0:8 offset1:9
    ds_read2st64_b32 v[138:139], v170 offset0:10 offset1:11
    ds_read2st64_b32 v[140:141], v170 offset0:12 offset1:13
    ds_read2st64_b32 v[142:143], v170 offset0:14 offset1:15
    s_waitcnt lgkmcnt(0)
    s_add_u32 m0, s29, 0
    s_mov_b32 s30, 3932160
    buffer_load_dwordx4 v164, s[12:15], s30 offen lds
    s_add_u32 m0, s29, 1024
    s_mov_b32 s30, 3964928
    buffer_load_dwordx4 v164, s[12:15], s30 offen lds
    s_add_u32 m0, s29, 2048
    s_mov_b32 s30, 4194304
    buffer_load_dwordx4 v164, s[12:15], s30 offen lds
    s_add_u32 m0, s29, 3072
    s_mov_b32 s30, 4227072
    buffer_load_dwordx4 v164, s[12:15], s30 offen lds
    s_waitcnt vmcnt(16)
    ds_read2st64_b32 v[144:145], v170 offset0:16 offset1:17
    ds_read2st64_b32 v[146:147], v170 offset0:18 offset1:19
    ds_read2st64_b32 v[148:149], v170 offset0:20 offset1:21
    ds_read2st64_b32 v[150:151], v170 offset0:22 offset1:23
    ds_read2st64_b32 v[152:153], v170 offset0:24 offset1:25
    ds_read2st64_b32 v[154:155], v170 offset0:26 offset1:27
    ds_read2st64_b32 v[156:157], v170 offset0:28 offset1:29
    ds_read2st64_b32 v[158:159], v170 offset0:30 offset1:31
    v_perm_b32 v120, v129, v128, s31
    v_accvgpr_write_b32 a36, v120
    v_perm_b32 v121, v129, v128, s32
    v_accvgpr_write_b32 a44, v121
    v_perm_b32 v122, v131, v130, s31
    v_accvgpr_write_b32 a37, v122
    v_perm_b32 v123, v131, v130, s32
    v_accvgpr_write_b32 a45, v123
    v_perm_b32 v124, v133, v132, s31
    v_accvgpr_write_b32 a38, v124
    v_perm_b32 v125, v133, v132, s32
    v_accvgpr_write_b32 a46, v125
    v_perm_b32 v126, v135, v134, s31
    v_accvgpr_write_b32 a39, v126
    v_perm_b32 v127, v135, v134, s32
    v_accvgpr_write_b32 a47, v127
    v_perm_b32 v120, v137, v136, s31
    v_accvgpr_write_b32 a48, v120
    v_perm_b32 v121, v137, v136, s32
    v_accvgpr_write_b32 a56, v121
    v_perm_b32 v122, v139, v138, s31
    v_accvgpr_write_b32 a49, v122
    v_perm_b32 v123, v139, v138, s32
    v_accvgpr_write_b32 a57, v123
    v_perm_b32 v124, v141, v140, s31
    v_accvgpr_write_b32 a50, v124
    v_perm_b32 v125, v141, v140, s32
    v_accvgpr_write_b32 a58, v125
    v_perm_b32 v126, v143, v142, s31
    v_accvgpr_write_b32 a51, v126
    v_perm_b32 v127, v143, v142, s32
    v_accvgpr_write_b32 a59, v127
    s_waitcnt lgkmcnt(0)
    s_add_u32 m0, s29, 4096
    s_mov_b32 s30, 4456448
    buffer_load_dwordx4 v164, s[12:15], s30 offen lds
    s_add_u32 m0, s29, 5120
    s_mov_b32 s30, 4489216
    buffer_load_dwordx4 v164, s[12:15], s30 offen lds
    s_add_u32 m0, s29, 6144
    s_mov_b32 s30, 4718592
    buffer_load_dwordx4 v164, s[12:15], s30 offen lds
    s_add_u32 m0, s29, 7168
    s_mov_b32 s30, 4751360
    buffer_load_dwordx4 v164, s[12:15], s30 offen lds
    s_waitcnt vmcnt(16)
    ds_read2st64_b32 v[128:129], v170 offset0:32 offset1:33
    ds_read2st64_b32 v[130:131], v170 offset0:34 offset1:35
    ds_read2st64_b32 v[132:133], v170 offset0:36 offset1:37
    ds_read2st64_b32 v[134:135], v170 offset0:38 offset1:39
    ds_read2st64_b32 v[136:137], v170 offset0:40 offset1:41
    ds_read2st64_b32 v[138:139], v170 offset0:42 offset1:43
    ds_read2st64_b32 v[140:141], v170 offset0:44 offset1:45
    ds_read2st64_b32 v[142:143], v170 offset0:46 offset1:47
    v_perm_b32 v120, v145, v144, s31
    v_accvgpr_write_b32 a52, v120
    v_perm_b32 v121, v145, v144, s32
    v_accvgpr_write_b32 a60, v121
    v_perm_b32 v122, v147, v146, s31
    v_accvgpr_write_b32 a53, v122
    v_perm_b32 v123, v147, v146, s32
    v_accvgpr_write_b32 a61, v123
    v_perm_b32 v124, v149, v148, s31
    v_accvgpr_write_b32 a54, v124
    v_perm_b32 v125, v149, v148, s32
    v_accvgpr_write_b32 a62, v125
    v_perm_b32 v126, v151, v150, s31
    v_accvgpr_write_b32 a55, v126
    v_perm_b32 v127, v151, v150, s32
    v_accvgpr_write_b32 a63, v127
    v_perm_b32 v120, v153, v152, s31
    v_accvgpr_write_b32 a64, v120
    v_perm_b32 v121, v153, v152, s32
    v_accvgpr_write_b32 a72, v121
    v_perm_b32 v122, v155, v154, s31
    v_accvgpr_write_b32 a65, v122
    v_perm_b32 v123, v155, v154, s32
    v_accvgpr_write_b32 a73, v123
    v_perm_b32 v124, v157, v156, s31
    v_accvgpr_write_b32 a66, v124
    v_perm_b32 v125, v157, v156, s32
    v_accvgpr_write_b32 a74, v125
    v_perm_b32 v126, v159, v158, s31
    v_accvgpr_write_b32 a67, v126
    v_perm_b32 v127, v159, v158, s32
    v_accvgpr_write_b32 a75, v127
    s_waitcnt lgkmcnt(0)
    s_add_u32 m0, s29, 8192
    s_mov_b32 s30, 4980736
    buffer_load_dwordx4 v164, s[12:15], s30 offen lds
    s_add_u32 m0, s29, 9216
    s_mov_b32 s30, 5013504
    buffer_load_dwordx4 v164, s[12:15], s30 offen lds
    s_add_u32 m0, s29, 10240
    s_mov_b32 s30, 2621440
    buffer_load_dwordx4 v164, s[12:15], s30 offen lds
    s_add_u32 m0, s29, 11264
    s_mov_b32 s30, 2654208
    buffer_load_dwordx4 v164, s[12:15], s30 offen lds
    s_waitcnt vmcnt(16)
    ds_read2st64_b32 v[144:145], v170 offset0:48 offset1:49
    ds_read2st64_b32 v[146:147], v170 offset0:50 offset1:51
    ds_read2st64_b32 v[148:149], v170 offset0:52 offset1:53
    ds_read2st64_b32 v[150:151], v170 offset0:54 offset1:55
    ds_read2st64_b32 v[152:153], v170 offset0:56 offset1:57
    ds_read2st64_b32 v[154:155], v170 offset0:58 offset1:59
    ds_read2st64_b32 v[156:157], v170 offset0:60 offset1:61
    ds_read2st64_b32 v[158:159], v170 offset0:62 offset1:63
    v_perm_b32 v120, v129, v128, s31
    v_accvgpr_write_b32 a68, v120
    v_perm_b32 v121, v129, v128, s32
    v_accvgpr_write_b32 a76, v121
    v_perm_b32 v122, v131, v130, s31
    v_accvgpr_write_b32 a69, v122
    v_perm_b32 v123, v131, v130, s32
    v_accvgpr_write_b32 a77, v123
    v_perm_b32 v124, v133, v132, s31
    v_accvgpr_write_b32 a70, v124
    v_perm_b32 v125, v133, v132, s32
    v_accvgpr_write_b32 a78, v125
    v_perm_b32 v126, v135, v134, s31
    v_accvgpr_write_b32 a71, v126
    v_perm_b32 v127, v135, v134, s32
    v_accvgpr_write_b32 a79, v127
    v_perm_b32 v120, v137, v136, s31
    v_accvgpr_write_b32 a0, v120
    v_perm_b32 v121, v137, v136, s32
    v_accvgpr_write_b32 a8, v121
    v_perm_b32 v122, v139, v138, s31
    v_accvgpr_write_b32 a1, v122
    v_perm_b32 v123, v139, v138, s32
    v_accvgpr_write_b32 a9, v123
    v_perm_b32 v124, v141, v140, s31
    v_accvgpr_write_b32 a2, v124
    v_perm_b32 v125, v141, v140, s32
    v_accvgpr_write_b32 a10, v125
    v_perm_b32 v126, v143, v142, s31
    v_accvgpr_write_b32 a3, v126
    v_perm_b32 v127, v143, v142, s32
    v_accvgpr_write_b32 a11, v127
    s_waitcnt lgkmcnt(0)
    s_add_u32 m0, s29, 12288
    s_mov_b32 s30, 2883584
    buffer_load_dwordx4 v164, s[12:15], s30 offen lds
    s_add_u32 m0, s29, 13312
    s_mov_b32 s30, 2916352
    buffer_load_dwordx4 v164, s[12:15], s30 offen lds
    s_add_u32 m0, s29, 14336
    s_mov_b32 s30, 3145728
    buffer_load_dwordx4 v164, s[12:15], s30 offen lds
    s_add_u32 m0, s29, 15360
    s_mov_b32 s30, 3178496
    buffer_load_dwordx4 v164, s[12:15], s30 offen lds
    s_waitcnt vmcnt(16)
    ds_read2st64_b32 v[128:129], v170 offset0:64 offset1:65
    ds_read2st64_b32 v[130:131], v170 offset0:66 offset1:67
    ds_read2st64_b32 v[132:133], v170 offset0:68 offset1:69
    ds_read2st64_b32 v[134:135], v170 offset0:70 offset1:71
    ds_read2st64_b32 v[136:137], v170 offset0:72 offset1:73
    ds_read2st64_b32 v[138:139], v170 offset0:74 offset1:75
    ds_read2st64_b32 v[140:141], v170 offset0:76 offset1:77
    ds_read2st64_b32 v[142:143], v170 offset0:78 offset1:79
    v_perm_b32 v120, v145, v144, s31
    v_accvgpr_write_b32 a4, v120
    v_perm_b32 v121, v145, v144, s32
    v_accvgpr_write_b32 a12, v121
    v_perm_b32 v122, v147, v146, s31
    v_accvgpr_write_b32 a5, v122
    v_perm_b32 v123, v147, v146, s32
    v_accvgpr_write_b32 a13, v123
    v_perm_b32 v124, v149, v148, s31
    v_accvgpr_write_b32 a6, v124
    v_perm_b32 v125, v149, v148, s32
    v_accvgpr_write_b32 a14, v125
    v_perm_b32 v126, v151, v150, s31
    v_accvgpr_write_b32 a7, v126
    v_perm_b32 v127, v151, v150, s32
    v_accvgpr_write_b32 a15, v127
    v_perm_b32 v120, v153, v152, s31
    v_accvgpr_write_b32 a16, v120
    v_perm_b32 v121, v153, v152, s32
    v_accvgpr_write_b32 a24, v121
    v_perm_b32 v122, v155, v154, s31
    v_accvgpr_write_b32 a17, v122
    v_perm_b32 v123, v155, v154, s32
    v_accvgpr_write_b32 a25, v123
    v_perm_b32 v124, v157, v156, s31
    v_accvgpr_write_b32 a18, v124
    v_perm_b32 v125, v157, v156, s32
    v_accvgpr_write_b32 a26, v125
    v_perm_b32 v126, v159, v158, s31
    v_accvgpr_write_b32 a19, v126
    v_perm_b32 v127, v159, v158, s32
    v_accvgpr_write_b32 a27, v127
    s_waitcnt lgkmcnt(0)
    s_add_u32 m0, s29, 16384
    s_mov_b32 s30, 3407872
    buffer_load_dwordx4 v164, s[12:15], s30 offen lds
    s_add_u32 m0, s29, 17408
    s_mov_b32 s30, 3440640
    buffer_load_dwordx4 v164, s[12:15], s30 offen lds
    s_add_u32 m0, s29, 18432
    s_mov_b32 s30, 3670016
    buffer_load_dwordx4 v164, s[12:15], s30 offen lds
    s_add_u32 m0, s29, 19456
    s_mov_b32 s30, 3702784
    buffer_load_dwordx4 v164, s[12:15], s30 offen lds
    s_waitcnt vmcnt(16)
    ds_read2st64_b32 v[144:145], v170 offset0:0 offset1:1
    ds_read2st64_b32 v[146:147], v170 offset0:2 offset1:3
    ds_read2st64_b32 v[148:149], v170 offset0:4 offset1:5
    ds_read2st64_b32 v[150:151], v170 offset0:6 offset1:7
    ds_read2st64_b32 v[152:153], v170 offset0:8 offset1:9
    ds_read2st64_b32 v[154:155], v170 offset0:10 offset1:11
    ds_read2st64_b32 v[156:157], v170 offset0:12 offset1:13
    ds_read2st64_b32 v[158:159], v170 offset0:14 offset1:15
    v_perm_b32 v120, v129, v128, s31
    v_accvgpr_write_b32 a20, v120
    v_perm_b32 v121, v129, v128, s32
    v_accvgpr_write_b32 a28, v121
    v_perm_b32 v122, v131, v130, s31
    v_accvgpr_write_b32 a21, v122
    v_perm_b32 v123, v131, v130, s32
    v_accvgpr_write_b32 a29, v123
    v_perm_b32 v124, v133, v132, s31
    v_accvgpr_write_b32 a22, v124
    v_perm_b32 v125, v133, v132, s32
    v_accvgpr_write_b32 a30, v125
    v_perm_b32 v126, v135, v134, s31
    v_accvgpr_write_b32 a23, v126
    v_perm_b32 v127, v135, v134, s32
    v_accvgpr_write_b32 a31, v127
    v_perm_b32 v120, v137, v136, s31
    v_accvgpr_write_b32 a32, v120
    v_perm_b32 v121, v137, v136, s32
    v_accvgpr_write_b32 a40, v121
    v_perm_b32 v122, v139, v138, s31
    v_accvgpr_write_b32 a33, v122
    v_perm_b32 v123, v139, v138, s32
    v_accvgpr_write_b32 a41, v123
    v_perm_b32 v124, v141, v140, s31
    v_accvgpr_write_b32 a34, v124
    v_perm_b32 v125, v141, v140, s32
    v_accvgpr_write_b32 a42, v125
    v_perm_b32 v126, v143, v142, s31
    v_accvgpr_write_b32 a35, v126
    v_perm_b32 v127, v143, v142, s32
    v_accvgpr_write_b32 a43, v127
    s_waitcnt lgkmcnt(0)
    s_add_u32 m0, s29, 0
    s_mov_b32 s30, 1310720
    buffer_load_dwordx4 v165, s[92:95], s30 offen lds
    s_add_u32 m0, s29, 1024
    s_mov_b32 s30, 1343488
    buffer_load_dwordx4 v165, s[92:95], s30 offen lds
    s_add_u32 m0, s29, 2048
    s_mov_b32 s30, 1572864
    buffer_load_dwordx4 v165, s[92:95], s30 offen lds
    s_add_u32 m0, s29, 3072
    s_mov_b32 s30, 1605632
    buffer_load_dwordx4 v165, s[92:95], s30 offen lds
    s_waitcnt vmcnt(16)
    ds_read2st64_b32 v[128:129], v170 offset0:16 offset1:17
    ds_read2st64_b32 v[130:131], v170 offset0:18 offset1:19
    ds_read2st64_b32 v[132:133], v170 offset0:20 offset1:21
    ds_read2st64_b32 v[134:135], v170 offset0:22 offset1:23
    ds_read2st64_b32 v[136:137], v170 offset0:24 offset1:25
    ds_read2st64_b32 v[138:139], v170 offset0:26 offset1:27
    ds_read2st64_b32 v[140:141], v170 offset0:28 offset1:29
    ds_read2st64_b32 v[142:143], v170 offset0:30 offset1:31
    v_perm_b32 v120, v145, v144, s31
    v_accvgpr_write_b32 a116, v120
    v_perm_b32 v121, v145, v144, s32
    v_accvgpr_write_b32 a124, v121
    v_perm_b32 v122, v147, v146, s31
    v_accvgpr_write_b32 a117, v122
    v_perm_b32 v123, v147, v146, s32
    v_accvgpr_write_b32 a125, v123
    v_perm_b32 v124, v149, v148, s31
    v_accvgpr_write_b32 a118, v124
    v_perm_b32 v125, v149, v148, s32
    v_accvgpr_write_b32 a126, v125
    v_perm_b32 v126, v151, v150, s31
    v_accvgpr_write_b32 a119, v126
    v_perm_b32 v127, v151, v150, s32
    v_accvgpr_write_b32 a127, v127
    v_perm_b32 v120, v153, v152, s31
    v_accvgpr_write_b32 a128, v120
    v_perm_b32 v121, v153, v152, s32
    v_accvgpr_write_b32 a136, v121
    v_perm_b32 v122, v155, v154, s31
    v_accvgpr_write_b32 a129, v122
    v_perm_b32 v123, v155, v154, s32
    v_accvgpr_write_b32 a137, v123
    v_perm_b32 v124, v157, v156, s31
    v_accvgpr_write_b32 a130, v124
    v_perm_b32 v125, v157, v156, s32
    v_accvgpr_write_b32 a138, v125
    v_perm_b32 v126, v159, v158, s31
    v_accvgpr_write_b32 a131, v126
    v_perm_b32 v127, v159, v158, s32
    v_accvgpr_write_b32 a139, v127
    s_waitcnt lgkmcnt(0)
    s_add_u32 m0, s29, 4096
    s_mov_b32 s30, 1835008
    buffer_load_dwordx4 v165, s[92:95], s30 offen lds
    s_add_u32 m0, s29, 5120
    s_mov_b32 s30, 1867776
    buffer_load_dwordx4 v165, s[92:95], s30 offen lds
    s_add_u32 m0, s29, 6144
    s_mov_b32 s30, 2097152
    buffer_load_dwordx4 v165, s[92:95], s30 offen lds
    s_add_u32 m0, s29, 7168
    s_mov_b32 s30, 2129920
    buffer_load_dwordx4 v165, s[92:95], s30 offen lds
    s_waitcnt vmcnt(16)
    ds_read2st64_b32 v[144:145], v170 offset0:32 offset1:33
    ds_read2st64_b32 v[146:147], v170 offset0:34 offset1:35
    ds_read2st64_b32 v[148:149], v170 offset0:36 offset1:37
    ds_read2st64_b32 v[150:151], v170 offset0:38 offset1:39
    ds_read2st64_b32 v[152:153], v170 offset0:40 offset1:41
    ds_read2st64_b32 v[154:155], v170 offset0:42 offset1:43
    ds_read2st64_b32 v[156:157], v170 offset0:44 offset1:45
    ds_read2st64_b32 v[158:159], v170 offset0:46 offset1:47
    v_perm_b32 v120, v129, v128, s31
    v_accvgpr_write_b32 a132, v120
    v_perm_b32 v121, v129, v128, s32
    v_accvgpr_write_b32 a140, v121
    v_perm_b32 v122, v131, v130, s31
    v_accvgpr_write_b32 a133, v122
    v_perm_b32 v123, v131, v130, s32
    v_accvgpr_write_b32 a141, v123
    v_perm_b32 v124, v133, v132, s31
    v_accvgpr_write_b32 a134, v124
    v_perm_b32 v125, v133, v132, s32
    v_accvgpr_write_b32 a142, v125
    v_perm_b32 v126, v135, v134, s31
    v_accvgpr_write_b32 a135, v126
    v_perm_b32 v127, v135, v134, s32
    v_accvgpr_write_b32 a143, v127
    v_perm_b32 v120, v137, v136, s31
    v_accvgpr_write_b32 a144, v120
    v_perm_b32 v121, v137, v136, s32
    v_accvgpr_write_b32 a152, v121
    v_perm_b32 v122, v139, v138, s31
    v_accvgpr_write_b32 a145, v122
    v_perm_b32 v123, v139, v138, s32
    v_accvgpr_write_b32 a153, v123
    v_perm_b32 v124, v141, v140, s31
    v_accvgpr_write_b32 a146, v124
    v_perm_b32 v125, v141, v140, s32
    v_accvgpr_write_b32 a154, v125
    v_perm_b32 v126, v143, v142, s31
    v_accvgpr_write_b32 a147, v126
    v_perm_b32 v127, v143, v142, s32
    v_accvgpr_write_b32 a155, v127
    s_waitcnt lgkmcnt(0)
    s_add_u32 m0, s29, 8192
    s_mov_b32 s30, 2359296
    buffer_load_dwordx4 v165, s[92:95], s30 offen lds
    s_add_u32 m0, s29, 9216
    s_mov_b32 s30, 2392064
    buffer_load_dwordx4 v165, s[92:95], s30 offen lds
    s_add_u32 m0, s29, 10240
    s_mov_b32 s30, 0
    buffer_load_dwordx4 v165, s[92:95], s30 offen lds
    s_add_u32 m0, s29, 11264
    s_mov_b32 s30, 32768
    buffer_load_dwordx4 v165, s[92:95], s30 offen lds
    s_waitcnt vmcnt(16)
    ds_read2st64_b32 v[128:129], v170 offset0:48 offset1:49
    ds_read2st64_b32 v[130:131], v170 offset0:50 offset1:51
    ds_read2st64_b32 v[132:133], v170 offset0:52 offset1:53
    ds_read2st64_b32 v[134:135], v170 offset0:54 offset1:55
    ds_read2st64_b32 v[136:137], v170 offset0:56 offset1:57
    ds_read2st64_b32 v[138:139], v170 offset0:58 offset1:59
    ds_read2st64_b32 v[140:141], v170 offset0:60 offset1:61
    ds_read2st64_b32 v[142:143], v170 offset0:62 offset1:63
    v_perm_b32 v120, v145, v144, s31
    v_accvgpr_write_b32 a148, v120
    v_perm_b32 v121, v145, v144, s32
    v_accvgpr_write_b32 a156, v121
    v_perm_b32 v122, v147, v146, s31
    v_accvgpr_write_b32 a149, v122
    v_perm_b32 v123, v147, v146, s32
    v_accvgpr_write_b32 a157, v123
    v_perm_b32 v124, v149, v148, s31
    v_accvgpr_write_b32 a150, v124
    v_perm_b32 v125, v149, v148, s32
    v_accvgpr_write_b32 a158, v125
    v_perm_b32 v126, v151, v150, s31
    v_accvgpr_write_b32 a151, v126
    v_perm_b32 v127, v151, v150, s32
    v_accvgpr_write_b32 a159, v127
    v_perm_b32 v120, v153, v152, s31
    v_accvgpr_write_b32 a80, v120
    v_perm_b32 v121, v153, v152, s32
    v_accvgpr_write_b32 a88, v121
    v_perm_b32 v122, v155, v154, s31
    v_accvgpr_write_b32 a81, v122
    v_perm_b32 v123, v155, v154, s32
    v_accvgpr_write_b32 a89, v123
    v_perm_b32 v124, v157, v156, s31
    v_accvgpr_write_b32 a82, v124
    v_perm_b32 v125, v157, v156, s32
    v_accvgpr_write_b32 a90, v125
    v_perm_b32 v126, v159, v158, s31
    v_accvgpr_write_b32 a83, v126
    v_perm_b32 v127, v159, v158, s32
    v_accvgpr_write_b32 a91, v127
    s_waitcnt lgkmcnt(0)
    s_add_u32 m0, s29, 12288
    s_mov_b32 s30, 262144
    buffer_load_dwordx4 v165, s[92:95], s30 offen lds
    s_add_u32 m0, s29, 13312
    s_mov_b32 s30, 294912
    buffer_load_dwordx4 v165, s[92:95], s30 offen lds
    s_add_u32 m0, s29, 14336
    s_mov_b32 s30, 524288
    buffer_load_dwordx4 v165, s[92:95], s30 offen lds
    s_add_u32 m0, s29, 15360
    s_mov_b32 s30, 557056
    buffer_load_dwordx4 v165, s[92:95], s30 offen lds
    buffer_load_dword v171, off, s[88:91], 0 offset:128 sc1
    s_waitcnt vmcnt(17)
    ds_read2st64_b32 v[144:145], v170 offset0:64 offset1:65
    ds_read2st64_b32 v[146:147], v170 offset0:66 offset1:67
    ds_read2st64_b32 v[148:149], v170 offset0:68 offset1:69
    ds_read2st64_b32 v[150:151], v170 offset0:70 offset1:71
    ds_read2st64_b32 v[152:153], v170 offset0:72 offset1:73
    ds_read2st64_b32 v[154:155], v170 offset0:74 offset1:75
    ds_read2st64_b32 v[156:157], v170 offset0:76 offset1:77
    ds_read2st64_b32 v[158:159], v170 offset0:78 offset1:79
    v_perm_b32 v120, v129, v128, s31
    v_accvgpr_write_b32 a84, v120
    v_perm_b32 v121, v129, v128, s32
    v_accvgpr_write_b32 a92, v121
    v_perm_b32 v122, v131, v130, s31
    v_accvgpr_write_b32 a85, v122
    v_perm_b32 v123, v131, v130, s32
    v_accvgpr_write_b32 a93, v123
    v_perm_b32 v124, v133, v132, s31
    v_accvgpr_write_b32 a86, v124
    v_perm_b32 v125, v133, v132, s32
    v_accvgpr_write_b32 a94, v125
    v_perm_b32 v126, v135, v134, s31
    v_accvgpr_write_b32 a87, v126
    v_perm_b32 v127, v135, v134, s32
    v_accvgpr_write_b32 a95, v127
    v_perm_b32 v120, v137, v136, s31
    v_accvgpr_write_b32 a96, v120
    v_perm_b32 v121, v137, v136, s32
    v_accvgpr_write_b32 a104, v121
    v_perm_b32 v122, v139, v138, s31
    v_accvgpr_write_b32 a97, v122
    v_perm_b32 v123, v139, v138, s32
    v_accvgpr_write_b32 a105, v123
    v_perm_b32 v124, v141, v140, s31
    v_accvgpr_write_b32 a98, v124
    v_perm_b32 v125, v141, v140, s32
    v_accvgpr_write_b32 a106, v125
    v_perm_b32 v126, v143, v142, s31
    v_accvgpr_write_b32 a99, v126
    v_perm_b32 v127, v143, v142, s32
    v_accvgpr_write_b32 a107, v127
    s_waitcnt lgkmcnt(0)
    s_add_u32 m0, s29, 16384
    s_mov_b32 s30, 786432
    buffer_load_dwordx4 v165, s[92:95], s30 offen lds
    s_add_u32 m0, s29, 17408
    s_mov_b32 s30, 819200
    buffer_load_dwordx4 v165, s[92:95], s30 offen lds
    s_add_u32 m0, s29, 18432
    s_mov_b32 s30, 1048576
    buffer_load_dwordx4 v165, s[92:95], s30 offen lds
    s_add_u32 m0, s29, 19456
    s_mov_b32 s30, 1081344
    buffer_load_dwordx4 v165, s[92:95], s30 offen lds
    buffer_load_dword v185, v184, s[92:95], 0 offen
    s_waitcnt vmcnt(18)
    ds_read2st64_b32 v[128:129], v170 offset0:0 offset1:1
    ds_read2st64_b32 v[130:131], v170 offset0:2 offset1:3
    ds_read2st64_b32 v[132:133], v170 offset0:4 offset1:5
    ds_read2st64_b32 v[134:135], v170 offset0:6 offset1:7
    ds_read2st64_b32 v[136:137], v170 offset0:8 offset1:9
    ds_read2st64_b32 v[138:139], v170 offset0:10 offset1:11
    ds_read2st64_b32 v[140:141], v170 offset0:12 offset1:13
    ds_read2st64_b32 v[142:143], v170 offset0:14 offset1:15
    v_perm_b32 v120, v145, v144, s31
    v_accvgpr_write_b32 a100, v120
    v_perm_b32 v121, v145, v144, s32
    v_accvgpr_write_b32 a108, v121
    v_perm_b32 v122, v147, v146, s31
    v_accvgpr_write_b32 a101, v122
    v_perm_b32 v123, v147, v146, s32
    v_accvgpr_write_b32 a109, v123
    v_perm_b32 v124, v149, v148, s31
    v_accvgpr_write_b32 a102, v124
    v_perm_b32 v125, v149, v148, s32
    v_accvgpr_write_b32 a110, v125
    v_perm_b32 v126, v151, v150, s31
    v_accvgpr_write_b32 a103, v126
    v_perm_b32 v127, v151, v150, s32
    v_accvgpr_write_b32 a111, v127
    v_perm_b32 v120, v153, v152, s31
    v_accvgpr_write_b32 a112, v120
    v_perm_b32 v121, v153, v152, s32
    v_accvgpr_write_b32 a120, v121
    v_perm_b32 v122, v155, v154, s31
    v_accvgpr_write_b32 a113, v122
    v_perm_b32 v123, v155, v154, s32
    v_accvgpr_write_b32 a121, v123
    v_perm_b32 v124, v157, v156, s31
    v_accvgpr_write_b32 a114, v124
    v_perm_b32 v125, v157, v156, s32
    v_accvgpr_write_b32 a122, v125
    v_perm_b32 v126, v159, v158, s31
    v_accvgpr_write_b32 a115, v126
    v_perm_b32 v127, v159, v158, s32
    v_accvgpr_write_b32 a123, v127
    s_waitcnt lgkmcnt(0)
    s_add_u32 m0, s29, 0
    s_mov_b32 s30, 3932160
    buffer_load_dwordx4 v165, s[92:95], s30 offen lds
    s_add_u32 m0, s29, 1024
    s_mov_b32 s30, 3964928
    buffer_load_dwordx4 v165, s[92:95], s30 offen lds
    s_add_u32 m0, s29, 2048
    s_mov_b32 s30, 4194304
    buffer_load_dwordx4 v165, s[92:95], s30 offen lds
    s_add_u32 m0, s29, 3072
    s_mov_b32 s30, 4227072
    buffer_load_dwordx4 v165, s[92:95], s30 offen lds
    s_waitcnt vmcnt(18)
    ds_read2st64_b32 v[144:145], v170 offset0:16 offset1:17
    ds_read2st64_b32 v[146:147], v170 offset0:18 offset1:19
    ds_read2st64_b32 v[148:149], v170 offset0:20 offset1:21
    ds_read2st64_b32 v[150:151], v170 offset0:22 offset1:23
    ds_read2st64_b32 v[152:153], v170 offset0:24 offset1:25
    ds_read2st64_b32 v[154:155], v170 offset0:26 offset1:27
    ds_read2st64_b32 v[156:157], v170 offset0:28 offset1:29
    ds_read2st64_b32 v[158:159], v170 offset0:30 offset1:31
    v_perm_b32 v120, v129, v128, s31
    v_accvgpr_write_b32 a196, v120
    v_perm_b32 v121, v129, v128, s32
    v_accvgpr_write_b32 a204, v121
    v_perm_b32 v122, v131, v130, s31
    v_accvgpr_write_b32 a197, v122
    v_perm_b32 v123, v131, v130, s32
    v_accvgpr_write_b32 a205, v123
    v_perm_b32 v124, v133, v132, s31
    v_accvgpr_write_b32 a198, v124
    v_perm_b32 v125, v133, v132, s32
    v_accvgpr_write_b32 a206, v125
    v_perm_b32 v126, v135, v134, s31
    v_accvgpr_write_b32 a199, v126
    v_perm_b32 v127, v135, v134, s32
    v_accvgpr_write_b32 a207, v127
    v_perm_b32 v120, v137, v136, s31
    v_accvgpr_write_b32 a208, v120
    v_perm_b32 v121, v137, v136, s32
    v_accvgpr_write_b32 a216, v121
    v_perm_b32 v122, v139, v138, s31
    v_accvgpr_write_b32 a209, v122
    v_perm_b32 v123, v139, v138, s32
    v_accvgpr_write_b32 a217, v123
    v_perm_b32 v124, v141, v140, s31
    v_accvgpr_write_b32 a210, v124
    v_perm_b32 v125, v141, v140, s32
    v_accvgpr_write_b32 a218, v125
    v_perm_b32 v126, v143, v142, s31
    v_accvgpr_write_b32 a211, v126
    v_perm_b32 v127, v143, v142, s32
    v_accvgpr_write_b32 a219, v127
    s_waitcnt lgkmcnt(0)
    s_add_u32 m0, s29, 4096
    s_mov_b32 s30, 4456448
    buffer_load_dwordx4 v165, s[92:95], s30 offen lds
    s_add_u32 m0, s29, 5120
    s_mov_b32 s30, 4489216
    buffer_load_dwordx4 v165, s[92:95], s30 offen lds
    s_add_u32 m0, s29, 6144
    s_mov_b32 s30, 4718592
    buffer_load_dwordx4 v165, s[92:95], s30 offen lds
    s_add_u32 m0, s29, 7168
    s_mov_b32 s30, 4751360
    buffer_load_dwordx4 v165, s[92:95], s30 offen lds
    s_waitcnt vmcnt(18)
    ds_read2st64_b32 v[128:129], v170 offset0:32 offset1:33
    ds_read2st64_b32 v[130:131], v170 offset0:34 offset1:35
    ds_read2st64_b32 v[132:133], v170 offset0:36 offset1:37
    ds_read2st64_b32 v[134:135], v170 offset0:38 offset1:39
    ds_read2st64_b32 v[136:137], v170 offset0:40 offset1:41
    ds_read2st64_b32 v[138:139], v170 offset0:42 offset1:43
    ds_read2st64_b32 v[140:141], v170 offset0:44 offset1:45
    ds_read2st64_b32 v[142:143], v170 offset0:46 offset1:47
    v_perm_b32 v120, v145, v144, s31
    v_accvgpr_write_b32 a212, v120
    v_perm_b32 v121, v145, v144, s32
    v_accvgpr_write_b32 a220, v121
    v_perm_b32 v122, v147, v146, s31
    v_accvgpr_write_b32 a213, v122
    v_perm_b32 v123, v147, v146, s32
    v_accvgpr_write_b32 a221, v123
    v_perm_b32 v124, v149, v148, s31
    v_accvgpr_write_b32 a214, v124
    v_perm_b32 v125, v149, v148, s32
    v_accvgpr_write_b32 a222, v125
    v_perm_b32 v126, v151, v150, s31
    v_accvgpr_write_b32 a215, v126
    v_perm_b32 v127, v151, v150, s32
    v_accvgpr_write_b32 a223, v127
    v_perm_b32 v120, v153, v152, s31
    v_accvgpr_write_b32 a224, v120
    v_perm_b32 v121, v153, v152, s32
    v_accvgpr_write_b32 a232, v121
    v_perm_b32 v122, v155, v154, s31
    v_accvgpr_write_b32 a225, v122
    v_perm_b32 v123, v155, v154, s32
    v_accvgpr_write_b32 a233, v123
    v_perm_b32 v124, v157, v156, s31
    v_accvgpr_write_b32 a226, v124
    v_perm_b32 v125, v157, v156, s32
    v_accvgpr_write_b32 a234, v125
    v_perm_b32 v126, v159, v158, s31
    v_accvgpr_write_b32 a227, v126
    v_perm_b32 v127, v159, v158, s32
    v_accvgpr_write_b32 a235, v127
    s_waitcnt lgkmcnt(0)
    s_add_u32 m0, s29, 8192
    s_mov_b32 s30, 4980736
    buffer_load_dwordx4 v165, s[92:95], s30 offen lds
    s_add_u32 m0, s29, 9216
    s_mov_b32 s30, 5013504
    buffer_load_dwordx4 v165, s[92:95], s30 offen lds
    s_add_u32 m0, s29, 10240
    s_mov_b32 s30, 2621440
    buffer_load_dwordx4 v165, s[92:95], s30 offen lds
    s_add_u32 m0, s29, 11264
    s_mov_b32 s30, 2654208
    buffer_load_dwordx4 v165, s[92:95], s30 offen lds
    s_waitcnt vmcnt(18)
    ds_read2st64_b32 v[144:145], v170 offset0:48 offset1:49
    ds_read2st64_b32 v[146:147], v170 offset0:50 offset1:51
    ds_read2st64_b32 v[148:149], v170 offset0:52 offset1:53
    ds_read2st64_b32 v[150:151], v170 offset0:54 offset1:55
    ds_read2st64_b32 v[152:153], v170 offset0:56 offset1:57
    ds_read2st64_b32 v[154:155], v170 offset0:58 offset1:59
    ds_read2st64_b32 v[156:157], v170 offset0:60 offset1:61
    ds_read2st64_b32 v[158:159], v170 offset0:62 offset1:63
    v_perm_b32 v120, v129, v128, s31
    v_accvgpr_write_b32 a228, v120
    v_perm_b32 v121, v129, v128, s32
    v_accvgpr_write_b32 a236, v121
    v_perm_b32 v122, v131, v130, s31
    v_accvgpr_write_b32 a229, v122
    v_perm_b32 v123, v131, v130, s32
    v_accvgpr_write_b32 a237, v123
    v_perm_b32 v124, v133, v132, s31
    v_accvgpr_write_b32 a230, v124
    v_perm_b32 v125, v133, v132, s32
    v_accvgpr_write_b32 a238, v125
    v_perm_b32 v126, v135, v134, s31
    v_accvgpr_write_b32 a231, v126
    v_perm_b32 v127, v135, v134, s32
    v_accvgpr_write_b32 a239, v127
    v_perm_b32 v120, v137, v136, s31
    v_accvgpr_write_b32 a160, v120
    v_perm_b32 v121, v137, v136, s32
    v_accvgpr_write_b32 a168, v121
    v_perm_b32 v122, v139, v138, s31
    v_accvgpr_write_b32 a161, v122
    v_perm_b32 v123, v139, v138, s32
    v_accvgpr_write_b32 a169, v123
    v_perm_b32 v124, v141, v140, s31
    v_accvgpr_write_b32 a162, v124
    v_perm_b32 v125, v141, v140, s32
    v_accvgpr_write_b32 a170, v125
    v_perm_b32 v126, v143, v142, s31
    v_accvgpr_write_b32 a163, v126
    v_perm_b32 v127, v143, v142, s32
    v_accvgpr_write_b32 a171, v127
    s_waitcnt lgkmcnt(0)
    s_add_u32 m0, s29, 12288
    s_mov_b32 s30, 2883584
    buffer_load_dwordx4 v165, s[92:95], s30 offen lds
    s_add_u32 m0, s29, 13312
    s_mov_b32 s30, 2916352
    buffer_load_dwordx4 v165, s[92:95], s30 offen lds
    s_add_u32 m0, s29, 14336
    s_mov_b32 s30, 3145728
    buffer_load_dwordx4 v165, s[92:95], s30 offen lds
    s_add_u32 m0, s29, 15360
    s_mov_b32 s30, 3178496
    buffer_load_dwordx4 v165, s[92:95], s30 offen lds
    s_waitcnt vmcnt(17)
    ds_read2st64_b32 v[128:129], v170 offset0:64 offset1:65
    ds_read2st64_b32 v[130:131], v170 offset0:66 offset1:67
    ds_read2st64_b32 v[132:133], v170 offset0:68 offset1:69
    ds_read2st64_b32 v[134:135], v170 offset0:70 offset1:71
    ds_read2st64_b32 v[136:137], v170 offset0:72 offset1:73
    ds_read2st64_b32 v[138:139], v170 offset0:74 offset1:75
    ds_read2st64_b32 v[140:141], v170 offset0:76 offset1:77
    ds_read2st64_b32 v[142:143], v170 offset0:78 offset1:79
    v_perm_b32 v120, v145, v144, s31
    v_accvgpr_write_b32 a164, v120
    v_perm_b32 v121, v145, v144, s32
    v_accvgpr_write_b32 a172, v121
    v_perm_b32 v122, v147, v146, s31
    v_accvgpr_write_b32 a165, v122
    v_perm_b32 v123, v147, v146, s32
    v_accvgpr_write_b32 a173, v123
    v_perm_b32 v124, v149, v148, s31
    v_accvgpr_write_b32 a166, v124
    v_perm_b32 v125, v149, v148, s32
    v_accvgpr_write_b32 a174, v125
    v_perm_b32 v126, v151, v150, s31
    v_accvgpr_write_b32 a167, v126
    v_perm_b32 v127, v151, v150, s32
    v_accvgpr_write_b32 a175, v127
    v_perm_b32 v120, v153, v152, s31
    v_accvgpr_write_b32 a176, v120
    v_perm_b32 v121, v153, v152, s32
    v_accvgpr_write_b32 a184, v121
    v_perm_b32 v122, v155, v154, s31
    v_accvgpr_write_b32 a177, v122
    v_perm_b32 v123, v155, v154, s32
    v_accvgpr_write_b32 a185, v123
    v_perm_b32 v124, v157, v156, s31
    v_accvgpr_write_b32 a178, v124
    v_perm_b32 v125, v157, v156, s32
    v_accvgpr_write_b32 a186, v125
    v_perm_b32 v126, v159, v158, s31
    v_accvgpr_write_b32 a179, v126
    v_perm_b32 v127, v159, v158, s32
    v_accvgpr_write_b32 a187, v127
    s_waitcnt lgkmcnt(0)
    s_add_u32 m0, s29, 16384
    s_mov_b32 s30, 3407872
    buffer_load_dwordx4 v165, s[92:95], s30 offen lds
    s_add_u32 m0, s29, 17408
    s_mov_b32 s30, 3440640
    buffer_load_dwordx4 v165, s[92:95], s30 offen lds
    s_add_u32 m0, s29, 18432
    s_mov_b32 s30, 3670016
    buffer_load_dwordx4 v165, s[92:95], s30 offen lds
    s_add_u32 m0, s29, 19456
    s_mov_b32 s30, 3702784
    buffer_load_dwordx4 v165, s[92:95], s30 offen lds
    s_mul_i32 s20, s16, 40960
    s_mul_i32 s21, s18, 10240
    s_add_u32 s20, s20, s21
    s_add_u32 s20, s20, 2097152
    s_add_u32 s21, s21, s40
    s_mov_b32 m0, s21
    s_nop 0
    buffer_load_dwordx4 v4, s[4:7], s20 offen offset:0 sc1 lds
    buffer_load_dwordx4 v4, s[4:7], s20 offen offset:1024 sc1 lds
    buffer_load_dwordx4 v4, s[4:7], s20 offen offset:2048 sc1 lds
    buffer_load_dwordx4 v4, s[4:7], s20 offen offset:3072 sc1 lds
    s_add_u32 s20, s20, 4096
    s_add_u32 s21, s21, 4096
    s_mov_b32 m0, s21
    s_nop 0
    buffer_load_dwordx4 v4, s[4:7], s20 offen offset:0 sc1 lds
    buffer_load_dwordx4 v4, s[4:7], s20 offen offset:1024 sc1 lds
    buffer_load_dwordx4 v4, s[4:7], s20 offen offset:2048 sc1 lds
    buffer_load_dwordx4 v4, s[4:7], s20 offen offset:3072 sc1 lds
    s_add_u32 s20, s20, 4096
    s_add_u32 s21, s21, 4096
    s_mov_b32 m0, s21
    s_nop 0
    buffer_load_dwordx4 v4, s[4:7], s20 offen offset:0 sc1 lds
    buffer_load_dwordx4 v4, s[4:7], s20 offen offset:1024 sc1 lds
    s_waitcnt vmcnt(26)
    ds_read2st64_b32 v[144:145], v170 offset0:0 offset1:1
    ds_read2st64_b32 v[146:147], v170 offset0:2 offset1:3
    ds_read2st64_b32 v[148:149], v170 offset0:4 offset1:5
    ds_read2st64_b32 v[150:151], v170 offset0:6 offset1:7
    ds_read2st64_b32 v[152:153], v170 offset0:8 offset1:9
    ds_read2st64_b32 v[154:155], v170 offset0:10 offset1:11
    ds_read2st64_b32 v[156:157], v170 offset0:12 offset1:13
    ds_read2st64_b32 v[158:159], v170 offset0:14 offset1:15
    v_perm_b32 v120, v129, v128, s31
    v_accvgpr_write_b32 a180, v120
    v_perm_b32 v121, v129, v128, s32
    v_accvgpr_write_b32 a188, v121
    v_perm_b32 v122, v131, v130, s31
    v_accvgpr_write_b32 a181, v122
    v_perm_b32 v123, v131, v130, s32
    v_accvgpr_write_b32 a189, v123
    v_perm_b32 v124, v133, v132, s31
    v_accvgpr_write_b32 a182, v124
    v_perm_b32 v125, v133, v132, s32
    v_accvgpr_write_b32 a190, v125
    v_perm_b32 v126, v135, v134, s31
    v_accvgpr_write_b32 a183, v126
    v_perm_b32 v127, v135, v134, s32
    v_accvgpr_write_b32 a191, v127
    v_perm_b32 v120, v137, v136, s31
    v_accvgpr_write_b32 a192, v120
    v_perm_b32 v121, v137, v136, s32
    v_accvgpr_write_b32 a200, v121
    v_perm_b32 v122, v139, v138, s31
    v_accvgpr_write_b32 a193, v122
    v_perm_b32 v123, v139, v138, s32
    v_accvgpr_write_b32 a201, v123
    v_perm_b32 v124, v141, v140, s31
    v_accvgpr_write_b32 a194, v124
    v_perm_b32 v125, v141, v140, s32
    v_accvgpr_write_b32 a202, v125
    v_perm_b32 v126, v143, v142, s31
    v_accvgpr_write_b32 a195, v126
    v_perm_b32 v127, v143, v142, s32
    v_accvgpr_write_b32 a203, v127
    s_waitcnt lgkmcnt(0)
    s_waitcnt vmcnt(22)
    ds_read2st64_b32 v[128:129], v170 offset0:16 offset1:17
    ds_read2st64_b32 v[130:131], v170 offset0:18 offset1:19
    ds_read2st64_b32 v[132:133], v170 offset0:20 offset1:21
    ds_read2st64_b32 v[134:135], v170 offset0:22 offset1:23
    ds_read2st64_b32 v[136:137], v170 offset0:24 offset1:25
    ds_read2st64_b32 v[138:139], v170 offset0:26 offset1:27
    ds_read2st64_b32 v[140:141], v170 offset0:28 offset1:29
    ds_read2st64_b32 v[142:143], v170 offset0:30 offset1:31
    v_perm_b32 v212, v145, v144, s31
    v_perm_b32 v220, v145, v144, s32
    v_perm_b32 v213, v147, v146, s31
    v_perm_b32 v221, v147, v146, s32
    v_perm_b32 v214, v149, v148, s31
    v_perm_b32 v222, v149, v148, s32
    v_perm_b32 v215, v151, v150, s31
    v_perm_b32 v223, v151, v150, s32
    v_perm_b32 v224, v153, v152, s31
    v_perm_b32 v232, v153, v152, s32
    v_perm_b32 v225, v155, v154, s31
    v_perm_b32 v233, v155, v154, s32
    v_perm_b32 v226, v157, v156, s31
    v_perm_b32 v234, v157, v156, s32
    v_perm_b32 v227, v159, v158, s31
    v_perm_b32 v235, v159, v158, s32
    s_waitcnt lgkmcnt(0)
    s_waitcnt vmcnt(18)
    ds_read2st64_b32 v[144:145], v170 offset0:32 offset1:33
    ds_read2st64_b32 v[146:147], v170 offset0:34 offset1:35
    ds_read2st64_b32 v[148:149], v170 offset0:36 offset1:37
    ds_read2st64_b32 v[150:151], v170 offset0:38 offset1:39
    ds_read2st64_b32 v[152:153], v170 offset0:40 offset1:41
    ds_read2st64_b32 v[154:155], v170 offset0:42 offset1:43
    ds_read2st64_b32 v[156:157], v170 offset0:44 offset1:45
    ds_read2st64_b32 v[158:159], v170 offset0:46 offset1:47
    v_perm_b32 v228, v129, v128, s31
    v_perm_b32 v236, v129, v128, s32
    v_perm_b32 v229, v131, v130, s31
    v_perm_b32 v237, v131, v130, s32
    v_perm_b32 v230, v133, v132, s31
    v_perm_b32 v238, v133, v132, s32
    v_perm_b32 v231, v135, v134, s31
    v_perm_b32 v239, v135, v134, s32
    v_perm_b32 v240, v137, v136, s31
    v_perm_b32 v248, v137, v136, s32
    v_perm_b32 v241, v139, v138, s31
    v_perm_b32 v249, v139, v138, s32
    v_perm_b32 v242, v141, v140, s31
    v_perm_b32 v250, v141, v140, s32
    v_perm_b32 v243, v143, v142, s31
    v_perm_b32 v251, v143, v142, s32
    s_waitcnt lgkmcnt(0)
    s_waitcnt vmcnt(14)
    ds_read2st64_b32 v[128:129], v170 offset0:48 offset1:49
    ds_read2st64_b32 v[130:131], v170 offset0:50 offset1:51
    ds_read2st64_b32 v[132:133], v170 offset0:52 offset1:53
    ds_read2st64_b32 v[134:135], v170 offset0:54 offset1:55
    ds_read2st64_b32 v[136:137], v170 offset0:56 offset1:57
    ds_read2st64_b32 v[138:139], v170 offset0:58 offset1:59
    ds_read2st64_b32 v[140:141], v170 offset0:60 offset1:61
    ds_read2st64_b32 v[142:143], v170 offset0:62 offset1:63
    v_perm_b32 v244, v145, v144, s31
    v_perm_b32 v252, v145, v144, s32
    v_perm_b32 v245, v147, v146, s31
    v_perm_b32 v253, v147, v146, s32
    v_perm_b32 v246, v149, v148, s31
    v_perm_b32 v254, v149, v148, s32
    v_perm_b32 v247, v151, v150, s31
    v_perm_b32 v255, v151, v150, s32
    v_perm_b32 v120, v153, v152, s31
    v_accvgpr_write_b32 a240, v120
    v_perm_b32 v121, v153, v152, s32
    v_accvgpr_write_b32 a248, v121
    v_perm_b32 v122, v155, v154, s31
    v_accvgpr_write_b32 a241, v122
    v_perm_b32 v123, v155, v154, s32
    v_accvgpr_write_b32 a249, v123
    v_perm_b32 v124, v157, v156, s31
    v_accvgpr_write_b32 a242, v124
    v_perm_b32 v125, v157, v156, s32
    v_accvgpr_write_b32 a250, v125
    v_perm_b32 v126, v159, v158, s31
    v_accvgpr_write_b32 a243, v126
    v_perm_b32 v127, v159, v158, s32
    v_accvgpr_write_b32 a251, v127
    s_waitcnt lgkmcnt(0)
    s_waitcnt vmcnt(10)
    ds_read2st64_b32 v[144:145], v170 offset0:64 offset1:65
    ds_read2st64_b32 v[146:147], v170 offset0:66 offset1:67
    ds_read2st64_b32 v[148:149], v170 offset0:68 offset1:69
    ds_read2st64_b32 v[150:151], v170 offset0:70 offset1:71
    ds_read2st64_b32 v[152:153], v170 offset0:72 offset1:73
    ds_read2st64_b32 v[154:155], v170 offset0:74 offset1:75
    ds_read2st64_b32 v[156:157], v170 offset0:76 offset1:77
    ds_read2st64_b32 v[158:159], v170 offset0:78 offset1:79
    v_perm_b32 v120, v129, v128, s31
    v_accvgpr_write_b32 a244, v120
    v_perm_b32 v121, v129, v128, s32
    v_accvgpr_write_b32 a252, v121
    v_perm_b32 v122, v131, v130, s31
    v_accvgpr_write_b32 a245, v122
    v_perm_b32 v123, v131, v130, s32
    v_accvgpr_write_b32 a253, v123
    v_perm_b32 v124, v133, v132, s31
    v_accvgpr_write_b32 a246, v124
    v_perm_b32 v125, v133, v132, s32
    v_accvgpr_write_b32 a254, v125
    v_perm_b32 v126, v135, v134, s31
    v_accvgpr_write_b32 a247, v126
    v_perm_b32 v127, v135, v134, s32
    v_accvgpr_write_b32 a255, v127
    v_perm_b32 v192, v137, v136, s31
    v_perm_b32 v200, v137, v136, s32
    v_perm_b32 v193, v139, v138, s31
    v_perm_b32 v201, v139, v138, s32
    v_perm_b32 v194, v141, v140, s31
    v_perm_b32 v202, v141, v140, s32
    v_perm_b32 v195, v143, v142, s31
    v_perm_b32 v203, v143, v142, s32
    s_waitcnt lgkmcnt(0)
    v_perm_b32 v196, v145, v144, s31
    v_perm_b32 v204, v145, v144, s32
    v_perm_b32 v197, v147, v146, s31
    v_perm_b32 v205, v147, v146, s32
    v_perm_b32 v198, v149, v148, s31
    v_perm_b32 v206, v149, v148, s32
    v_perm_b32 v199, v151, v150, s31
    v_perm_b32 v207, v151, v150, s32
    v_perm_b32 v208, v153, v152, s31
    v_perm_b32 v216, v153, v152, s32
    v_perm_b32 v209, v155, v154, s31
    v_perm_b32 v217, v155, v154, s32
    v_perm_b32 v210, v157, v156, s31
    v_perm_b32 v218, v157, v156, s32
    v_perm_b32 v211, v159, v158, s31
    v_perm_b32 v219, v159, v158, s32
    s_branch rev_2_b
rev_2_a:
    v_bfe_u32 v160, v1, 2, 2
    v_lshlrev_b32 v160, 6, v160
    v_and_b32 v161, 3, v1
    v_lshl_add_u32 v160, v161, 4, v160
    v_bfe_u32 v161, v1, 4, 1
    v_lshrrev_b32 v162, 5, v1
    ds_bpermute_b32 v164, v160, v10
    v_mul_u32_u24 v163, 8192, v161
    v_mul_u32_u24 v170, 16384, v162
    s_waitcnt lgkmcnt(0)
    v_add3_u32 v164, v164, v163, v170
    ds_bpermute_b32 v165, v160, v10
    v_mul_u32_u24 v163, 8192, v161
    v_mul_u32_u24 v170, 16384, v162
    s_waitcnt lgkmcnt(0)
    v_add3_u32 v165, v165, v163, v170
    s_mul_i32 s29, s18, 20480
    s_add_u32 s29, s29, 40960
    v_lshl_add_u32 v170, v1, 2, s29
    s_add_u32 m0, s29, 0
    s_mov_b32 s30, 0
    buffer_load_dwordx4 v164, s[12:15], s30 offen lds
    s_add_u32 m0, s29, 1024
    s_mov_b32 s30, 32768
    buffer_load_dwordx4 v164, s[12:15], s30 offen lds
    s_add_u32 m0, s29, 2048
    s_mov_b32 s30, 262144
    buffer_load_dwordx4 v164, s[12:15], s30 offen lds
    s_add_u32 m0, s29, 3072
    s_mov_b32 s30, 294912
    buffer_load_dwordx4 v164, s[12:15], s30 offen lds
    s_add_u32 m0, s29, 4096
    s_mov_b32 s30, 524288
    buffer_load_dwordx4 v164, s[12:15], s30 offen lds
    s_add_u32 m0, s29, 5120
    s_mov_b32 s30, 557056
    buffer_load_dwordx4 v164, s[12:15], s30 offen lds
    s_add_u32 m0, s29, 6144
    s_mov_b32 s30, 786432
    buffer_load_dwordx4 v164, s[12:15], s30 offen lds
    s_add_u32 m0, s29, 7168
    s_mov_b32 s30, 819200
    buffer_load_dwordx4 v164, s[12:15], s30 offen lds
    s_add_u32 m0, s29, 8192
    s_mov_b32 s30, 1048576
    buffer_load_dwordx4 v164, s[12:15], s30 offen lds
    s_add_u32 m0, s29, 9216
    s_mov_b32 s30, 1081344
    buffer_load_dwordx4 v164, s[12:15], s30 offen lds
    s_add_u32 m0, s29, 10240
    s_mov_b32 s30, 1310720
    buffer_load_dwordx4 v164, s[12:15], s30 offen lds
    s_add_u32 m0, s29, 11264
    s_mov_b32 s30, 1343488
    buffer_load_dwordx4 v164, s[12:15], s30 offen lds
    s_add_u32 m0, s29, 12288
    s_mov_b32 s30, 1572864
    buffer_load_dwordx4 v164, s[12:15], s30 offen lds
    s_add_u32 m0, s29, 13312
    s_mov_b32 s30, 1605632
    buffer_load_dwordx4 v164, s[12:15], s30 offen lds
    s_add_u32 m0, s29, 14336
    s_mov_b32 s30, 1835008
    buffer_load_dwordx4 v164, s[12:15], s30 offen lds
    s_add_u32 m0, s29, 15360
    s_mov_b32 s30, 1867776
    buffer_load_dwordx4 v164, s[12:15], s30 offen lds
    s_add_u32 m0, s29, 16384
    s_mov_b32 s30, 2097152
    buffer_load_dwordx4 v164, s[12:15], s30 offen lds
    s_add_u32 m0, s29, 17408
    s_mov_b32 s30, 2129920
    buffer_load_dwordx4 v164, s[12:15], s30 offen lds
    s_add_u32 m0, s29, 18432
    s_mov_b32 s30, 2359296
    buffer_load_dwordx4 v164, s[12:15], s30 offen lds
    s_add_u32 m0, s29, 19456
    s_mov_b32 s30, 2392064
    buffer_load_dwordx4 v164, s[12:15], s30 offen lds
    s_waitcnt vmcnt(16)
    ds_read2st64_b32 v[128:129], v170 offset0:0 offset1:1
    ds_read2st64_b32 v[130:131], v170 offset0:2 offset1:3
    ds_read2st64_b32 v[132:133], v170 offset0:4 offset1:5
    ds_read2st64_b32 v[134:135], v170 offset0:6 offset1:7
    ds_read2st64_b32 v[136:137], v170 offset0:8 offset1:9
    ds_read2st64_b32 v[138:139], v170 offset0:10 offset1:11
    ds_read2st64_b32 v[140:141], v170 offset0:12 offset1:13
    ds_read2st64_b32 v[142:143], v170 offset0:14 offset1:15
    s_waitcnt lgkmcnt(0)
    s_add_u32 m0, s29, 0
    s_mov_b32 s30, 2621440
    buffer_load_dwordx4 v164, s[12:15], s30 offen lds
    s_add_u32 m0, s29, 1024
    s_mov_b32 s30, 2654208
    buffer_load_dwordx4 v164, s[12:15], s30 offen lds
    s_add_u32 m0, s29, 2048
    s_mov_b32 s30, 2883584
    buffer_load_dwordx4 v164, s[12:15], s30 offen lds
    s_add_u32 m0, s29, 3072
    s_mov_b32 s30, 2916352
    buffer_load_dwordx4 v164, s[12:15], s30 offen lds
    s_waitcnt vmcnt(16)
    ds_read2st64_b32 v[144:145], v170 offset0:16 offset1:17
    ds_read2st64_b32 v[146:147], v170 offset0:18 offset1:19
    ds_read2st64_b32 v[148:149], v170 offset0:20 offset1:21
    ds_read2st64_b32 v[150:151], v170 offset0:22 offset1:23
    ds_read2st64_b32 v[152:153], v170 offset0:24 offset1:25
    ds_read2st64_b32 v[154:155], v170 offset0:26 offset1:27
    ds_read2st64_b32 v[156:157], v170 offset0:28 offset1:29
    ds_read2st64_b32 v[158:159], v170 offset0:30 offset1:31
    v_perm_b32 v120, v129, v128, s31
    v_accvgpr_write_b32 a0, v120
    v_perm_b32 v121, v129, v128, s32
    v_accvgpr_write_b32 a8, v121
    v_perm_b32 v122, v131, v130, s31
    v_accvgpr_write_b32 a1, v122
    v_perm_b32 v123, v131, v130, s32
    v_accvgpr_write_b32 a9, v123
    v_perm_b32 v124, v133, v132, s31
    v_accvgpr_write_b32 a2, v124
    v_perm_b32 v125, v133, v132, s32
    v_accvgpr_write_b32 a10, v125
    v_perm_b32 v126, v135, v134, s31
    v_accvgpr_write_b32 a3, v126
    v_perm_b32 v127, v135, v134, s32
    v_accvgpr_write_b32 a11, v127
    v_perm_b32 v120, v137, v136, s31
    v_accvgpr_write_b32 a4, v120
    v_perm_b32 v121, v137, v136, s32
    v_accvgpr_write_b32 a12, v121
    v_perm_b32 v122, v139, v138, s31
    v_accvgpr_write_b32 a5, v122
    v_perm_b32 v123, v139, v138, s32
    v_accvgpr_write_b32 a13, v123
    v_perm_b32 v124, v141, v140, s31
    v_accvgpr_write_b32 a6, v124
    v_perm_b32 v125, v141, v140, s32
    v_accvgpr_write_b32 a14, v125
    v_perm_b32 v126, v143, v142, s31
    v_accvgpr_write_b32 a7, v126
    v_perm_b32 v127, v143, v142, s32
    v_accvgpr_write_b32 a15, v127
    s_waitcnt lgkmcnt(0)
    s_add_u32 m0, s29, 4096
    s_mov_b32 s30, 3145728
    buffer_load_dwordx4 v164, s[12:15], s30 offen lds
    s_add_u32 m0, s29, 5120
    s_mov_b32 s30, 3178496
    buffer_load_dwordx4 v164, s[12:15], s30 offen lds
    s_add_u32 m0, s29, 6144
    s_mov_b32 s30, 3407872
    buffer_load_dwordx4 v164, s[12:15], s30 offen lds
    s_add_u32 m0, s29, 7168
    s_mov_b32 s30, 3440640
    buffer_load_dwordx4 v164, s[12:15], s30 offen lds
    s_waitcnt vmcnt(16)
    ds_read2st64_b32 v[128:129], v170 offset0:32 offset1:33
    ds_read2st64_b32 v[130:131], v170 offset0:34 offset1:35
    ds_read2st64_b32 v[132:133], v170 offset0:36 offset1:37
    ds_read2st64_b32 v[134:135], v170 offset0:38 offset1:39
    ds_read2st64_b32 v[136:137], v170 offset0:40 offset1:41
    ds_read2st64_b32 v[138:139], v170 offset0:42 offset1:43
    ds_read2st64_b32 v[140:141], v170 offset0:44 offset1:45
    ds_read2st64_b32 v[142:143], v170 offset0:46 offset1:47
    v_perm_b32 v120, v145, v144, s31
    v_accvgpr_write_b32 a16, v120
    v_perm_b32 v121, v145, v144, s32
    v_accvgpr_write_b32 a24, v121
    v_perm_b32 v122, v147, v146, s31
    v_accvgpr_write_b32 a17, v122
    v_perm_b32 v123, v147, v146, s32
    v_accvgpr_write_b32 a25, v123
    v_perm_b32 v124, v149, v148, s31
    v_accvgpr_write_b32 a18, v124
    v_perm_b32 v125, v149, v148, s32
    v_accvgpr_write_b32 a26, v125
    v_perm_b32 v126, v151, v150, s31
    v_accvgpr_write_b32 a19, v126
    v_perm_b32 v127, v151, v150, s32
    v_accvgpr_write_b32 a27, v127
    v_perm_b32 v120, v153, v152, s31
    v_accvgpr_write_b32 a20, v120
    v_perm_b32 v121, v153, v152, s32
    v_accvgpr_write_b32 a28, v121
    v_perm_b32 v122, v155, v154, s31
    v_accvgpr_write_b32 a21, v122
    v_perm_b32 v123, v155, v154, s32
    v_accvgpr_write_b32 a29, v123
    v_perm_b32 v124, v157, v156, s31
    v_accvgpr_write_b32 a22, v124
    v_perm_b32 v125, v157, v156, s32
    v_accvgpr_write_b32 a30, v125
    v_perm_b32 v126, v159, v158, s31
    v_accvgpr_write_b32 a23, v126
    v_perm_b32 v127, v159, v158, s32
    v_accvgpr_write_b32 a31, v127
    s_waitcnt lgkmcnt(0)
    s_add_u32 m0, s29, 8192
    s_mov_b32 s30, 3670016
    buffer_load_dwordx4 v164, s[12:15], s30 offen lds
    s_add_u32 m0, s29, 9216
    s_mov_b32 s30, 3702784
    buffer_load_dwordx4 v164, s[12:15], s30 offen lds
    s_add_u32 m0, s29, 10240
    s_mov_b32 s30, 3932160
    buffer_load_dwordx4 v164, s[12:15], s30 offen lds
    s_add_u32 m0, s29, 11264
    s_mov_b32 s30, 3964928
    buffer_load_dwordx4 v164, s[12:15], s30 offen lds
    s_waitcnt vmcnt(16)
    ds_read2st64_b32 v[144:145], v170 offset0:48 offset1:49
    ds_read2st64_b32 v[146:147], v170 offset0:50 offset1:51
    ds_read2st64_b32 v[148:149], v170 offset0:52 offset1:53
    ds_read2st64_b32 v[150:151], v170 offset0:54 offset1:55
    ds_read2st64_b32 v[152:153], v170 offset0:56 offset1:57
    ds_read2st64_b32 v[154:155], v170 offset0:58 offset1:59
    ds_read2st64_b32 v[156:157], v170 offset0:60 offset1:61
    ds_read2st64_b32 v[158:159], v170 offset0:62 offset1:63
    v_perm_b32 v120, v129, v128, s31
    v_accvgpr_write_b32 a32, v120
    v_perm_b32 v121, v129, v128, s32
    v_accvgpr_write_b32 a40, v121
    v_perm_b32 v122, v131, v130, s31
    v_accvgpr_write_b32 a33, v122
    v_perm_b32 v123, v131, v130, s32
    v_accvgpr_write_b32 a41, v123
    v_perm_b32 v124, v133, v132, s31
    v_accvgpr_write_b32 a34, v124
    v_perm_b32 v125, v133, v132, s32
    v_accvgpr_write_b32 a42, v125
    v_perm_b32 v126, v135, v134, s31
    v_accvgpr_write_b32 a35, v126
    v_perm_b32 v127, v135, v134, s32
    v_accvgpr_write_b32 a43, v127
    v_perm_b32 v120, v137, v136, s31
    v_accvgpr_write_b32 a36, v120
    v_perm_b32 v121, v137, v136, s32
    v_accvgpr_write_b32 a44, v121
    v_perm_b32 v122, v139, v138, s31
    v_accvgpr_write_b32 a37, v122
    v_perm_b32 v123, v139, v138, s32
    v_accvgpr_write_b32 a45, v123
    v_perm_b32 v124, v141, v140, s31
    v_accvgpr_write_b32 a38, v124
    v_perm_b32 v125, v141, v140, s32
    v_accvgpr_write_b32 a46, v125
    v_perm_b32 v126, v143, v142, s31
    v_accvgpr_write_b32 a39, v126
    v_perm_b32 v127, v143, v142, s32
    v_accvgpr_write_b32 a47, v127
    s_waitcnt lgkmcnt(0)
    s_add_u32 m0, s29, 12288
    s_mov_b32 s30, 4194304
    buffer_load_dwordx4 v164, s[12:15], s30 offen lds
    s_add_u32 m0, s29, 13312
    s_mov_b32 s30, 4227072
    buffer_load_dwordx4 v164, s[12:15], s30 offen lds
    s_add_u32 m0, s29, 14336
    s_mov_b32 s30, 4456448
    buffer_load_dwordx4 v164, s[12:15], s30 offen lds
    s_add_u32 m0, s29, 15360
    s_mov_b32 s30, 4489216
    buffer_load_dwordx4 v164, s[12:15], s30 offen lds
    s_waitcnt vmcnt(16)
    ds_read2st64_b32 v[128:129], v170 offset0:64 offset1:65
    ds_read2st64_b32 v[130:131], v170 offset0:66 offset1:67
    ds_read2st64_b32 v[132:133], v170 offset0:68 offset1:69
    ds_read2st64_b32 v[134:135], v170 offset0:70 offset1:71
    ds_read2st64_b32 v[136:137], v170 offset0:72 offset1:73
    ds_read2st64_b32 v[138:139], v170 offset0:74 offset1:75
    ds_read2st64_b32 v[140:141], v170 offset0:76 offset1:77
    ds_read2st64_b32 v[142:143], v170 offset0:78 offset1:79
    v_perm_b32 v120, v145, v144, s31
    v_accvgpr_write_b32 a48, v120
    v_perm_b32 v121, v145, v144, s32
    v_accvgpr_write_b32 a56, v121
    v_perm_b32 v122, v147, v146, s31
    v_accvgpr_write_b32 a49, v122
    v_perm_b32 v123, v147, v146, s32
    v_accvgpr_write_b32 a57, v123
    v_perm_b32 v124, v149, v148, s31
    v_accvgpr_write_b32 a50, v124
    v_perm_b32 v125, v149, v148, s32
    v_accvgpr_write_b32 a58, v125
    v_perm_b32 v126, v151, v150, s31
    v_accvgpr_write_b32 a51, v126
    v_perm_b32 v127, v151, v150, s32
    v_accvgpr_write_b32 a59, v127
    v_perm_b32 v120, v153, v152, s31
    v_accvgpr_write_b32 a52, v120
    v_perm_b32 v121, v153, v152, s32
    v_accvgpr_write_b32 a60, v121
    v_perm_b32 v122, v155, v154, s31
    v_accvgpr_write_b32 a53, v122
    v_perm_b32 v123, v155, v154, s32
    v_accvgpr_write_b32 a61, v123
    v_perm_b32 v124, v157, v156, s31
    v_accvgpr_write_b32 a54, v124
    v_perm_b32 v125, v157, v156, s32
    v_accvgpr_write_b32 a62, v125
    v_perm_b32 v126, v159, v158, s31
    v_accvgpr_write_b32 a55, v126
    v_perm_b32 v127, v159, v158, s32
    v_accvgpr_write_b32 a63, v127
    s_waitcnt lgkmcnt(0)
    s_add_u32 m0, s29, 16384
    s_mov_b32 s30, 4718592
    buffer_load_dwordx4 v164, s[12:15], s30 offen lds
    s_add_u32 m0, s29, 17408
    s_mov_b32 s30, 4751360
    buffer_load_dwordx4 v164, s[12:15], s30 offen lds
    s_add_u32 m0, s29, 18432
    s_mov_b32 s30, 4980736
    buffer_load_dwordx4 v164, s[12:15], s30 offen lds
    s_add_u32 m0, s29, 19456
    s_mov_b32 s30, 5013504
    buffer_load_dwordx4 v164, s[12:15], s30 offen lds
    s_waitcnt vmcnt(16)
    ds_read2st64_b32 v[144:145], v170 offset0:0 offset1:1
    ds_read2st64_b32 v[146:147], v170 offset0:2 offset1:3
    ds_read2st64_b32 v[148:149], v170 offset0:4 offset1:5
    ds_read2st64_b32 v[150:151], v170 offset0:6 offset1:7
    ds_read2st64_b32 v[152:153], v170 offset0:8 offset1:9
    ds_read2st64_b32 v[154:155], v170 offset0:10 offset1:11
    ds_read2st64_b32 v[156:157], v170 offset0:12 offset1:13
    ds_read2st64_b32 v[158:159], v170 offset0:14 offset1:15
    v_perm_b32 v120, v129, v128, s31
    v_accvgpr_write_b32 a64, v120
    v_perm_b32 v121, v129, v128, s32
    v_accvgpr_write_b32 a72, v121
    v_perm_b32 v122, v131, v130, s31
    v_accvgpr_write_b32 a65, v122
    v_perm_b32 v123, v131, v130, s32
    v_accvgpr_write_b32 a73, v123
    v_perm_b32 v124, v133, v132, s31
    v_accvgpr_write_b32 a66, v124
    v_perm_b32 v125, v133, v132, s32
    v_accvgpr_write_b32 a74, v125
    v_perm_b32 v126, v135, v134, s31
    v_accvgpr_write_b32 a67, v126
    v_perm_b32 v127, v135, v134, s32
    v_accvgpr_write_b32 a75, v127
    v_perm_b32 v120, v137, v136, s31
    v_accvgpr_write_b32 a68, v120
    v_perm_b32 v121, v137, v136, s32
    v_accvgpr_write_b32 a76, v121
    v_perm_b32 v122, v139, v138, s31
    v_accvgpr_write_b32 a69, v122
    v_perm_b32 v123, v139, v138, s32
    v_accvgpr_write_b32 a77, v123
    v_perm_b32 v124, v141, v140, s31
    v_accvgpr_write_b32 a70, v124
    v_perm_b32 v125, v141, v140, s32
    v_accvgpr_write_b32 a78, v125
    v_perm_b32 v126, v143, v142, s31
    v_accvgpr_write_b32 a71, v126
    v_perm_b32 v127, v143, v142, s32
    v_accvgpr_write_b32 a79, v127
    s_waitcnt lgkmcnt(0)
    s_add_u32 m0, s29, 0
    s_mov_b32 s30, 0
    buffer_load_dwordx4 v165, s[92:95], s30 offen lds
    s_add_u32 m0, s29, 1024
    s_mov_b32 s30, 32768
    buffer_load_dwordx4 v165, s[92:95], s30 offen lds
    s_add_u32 m0, s29, 2048
    s_mov_b32 s30, 262144
    buffer_load_dwordx4 v165, s[92:95], s30 offen lds
    s_add_u32 m0, s29, 3072
    s_mov_b32 s30, 294912
    buffer_load_dwordx4 v165, s[92:95], s30 offen lds
    s_waitcnt vmcnt(16)
    ds_read2st64_b32 v[128:129], v170 offset0:16 offset1:17
    ds_read2st64_b32 v[130:131], v170 offset0:18 offset1:19
    ds_read2st64_b32 v[132:133], v170 offset0:20 offset1:21
    ds_read2st64_b32 v[134:135], v170 offset0:22 offset1:23
    ds_read2st64_b32 v[136:137], v170 offset0:24 offset1:25
    ds_read2st64_b32 v[138:139], v170 offset0:26 offset1:27
    ds_read2st64_b32 v[140:141], v170 offset0:28 offset1:29
    ds_read2st64_b32 v[142:143], v170 offset0:30 offset1:31
    v_perm_b32 v120, v145, v144, s31
    v_accvgpr_write_b32 a80, v120
    v_perm_b32 v121, v145, v144, s32
    v_accvgpr_write_b32 a88, v121
    v_perm_b32 v122, v147, v146, s31
    v_accvgpr_write_b32 a81, v122
    v_perm_b32 v123, v147, v146, s32
    v_accvgpr_write_b32 a89, v123
    v_perm_b32 v124, v149, v148, s31
    v_accvgpr_write_b32 a82, v124
    v_perm_b32 v125, v149, v148, s32
    v_accvgpr_write_b32 a90, v125
    v_perm_b32 v126, v151, v150, s31
    v_accvgpr_write_b32 a83, v126
    v_perm_b32 v127, v151, v150, s32
    v_accvgpr_write_b32 a91, v127
    v_perm_b32 v120, v153, v152, s31
    v_accvgpr_write_b32 a84, v120
    v_perm_b32 v121, v153, v152, s32
    v_accvgpr_write_b32 a92, v121
    v_perm_b32 v122, v155, v154, s31
    v_accvgpr_write_b32 a85, v122
    v_perm_b32 v123, v155, v154, s32
    v_accvgpr_write_b32 a93, v123
    v_perm_b32 v124, v157, v156, s31
    v_accvgpr_write_b32 a86, v124
    v_perm_b32 v125, v157, v156, s32
    v_accvgpr_write_b32 a94, v125
    v_perm_b32 v126, v159, v158, s31
    v_accvgpr_write_b32 a87, v126
    v_perm_b32 v127, v159, v158, s32
    v_accvgpr_write_b32 a95, v127
    s_waitcnt lgkmcnt(0)
    s_add_u32 m0, s29, 4096
    s_mov_b32 s30, 524288
    buffer_load_dwordx4 v165, s[92:95], s30 offen lds
    s_add_u32 m0, s29, 5120
    s_mov_b32 s30, 557056
    buffer_load_dwordx4 v165, s[92:95], s30 offen lds
    s_add_u32 m0, s29, 6144
    s_mov_b32 s30, 786432
    buffer_load_dwordx4 v165, s[92:95], s30 offen lds
    s_add_u32 m0, s29, 7168
    s_mov_b32 s30, 819200
    buffer_load_dwordx4 v165, s[92:95], s30 offen lds
    s_waitcnt vmcnt(16)
    ds_read2st64_b32 v[144:145], v170 offset0:32 offset1:33
    ds_read2st64_b32 v[146:147], v170 offset0:34 offset1:35
    ds_read2st64_b32 v[148:149], v170 offset0:36 offset1:37
    ds_read2st64_b32 v[150:151], v170 offset0:38 offset1:39
    ds_read2st64_b32 v[152:153], v170 offset0:40 offset1:41
    ds_read2st64_b32 v[154:155], v170 offset0:42 offset1:43
    ds_read2st64_b32 v[156:157], v170 offset0:44 offset1:45
    ds_read2st64_b32 v[158:159], v170 offset0:46 offset1:47
    v_perm_b32 v120, v129, v128, s31
    v_accvgpr_write_b32 a96, v120
    v_perm_b32 v121, v129, v128, s32
    v_accvgpr_write_b32 a104, v121
    v_perm_b32 v122, v131, v130, s31
    v_accvgpr_write_b32 a97, v122
    v_perm_b32 v123, v131, v130, s32
    v_accvgpr_write_b32 a105, v123
    v_perm_b32 v124, v133, v132, s31
    v_accvgpr_write_b32 a98, v124
    v_perm_b32 v125, v133, v132, s32
    v_accvgpr_write_b32 a106, v125
    v_perm_b32 v126, v135, v134, s31
    v_accvgpr_write_b32 a99, v126
    v_perm_b32 v127, v135, v134, s32
    v_accvgpr_write_b32 a107, v127
    v_perm_b32 v120, v137, v136, s31
    v_accvgpr_write_b32 a100, v120
    v_perm_b32 v121, v137, v136, s32
    v_accvgpr_write_b32 a108, v121
    v_perm_b32 v122, v139, v138, s31
    v_accvgpr_write_b32 a101, v122
    v_perm_b32 v123, v139, v138, s32
    v_accvgpr_write_b32 a109, v123
    v_perm_b32 v124, v141, v140, s31
    v_accvgpr_write_b32 a102, v124
    v_perm_b32 v125, v141, v140, s32
    v_accvgpr_write_b32 a110, v125
    v_perm_b32 v126, v143, v142, s31
    v_accvgpr_write_b32 a103, v126
    v_perm_b32 v127, v143, v142, s32
    v_accvgpr_write_b32 a111, v127
    s_waitcnt lgkmcnt(0)
    s_add_u32 m0, s29, 8192
    s_mov_b32 s30, 1048576
    buffer_load_dwordx4 v165, s[92:95], s30 offen lds
    s_add_u32 m0, s29, 9216
    s_mov_b32 s30, 1081344
    buffer_load_dwordx4 v165, s[92:95], s30 offen lds
    s_add_u32 m0, s29, 10240
    s_mov_b32 s30, 1310720
    buffer_load_dwordx4 v165, s[92:95], s30 offen lds
    s_add_u32 m0, s29, 11264
    s_mov_b32 s30, 1343488
    buffer_load_dwordx4 v165, s[92:95], s30 offen lds
    s_waitcnt vmcnt(16)
    ds_read2st64_b32 v[128:129], v170 offset0:48 offset1:49
    ds_read2st64_b32 v[130:131], v170 offset0:50 offset1:51
    ds_read2st64_b32 v[132:133], v170 offset0:52 offset1:53
    ds_read2st64_b32 v[134:135], v170 offset0:54 offset1:55
    ds_read2st64_b32 v[136:137], v170 offset0:56 offset1:57
    ds_read2st64_b32 v[138:139], v170 offset0:58 offset1:59
    ds_read2st64_b32 v[140:141], v170 offset0:60 offset1:61
    ds_read2st64_b32 v[142:143], v170 offset0:62 offset1:63
    v_perm_b32 v120, v145, v144, s31
    v_accvgpr_write_b32 a112, v120
    v_perm_b32 v121, v145, v144, s32
    v_accvgpr_write_b32 a120, v121
    v_perm_b32 v122, v147, v146, s31
    v_accvgpr_write_b32 a113, v122
    v_perm_b32 v123, v147, v146, s32
    v_accvgpr_write_b32 a121, v123
    v_perm_b32 v124, v149, v148, s31
    v_accvgpr_write_b32 a114, v124
    v_perm_b32 v125, v149, v148, s32
    v_accvgpr_write_b32 a122, v125
    v_perm_b32 v126, v151, v150, s31
    v_accvgpr_write_b32 a115, v126
    v_perm_b32 v127, v151, v150, s32
    v_accvgpr_write_b32 a123, v127
    v_perm_b32 v120, v153, v152, s31
    v_accvgpr_write_b32 a116, v120
    v_perm_b32 v121, v153, v152, s32
    v_accvgpr_write_b32 a124, v121
    v_perm_b32 v122, v155, v154, s31
    v_accvgpr_write_b32 a117, v122
    v_perm_b32 v123, v155, v154, s32
    v_accvgpr_write_b32 a125, v123
    v_perm_b32 v124, v157, v156, s31
    v_accvgpr_write_b32 a118, v124
    v_perm_b32 v125, v157, v156, s32
    v_accvgpr_write_b32 a126, v125
    v_perm_b32 v126, v159, v158, s31
    v_accvgpr_write_b32 a119, v126
    v_perm_b32 v127, v159, v158, s32
    v_accvgpr_write_b32 a127, v127
    s_waitcnt lgkmcnt(0)
    s_add_u32 m0, s29, 12288
    s_mov_b32 s30, 1572864
    buffer_load_dwordx4 v165, s[92:95], s30 offen lds
    s_add_u32 m0, s29, 13312
    s_mov_b32 s30, 1605632
    buffer_load_dwordx4 v165, s[92:95], s30 offen lds
    s_add_u32 m0, s29, 14336
    s_mov_b32 s30, 1835008
    buffer_load_dwordx4 v165, s[92:95], s30 offen lds
    s_add_u32 m0, s29, 15360
    s_mov_b32 s30, 1867776
    buffer_load_dwordx4 v165, s[92:95], s30 offen lds
    buffer_load_dword v171, off, s[88:91], 0 offset:128 sc1
    s_waitcnt vmcnt(17)
    ds_read2st64_b32 v[144:145], v170 offset0:64 offset1:65
    ds_read2st64_b32 v[146:147], v170 offset0:66 offset1:67
    ds_read2st64_b32 v[148:149], v170 offset0:68 offset1:69
    ds_read2st64_b32 v[150:151], v170 offset0:70 offset1:71
    ds_read2st64_b32 v[152:153], v170 offset0:72 offset1:73
    ds_read2st64_b32 v[154:155], v170 offset0:74 offset1:75
    ds_read2st64_b32 v[156:157], v170 offset0:76 offset1:77
    ds_read2st64_b32 v[158:159], v170 offset0:78 offset1:79
    v_perm_b32 v120, v129, v128, s31
    v_accvgpr_write_b32 a128, v120
    v_perm_b32 v121, v129, v128, s32
    v_accvgpr_write_b32 a136, v121
    v_perm_b32 v122, v131, v130, s31
    v_accvgpr_write_b32 a129, v122
    v_perm_b32 v123, v131, v130, s32
    v_accvgpr_write_b32 a137, v123
    v_perm_b32 v124, v133, v132, s31
    v_accvgpr_write_b32 a130, v124
    v_perm_b32 v125, v133, v132, s32
    v_accvgpr_write_b32 a138, v125
    v_perm_b32 v126, v135, v134, s31
    v_accvgpr_write_b32 a131, v126
    v_perm_b32 v127, v135, v134, s32
    v_accvgpr_write_b32 a139, v127
    v_perm_b32 v120, v137, v136, s31
    v_accvgpr_write_b32 a132, v120
    v_perm_b32 v121, v137, v136, s32
    v_accvgpr_write_b32 a140, v121
    v_perm_b32 v122, v139, v138, s31
    v_accvgpr_write_b32 a133, v122
    v_perm_b32 v123, v139, v138, s32
    v_accvgpr_write_b32 a141, v123
    v_perm_b32 v124, v141, v140, s31
    v_accvgpr_write_b32 a134, v124
    v_perm_b32 v125, v141, v140, s32
    v_accvgpr_write_b32 a142, v125
    v_perm_b32 v126, v143, v142, s31
    v_accvgpr_write_b32 a135, v126
    v_perm_b32 v127, v143, v142, s32
    v_accvgpr_write_b32 a143, v127
    s_waitcnt lgkmcnt(0)
    s_add_u32 m0, s29, 16384
    s_mov_b32 s30, 2097152
    buffer_load_dwordx4 v165, s[92:95], s30 offen lds
    s_add_u32 m0, s29, 17408
    s_mov_b32 s30, 2129920
    buffer_load_dwordx4 v165, s[92:95], s30 offen lds
    s_add_u32 m0, s29, 18432
    s_mov_b32 s30, 2359296
    buffer_load_dwordx4 v165, s[92:95], s30 offen lds
    s_add_u32 m0, s29, 19456
    s_mov_b32 s30, 2392064
    buffer_load_dwordx4 v165, s[92:95], s30 offen lds
    buffer_load_dword v185, v184, s[92:95], 0 offen
    s_waitcnt vmcnt(18)
    ds_read2st64_b32 v[128:129], v170 offset0:0 offset1:1
    ds_read2st64_b32 v[130:131], v170 offset0:2 offset1:3
    ds_read2st64_b32 v[132:133], v170 offset0:4 offset1:5
    ds_read2st64_b32 v[134:135], v170 offset0:6 offset1:7
    ds_read2st64_b32 v[136:137], v170 offset0:8 offset1:9
    ds_read2st64_b32 v[138:139], v170 offset0:10 offset1:11
    ds_read2st64_b32 v[140:141], v170 offset0:12 offset1:13
    ds_read2st64_b32 v[142:143], v170 offset0:14 offset1:15
    v_perm_b32 v120, v145, v144, s31
    v_accvgpr_write_b32 a144, v120
    v_perm_b32 v121, v145, v144, s32
    v_accvgpr_write_b32 a152, v121
    v_perm_b32 v122, v147, v146, s31
    v_accvgpr_write_b32 a145, v122
    v_perm_b32 v123, v147, v146, s32
    v_accvgpr_write_b32 a153, v123
    v_perm_b32 v124, v149, v148, s31
    v_accvgpr_write_b32 a146, v124
    v_perm_b32 v125, v149, v148, s32
    v_accvgpr_write_b32 a154, v125
    v_perm_b32 v126, v151, v150, s31
    v_accvgpr_write_b32 a147, v126
    v_perm_b32 v127, v151, v150, s32
    v_accvgpr_write_b32 a155, v127
    v_perm_b32 v120, v153, v152, s31
    v_accvgpr_write_b32 a148, v120
    v_perm_b32 v121, v153, v152, s32
    v_accvgpr_write_b32 a156, v121
    v_perm_b32 v122, v155, v154, s31
    v_accvgpr_write_b32 a149, v122
    v_perm_b32 v123, v155, v154, s32
    v_accvgpr_write_b32 a157, v123
    v_perm_b32 v124, v157, v156, s31
    v_accvgpr_write_b32 a150, v124
    v_perm_b32 v125, v157, v156, s32
    v_accvgpr_write_b32 a158, v125
    v_perm_b32 v126, v159, v158, s31
    v_accvgpr_write_b32 a151, v126
    v_perm_b32 v127, v159, v158, s32
    v_accvgpr_write_b32 a159, v127
    s_waitcnt lgkmcnt(0)
    s_add_u32 m0, s29, 0
    s_mov_b32 s30, 2621440
    buffer_load_dwordx4 v165, s[92:95], s30 offen lds
    s_add_u32 m0, s29, 1024
    s_mov_b32 s30, 2654208
    buffer_load_dwordx4 v165, s[92:95], s30 offen lds
    s_add_u32 m0, s29, 2048
    s_mov_b32 s30, 2883584
    buffer_load_dwordx4 v165, s[92:95], s30 offen lds
    s_add_u32 m0, s29, 3072
    s_mov_b32 s30, 2916352
    buffer_load_dwordx4 v165, s[92:95], s30 offen lds
    s_waitcnt vmcnt(18)
    ds_read2st64_b32 v[144:145], v170 offset0:16 offset1:17
    ds_read2st64_b32 v[146:147], v170 offset0:18 offset1:19
    ds_read2st64_b32 v[148:149], v170 offset0:20 offset1:21
    ds_read2st64_b32 v[150:151], v170 offset0:22 offset1:23
    ds_read2st64_b32 v[152:153], v170 offset0:24 offset1:25
    ds_read2st64_b32 v[154:155], v170 offset0:26 offset1:27
    ds_read2st64_b32 v[156:157], v170 offset0:28 offset1:29
    ds_read2st64_b32 v[158:159], v170 offset0:30 offset1:31
    v_perm_b32 v120, v129, v128, s31
    v_accvgpr_write_b32 a160, v120
    v_perm_b32 v121, v129, v128, s32
    v_accvgpr_write_b32 a168, v121
    v_perm_b32 v122, v131, v130, s31
    v_accvgpr_write_b32 a161, v122
    v_perm_b32 v123, v131, v130, s32
    v_accvgpr_write_b32 a169, v123
    v_perm_b32 v124, v133, v132, s31
    v_accvgpr_write_b32 a162, v124
    v_perm_b32 v125, v133, v132, s32
    v_accvgpr_write_b32 a170, v125
    v_perm_b32 v126, v135, v134, s31
    v_accvgpr_write_b32 a163, v126
    v_perm_b32 v127, v135, v134, s32
    v_accvgpr_write_b32 a171, v127
    v_perm_b32 v120, v137, v136, s31
    v_accvgpr_write_b32 a164, v120
    v_perm_b32 v121, v137, v136, s32
    v_accvgpr_write_b32 a172, v121
    v_perm_b32 v122, v139, v138, s31
    v_accvgpr_write_b32 a165, v122
    v_perm_b32 v123, v139, v138, s32
    v_accvgpr_write_b32 a173, v123
    v_perm_b32 v124, v141, v140, s31
    v_accvgpr_write_b32 a166, v124
    v_perm_b32 v125, v141, v140, s32
    v_accvgpr_write_b32 a174, v125
    v_perm_b32 v126, v143, v142, s31
    v_accvgpr_write_b32 a167, v126
    v_perm_b32 v127, v143, v142, s32
    v_accvgpr_write_b32 a175, v127
    s_waitcnt lgkmcnt(0)
    s_add_u32 m0, s29, 4096
    s_mov_b32 s30, 3145728
    buffer_load_dwordx4 v165, s[92:95], s30 offen lds
    s_add_u32 m0, s29, 5120
    s_mov_b32 s30, 3178496
    buffer_load_dwordx4 v165, s[92:95], s30 offen lds
    s_add_u32 m0, s29, 6144
    s_mov_b32 s30, 3407872
    buffer_load_dwordx4 v165, s[92:95], s30 offen lds
    s_add_u32 m0, s29, 7168
    s_mov_b32 s30, 3440640
    buffer_load_dwordx4 v165, s[92:95], s30 offen lds
    s_waitcnt vmcnt(18)
    ds_read2st64_b32 v[128:129], v170 offset0:32 offset1:33
    ds_read2st64_b32 v[130:131], v170 offset0:34 offset1:35
    ds_read2st64_b32 v[132:133], v170 offset0:36 offset1:37
    ds_read2st64_b32 v[134:135], v170 offset0:38 offset1:39
    ds_read2st64_b32 v[136:137], v170 offset0:40 offset1:41
    ds_read2st64_b32 v[138:139], v170 offset0:42 offset1:43
    ds_read2st64_b32 v[140:141], v170 offset0:44 offset1:45
    ds_read2st64_b32 v[142:143], v170 offset0:46 offset1:47
    v_perm_b32 v120, v145, v144, s31
    v_accvgpr_write_b32 a176, v120
    v_perm_b32 v121, v145, v144, s32
    v_accvgpr_write_b32 a184, v121
    v_perm_b32 v122, v147, v146, s31
    v_accvgpr_write_b32 a177, v122
    v_perm_b32 v123, v147, v146, s32
    v_accvgpr_write_b32 a185, v123
    v_perm_b32 v124, v149, v148, s31
    v_accvgpr_write_b32 a178, v124
    v_perm_b32 v125, v149, v148, s32
    v_accvgpr_write_b32 a186, v125
    v_perm_b32 v126, v151, v150, s31
    v_accvgpr_write_b32 a179, v126
    v_perm_b32 v127, v151, v150, s32
    v_accvgpr_write_b32 a187, v127
    v_perm_b32 v120, v153, v152, s31
    v_accvgpr_write_b32 a180, v120
    v_perm_b32 v121, v153, v152, s32
    v_accvgpr_write_b32 a188, v121
    v_perm_b32 v122, v155, v154, s31
    v_accvgpr_write_b32 a181, v122
    v_perm_b32 v123, v155, v154, s32
    v_accvgpr_write_b32 a189, v123
    v_perm_b32 v124, v157, v156, s31
    v_accvgpr_write_b32 a182, v124
    v_perm_b32 v125, v157, v156, s32
    v_accvgpr_write_b32 a190, v125
    v_perm_b32 v126, v159, v158, s31
    v_accvgpr_write_b32 a183, v126
    v_perm_b32 v127, v159, v158, s32
    v_accvgpr_write_b32 a191, v127
    s_waitcnt lgkmcnt(0)
    s_add_u32 m0, s29, 8192
    s_mov_b32 s30, 3670016
    buffer_load_dwordx4 v165, s[92:95], s30 offen lds
    s_add_u32 m0, s29, 9216
    s_mov_b32 s30, 3702784
    buffer_load_dwordx4 v165, s[92:95], s30 offen lds
    s_add_u32 m0, s29, 10240
    s_mov_b32 s30, 3932160
    buffer_load_dwordx4 v165, s[92:95], s30 offen lds
    s_add_u32 m0, s29, 11264
    s_mov_b32 s30, 3964928
    buffer_load_dwordx4 v165, s[92:95], s30 offen lds
    s_waitcnt vmcnt(18)
    ds_read2st64_b32 v[144:145], v170 offset0:48 offset1:49
    ds_read2st64_b32 v[146:147], v170 offset0:50 offset1:51
    ds_read2st64_b32 v[148:149], v170 offset0:52 offset1:53
    ds_read2st64_b32 v[150:151], v170 offset0:54 offset1:55
    ds_read2st64_b32 v[152:153], v170 offset0:56 offset1:57
    ds_read2st64_b32 v[154:155], v170 offset0:58 offset1:59
    ds_read2st64_b32 v[156:157], v170 offset0:60 offset1:61
    ds_read2st64_b32 v[158:159], v170 offset0:62 offset1:63
    v_perm_b32 v120, v129, v128, s31
    v_accvgpr_write_b32 a192, v120
    v_perm_b32 v121, v129, v128, s32
    v_accvgpr_write_b32 a200, v121
    v_perm_b32 v122, v131, v130, s31
    v_accvgpr_write_b32 a193, v122
    v_perm_b32 v123, v131, v130, s32
    v_accvgpr_write_b32 a201, v123
    v_perm_b32 v124, v133, v132, s31
    v_accvgpr_write_b32 a194, v124
    v_perm_b32 v125, v133, v132, s32
    v_accvgpr_write_b32 a202, v125
    v_perm_b32 v126, v135, v134, s31
    v_accvgpr_write_b32 a195, v126
    v_perm_b32 v127, v135, v134, s32
    v_accvgpr_write_b32 a203, v127
    v_perm_b32 v120, v137, v136, s31
    v_accvgpr_write_b32 a196, v120
    v_perm_b32 v121, v137, v136, s32
    v_accvgpr_write_b32 a204, v121
    v_perm_b32 v122, v139, v138, s31
    v_accvgpr_write_b32 a197, v122
    v_perm_b32 v123, v139, v138, s32
    v_accvgpr_write_b32 a205, v123
    v_perm_b32 v124, v141, v140, s31
    v_accvgpr_write_b32 a198, v124
    v_perm_b32 v125, v141, v140, s32
    v_accvgpr_write_b32 a206, v125
    v_perm_b32 v126, v143, v142, s31
    v_accvgpr_write_b32 a199, v126
    v_perm_b32 v127, v143, v142, s32
    v_accvgpr_write_b32 a207, v127
    s_waitcnt lgkmcnt(0)
    s_add_u32 m0, s29, 12288
    s_mov_b32 s30, 4194304
    buffer_load_dwordx4 v165, s[92:95], s30 offen lds
    s_add_u32 m0, s29, 13312
    s_mov_b32 s30, 4227072
    buffer_load_dwordx4 v165, s[92:95], s30 offen lds
    s_add_u32 m0, s29, 14336
    s_mov_b32 s30, 4456448
    buffer_load_dwordx4 v165, s[92:95], s30 offen lds
    s_add_u32 m0, s29, 15360
    s_mov_b32 s30, 4489216
    buffer_load_dwordx4 v165, s[92:95], s30 offen lds
    s_waitcnt vmcnt(17)
    ds_read2st64_b32 v[128:129], v170 offset0:64 offset1:65
    ds_read2st64_b32 v[130:131], v170 offset0:66 offset1:67
    ds_read2st64_b32 v[132:133], v170 offset0:68 offset1:69
    ds_read2st64_b32 v[134:135], v170 offset0:70 offset1:71
    ds_read2st64_b32 v[136:137], v170 offset0:72 offset1:73
    ds_read2st64_b32 v[138:139], v170 offset0:74 offset1:75
    ds_read2st64_b32 v[140:141], v170 offset0:76 offset1:77
    ds_read2st64_b32 v[142:143], v170 offset0:78 offset1:79
    v_perm_b32 v120, v145, v144, s31
    v_accvgpr_write_b32 a208, v120
    v_perm_b32 v121, v145, v144, s32
    v_accvgpr_write_b32 a216, v121
    v_perm_b32 v122, v147, v146, s31
    v_accvgpr_write_b32 a209, v122
    v_perm_b32 v123, v147, v146, s32
    v_accvgpr_write_b32 a217, v123
    v_perm_b32 v124, v149, v148, s31
    v_accvgpr_write_b32 a210, v124
    v_perm_b32 v125, v149, v148, s32
    v_accvgpr_write_b32 a218, v125
    v_perm_b32 v126, v151, v150, s31
    v_accvgpr_write_b32 a211, v126
    v_perm_b32 v127, v151, v150, s32
    v_accvgpr_write_b32 a219, v127
    v_perm_b32 v120, v153, v152, s31
    v_accvgpr_write_b32 a212, v120
    v_perm_b32 v121, v153, v152, s32
    v_accvgpr_write_b32 a220, v121
    v_perm_b32 v122, v155, v154, s31
    v_accvgpr_write_b32 a213, v122
    v_perm_b32 v123, v155, v154, s32
    v_accvgpr_write_b32 a221, v123
    v_perm_b32 v124, v157, v156, s31
    v_accvgpr_write_b32 a214, v124
    v_perm_b32 v125, v157, v156, s32
    v_accvgpr_write_b32 a222, v125
    v_perm_b32 v126, v159, v158, s31
    v_accvgpr_write_b32 a215, v126
    v_perm_b32 v127, v159, v158, s32
    v_accvgpr_write_b32 a223, v127
    s_waitcnt lgkmcnt(0)
    s_add_u32 m0, s29, 16384
    s_mov_b32 s30, 4718592
    buffer_load_dwordx4 v165, s[92:95], s30 offen lds
    s_add_u32 m0, s29, 17408
    s_mov_b32 s30, 4751360
    buffer_load_dwordx4 v165, s[92:95], s30 offen lds
    s_add_u32 m0, s29, 18432
    s_mov_b32 s30, 4980736
    buffer_load_dwordx4 v165, s[92:95], s30 offen lds
    s_add_u32 m0, s29, 19456
    s_mov_b32 s30, 5013504
    buffer_load_dwordx4 v165, s[92:95], s30 offen lds
    s_mul_i32 s20, s16, 40960
    s_mul_i32 s21, s18, 10240
    s_add_u32 s20, s20, s21
    s_add_u32 s20, s20, 2097152
    s_add_u32 s21, s21, s40
    s_mov_b32 m0, s21
    s_nop 0
    buffer_load_dwordx4 v4, s[4:7], s20 offen offset:0 sc1 lds
    buffer_load_dwordx4 v4, s[4:7], s20 offen offset:1024 sc1 lds
    buffer_load_dwordx4 v4, s[4:7], s20 offen offset:2048 sc1 lds
    buffer_load_dwordx4 v4, s[4:7], s20 offen offset:3072 sc1 lds
    s_add_u32 s20, s20, 4096
    s_add_u32 s21, s21, 4096
    s_mov_b32 m0, s21
    s_nop 0
    buffer_load_dwordx4 v4, s[4:7], s20 offen offset:0 sc1 lds
    buffer_load_dwordx4 v4, s[4:7], s20 offen offset:1024 sc1 lds
    buffer_load_dwordx4 v4, s[4:7], s20 offen offset:2048 sc1 lds
    buffer_load_dwordx4 v4, s[4:7], s20 offen offset:3072 sc1 lds
    s_add_u32 s20, s20, 4096
    s_add_u32 s21, s21, 4096
    s_mov_b32 m0, s21
    s_nop 0
    buffer_load_dwordx4 v4, s[4:7], s20 offen offset:0 sc1 lds
    buffer_load_dwordx4 v4, s[4:7], s20 offen offset:1024 sc1 lds
    s_waitcnt vmcnt(26)
    ds_read2st64_b32 v[144:145], v170 offset0:0 offset1:1
    ds_read2st64_b32 v[146:147], v170 offset0:2 offset1:3
    ds_read2st64_b32 v[148:149], v170 offset0:4 offset1:5
    ds_read2st64_b32 v[150:151], v170 offset0:6 offset1:7
    ds_read2st64_b32 v[152:153], v170 offset0:8 offset1:9
    ds_read2st64_b32 v[154:155], v170 offset0:10 offset1:11
    ds_read2st64_b32 v[156:157], v170 offset0:12 offset1:13
    ds_read2st64_b32 v[158:159], v170 offset0:14 offset1:15
    v_perm_b32 v120, v129, v128, s31
    v_accvgpr_write_b32 a224, v120
    v_perm_b32 v121, v129, v128, s32
    v_accvgpr_write_b32 a232, v121
    v_perm_b32 v122, v131, v130, s31
    v_accvgpr_write_b32 a225, v122
    v_perm_b32 v123, v131, v130, s32
    v_accvgpr_write_b32 a233, v123
    v_perm_b32 v124, v133, v132, s31
    v_accvgpr_write_b32 a226, v124
    v_perm_b32 v125, v133, v132, s32
    v_accvgpr_write_b32 a234, v125
    v_perm_b32 v126, v135, v134, s31
    v_accvgpr_write_b32 a227, v126
    v_perm_b32 v127, v135, v134, s32
    v_accvgpr_write_b32 a235, v127
    v_perm_b32 v120, v137, v136, s31
    v_accvgpr_write_b32 a228, v120
    v_perm_b32 v121, v137, v136, s32
    v_accvgpr_write_b32 a236, v121
    v_perm_b32 v122, v139, v138, s31
    v_accvgpr_write_b32 a229, v122
    v_perm_b32 v123, v139, v138, s32
    v_accvgpr_write_b32 a237, v123
    v_perm_b32 v124, v141, v140, s31
    v_accvgpr_write_b32 a230, v124
    v_perm_b32 v125, v141, v140, s32
    v_accvgpr_write_b32 a238, v125
    v_perm_b32 v126, v143, v142, s31
    v_accvgpr_write_b32 a231, v126
    v_perm_b32 v127, v143, v142, s32
    v_accvgpr_write_b32 a239, v127
    s_waitcnt lgkmcnt(0)
    s_waitcnt vmcnt(22)
    ds_read2st64_b32 v[128:129], v170 offset0:16 offset1:17
    ds_read2st64_b32 v[130:131], v170 offset0:18 offset1:19
    ds_read2st64_b32 v[132:133], v170 offset0:20 offset1:21
    ds_read2st64_b32 v[134:135], v170 offset0:22 offset1:23
    ds_read2st64_b32 v[136:137], v170 offset0:24 offset1:25
    ds_read2st64_b32 v[138:139], v170 offset0:26 offset1:27
    ds_read2st64_b32 v[140:141], v170 offset0:28 offset1:29
    ds_read2st64_b32 v[142:143], v170 offset0:30 offset1:31
    v_perm_b32 v120, v145, v144, s31
    v_accvgpr_write_b32 a240, v120
    v_perm_b32 v121, v145, v144, s32
    v_accvgpr_write_b32 a248, v121
    v_perm_b32 v122, v147, v146, s31
    v_accvgpr_write_b32 a241, v122
    v_perm_b32 v123, v147, v146, s32
    v_accvgpr_write_b32 a249, v123
    v_perm_b32 v124, v149, v148, s31
    v_accvgpr_write_b32 a242, v124
    v_perm_b32 v125, v149, v148, s32
    v_accvgpr_write_b32 a250, v125
    v_perm_b32 v126, v151, v150, s31
    v_accvgpr_write_b32 a243, v126
    v_perm_b32 v127, v151, v150, s32
    v_accvgpr_write_b32 a251, v127
    v_perm_b32 v120, v153, v152, s31
    v_accvgpr_write_b32 a244, v120
    v_perm_b32 v121, v153, v152, s32
    v_accvgpr_write_b32 a252, v121
    v_perm_b32 v122, v155, v154, s31
    v_accvgpr_write_b32 a245, v122
    v_perm_b32 v123, v155, v154, s32
    v_accvgpr_write_b32 a253, v123
    v_perm_b32 v124, v157, v156, s31
    v_accvgpr_write_b32 a246, v124
    v_perm_b32 v125, v157, v156, s32
    v_accvgpr_write_b32 a254, v125
    v_perm_b32 v126, v159, v158, s31
    v_accvgpr_write_b32 a247, v126
    v_perm_b32 v127, v159, v158, s32
    v_accvgpr_write_b32 a255, v127
    s_waitcnt lgkmcnt(0)
    s_waitcnt vmcnt(18)
    ds_read2st64_b32 v[144:145], v170 offset0:32 offset1:33
    ds_read2st64_b32 v[146:147], v170 offset0:34 offset1:35
    ds_read2st64_b32 v[148:149], v170 offset0:36 offset1:37
    ds_read2st64_b32 v[150:151], v170 offset0:38 offset1:39
    ds_read2st64_b32 v[152:153], v170 offset0:40 offset1:41
    ds_read2st64_b32 v[154:155], v170 offset0:42 offset1:43
    ds_read2st64_b32 v[156:157], v170 offset0:44 offset1:45
    ds_read2st64_b32 v[158:159], v170 offset0:46 offset1:47
    v_perm_b32 v192, v129, v128, s31
    v_perm_b32 v200, v129, v128, s32
    v_perm_b32 v193, v131, v130, s31
    v_perm_b32 v201, v131, v130, s32
    v_perm_b32 v194, v133, v132, s31
    v_perm_b32 v202, v133, v132, s32
    v_perm_b32 v195, v135, v134, s31
    v_perm_b32 v203, v135, v134, s32
    v_perm_b32 v196, v137, v136, s31
    v_perm_b32 v204, v137, v136, s32
    v_perm_b32 v197, v139, v138, s31
    v_perm_b32 v205, v139, v138, s32
    v_perm_b32 v198, v141, v140, s31
    v_perm_b32 v206, v141, v140, s32
    v_perm_b32 v199, v143, v142, s31
    v_perm_b32 v207, v143, v142, s32
    s_waitcnt lgkmcnt(0)
    s_waitcnt vmcnt(14)
    ds_read2st64_b32 v[128:129], v170 offset0:48 offset1:49
    ds_read2st64_b32 v[130:131], v170 offset0:50 offset1:51
    ds_read2st64_b32 v[132:133], v170 offset0:52 offset1:53
    ds_read2st64_b32 v[134:135], v170 offset0:54 offset1:55
    ds_read2st64_b32 v[136:137], v170 offset0:56 offset1:57
    ds_read2st64_b32 v[138:139], v170 offset0:58 offset1:59
    ds_read2st64_b32 v[140:141], v170 offset0:60 offset1:61
    ds_read2st64_b32 v[142:143], v170 offset0:62 offset1:63
    v_perm_b32 v208, v145, v144, s31
    v_perm_b32 v216, v145, v144, s32
    v_perm_b32 v209, v147, v146, s31
    v_perm_b32 v217, v147, v146, s32
    v_perm_b32 v210, v149, v148, s31
    v_perm_b32 v218, v149, v148, s32
    v_perm_b32 v211, v151, v150, s31
    v_perm_b32 v219, v151, v150, s32
    v_perm_b32 v212, v153, v152, s31
    v_perm_b32 v220, v153, v152, s32
    v_perm_b32 v213, v155, v154, s31
    v_perm_b32 v221, v155, v154, s32
    v_perm_b32 v214, v157, v156, s31
    v_perm_b32 v222, v157, v156, s32
    v_perm_b32 v215, v159, v158, s31
    v_perm_b32 v223, v159, v158, s32
    s_waitcnt lgkmcnt(0)
    s_waitcnt vmcnt(10)
    ds_read2st64_b32 v[144:145], v170 offset0:64 offset1:65
    ds_read2st64_b32 v[146:147], v170 offset0:66 offset1:67
    ds_read2st64_b32 v[148:149], v170 offset0:68 offset1:69
    ds_read2st64_b32 v[150:151], v170 offset0:70 offset1:71
    ds_read2st64_b32 v[152:153], v170 offset0:72 offset1:73
    ds_read2st64_b32 v[154:155], v170 offset0:74 offset1:75
    ds_read2st64_b32 v[156:157], v170 offset0:76 offset1:77
    ds_read2st64_b32 v[158:159], v170 offset0:78 offset1:79
    v_perm_b32 v224, v129, v128, s31
    v_perm_b32 v232, v129, v128, s32
    v_perm_b32 v225, v131, v130, s31
    v_perm_b32 v233, v131, v130, s32
    v_perm_b32 v226, v133, v132, s31
    v_perm_b32 v234, v133, v132, s32
    v_perm_b32 v227, v135, v134, s31
    v_perm_b32 v235, v135, v134, s32
    v_perm_b32 v228, v137, v136, s31
    v_perm_b32 v236, v137, v136, s32
    v_perm_b32 v229, v139, v138, s31
    v_perm_b32 v237, v139, v138, s32
    v_perm_b32 v230, v141, v140, s31
    v_perm_b32 v238, v141, v140, s32
    v_perm_b32 v231, v143, v142, s31
    v_perm_b32 v239, v143, v142, s32
    s_waitcnt lgkmcnt(0)
    v_perm_b32 v240, v145, v144, s31
    v_perm_b32 v248, v145, v144, s32
    v_perm_b32 v241, v147, v146, s31
    v_perm_b32 v249, v147, v146, s32
    v_perm_b32 v242, v149, v148, s31
    v_perm_b32 v250, v149, v148, s32
    v_perm_b32 v243, v151, v150, s31
    v_perm_b32 v251, v151, v150, s32
    v_perm_b32 v244, v153, v152, s31
    v_perm_b32 v252, v153, v152, s32
    v_perm_b32 v245, v155, v154, s31
    v_perm_b32 v253, v155, v154, s32
    v_perm_b32 v246, v157, v156, s31
    v_perm_b32 v254, v157, v156, s32
    v_perm_b32 v247, v159, v158, s31
    v_perm_b32 v255, v159, v158, s32
rev_2_b:
    s_mov_b32 s21, 0
    v_readfirstlane_b32 s19, v171
    s_and_b32 s22, s19, 255
    s_xor_b32 s22, s22, 64
    v_mov_b32 v172, 40960
    s_cmp_eq_u32 s18, 0
    s_cbranch_scc0 wi_4_w
    s_branch wi_4_chk
wi_4:
    buffer_load_dword v171, off, s[88:91], 0 offset:128 sc1
    s_waitcnt vmcnt(0)
wi_4_chk:
    v_readfirstlane_b32 s19, v171
    s_and_b32 s20, s19, 255
    s_cmp_eq_u32 s20, 64
    s_cbranch_scc1 wi_4_ok
    s_sleep 2
    s_add_u32 s21, s21, 1
    s_cmp_lt_u32 s21, 200000
    s_cbranch_scc1 wi_4
wi_4_ok:
    ds_write_b32 v172, v171
wi_4_w:
    s_waitcnt vmcnt(0) lgkmcnt(0)
    s_barrier
    ds_read_b32 v171, v172
    s_waitcnt lgkmcnt(0)
    v_readfirstlane_b32 s19, v171
    s_cmp_gt_u32 s19, 33024
    s_cselect_b32 s19, 0x2000, 0
    s_xor_b32 s34, s19, 0x2000
    s_cmp_eq_u32 s22, 0
    s_cbranch_scc1 nbk_3
    s_mul_i32 s20, s16, 40960
    s_mul_i32 s21, s18, 10240
    s_add_u32 s20, s20, s21
    s_add_u32 s20, s20, 2097152
    s_add_u32 s21, s21, s40
    s_mov_b32 m0, s21
    s_nop 0
    buffer_load_dwordx4 v4, s[4:7], s20 offen offset:0 sc1 lds
    buffer_load_dwordx4 v4, s[4:7], s20 offen offset:1024 sc1 lds
    buffer_load_dwordx4 v4, s[4:7], s20 offen offset:2048 sc1 lds
    buffer_load_dwordx4 v4, s[4:7], s20 offen offset:3072 sc1 lds
    s_add_u32 s20, s20, 4096
    s_add_u32 s21, s21, 4096
    s_mov_b32 m0, s21
    s_nop 0
    buffer_load_dwordx4 v4, s[4:7], s20 offen offset:0 sc1 lds
    buffer_load_dwordx4 v4, s[4:7], s20 offen offset:1024 sc1 lds
    buffer_load_dwordx4 v4, s[4:7], s20 offen offset:2048 sc1 lds
    buffer_load_dwordx4 v4, s[4:7], s20 offen offset:3072 sc1 lds
    s_add_u32 s20, s20, 4096
    s_add_u32 s21, s21, 4096
    s_mov_b32 m0, s21
    s_nop 0
    buffer_load_dwordx4 v4, s[4:7], s20 offen offset:0 sc1 lds
    buffer_load_dwordx4 v4, s[4:7], s20 offen offset:1024 sc1 lds
nbk_3:
    v_and_b32 v8, 1, v13
    v_lshlrev_b32 v8, 10, v8
    v_lshrrev_b32 v14, 1, v13
    v_lshl_add_u32 v8, v14, 9, v8
    v_lshl_add_u32 v8, v12, 4, v8
    s_and_b32 s20, s18, 1
    s_lshl_b32 s20, s20, 11
    s_lshr_b32 s21, s18, 1
    s_lshl_b32 s21, s21, 8
    s_add_u32 s20, s20, s21
    v_add_u32 v8, s20, v8
    s_mov_b32 s33, 0x3e0293ee
    s_and_b32 s21, s42, 1
    s_lshl_b32 s21, s21, 2
    s_lshr_b32 s20, s42, 1
    s_lshl_b32 s20, s20, 7
    s_add_u32 s20, s20, s21
    s_add_u32 s20, s20, 1851392
    s_add_u32 s20, s20, s19
    s_cmp_eq_u32 s18, 0
    s_cselect_b32 s20, s20, 0x40000000
    v_mov_b32 v9, s20
    v_cmp_eq_u32 vcc, 0, v1
    v_mov_b32 v3, 0x40000000
    s_nop 0
    v_cndmask_b32 v9, v3, v9, vcc
    v_mov_b32 v2, v4
    s_mul_i32 s49, s18, 10240
    s_add_u32 s48, s49, 2093056
    s_mov_b32 s22, 0
    s_mov_b32 s23, 0
    s_mov_b32 s50, 0
    s_waitcnt vmcnt(0)
    s_barrier
    ds_read_b128 v[100:103], v2 offset:0
    ds_read_b128 v[104:107], v2 offset:1024
    ds_read_b128 v[108:111], v2 offset:2048
    ds_read_b128 v[112:115], v2 offset:3072
L_qkx_loop:
    v_mov_b32 v5, v2
    s_waitcnt lgkmcnt(3)
    v_mfma_f32_16x16x32_bf16 v[16:19], a[0:3], v[100:103], 0
    ds_read_b128 v[116:119], v5 offset:4096
    s_barrier
    v_mfma_f32_16x16x32_bf16 v[20:23], a[8:11], v[100:103], 0
    v_xor_b32 v2, 40960, v2
    s_xor_b32 s40, s40, 40960
    v_mfma_f32_16x16x32_bf16 v[24:27], a[160:163], v[100:103], 0
    s_add_u32 s47, s40, s49
    s_sub_u32 s20, s16, 1
    v_mov_b32 v10, s20
    v_mfma_f32_16x16x32_bf16 v[28:31], a[168:171], v[100:103], 0
    s_waitcnt lgkmcnt(3)
    s_cmp_lt_u32 s16, 3
    s_cselect_b32 s20, 2, s41
    v_mfma_f32_16x16x32_bf16 v[16:19], a[4:7], v[104:107], v[16:19]
    ds_read_b128 v[100:103], v5 offset:5120
    s_add_u32 s43, s16, s20
    s_min_u32 s46, s43, 63
    v_mfma_f32_16x16x32_bf16 v[20:23], a[12:15], v[104:107], v[20:23]
    s_mul_i32 s46, s46, 40960
    s_add_u32 s46, s46, s48
    v_cvt_pk_bf16_f32 v48, v32, v34
    v_mfma_f32_16x16x32_bf16 v[24:27], a[164:167], v[104:107], v[24:27]
    v_cvt_pk_bf16_f32 v49, v33, v35
    v_cvt_pk_bf16_f32 v50, v36, v38
    v_mfma_f32_16x16x32_bf16 v[28:31], a[172:175], v[104:107], v[28:31]
    s_waitcnt lgkmcnt(3)
    v_cvt_pk_bf16_f32 v51, v37, v39
    v_mfma_f32_16x16x32_bf16 v[16:19], a[16:19], v[108:111], v[16:19]
    ds_read_b128 v[104:107], v5 offset:6144
    buffer_store_dwordx4 v[48:51], v3, s[4:7], s22 offen sc1
    v_mfma_f32_16x16x32_bf16 v[20:23], a[24:27], v[108:111], v[20:23]
    v_mul_f32 v40, s33, v40
    v_mul_f32 v41, s33, v41
    v_mfma_f32_16x16x32_bf16 v[24:27], a[176:179], v[108:111], v[24:27]
    v_mul_f32 v42, s33, v42
    v_mul_f32 v43, s33, v43
    v_mfma_f32_16x16x32_bf16 v[28:31], a[184:187], v[108:111], v[28:31]
    s_waitcnt lgkmcnt(3)
    v_mul_f32 v44, s33, v44
    v_mul_f32 v45, s33, v45
    v_mfma_f32_16x16x32_bf16 v[16:19], a[20:23], v[112:115], v[16:19]
    ds_read_b128 v[108:111], v5 offset:7168
    v_mul_f32 v46, s33, v46
    v_mul_f32 v47, s33, v47
    v_mfma_f32_16x16x32_bf16 v[20:23], a[28:31], v[112:115], v[20:23]
    v_cvt_pk_bf16_f32 v52, v40, v42
    v_cvt_pk_bf16_f32 v53, v41, v43
    v_mfma_f32_16x16x32_bf16 v[24:27], a[180:183], v[112:115], v[24:27]
    v_cvt_pk_bf16_f32 v54, v44, v46
    v_cvt_pk_bf16_f32 v55, v45, v47
    v_mfma_f32_16x16x32_bf16 v[28:31], a[188:191], v[112:115], v[28:31]
    s_waitcnt lgkmcnt(3)
    buffer_store_dwordx4 v[52:55], v3, s[4:7], s23 offen sc1
    v_mfma_f32_16x16x32_bf16 v[16:19], a[32:35], v[116:119], v[16:19]
    ds_read_b128 v[112:115], v5 offset:8192
    s_add_u32 s22, s22, 4096
    s_add_u32 s23, s23, 4096
    v_mfma_f32_16x16x32_bf16 v[20:23], a[40:43], v[116:119], v[20:23]
    s_and_b32 s22, s16, 63
    s_lshl_b32 s22, s22, 5
    s_add_u32 s22, s22, s17
    v_mfma_f32_16x16x32_bf16 v[24:27], a[192:195], v[116:119], v[24:27]
    s_lshl_b32 s22, s22, 15
    s_add_u32 s22, s22, 8388608
    s_lshr_b32 s21, s22, 8
    v_mfma_f32_16x16x32_bf16 v[28:31], a[200:203], v[116:119], v[28:31]
    s_waitcnt lgkmcnt(3)
    s_xor_b32 s21, s21, s19
    s_and_b32 s21, s21, 0x2000
    v_mfma_f32_16x16x32_bf16 v[16:19], a[36:39], v[100:103], v[16:19]
    ds_read_b128 v[116:119], v5 offset:9216
    s_or_b32 s22, s22, s21
    s_add_u32 s23, s22, 16384
    v_mfma_f32_16x16x32_bf16 v[20:23], a[44:47], v[100:103], v[20:23]
    v_mov_b32 v3, v8
    v_mfma_f32_16x16x32_bf16 v[24:27], a[196:199], v[100:103], v[24:27]
    v_mfma_f32_16x16x32_bf16 v[28:31], a[204:207], v[100:103], v[28:31]
    s_waitcnt lgkmcnt(3)
    v_mfma_f32_16x16x32_bf16 v[16:19], a[48:51], v[104:107], v[16:19]
    ds_read_b128 v[100:103], v5 offset:10240
    v_mfma_f32_16x16x32_bf16 v[20:23], a[56:59], v[104:107], v[20:23]
    v_mfma_f32_16x16x32_bf16 v[24:27], a[208:211], v[104:107], v[24:27]
    s_add_u32 m0, s47, 0
    s_add_u32 s46, s46, 4096
    buffer_load_dwordx4 v4, s[4:7], s46 offen offset:0 sc1 lds
    v_mfma_f32_16x16x32_bf16 v[28:31], a[216:219], v[104:107], v[28:31]
    s_waitcnt lgkmcnt(3)
    v_mfma_f32_16x16x32_bf16 v[16:19], a[52:55], v[108:111], v[16:19]
    ds_read_b128 v[104:107], v5 offset:11264
    v_mfma_f32_16x16x32_bf16 v[20:23], a[60:63], v[108:111], v[20:23]
    v_mfma_f32_16x16x32_bf16 v[24:27], a[212:215], v[108:111], v[24:27]
    buffer_load_dwordx4 v4, s[4:7], s46 offen offset:1024 sc1 lds
    v_mfma_f32_16x16x32_bf16 v[28:31], a[220:223], v[108:111], v[28:31]
    s_waitcnt lgkmcnt(3)
    v_mfma_f32_16x16x32_bf16 v[16:19], a[64:67], v[112:115], v[16:19]
    ds_read_b128 v[108:111], v5 offset:12288
    v_mfma_f32_16x16x32_bf16 v[20:23], a[72:75], v[112:115], v[20:23]
    v_mfma_f32_16x16x32_bf16 v[24:27], a[224:227], v[112:115], v[24:27]
    buffer_load_dwordx4 v4, s[4:7], s46 offen offset:2048 sc1 lds
    v_mfma_f32_16x16x32_bf16 v[28:31], a[232:235], v[112:115], v[28:31]
    s_waitcnt lgkmcnt(3)
    v_mfma_f32_16x16x32_bf16 v[16:19], a[68:71], v[116:119], v[16:19]
    ds_read_b128 v[112:115], v5 offset:13312
    v_mfma_f32_16x16x32_bf16 v[20:23], a[76:79], v[116:119], v[20:23]
    v_mfma_f32_16x16x32_bf16 v[24:27], a[228:231], v[116:119], v[24:27]
    buffer_load_dwordx4 v4, s[4:7], s46 offen offset:3072 sc1 lds
    v_mfma_f32_16x16x32_bf16 v[28:31], a[236:239], v[116:119], v[28:31]
    s_waitcnt lgkmcnt(3)
    v_mfma_f32_16x16x32_bf16 v[16:19], a[80:83], v[100:103], v[16:19]
    ds_read_b128 v[116:119], v5 offset:14336
    v_mfma_f32_16x16x32_bf16 v[20:23], a[88:91], v[100:103], v[20:23]
    v_mfma_f32_16x16x32_bf16 v[24:27], a[240:243], v[100:103], v[24:27]
    s_add_u32 m0, s47, 4096
    s_add_u32 s46, s46, 4096
    buffer_load_dwordx4 v4, s[4:7], s46 offen offset:0 sc1 lds
    v_mfma_f32_16x16x32_bf16 v[28:31], a[248:251], v[100:103], v[28:31]
    s_waitcnt lgkmcnt(3)
    v_mfma_f32_16x16x32_bf16 v[16:19], a[84:87], v[104:107], v[16:19]
    ds_read_b128 v[100:103], v5 offset:15360
    v_mfma_f32_16x16x32_bf16 v[20:23], a[92:95], v[104:107], v[20:23]
    v_mfma_f32_16x16x32_bf16 v[24:27], a[244:247], v[104:107], v[24:27]
    buffer_load_dwordx4 v4, s[4:7], s46 offen offset:1024 sc1 lds
    v_mfma_f32_16x16x32_bf16 v[28:31], a[252:255], v[104:107], v[28:31]
    s_waitcnt lgkmcnt(3)
    v_mfma_f32_16x16x32_bf16 v[16:19], a[96:99], v[108:111], v[16:19]
    ds_read_b128 v[104:107], v5 offset:16384
    v_mfma_f32_16x16x32_bf16 v[20:23], a[104:107], v[108:111], v[20:23]
    v_mfma_f32_16x16x32_bf16 v[24:27], v[192:195], v[108:111], v[24:27]
    buffer_load_dwordx4 v4, s[4:7], s46 offen offset:2048 sc1 lds
    v_mfma_f32_16x16x32_bf16 v[28:31], v[200:203], v[108:111], v[28:31]
    s_waitcnt lgkmcnt(3)
    v_mfma_f32_16x16x32_bf16 v[16:19], a[100:103], v[112:115], v[16:19]
    ds_read_b128 v[108:111], v5 offset:17408
    v_mfma_f32_16x16x32_bf16 v[20:23], a[108:111], v[112:115], v[20:23]
    v_mfma_f32_16x16x32_bf16 v[24:27], v[196:199], v[112:115], v[24:27]
    buffer_load_dwordx4 v4, s[4:7], s46 offen offset:3072 sc1 lds
    v_mfma_f32_16x16x32_bf16 v[28:31], v[204:207], v[112:115], v[28:31]
    s_waitcnt lgkmcnt(3)
    v_mfma_f32_16x16x32_bf16 v[16:19], a[112:115], v[116:119], v[16:19]
    ds_read_b128 v[112:115], v5 offset:18432
    v_mfma_f32_16x16x32_bf16 v[20:23], a[120:123], v[116:119], v[20:23]
    v_mfma_f32_16x16x32_bf16 v[24:27], v[208:211], v[116:119], v[24:27]
    s_add_u32 m0, s47, 8192
    s_add_u32 s46, s46, 4096
    buffer_load_dwordx4 v4, s[4:7], s46 offen offset:0 sc1 lds
    v_mfma_f32_16x16x32_bf16 v[28:31], v[216:219], v[116:119], v[28:31]
    s_waitcnt lgkmcnt(3)
    v_mfma_f32_16x16x32_bf16 v[16:19], a[116:119], v[100:103], v[16:19]
    ds_read_b128 v[116:119], v5 offset:19456
    v_mfma_f32_16x16x32_bf16 v[20:23], a[124:127], v[100:103], v[20:23]
    v_mfma_f32_16x16x32_bf16 v[24:27], v[212:215], v[100:103], v[24:27]
    buffer_load_dwordx4 v4, s[4:7], s46 offen offset:1024 sc1 lds
    v_mfma_f32_16x16x32_bf16 v[28:31], v[220:223], v[100:103], v[28:31]
    s_waitcnt lgkmcnt(3)
    v_mfma_f32_16x16x32_bf16 v[16:19], a[128:131], v[104:107], v[16:19]
    ds_read_b128 v[100:103], v5 offset:20480
    v_mfma_f32_16x16x32_bf16 v[20:23], a[136:139], v[104:107], v[20:23]
    v_mfma_f32_16x16x32_bf16 v[24:27], v[224:227], v[104:107], v[24:27]
    v_mfma_f32_16x16x32_bf16 v[28:31], v[232:235], v[104:107], v[28:31]
    s_waitcnt lgkmcnt(3)
    v_mfma_f32_16x16x32_bf16 v[16:19], a[132:135], v[108:111], v[16:19]
    ds_read_b128 v[104:107], v5 offset:21504
    v_mfma_f32_16x16x32_bf16 v[20:23], a[140:143], v[108:111], v[20:23]
    v_mfma_f32_16x16x32_bf16 v[24:27], v[228:231], v[108:111], v[24:27]
    v_mfma_f32_16x16x32_bf16 v[28:31], v[236:239], v[108:111], v[28:31]
    s_waitcnt lgkmcnt(3)
    v_mfma_f32_16x16x32_bf16 v[16:19], a[144:147], v[112:115], v[16:19]
    ds_read_b128 v[108:111], v5 offset:22528
    v_mfma_f32_16x16x32_bf16 v[20:23], a[152:155], v[112:115], v[20:23]
    v_mfma_f32_16x16x32_bf16 v[24:27], v[240:243], v[112:115], v[24:27]
    v_mfma_f32_16x16x32_bf16 v[28:31], v[248:251], v[112:115], v[28:31]
    s_waitcnt lgkmcnt(3)
    v_mfma_f32_16x16x32_bf16 v[16:19], a[148:151], v[116:119], v[16:19]
    ds_read_b128 v[112:115], v5 offset:23552
    v_mfma_f32_16x16x32_bf16 v[20:23], a[156:159], v[116:119], v[20:23]
    v_mfma_f32_16x16x32_bf16 v[24:27], v[244:247], v[116:119], v[24:27]
    v_mfma_f32_16x16x32_bf16 v[28:31], v[252:255], v[116:119], v[28:31]
    s_waitcnt lgkmcnt(3)
    v_mfma_f32_16x16x32_bf16 v[32:35], a[0:3], v[100:103], 0
    ds_read_b128 v[116:119], v5 offset:24576
    v_mfma_f32_16x16x32_bf16 v[36:39], a[8:11], v[100:103], 0
    v_mfma_f32_16x16x32_bf16 v[40:43], a[160:163], v[100:103], 0
    v_cvt_pk_bf16_f32 v48, v16, v18
    v_cvt_pk_bf16_f32 v49, v17, v19
    v_mfma_f32_16x16x32_bf16 v[44:47], a[168:171], v[100:103], 0
    s_waitcnt lgkmcnt(3)
    v_cvt_pk_bf16_f32 v50, v20, v22
    v_cvt_pk_bf16_f32 v51, v21, v23
    v_mfma_f32_16x16x32_bf16 v[32:35], a[4:7], v[104:107], v[32:35]
    ds_read_b128 v[100:103], v5 offset:25600
    buffer_store_dwordx4 v[48:51], v8, s[4:7], s22 offen sc1
    v_mfma_f32_16x16x32_bf16 v[36:39], a[12:15], v[104:107], v[36:39]
    v_mul_f32 v24, s33, v24
    v_mul_f32 v25, s33, v25
    v_mfma_f32_16x16x32_bf16 v[40:43], a[164:167], v[104:107], v[40:43]
    v_mul_f32 v26, s33, v26
    v_mul_f32 v27, s33, v27
    v_mfma_f32_16x16x32_bf16 v[44:47], a[172:175], v[104:107], v[44:47]
    s_waitcnt lgkmcnt(3)
    v_mul_f32 v28, s33, v28
    v_mul_f32 v29, s33, v29
    v_mfma_f32_16x16x32_bf16 v[32:35], a[16:19], v[108:111], v[32:35]
    ds_read_b128 v[104:107], v5 offset:26624
    v_mul_f32 v30, s33, v30
    v_mul_f32 v31, s33, v31
    v_mfma_f32_16x16x32_bf16 v[36:39], a[24:27], v[108:111], v[36:39]
    v_cvt_pk_bf16_f32 v52, v24, v26
    v_cvt_pk_bf16_f32 v53, v25, v27
    v_mfma_f32_16x16x32_bf16 v[40:43], a[176:179], v[108:111], v[40:43]
    v_cvt_pk_bf16_f32 v54, v28, v30
    v_cvt_pk_bf16_f32 v55, v29, v31
    v_mfma_f32_16x16x32_bf16 v[44:47], a[184:187], v[108:111], v[44:47]
    s_waitcnt lgkmcnt(3)
    buffer_store_dwordx4 v[52:55], v8, s[4:7], s23 offen sc1
    v_mfma_f32_16x16x32_bf16 v[32:35], a[20:23], v[112:115], v[32:35]
    ds_read_b128 v[108:111], v5 offset:27648
    s_add_u32 s22, s22, 4096
    s_add_u32 s23, s23, 4096
    v_mfma_f32_16x16x32_bf16 v[36:39], a[28:31], v[112:115], v[36:39]
    v_mfma_f32_16x16x32_bf16 v[40:43], a[180:183], v[112:115], v[40:43]
    v_mfma_f32_16x16x32_bf16 v[44:47], a[188:191], v[112:115], v[44:47]
    s_waitcnt lgkmcnt(3)
    v_mfma_f32_16x16x32_bf16 v[32:35], a[32:35], v[116:119], v[32:35]
    ds_read_b128 v[112:115], v5 offset:28672
    v_mfma_f32_16x16x32_bf16 v[36:39], a[40:43], v[116:119], v[36:39]
    v_mfma_f32_16x16x32_bf16 v[40:43], a[192:195], v[116:119], v[40:43]
    v_mfma_f32_16x16x32_bf16 v[44:47], a[200:203], v[116:119], v[44:47]
    s_waitcnt lgkmcnt(3)
    v_mfma_f32_16x16x32_bf16 v[32:35], a[36:39], v[100:103], v[32:35]
    ds_read_b128 v[116:119], v5 offset:29696
    v_mfma_f32_16x16x32_bf16 v[36:39], a[44:47], v[100:103], v[36:39]
    v_mfma_f32_16x16x32_bf16 v[40:43], a[196:199], v[100:103], v[40:43]
    v_mfma_f32_16x16x32_bf16 v[44:47], a[204:207], v[100:103], v[44:47]
    s_waitcnt lgkmcnt(3)
    v_mfma_f32_16x16x32_bf16 v[32:35], a[48:51], v[104:107], v[32:35]
    ds_read_b128 v[100:103], v5 offset:30720
    v_mfma_f32_16x16x32_bf16 v[36:39], a[56:59], v[104:107], v[36:39]
    v_mfma_f32_16x16x32_bf16 v[40:43], a[208:211], v[104:107], v[40:43]
    v_mfma_f32_16x16x32_bf16 v[44:47], a[216:219], v[104:107], v[44:47]
    s_waitcnt lgkmcnt(3)
    v_mfma_f32_16x16x32_bf16 v[32:35], a[52:55], v[108:111], v[32:35]
    ds_read_b128 v[104:107], v5 offset:31744
    v_mfma_f32_16x16x32_bf16 v[36:39], a[60:63], v[108:111], v[36:39]
    v_mfma_f32_16x16x32_bf16 v[40:43], a[212:215], v[108:111], v[40:43]
    v_mfma_f32_16x16x32_bf16 v[44:47], a[220:223], v[108:111], v[44:47]
    s_waitcnt lgkmcnt(3)
    v_mfma_f32_16x16x32_bf16 v[32:35], a[64:67], v[112:115], v[32:35]
    ds_read_b128 v[108:111], v5 offset:32768
    v_mfma_f32_16x16x32_bf16 v[36:39], a[72:75], v[112:115], v[36:39]
    v_mfma_f32_16x16x32_bf16 v[40:43], a[224:227], v[112:115], v[40:43]
    v_mfma_f32_16x16x32_bf16 v[44:47], a[232:235], v[112:115], v[44:47]
    s_waitcnt lgkmcnt(3)
    v_mfma_f32_16x16x32_bf16 v[32:35], a[68:71], v[116:119], v[32:35]
    ds_read_b128 v[112:115], v5 offset:33792
    v_mfma_f32_16x16x32_bf16 v[36:39], a[76:79], v[116:119], v[36:39]
    v_mfma_f32_16x16x32_bf16 v[40:43], a[228:231], v[116:119], v[40:43]
    v_mfma_f32_16x16x32_bf16 v[44:47], a[236:239], v[116:119], v[44:47]
    s_waitcnt lgkmcnt(3)
    v_mfma_f32_16x16x32_bf16 v[32:35], a[80:83], v[100:103], v[32:35]
    ds_read_b128 v[116:119], v5 offset:34816
    v_mfma_f32_16x16x32_bf16 v[36:39], a[88:91], v[100:103], v[36:39]
    v_mfma_f32_16x16x32_bf16 v[40:43], a[240:243], v[100:103], v[40:43]
    v_mfma_f32_16x16x32_bf16 v[44:47], a[248:251], v[100:103], v[44:47]
    s_waitcnt lgkmcnt(3)
    v_mfma_f32_16x16x32_bf16 v[32:35], a[84:87], v[104:107], v[32:35]
    ds_read_b128 v[100:103], v5 offset:35840
    v_mfma_f32_16x16x32_bf16 v[36:39], a[92:95], v[104:107], v[36:39]
    v_mfma_f32_16x16x32_bf16 v[40:43], a[244:247], v[104:107], v[40:43]
    v_mfma_f32_16x16x32_bf16 v[44:47], a[252:255], v[104:107], v[44:47]
    s_waitcnt lgkmcnt(3)
    v_mfma_f32_16x16x32_bf16 v[32:35], a[96:99], v[108:111], v[32:35]
    ds_read_b128 v[104:107], v5 offset:36864
    v_mfma_f32_16x16x32_bf16 v[36:39], a[104:107], v[108:111], v[36:39]
    v_mfma_f32_16x16x32_bf16 v[40:43], v[192:195], v[108:111], v[40:43]
    v_mfma_f32_16x16x32_bf16 v[44:47], v[200:203], v[108:111], v[44:47]
    s_waitcnt lgkmcnt(3)
    v_mfma_f32_16x16x32_bf16 v[32:35], a[100:103], v[112:115], v[32:35]
    ds_read_b128 v[108:111], v5 offset:37888
    v_mfma_f32_16x16x32_bf16 v[36:39], a[108:111], v[112:115], v[36:39]
    v_mfma_f32_16x16x32_bf16 v[40:43], v[196:199], v[112:115], v[40:43]
    v_mfma_f32_16x16x32_bf16 v[44:47], v[204:207], v[112:115], v[44:47]
    s_waitcnt lgkmcnt(3)
    v_mfma_f32_16x16x32_bf16 v[32:35], a[112:115], v[116:119], v[32:35]
    ds_read_b128 v[112:115], v5 offset:38912
    v_mfma_f32_16x16x32_bf16 v[36:39], a[120:123], v[116:119], v[36:39]
    v_mfma_f32_16x16x32_bf16 v[40:43], v[208:211], v[116:119], v[40:43]
    v_mfma_f32_16x16x32_bf16 v[44:47], v[216:219], v[116:119], v[44:47]
    s_waitcnt lgkmcnt(3)
    v_mfma_f32_16x16x32_bf16 v[32:35], a[116:119], v[100:103], v[32:35]
    ds_read_b128 v[116:119], v5 offset:39936
    v_mfma_f32_16x16x32_bf16 v[36:39], a[124:127], v[100:103], v[36:39]
    v_mfma_f32_16x16x32_bf16 v[40:43], v[212:215], v[100:103], v[40:43]
    s_waitcnt vmcnt(2)
    s_barrier
    buffer_store_dword v10, v9, s[8:11], 0 offen sc1
    v_mfma_f32_16x16x32_bf16 v[44:47], v[220:223], v[100:103], v[44:47]
    s_waitcnt lgkmcnt(3)
    v_mfma_f32_16x16x32_bf16 v[32:35], a[128:131], v[104:107], v[32:35]
    ds_read_b128 v[100:103], v2 offset:0
    v_mfma_f32_16x16x32_bf16 v[36:39], a[136:139], v[104:107], v[36:39]
    v_mfma_f32_16x16x32_bf16 v[40:43], v[224:227], v[104:107], v[40:43]
    v_mfma_f32_16x16x32_bf16 v[44:47], v[232:235], v[104:107], v[44:47]
    s_waitcnt lgkmcnt(3)
    v_mfma_f32_16x16x32_bf16 v[32:35], a[132:135], v[108:111], v[32:35]
    ds_read_b128 v[104:107], v2 offset:1024
    v_mfma_f32_16x16x32_bf16 v[36:39], a[140:143], v[108:111], v[36:39]
    v_mfma_f32_16x16x32_bf16 v[40:43], v[228:231], v[108:111], v[40:43]
    v_mfma_f32_16x16x32_bf16 v[44:47], v[236:239], v[108:111], v[44:47]
    s_waitcnt lgkmcnt(3)
    v_mfma_f32_16x16x32_bf16 v[32:35], a[144:147], v[112:115], v[32:35]
    ds_read_b128 v[108:111], v2 offset:2048
    v_mfma_f32_16x16x32_bf16 v[36:39], a[152:155], v[112:115], v[36:39]
    v_mfma_f32_16x16x32_bf16 v[40:43], v[240:243], v[112:115], v[40:43]
    v_mfma_f32_16x16x32_bf16 v[44:47], v[248:251], v[112:115], v[44:47]
    s_waitcnt lgkmcnt(3)
    v_mfma_f32_16x16x32_bf16 v[32:35], a[148:151], v[116:119], v[32:35]
    ds_read_b128 v[112:115], v2 offset:3072
    v_mfma_f32_16x16x32_bf16 v[36:39], a[156:159], v[116:119], v[36:39]
    v_mfma_f32_16x16x32_bf16 v[40:43], v[244:247], v[116:119], v[40:43]
    s_mov_b32 s16, s43
    s_cmp_lt_u32 s16, s50
    v_mfma_f32_16x16x32_bf16 v[44:47], v[252:255], v[116:119], v[44:47]
    s_cbranch_scc1 L_qkx_loop
    s_nop 7
    s_waitcnt lgkmcnt(0)
    v_cvt_pk_bf16_f32 v48, v32, v34
    v_cvt_pk_bf16_f32 v49, v33, v35
    v_cvt_pk_bf16_f32 v50, v36, v38
    v_cvt_pk_bf16_f32 v51, v37, v39
    buffer_store_dwordx4 v[48:51], v3, s[4:7], s22 offen sc1
    v_mul_f32 v40, s33, v40
    v_mul_f32 v41, s33, v41
    v_mul_f32 v42, s33, v42
    v_mul_f32 v43, s33, v43
    v_mul_f32 v44, s33, v44
    v_mul_f32 v45, s33, v45
    v_mul_f32 v46, s33, v46
    v_mul_f32 v47, s33, v47
    v_cvt_pk_bf16_f32 v52, v40, v42
    v_cvt_pk_bf16_f32 v53, v41, v43
    v_cvt_pk_bf16_f32 v54, v44, v46
    v_cvt_pk_bf16_f32 v55, v45, v47
    buffer_store_dwordx4 v[52:55], v3, s[4:7], s23 offen sc1
    s_add_u32 s22, s22, 4096
    s_add_u32 s23, s23, 4096
    s_cmp_lt_u32 s16, 4
    s_cselect_b32 s50, 0, 64
    s_sub_u32 s20, s16, 1
    s_cmp_lt_u32 s16, 64
    s_cselect_b32 s20, s20, 64
    v_mov_b32 v10, s20
    s_waitcnt vmcnt(0)
    s_barrier
    buffer_store_dword v10, v9, s[8:11], 0 offen sc1
    v_mov_b32 v3, 0x40000000
    s_cbranch_scc1 L_qkx_loop
    s_branch L_x_done
L_x_vox:
    v_and_b32 v1, 63, v0
    v_lshrrev_b32 v2, 6, v0
    s_nop 0
    v_readfirstlane_b32 s18, v2
    v_and_b32 v12, 15, v1
    v_lshrrev_b32 v13, 4, v1
    v_lshlrev_b32 v4, 4, v1
    v_mov_b32 v11, -1
    s_mov_b32 s31, 0x05040100
    s_mov_b32 s32, 0x07060302
    v_lshlrev_b32 v10, 16, v13
    v_lshl_add_u32 v10, v12, 2, v10
    s_lshl_b32 s20, s17, 8
    s_lshl_b32 s21, s18, 6
    s_add_u32 s20, s20, s21
    v_add_u32 v10, s20, v10
    v_mov_b32 v9, v10
    v_mul_u32_u24 v10, 10240, v13
    v_lshl_add_u32 v10, v12, 2, v10
    s_mul_i32 s20, s17, 163840
    s_mul_i32 s21, s18, 320
    s_add_u32 s20, s20, s21
    v_add_u32 v10, s20, v10
    s_load_dwordx2 s[12:13], s[0:1], 32
    s_mov_b32 s14, 5242880
    s_mov_b32 s15, 0x20000
    s_waitcnt lgkmcnt(0)
    s_load_dwordx2 s[92:93], s[0:1], 40
    s_mov_b32 s94, 5242880
    s_mov_b32 s95, 0x20000
    s_waitcnt lgkmcnt(0)
    s_mov_b32 s40, 0
    s_and_b32 s20, s17, 3
    s_lshr_b32 s21, s20, 1
    s_sub_u32 s21, s20, s21
    s_lshl_b32 s21, s21, 1
    s_and_b32 s22, s16, 1
    s_add_u32 s21, s21, s22
    s_lshl_b32 s21, s21, 2
    s_add_u32 s21, s21, s18
    s_mul_i32 s21, s21, 81920
    s_and_b32 s22, s17, 28
    s_lshl_b32 s22, s22, 8
    s_add_u32 s21, s21, s22
    s_add_u32 s21, s21, 3277056
    s_cmp_eq_u32 s20, 1
    s_cselect_b32 s21, 0x40000000, s21
    v_lshrrev_b32 v184, 1, v1
    v_lshlrev_b32 v184, 13, v184
    v_and_b32 v185, 1, v1
    v_lshl_add_u32 v184, v185, 7, v184
    v_add_u32 v184, s21, v184
    v_cmp_gt_u32 vcc, 20, v1
    v_mov_b32 v185, 0x40000000
    s_nop 0
    v_cndmask_b32 v184, v185, v184, vcc
    s_bitcmp1_b32 s16, 0
    s_cbranch_scc0 rev_5_a
    v_bfe_u32 v160, v1, 2, 2
    v_lshlrev_b32 v160, 6, v160
    v_and_b32 v161, 3, v1
    v_lshl_add_u32 v160, v161, 4, v160
    v_bfe_u32 v161, v1, 4, 1
    v_lshrrev_b32 v162, 5, v1
    ds_bpermute_b32 v164, v160, v9
    v_mul_u32_u24 v163, 8192, v161
    v_mul_u32_u24 v170, 16384, v162
    s_waitcnt lgkmcnt(0)
    v_add3_u32 v164, v164, v163, v170
    ds_bpermute_b32 v165, v160, v10
    v_mul_u32_u24 v163, 2560, v161
    v_mul_u32_u24 v170, 1280, v162
    s_waitcnt lgkmcnt(0)
    v_add3_u32 v165, v165, v163, v170
    s_mul_i32 s29, s18, 20480
    s_add_u32 s29, s29, 40960
    v_lshl_add_u32 v170, v1, 2, s29
    s_add_u32 m0, s29, 0
    s_mov_b32 s30, 1310720
    buffer_load_dwordx4 v164, s[12:15], s30 offen lds
    s_add_u32 m0, s29, 1024
    s_mov_b32 s30, 1343488
    buffer_load_dwordx4 v164, s[12:15], s30 offen lds
    s_add_u32 m0, s29, 2048
    s_mov_b32 s30, 1572864
    buffer_load_dwordx4 v164, s[12:15], s30 offen lds
    s_add_u32 m0, s29, 3072
    s_mov_b32 s30, 1605632
    buffer_load_dwordx4 v164, s[12:15], s30 offen lds
    s_add_u32 m0, s29, 4096
    s_mov_b32 s30, 1835008
    buffer_load_dwordx4 v164, s[12:15], s30 offen lds
    s_add_u32 m0, s29, 5120
    s_mov_b32 s30, 1867776
    buffer_load_dwordx4 v164, s[12:15], s30 offen lds
    s_add_u32 m0, s29, 6144
    s_mov_b32 s30, 2097152
    buffer_load_dwordx4 v164, s[12:15], s30 offen lds
    s_add_u32 m0, s29, 7168
    s_mov_b32 s30, 2129920
    buffer_load_dwordx4 v164, s[12:15], s30 offen lds
    s_add_u32 m0, s29, 8192
    s_mov_b32 s30, 2359296
    buffer_load_dwordx4 v164, s[12:15], s30 offen lds
    s_add_u32 m0, s29, 9216
    s_mov_b32 s30, 2392064
    buffer_load_dwordx4 v164, s[12:15], s30 offen lds
    s_add_u32 m0, s29, 10240
    s_mov_b32 s30, 0
    buffer_load_dwordx4 v164, s[12:15], s30 offen lds
    s_add_u32 m0, s29, 11264
    s_mov_b32 s30, 32768
    buffer_load_dwordx4 v164, s[12:15], s30 offen lds
    s_add_u32 m0, s29, 12288
    s_mov_b32 s30, 262144
    buffer_load_dwordx4 v164, s[12:15], s30 offen lds
    s_add_u32 m0, s29, 13312
    s_mov_b32 s30, 294912
    buffer_load_dwordx4 v164, s[12:15], s30 offen lds
    s_add_u32 m0, s29, 14336
    s_mov_b32 s30, 524288
    buffer_load_dwordx4 v164, s[12:15], s30 offen lds
    s_add_u32 m0, s29, 15360
    s_mov_b32 s30, 557056
    buffer_load_dwordx4 v164, s[12:15], s30 offen lds
    s_add_u32 m0, s29, 16384
    s_mov_b32 s30, 786432
    buffer_load_dwordx4 v164, s[12:15], s30 offen lds
    s_add_u32 m0, s29, 17408
    s_mov_b32 s30, 819200
    buffer_load_dwordx4 v164, s[12:15], s30 offen lds
    s_add_u32 m0, s29, 18432
    s_mov_b32 s30, 1048576
    buffer_load_dwordx4 v164, s[12:15], s30 offen lds
    s_add_u32 m0, s29, 19456
    s_mov_b32 s30, 1081344
    buffer_load_dwordx4 v164, s[12:15], s30 offen lds
    s_waitcnt vmcnt(16)
    ds_read2st64_b32 v[128:129], v170 offset0:0 offset1:1
    ds_read2st64_b32 v[130:131], v170 offset0:2 offset1:3
    ds_read2st64_b32 v[132:133], v170 offset0:4 offset1:5
    ds_read2st64_b32 v[134:135], v170 offset0:6 offset1:7
    ds_read2st64_b32 v[136:137], v170 offset0:8 offset1:9
    ds_read2st64_b32 v[138:139], v170 offset0:10 offset1:11
    ds_read2st64_b32 v[140:141], v170 offset0:12 offset1:13
    ds_read2st64_b32 v[142:143], v170 offset0:14 offset1:15
    s_waitcnt lgkmcnt(0)
    s_add_u32 m0, s29, 0
    s_mov_b32 s30, 3932160
    buffer_load_dwordx4 v164, s[12:15], s30 offen lds
    s_add_u32 m0, s29, 1024
    s_mov_b32 s30, 3964928
    buffer_load_dwordx4 v164, s[12:15], s30 offen lds
    s_add_u32 m0, s29, 2048
    s_mov_b32 s30, 4194304
    buffer_load_dwordx4 v164, s[12:15], s30 offen lds
    s_add_u32 m0, s29, 3072
    s_mov_b32 s30, 4227072
    buffer_load_dwordx4 v164, s[12:15], s30 offen lds
    s_waitcnt vmcnt(16)
    ds_read2st64_b32 v[144:145], v170 offset0:16 offset1:17
    ds_read2st64_b32 v[146:147], v170 offset0:18 offset1:19
    ds_read2st64_b32 v[148:149], v170 offset0:20 offset1:21
    ds_read2st64_b32 v[150:151], v170 offset0:22 offset1:23
    ds_read2st64_b32 v[152:153], v170 offset0:24 offset1:25
    ds_read2st64_b32 v[154:155], v170 offset0:26 offset1:27
    ds_read2st64_b32 v[156:157], v170 offset0:28 offset1:29
    ds_read2st64_b32 v[158:159], v170 offset0:30 offset1:31
    v_perm_b32 v120, v129, v128, s31
    v_accvgpr_write_b32 a36, v120
    v_perm_b32 v121, v129, v128, s32
    v_accvgpr_write_b32 a44, v121
    v_perm_b32 v122, v131, v130, s31
    v_accvgpr_write_b32 a37, v122
    v_perm_b32 v123, v131, v130, s32
    v_accvgpr_write_b32 a45, v123
    v_perm_b32 v124, v133, v132, s31
    v_accvgpr_write_b32 a38, v124
    v_perm_b32 v125, v133, v132, s32
    v_accvgpr_write_b32 a46, v125
    v_perm_b32 v126, v135, v134, s31
    v_accvgpr_write_b32 a39, v126
    v_perm_b32 v127, v135, v134, s32
    v_accvgpr_write_b32 a47, v127
    v_perm_b32 v120, v137, v136, s31
    v_accvgpr_write_b32 a48, v120
    v_perm_b32 v121, v137, v136, s32
    v_accvgpr_write_b32 a56, v121
    v_perm_b32 v122, v139, v138, s31
    v_accvgpr_write_b32 a49, v122
    v_perm_b32 v123, v139, v138, s32
    v_accvgpr_write_b32 a57, v123
    v_perm_b32 v124, v141, v140, s31
    v_accvgpr_write_b32 a50, v124
    v_perm_b32 v125, v141, v140, s32
    v_accvgpr_write_b32 a58, v125
    v_perm_b32 v126, v143, v142, s31
    v_accvgpr_write_b32 a51, v126
    v_perm_b32 v127, v143, v142, s32
    v_accvgpr_write_b32 a59, v127
    s_waitcnt lgkmcnt(0)
    s_add_u32 m0, s29, 4096
    s_mov_b32 s30, 4456448
    buffer_load_dwordx4 v164, s[12:15], s30 offen lds
    s_add_u32 m0, s29, 5120
    s_mov_b32 s30, 4489216
    buffer_load_dwordx4 v164, s[12:15], s30 offen lds
    s_add_u32 m0, s29, 6144
    s_mov_b32 s30, 4718592
    buffer_load_dwordx4 v164, s[12:15], s30 offen lds
    s_add_u32 m0, s29, 7168
    s_mov_b32 s30, 4751360
    buffer_load_dwordx4 v164, s[12:15], s30 offen lds
    buffer_load_dword v185, v184, s[12:15], 0 offen
    s_waitcnt vmcnt(17)
    ds_read2st64_b32 v[128:129], v170 offset0:32 offset1:33
    ds_read2st64_b32 v[130:131], v170 offset0:34 offset1:35
    ds_read2st64_b32 v[132:133], v170 offset0:36 offset1:37
    ds_read2st64_b32 v[134:135], v170 offset0:38 offset1:39
    ds_read2st64_b32 v[136:137], v170 offset0:40 offset1:41
    ds_read2st64_b32 v[138:139], v170 offset0:42 offset1:43
    ds_read2st64_b32 v[140:141], v170 offset0:44 offset1:45
    ds_read2st64_b32 v[142:143], v170 offset0:46 offset1:47
    v_perm_b32 v120, v145, v144, s31
    v_accvgpr_write_b32 a52, v120
    v_perm_b32 v121, v145, v144, s32
    v_accvgpr_write_b32 a60, v121
    v_perm_b32 v122, v147, v146, s31
    v_accvgpr_write_b32 a53, v122
    v_perm_b32 v123, v147, v146, s32
    v_accvgpr_write_b32 a61, v123
    v_perm_b32 v124, v149, v148, s31
    v_accvgpr_write_b32 a54, v124
    v_perm_b32 v125, v149, v148, s32
    v_accvgpr_write_b32 a62, v125
    v_perm_b32 v126, v151, v150, s31
    v_accvgpr_write_b32 a55, v126
    v_perm_b32 v127, v151, v150, s32
    v_accvgpr_write_b32 a63, v127
    v_perm_b32 v120, v153, v152, s31
    v_accvgpr_write_b32 a64, v120
    v_perm_b32 v121, v153, v152, s32
    v_accvgpr_write_b32 a72, v121
    v_perm_b32 v122, v155, v154, s31
    v_accvgpr_write_b32 a65, v122
    v_perm_b32 v123, v155, v154, s32
    v_accvgpr_write_b32 a73, v123
    v_perm_b32 v124, v157, v156, s31
    v_accvgpr_write_b32 a66, v124
    v_perm_b32 v125, v157, v156, s32
    v_accvgpr_write_b32 a74, v125
    v_perm_b32 v126, v159, v158, s31
    v_accvgpr_write_b32 a67, v126
    v_perm_b32 v127, v159, v158, s32
    v_accvgpr_write_b32 a75, v127
    s_waitcnt lgkmcnt(0)
    s_add_u32 m0, s29, 8192
    s_mov_b32 s30, 4980736
    buffer_load_dwordx4 v164, s[12:15], s30 offen lds
    s_add_u32 m0, s29, 9216
    s_mov_b32 s30, 5013504
    buffer_load_dwordx4 v164, s[12:15], s30 offen lds
    s_add_u32 m0, s29, 10240
    s_mov_b32 s30, 2621440
    buffer_load_dwordx4 v164, s[12:15], s30 offen lds
    s_add_u32 m0, s29, 11264
    s_mov_b32 s30, 2654208
    buffer_load_dwordx4 v164, s[12:15], s30 offen lds
    s_waitcnt vmcnt(17)
    ds_read2st64_b32 v[144:145], v170 offset0:48 offset1:49
    ds_read2st64_b32 v[146:147], v170 offset0:50 offset1:51
    ds_read2st64_b32 v[148:149], v170 offset0:52 offset1:53
    ds_read2st64_b32 v[150:151], v170 offset0:54 offset1:55
    ds_read2st64_b32 v[152:153], v170 offset0:56 offset1:57
    ds_read2st64_b32 v[154:155], v170 offset0:58 offset1:59
    ds_read2st64_b32 v[156:157], v170 offset0:60 offset1:61
    ds_read2st64_b32 v[158:159], v170 offset0:62 offset1:63
    v_perm_b32 v120, v129, v128, s31
    v_accvgpr_write_b32 a68, v120
    v_perm_b32 v121, v129, v128, s32
    v_accvgpr_write_b32 a76, v121
    v_perm_b32 v122, v131, v130, s31
    v_accvgpr_write_b32 a69, v122
    v_perm_b32 v123, v131, v130, s32
    v_accvgpr_write_b32 a77, v123
    v_perm_b32 v124, v133, v132, s31
    v_accvgpr_write_b32 a70, v124
    v_perm_b32 v125, v133, v132, s32
    v_accvgpr_write_b32 a78, v125
    v_perm_b32 v126, v135, v134, s31
    v_accvgpr_write_b32 a71, v126
    v_perm_b32 v127, v135, v134, s32
    v_accvgpr_write_b32 a79, v127
    v_perm_b32 v120, v137, v136, s31
    v_accvgpr_write_b32 a0, v120
    v_perm_b32 v121, v137, v136, s32
    v_accvgpr_write_b32 a8, v121
    v_perm_b32 v122, v139, v138, s31
    v_accvgpr_write_b32 a1, v122
    v_perm_b32 v123, v139, v138, s32
    v_accvgpr_write_b32 a9, v123
    v_perm_b32 v124, v141, v140, s31
    v_accvgpr_write_b32 a2, v124
    v_perm_b32 v125, v141, v140, s32
    v_accvgpr_write_b32 a10, v125
    v_perm_b32 v126, v143, v142, s31
    v_accvgpr_write_b32 a3, v126
    v_perm_b32 v127, v143, v142, s32
    v_accvgpr_write_b32 a11, v127
    s_waitcnt lgkmcnt(0)
    s_add_u32 m0, s29, 12288
    s_mov_b32 s30, 2883584
    buffer_load_dwordx4 v164, s[12:15], s30 offen lds
    s_add_u32 m0, s29, 13312
    s_mov_b32 s30, 2916352
    buffer_load_dwordx4 v164, s[12:15], s30 offen lds
    s_add_u32 m0, s29, 14336
    s_mov_b32 s30, 3145728
    buffer_load_dwordx4 v164, s[12:15], s30 offen lds
    s_add_u32 m0, s29, 15360
    s_mov_b32 s30, 3178496
    buffer_load_dwordx4 v164, s[12:15], s30 offen lds
    s_waitcnt vmcnt(17)
    ds_read2st64_b32 v[128:129], v170 offset0:64 offset1:65
    ds_read2st64_b32 v[130:131], v170 offset0:66 offset1:67
    ds_read2st64_b32 v[132:133], v170 offset0:68 offset1:69
    ds_read2st64_b32 v[134:135], v170 offset0:70 offset1:71
    ds_read2st64_b32 v[136:137], v170 offset0:72 offset1:73
    ds_read2st64_b32 v[138:139], v170 offset0:74 offset1:75
    ds_read2st64_b32 v[140:141], v170 offset0:76 offset1:77
    ds_read2st64_b32 v[142:143], v170 offset0:78 offset1:79
    v_perm_b32 v120, v145, v144, s31
    v_accvgpr_write_b32 a4, v120
    v_perm_b32 v121, v145, v144, s32
    v_accvgpr_write_b32 a12, v121
    v_perm_b32 v122, v147, v146, s31
    v_accvgpr_write_b32 a5, v122
    v_perm_b32 v123, v147, v146, s32
    v_accvgpr_write_b32 a13, v123
    v_perm_b32 v124, v149, v148, s31
    v_accvgpr_write_b32 a6, v124
    v_perm_b32 v125, v149, v148, s32
    v_accvgpr_write_b32 a14, v125
    v_perm_b32 v126, v151, v150, s31
    v_accvgpr_write_b32 a7, v126
    v_perm_b32 v127, v151, v150, s32
    v_accvgpr_write_b32 a15, v127
    v_perm_b32 v120, v153, v152, s31
    v_accvgpr_write_b32 a16, v120
    v_perm_b32 v121, v153, v152, s32
    v_accvgpr_write_b32 a24, v121
    v_perm_b32 v122, v155, v154, s31
    v_accvgpr_write_b32 a17, v122
    v_perm_b32 v123, v155, v154, s32
    v_accvgpr_write_b32 a25, v123
    v_perm_b32 v124, v157, v156, s31
    v_accvgpr_write_b32 a18, v124
    v_perm_b32 v125, v157, v156, s32
    v_accvgpr_write_b32 a26, v125
    v_perm_b32 v126, v159, v158, s31
    v_accvgpr_write_b32 a19, v126
    v_perm_b32 v127, v159, v158, s32
    v_accvgpr_write_b32 a27, v127
    s_waitcnt lgkmcnt(0)
    s_add_u32 m0, s29, 16384
    s_mov_b32 s30, 3407872
    buffer_load_dwordx4 v164, s[12:15], s30 offen lds
    s_add_u32 m0, s29, 17408
    s_mov_b32 s30, 3440640
    buffer_load_dwordx4 v164, s[12:15], s30 offen lds
    s_add_u32 m0, s29, 18432
    s_mov_b32 s30, 3670016
    buffer_load_dwordx4 v164, s[12:15], s30 offen lds
    s_add_u32 m0, s29, 19456
    s_mov_b32 s30, 3702784
    buffer_load_dwordx4 v164, s[12:15], s30 offen lds
    s_waitcnt vmcnt(17)
    ds_read2st64_b32 v[144:145], v170 offset0:0 offset1:1
    ds_read2st64_b32 v[146:147], v170 offset0:2 offset1:3
    ds_read2st64_b32 v[148:149], v170 offset0:4 offset1:5
    ds_read2st64_b32 v[150:151], v170 offset0:6 offset1:7
    ds_read2st64_b32 v[152:153], v170 offset0:8 offset1:9
    ds_read2st64_b32 v[154:155], v170 offset0:10 offset1:11
    ds_read2st64_b32 v[156:157], v170 offset0:12 offset1:13
    ds_read2st64_b32 v[158:159], v170 offset0:14 offset1:15
    v_perm_b32 v120, v129, v128, s31
    v_accvgpr_write_b32 a20, v120
    v_perm_b32 v121, v129, v128, s32
    v_accvgpr_write_b32 a28, v121
    v_perm_b32 v122, v131, v130, s31
    v_accvgpr_write_b32 a21, v122
    v_perm_b32 v123, v131, v130, s32
    v_accvgpr_write_b32 a29, v123
    v_perm_b32 v124, v133, v132, s31
    v_accvgpr_write_b32 a22, v124
    v_perm_b32 v125, v133, v132, s32
    v_accvgpr_write_b32 a30, v125
    v_perm_b32 v126, v135, v134, s31
    v_accvgpr_write_b32 a23, v126
    v_perm_b32 v127, v135, v134, s32
    v_accvgpr_write_b32 a31, v127
    v_perm_b32 v120, v137, v136, s31
    v_accvgpr_write_b32 a32, v120
    v_perm_b32 v121, v137, v136, s32
    v_accvgpr_write_b32 a40, v121
    v_perm_b32 v122, v139, v138, s31
    v_accvgpr_write_b32 a33, v122
    v_perm_b32 v123, v139, v138, s32
    v_accvgpr_write_b32 a41, v123
    v_perm_b32 v124, v141, v140, s31
    v_accvgpr_write_b32 a34, v124
    v_perm_b32 v125, v141, v140, s32
    v_accvgpr_write_b32 a42, v125
    v_perm_b32 v126, v143, v142, s31
    v_accvgpr_write_b32 a35, v126
    v_perm_b32 v127, v143, v142, s32
    v_accvgpr_write_b32 a43, v127
    s_waitcnt lgkmcnt(0)
    s_add_u32 m0, s29, 0
    s_mov_b32 s30, 40960
    buffer_load_dwordx4 v165, s[92:95], s30 offen lds
    s_add_u32 m0, s29, 1024
    s_mov_b32 s30, 41024
    buffer_load_dwordx4 v165, s[92:95], s30 offen lds
    s_add_u32 m0, s29, 2048
    s_mov_b32 s30, 41088
    buffer_load_dwordx4 v165, s[92:95], s30 offen lds
    s_add_u32 m0, s29, 3072
    s_mov_b32 s30, 41152
    buffer_load_dwordx4 v165, s[92:95], s30 offen lds
    s_waitcnt vmcnt(17)
    ds_read2st64_b32 v[128:129], v170 offset0:16 offset1:17
    ds_read2st64_b32 v[130:131], v170 offset0:18 offset1:19
    ds_read2st64_b32 v[132:133], v170 offset0:20 offset1:21
    ds_read2st64_b32 v[134:135], v170 offset0:22 offset1:23
    ds_read2st64_b32 v[136:137], v170 offset0:24 offset1:25
    ds_read2st64_b32 v[138:139], v170 offset0:26 offset1:27
    ds_read2st64_b32 v[140:141], v170 offset0:28 offset1:29
    ds_read2st64_b32 v[142:143], v170 offset0:30 offset1:31
    v_perm_b32 v120, v145, v144, s31
    v_accvgpr_write_b32 a116, v120
    v_perm_b32 v121, v145, v144, s32
    v_accvgpr_write_b32 a124, v121
    v_perm_b32 v122, v147, v146, s31
    v_accvgpr_write_b32 a117, v122
    v_perm_b32 v123, v147, v146, s32
    v_accvgpr_write_b32 a125, v123
    v_perm_b32 v124, v149, v148, s31
    v_accvgpr_write_b32 a118, v124
    v_perm_b32 v125, v149, v148, s32
    v_accvgpr_write_b32 a126, v125
    v_perm_b32 v126, v151, v150, s31
    v_accvgpr_write_b32 a119, v126
    v_perm_b32 v127, v151, v150, s32
    v_accvgpr_write_b32 a127, v127
    v_perm_b32 v120, v153, v152, s31
    v_accvgpr_write_b32 a128, v120
    v_perm_b32 v121, v153, v152, s32
    v_accvgpr_write_b32 a136, v121
    v_perm_b32 v122, v155, v154, s31
    v_accvgpr_write_b32 a129, v122
    v_perm_b32 v123, v155, v154, s32
    v_accvgpr_write_b32 a137, v123
    v_perm_b32 v124, v157, v156, s31
    v_accvgpr_write_b32 a130, v124
    v_perm_b32 v125, v157, v156, s32
    v_accvgpr_write_b32 a138, v125
    v_perm_b32 v126, v159, v158, s31
    v_accvgpr_write_b32 a131, v126
    v_perm_b32 v127, v159, v158, s32
    v_accvgpr_write_b32 a139, v127
    s_waitcnt lgkmcnt(0)
    s_add_u32 m0, s29, 4096
    s_mov_b32 s30, 41216
    buffer_load_dwordx4 v165, s[92:95], s30 offen lds
    s_add_u32 m0, s29, 5120
    s_mov_b32 s30, 46080
    buffer_load_dwordx4 v165, s[92:95], s30 offen lds
    s_add_u32 m0, s29, 6144
    s_mov_b32 s30, 46144
    buffer_load_dwordx4 v165, s[92:95], s30 offen lds
    s_add_u32 m0, s29, 7168
    s_mov_b32 s30, 46208
    buffer_load_dwordx4 v165, s[92:95], s30 offen lds
    s_waitcnt vmcnt(16)
    ds_read2st64_b32 v[144:145], v170 offset0:32 offset1:33
    ds_read2st64_b32 v[146:147], v170 offset0:34 offset1:35
    ds_read2st64_b32 v[148:149], v170 offset0:36 offset1:37
    ds_read2st64_b32 v[150:151], v170 offset0:38 offset1:39
    ds_read2st64_b32 v[152:153], v170 offset0:40 offset1:41
    ds_read2st64_b32 v[154:155], v170 offset0:42 offset1:43
    ds_read2st64_b32 v[156:157], v170 offset0:44 offset1:45
    ds_read2st64_b32 v[158:159], v170 offset0:46 offset1:47
    v_perm_b32 v120, v129, v128, s31
    v_accvgpr_write_b32 a132, v120
    v_perm_b32 v121, v129, v128, s32
    v_accvgpr_write_b32 a140, v121
    v_perm_b32 v122, v131, v130, s31
    v_accvgpr_write_b32 a133, v122
    v_perm_b32 v123, v131, v130, s32
    v_accvgpr_write_b32 a141, v123
    v_perm_b32 v124, v133, v132, s31
    v_accvgpr_write_b32 a134, v124
    v_perm_b32 v125, v133, v132, s32
    v_accvgpr_write_b32 a142, v125
    v_perm_b32 v126, v135, v134, s31
    v_accvgpr_write_b32 a135, v126
    v_perm_b32 v127, v135, v134, s32
    v_accvgpr_write_b32 a143, v127
    v_perm_b32 v120, v137, v136, s31
    v_accvgpr_write_b32 a144, v120
    v_perm_b32 v121, v137, v136, s32
    v_accvgpr_write_b32 a152, v121
    v_perm_b32 v122, v139, v138, s31
    v_accvgpr_write_b32 a145, v122
    v_perm_b32 v123, v139, v138, s32
    v_accvgpr_write_b32 a153, v123
    v_perm_b32 v124, v141, v140, s31
    v_accvgpr_write_b32 a146, v124
    v_perm_b32 v125, v141, v140, s32
    v_accvgpr_write_b32 a154, v125
    v_perm_b32 v126, v143, v142, s31
    v_accvgpr_write_b32 a147, v126
    v_perm_b32 v127, v143, v142, s32
    v_accvgpr_write_b32 a155, v127
    s_waitcnt lgkmcnt(0)
    s_add_u32 m0, s29, 8192
    s_mov_b32 s30, 46272
    buffer_load_dwordx4 v165, s[92:95], s30 offen lds
    s_add_u32 m0, s29, 9216
    s_mov_b32 s30, 46336
    buffer_load_dwordx4 v165, s[92:95], s30 offen lds
    s_add_u32 m0, s29, 10240
    s_mov_b32 s30, 0
    buffer_load_dwordx4 v165, s[92:95], s30 offen lds
    s_add_u32 m0, s29, 11264
    s_mov_b32 s30, 64
    buffer_load_dwordx4 v165, s[92:95], s30 offen lds
    s_waitcnt vmcnt(16)
    ds_read2st64_b32 v[128:129], v170 offset0:48 offset1:49
    ds_read2st64_b32 v[130:131], v170 offset0:50 offset1:51
    ds_read2st64_b32 v[132:133], v170 offset0:52 offset1:53
    ds_read2st64_b32 v[134:135], v170 offset0:54 offset1:55
    ds_read2st64_b32 v[136:137], v170 offset0:56 offset1:57
    ds_read2st64_b32 v[138:139], v170 offset0:58 offset1:59
    ds_read2st64_b32 v[140:141], v170 offset0:60 offset1:61
    ds_read2st64_b32 v[142:143], v170 offset0:62 offset1:63
    v_perm_b32 v120, v145, v144, s31
    v_accvgpr_write_b32 a148, v120
    v_perm_b32 v121, v145, v144, s32
    v_accvgpr_write_b32 a156, v121
    v_perm_b32 v122, v147, v146, s31
    v_accvgpr_write_b32 a149, v122
    v_perm_b32 v123, v147, v146, s32
    v_accvgpr_write_b32 a157, v123
    v_perm_b32 v124, v149, v148, s31
    v_accvgpr_write_b32 a150, v124
    v_perm_b32 v125, v149, v148, s32
    v_accvgpr_write_b32 a158, v125
    v_perm_b32 v126, v151, v150, s31
    v_accvgpr_write_b32 a151, v126
    v_perm_b32 v127, v151, v150, s32
    v_accvgpr_write_b32 a159, v127
    v_perm_b32 v120, v153, v152, s31
    v_accvgpr_write_b32 a80, v120
    v_perm_b32 v121, v153, v152, s32
    v_accvgpr_write_b32 a88, v121
    v_perm_b32 v122, v155, v154, s31
    v_accvgpr_write_b32 a81, v122
    v_perm_b32 v123, v155, v154, s32
    v_accvgpr_write_b32 a89, v123
    v_perm_b32 v124, v157, v156, s31
    v_accvgpr_write_b32 a82, v124
    v_perm_b32 v125, v157, v156, s32
    v_accvgpr_write_b32 a90, v125
    v_perm_b32 v126, v159, v158, s31
    v_accvgpr_write_b32 a83, v126
    v_perm_b32 v127, v159, v158, s32
    v_accvgpr_write_b32 a91, v127
    s_waitcnt lgkmcnt(0)
    s_add_u32 m0, s29, 12288
    s_mov_b32 s30, 128
    buffer_load_dwordx4 v165, s[92:95], s30 offen lds
    s_add_u32 m0, s29, 13312
    s_mov_b32 s30, 192
    buffer_load_dwordx4 v165, s[92:95], s30 offen lds
    s_add_u32 m0, s29, 14336
    s_mov_b32 s30, 256
    buffer_load_dwordx4 v165, s[92:95], s30 offen lds
    s_add_u32 m0, s29, 15360
    s_mov_b32 s30, 5120
    buffer_load_dwordx4 v165, s[92:95], s30 offen lds
    buffer_load_dword v171, off, s[88:91], 0 offset:128 sc1
    s_waitcnt vmcnt(17)
    ds_read2st64_b32 v[144:145], v170 offset0:64 offset1:65
    ds_read2st64_b32 v[146:147], v170 offset0:66 offset1:67
    ds_read2st64_b32 v[148:149], v170 offset0:68 offset1:69
    ds_read2st64_b32 v[150:151], v170 offset0:70 offset1:71
    ds_read2st64_b32 v[152:153], v170 offset0:72 offset1:73
    ds_read2st64_b32 v[154:155], v170 offset0:74 offset1:75
    ds_read2st64_b32 v[156:157], v170 offset0:76 offset1:77
    ds_read2st64_b32 v[158:159], v170 offset0:78 offset1:79
    v_perm_b32 v120, v129, v128, s31
    v_accvgpr_write_b32 a84, v120
    v_perm_b32 v121, v129, v128, s32
    v_accvgpr_write_b32 a92, v121
    v_perm_b32 v122, v131, v130, s31
    v_accvgpr_write_b32 a85, v122
    v_perm_b32 v123, v131, v130, s32
    v_accvgpr_write_b32 a93, v123
    v_perm_b32 v124, v133, v132, s31
    v_accvgpr_write_b32 a86, v124
    v_perm_b32 v125, v133, v132, s32
    v_accvgpr_write_b32 a94, v125
    v_perm_b32 v126, v135, v134, s31
    v_accvgpr_write_b32 a87, v126
    v_perm_b32 v127, v135, v134, s32
    v_accvgpr_write_b32 a95, v127
    v_perm_b32 v120, v137, v136, s31
    v_accvgpr_write_b32 a96, v120
    v_perm_b32 v121, v137, v136, s32
    v_accvgpr_write_b32 a104, v121
    v_perm_b32 v122, v139, v138, s31
    v_accvgpr_write_b32 a97, v122
    v_perm_b32 v123, v139, v138, s32
    v_accvgpr_write_b32 a105, v123
    v_perm_b32 v124, v141, v140, s31
    v_accvgpr_write_b32 a98, v124
    v_perm_b32 v125, v141, v140, s32
    v_accvgpr_write_b32 a106, v125
    v_perm_b32 v126, v143, v142, s31
    v_accvgpr_write_b32 a99, v126
    v_perm_b32 v127, v143, v142, s32
    v_accvgpr_write_b32 a107, v127
    s_waitcnt lgkmcnt(0)
    s_add_u32 m0, s29, 16384
    s_mov_b32 s30, 5184
    buffer_load_dwordx4 v165, s[92:95], s30 offen lds
    s_add_u32 m0, s29, 17408
    s_mov_b32 s30, 5248
    buffer_load_dwordx4 v165, s[92:95], s30 offen lds
    s_add_u32 m0, s29, 18432
    s_mov_b32 s30, 5312
    buffer_load_dwordx4 v165, s[92:95], s30 offen lds
    s_add_u32 m0, s29, 19456
    s_mov_b32 s30, 5376
    buffer_load_dwordx4 v165, s[92:95], s30 offen lds
    s_waitcnt vmcnt(17)
    ds_read2st64_b32 v[128:129], v170 offset0:0 offset1:1
    ds_read2st64_b32 v[130:131], v170 offset0:2 offset1:3
    ds_read2st64_b32 v[132:133], v170 offset0:4 offset1:5
    ds_read2st64_b32 v[134:135], v170 offset0:6 offset1:7
    ds_read2st64_b32 v[136:137], v170 offset0:8 offset1:9
    ds_read2st64_b32 v[138:139], v170 offset0:10 offset1:11
    ds_read2st64_b32 v[140:141], v170 offset0:12 offset1:13
    ds_read2st64_b32 v[142:143], v170 offset0:14 offset1:15
    v_perm_b32 v120, v145, v144, s31
    v_accvgpr_write_b32 a100, v120
    v_perm_b32 v121, v145, v144, s32
    v_accvgpr_write_b32 a108, v121
    v_perm_b32 v122, v147, v146, s31
    v_accvgpr_write_b32 a101, v122
    v_perm_b32 v123, v147, v146, s32
    v_accvgpr_write_b32 a109, v123
    v_perm_b32 v124, v149, v148, s31
    v_accvgpr_write_b32 a102, v124
    v_perm_b32 v125, v149, v148, s32
    v_accvgpr_write_b32 a110, v125
    v_perm_b32 v126, v151, v150, s31
    v_accvgpr_write_b32 a103, v126
    v_perm_b32 v127, v151, v150, s32
    v_accvgpr_write_b32 a111, v127
    v_perm_b32 v120, v153, v152, s31
    v_accvgpr_write_b32 a112, v120
    v_perm_b32 v121, v153, v152, s32
    v_accvgpr_write_b32 a120, v121
    v_perm_b32 v122, v155, v154, s31
    v_accvgpr_write_b32 a113, v122
    v_perm_b32 v123, v155, v154, s32
    v_accvgpr_write_b32 a121, v123
    v_perm_b32 v124, v157, v156, s31
    v_accvgpr_write_b32 a114, v124
    v_perm_b32 v125, v157, v156, s32
    v_accvgpr_write_b32 a122, v125
    v_perm_b32 v126, v159, v158, s31
    v_accvgpr_write_b32 a115, v126
    v_perm_b32 v127, v159, v158, s32
    v_accvgpr_write_b32 a123, v127
    s_waitcnt lgkmcnt(0)
    s_add_u32 m0, s29, 0
    s_mov_b32 s30, 122880
    buffer_load_dwordx4 v165, s[92:95], s30 offen lds
    s_add_u32 m0, s29, 1024
    s_mov_b32 s30, 122944
    buffer_load_dwordx4 v165, s[92:95], s30 offen lds
    s_add_u32 m0, s29, 2048
    s_mov_b32 s30, 123008
    buffer_load_dwordx4 v165, s[92:95], s30 offen lds
    s_add_u32 m0, s29, 3072
    s_mov_b32 s30, 123072
    buffer_load_dwordx4 v165, s[92:95], s30 offen lds
    s_waitcnt vmcnt(17)
    ds_read2st64_b32 v[144:145], v170 offset0:16 offset1:17
    ds_read2st64_b32 v[146:147], v170 offset0:18 offset1:19
    ds_read2st64_b32 v[148:149], v170 offset0:20 offset1:21
    ds_read2st64_b32 v[150:151], v170 offset0:22 offset1:23
    ds_read2st64_b32 v[152:153], v170 offset0:24 offset1:25
    ds_read2st64_b32 v[154:155], v170 offset0:26 offset1:27
    ds_read2st64_b32 v[156:157], v170 offset0:28 offset1:29
    ds_read2st64_b32 v[158:159], v170 offset0:30 offset1:31
    v_perm_b32 v120, v129, v128, s31
    v_accvgpr_write_b32 a164, v120
    v_perm_b32 v121, v129, v128, s32
    v_accvgpr_write_b32 a180, v121
    v_perm_b32 v122, v131, v130, s31
    v_accvgpr_write_b32 a165, v122
    v_perm_b32 v123, v131, v130, s32
    v_accvgpr_write_b32 a181, v123
    v_perm_b32 v124, v133, v132, s31
    v_accvgpr_write_b32 a196, v124
    v_perm_b32 v125, v133, v132, s32
    v_accvgpr_write_b32 a212, v125
    v_perm_b32 v126, v135, v134, s31
    v_accvgpr_write_b32 a197, v126
    v_perm_b32 v127, v135, v134, s32
    v_accvgpr_write_b32 a213, v127
    v_perm_b32 v120, v137, v136, s31
    v_accvgpr_write_b32 a228, v120
    v_perm_b32 v121, v137, v136, s32
    v_accvgpr_write_b32 a244, v121
    v_perm_b32 v122, v139, v138, s31
    v_accvgpr_write_b32 a229, v122
    v_perm_b32 v123, v139, v138, s32
    v_accvgpr_write_b32 a245, v123
    v_perm_b32 v196, v141, v140, s31
    v_perm_b32 v212, v141, v140, s32
    v_perm_b32 v197, v143, v142, s31
    v_perm_b32 v213, v143, v142, s32
    s_waitcnt lgkmcnt(0)
    s_add_u32 m0, s29, 4096
    s_mov_b32 s30, 123136
    buffer_load_dwordx4 v165, s[92:95], s30 offen lds
    s_add_u32 m0, s29, 5120
    s_mov_b32 s30, 128000
    buffer_load_dwordx4 v165, s[92:95], s30 offen lds
    s_add_u32 m0, s29, 6144
    s_mov_b32 s30, 128064
    buffer_load_dwordx4 v165, s[92:95], s30 offen lds
    s_add_u32 m0, s29, 7168
    s_mov_b32 s30, 128128
    buffer_load_dwordx4 v165, s[92:95], s30 offen lds
    s_waitcnt vmcnt(17)
    ds_read2st64_b32 v[128:129], v170 offset0:32 offset1:33
    ds_read2st64_b32 v[130:131], v170 offset0:34 offset1:35
    ds_read2st64_b32 v[132:133], v170 offset0:36 offset1:37
    ds_read2st64_b32 v[134:135], v170 offset0:38 offset1:39
    ds_read2st64_b32 v[136:137], v170 offset0:40 offset1:41
    ds_read2st64_b32 v[138:139], v170 offset0:42 offset1:43
    ds_read2st64_b32 v[140:141], v170 offset0:44 offset1:45
    ds_read2st64_b32 v[142:143], v170 offset0:46 offset1:47
    v_perm_b32 v228, v145, v144, s31
    v_perm_b32 v244, v145, v144, s32
    v_perm_b32 v229, v147, v146, s31
    v_perm_b32 v245, v147, v146, s32
    v_perm_b32 v124, v149, v148, s31
    v_accvgpr_write_b32 a166, v124
    v_perm_b32 v125, v149, v148, s32
    v_accvgpr_write_b32 a182, v125
    v_perm_b32 v126, v151, v150, s31
    v_accvgpr_write_b32 a167, v126
    v_perm_b32 v127, v151, v150, s32
    v_accvgpr_write_b32 a183, v127
    v_perm_b32 v120, v153, v152, s31
    v_accvgpr_write_b32 a198, v120
    v_perm_b32 v121, v153, v152, s32
    v_accvgpr_write_b32 a214, v121
    v_perm_b32 v122, v155, v154, s31
    v_accvgpr_write_b32 a199, v122
    v_perm_b32 v123, v155, v154, s32
    v_accvgpr_write_b32 a215, v123
    v_perm_b32 v124, v157, v156, s31
    v_accvgpr_write_b32 a230, v124
    v_perm_b32 v125, v157, v156, s32
    v_accvgpr_write_b32 a246, v125
    v_perm_b32 v126, v159, v158, s31
    v_accvgpr_write_b32 a231, v126
    v_perm_b32 v127, v159, v158, s32
    v_accvgpr_write_b32 a247, v127
    s_waitcnt lgkmcnt(0)
    s_add_u32 m0, s29, 8192
    s_mov_b32 s30, 128192
    buffer_load_dwordx4 v165, s[92:95], s30 offen lds
    s_add_u32 m0, s29, 9216
    s_mov_b32 s30, 128256
    buffer_load_dwordx4 v165, s[92:95], s30 offen lds
    s_add_u32 m0, s29, 10240
    s_mov_b32 s30, 81920
    buffer_load_dwordx4 v165, s[92:95], s30 offen lds
    s_add_u32 m0, s29, 11264
    s_mov_b32 s30, 81984
    buffer_load_dwordx4 v165, s[92:95], s30 offen lds
    s_waitcnt vmcnt(17)
    ds_read2st64_b32 v[144:145], v170 offset0:48 offset1:49
    ds_read2st64_b32 v[146:147], v170 offset0:50 offset1:51
    ds_read2st64_b32 v[148:149], v170 offset0:52 offset1:53
    ds_read2st64_b32 v[150:151], v170 offset0:54 offset1:55
    ds_read2st64_b32 v[152:153], v170 offset0:56 offset1:57
    ds_read2st64_b32 v[154:155], v170 offset0:58 offset1:59
    ds_read2st64_b32 v[156:157], v170 offset0:60 offset1:61
    ds_read2st64_b32 v[158:159], v170 offset0:62 offset1:63
    v_perm_b32 v198, v129, v128, s31
    v_perm_b32 v214, v129, v128, s32
    v_perm_b32 v199, v131, v130, s31
    v_perm_b32 v215, v131, v130, s32
    v_perm_b32 v230, v133, v132, s31
    v_perm_b32 v246, v133, v132, s32
    v_perm_b32 v231, v135, v134, s31
    v_perm_b32 v247, v135, v134, s32
    v_perm_b32 v120, v137, v136, s31
    v_accvgpr_write_b32 a160, v120
    v_perm_b32 v121, v137, v136, s32
    v_accvgpr_write_b32 a176, v121
    v_perm_b32 v122, v139, v138, s31
    v_accvgpr_write_b32 a161, v122
    v_perm_b32 v123, v139, v138, s32
    v_accvgpr_write_b32 a177, v123
    v_perm_b32 v124, v141, v140, s31
    v_accvgpr_write_b32 a192, v124
    v_perm_b32 v125, v141, v140, s32
    v_accvgpr_write_b32 a208, v125
    v_perm_b32 v126, v143, v142, s31
    v_accvgpr_write_b32 a193, v126
    v_perm_b32 v127, v143, v142, s32
    v_accvgpr_write_b32 a209, v127
    s_waitcnt lgkmcnt(0)
    s_add_u32 m0, s29, 12288
    s_mov_b32 s30, 82048
    buffer_load_dwordx4 v165, s[92:95], s30 offen lds
    s_add_u32 m0, s29, 13312
    s_mov_b32 s30, 82112
    buffer_load_dwordx4 v165, s[92:95], s30 offen lds
    s_add_u32 m0, s29, 14336
    s_mov_b32 s30, 82176
    buffer_load_dwordx4 v165, s[92:95], s30 offen lds
    s_add_u32 m0, s29, 15360
    s_mov_b32 s30, 87040
    buffer_load_dwordx4 v165, s[92:95], s30 offen lds
    s_waitcnt vmcnt(16)
    ds_read2st64_b32 v[128:129], v170 offset0:64 offset1:65
    ds_read2st64_b32 v[130:131], v170 offset0:66 offset1:67
    ds_read2st64_b32 v[132:133], v170 offset0:68 offset1:69
    ds_read2st64_b32 v[134:135], v170 offset0:70 offset1:71
    ds_read2st64_b32 v[136:137], v170 offset0:72 offset1:73
    ds_read2st64_b32 v[138:139], v170 offset0:74 offset1:75
    ds_read2st64_b32 v[140:141], v170 offset0:76 offset1:77
    ds_read2st64_b32 v[142:143], v170 offset0:78 offset1:79
    v_perm_b32 v120, v145, v144, s31
    v_accvgpr_write_b32 a224, v120
    v_perm_b32 v121, v145, v144, s32
    v_accvgpr_write_b32 a240, v121
    v_perm_b32 v122, v147, v146, s31
    v_accvgpr_write_b32 a225, v122
    v_perm_b32 v123, v147, v146, s32
    v_accvgpr_write_b32 a241, v123
    v_perm_b32 v192, v149, v148, s31
    v_perm_b32 v208, v149, v148, s32
    v_perm_b32 v193, v151, v150, s31
    v_perm_b32 v209, v151, v150, s32
    v_perm_b32 v224, v153, v152, s31
    v_perm_b32 v240, v153, v152, s32
    v_perm_b32 v225, v155, v154, s31
    v_perm_b32 v241, v155, v154, s32
    v_perm_b32 v124, v157, v156, s31
    v_accvgpr_write_b32 a162, v124
    v_perm_b32 v125, v157, v156, s32
    v_accvgpr_write_b32 a178, v125
    v_perm_b32 v126, v159, v158, s31
    v_accvgpr_write_b32 a163, v126
    v_perm_b32 v127, v159, v158, s32
    v_accvgpr_write_b32 a179, v127
    s_waitcnt lgkmcnt(0)
    s_add_u32 m0, s29, 16384
    s_mov_b32 s30, 87104
    buffer_load_dwordx4 v165, s[92:95], s30 offen lds
    s_add_u32 m0, s29, 17408
    s_mov_b32 s30, 87168
    buffer_load_dwordx4 v165, s[92:95], s30 offen lds
    s_add_u32 m0, s29, 18432
    s_mov_b32 s30, 87232
    buffer_load_dwordx4 v165, s[92:95], s30 offen lds
    s_add_u32 m0, s29, 19456
    s_mov_b32 s30, 87296
    buffer_load_dwordx4 v165, s[92:95], s30 offen lds
    s_mul_i32 s20, s16, 40960
    s_mul_i32 s21, s18, 10240
    s_add_u32 s20, s20, s21
    s_add_u32 s20, s20, 2097152
    s_add_u32 s21, s21, s40
    s_mov_b32 m0, s21
    s_nop 0
    buffer_load_dwordx4 v4, s[4:7], s20 offen offset:0 sc1 lds
    buffer_load_dwordx4 v4, s[4:7], s20 offen offset:1024 sc1 lds
    buffer_load_dwordx4 v4, s[4:7], s20 offen offset:2048 sc1 lds
    buffer_load_dwordx4 v4, s[4:7], s20 offen offset:3072 sc1 lds
    s_add_u32 s20, s20, 4096
    s_add_u32 s21, s21, 4096
    s_mov_b32 m0, s21
    s_nop 0
    buffer_load_dwordx4 v4, s[4:7], s20 offen offset:0 sc1 lds
    buffer_load_dwordx4 v4, s[4:7], s20 offen offset:1024 sc1 lds
    buffer_load_dwordx4 v4, s[4:7], s20 offen offset:2048 sc1 lds
    buffer_load_dwordx4 v4, s[4:7], s20 offen offset:3072 sc1 lds
    s_add_u32 s20, s20, 4096
    s_add_u32 s21, s21, 4096
    s_mov_b32 m0, s21
    s_nop 0
    buffer_load_dwordx4 v4, s[4:7], s20 offen offset:0 sc1 lds
    buffer_load_dwordx4 v4, s[4:7], s20 offen offset:1024 sc1 lds
    s_waitcnt vmcnt(26)
    ds_read2st64_b32 v[144:145], v170 offset0:0 offset1:1
    ds_read2st64_b32 v[146:147], v170 offset0:2 offset1:3
    ds_read2st64_b32 v[148:149], v170 offset0:4 offset1:5
    ds_read2st64_b32 v[150:151], v170 offset0:6 offset1:7
    ds_read2st64_b32 v[152:153], v170 offset0:8 offset1:9
    ds_read2st64_b32 v[154:155], v170 offset0:10 offset1:11
    ds_read2st64_b32 v[156:157], v170 offset0:12 offset1:13
    ds_read2st64_b32 v[158:159], v170 offset0:14 offset1:15
    v_perm_b32 v120, v129, v128, s31
    v_accvgpr_write_b32 a194, v120
    v_perm_b32 v121, v129, v128, s32
    v_accvgpr_write_b32 a210, v121
    v_perm_b32 v122, v131, v130, s31
    v_accvgpr_write_b32 a195, v122
    v_perm_b32 v123, v131, v130, s32
    v_accvgpr_write_b32 a211, v123
    v_perm_b32 v124, v133, v132, s31
    v_accvgpr_write_b32 a226, v124
    v_perm_b32 v125, v133, v132, s32
    v_accvgpr_write_b32 a242, v125
    v_perm_b32 v126, v135, v134, s31
    v_accvgpr_write_b32 a227, v126
    v_perm_b32 v127, v135, v134, s32
    v_accvgpr_write_b32 a243, v127
    v_perm_b32 v194, v137, v136, s31
    v_perm_b32 v210, v137, v136, s32
    v_perm_b32 v195, v139, v138, s31
    v_perm_b32 v211, v139, v138, s32
    v_perm_b32 v226, v141, v140, s31
    v_perm_b32 v242, v141, v140, s32
    v_perm_b32 v227, v143, v142, s31
    v_perm_b32 v243, v143, v142, s32
    s_waitcnt lgkmcnt(0)
    s_waitcnt vmcnt(22)
    ds_read2st64_b32 v[128:129], v170 offset0:16 offset1:17
    ds_read2st64_b32 v[130:131], v170 offset0:18 offset1:19
    ds_read2st64_b32 v[132:133], v170 offset0:20 offset1:21
    ds_read2st64_b32 v[134:135], v170 offset0:22 offset1:23
    ds_read2st64_b32 v[136:137], v170 offset0:24 offset1:25
    ds_read2st64_b32 v[138:139], v170 offset0:26 offset1:27
    ds_read2st64_b32 v[140:141], v170 offset0:28 offset1:29
    ds_read2st64_b32 v[142:143], v170 offset0:30 offset1:31
    v_perm_b32 v120, v145, v144, s31
    v_accvgpr_write_b32 a172, v120
    v_perm_b32 v121, v145, v144, s32
    v_accvgpr_write_b32 a188, v121
    v_perm_b32 v122, v147, v146, s31
    v_accvgpr_write_b32 a173, v122
    v_perm_b32 v123, v147, v146, s32
    v_accvgpr_write_b32 a189, v123
    v_perm_b32 v124, v149, v148, s31
    v_accvgpr_write_b32 a204, v124
    v_perm_b32 v125, v149, v148, s32
    v_accvgpr_write_b32 a220, v125
    v_perm_b32 v126, v151, v150, s31
    v_accvgpr_write_b32 a205, v126
    v_perm_b32 v127, v151, v150, s32
    v_accvgpr_write_b32 a221, v127
    v_perm_b32 v120, v153, v152, s31
    v_accvgpr_write_b32 a236, v120
    v_perm_b32 v121, v153, v152, s32
    v_accvgpr_write_b32 a252, v121
    v_perm_b32 v122, v155, v154, s31
    v_accvgpr_write_b32 a237, v122
    v_perm_b32 v123, v155, v154, s32
    v_accvgpr_write_b32 a253, v123
    v_perm_b32 v204, v157, v156, s31
    v_perm_b32 v220, v157, v156, s32
    v_perm_b32 v205, v159, v158, s31
    v_perm_b32 v221, v159, v158, s32
    s_waitcnt lgkmcnt(0)
    s_waitcnt vmcnt(18)
    ds_read2st64_b32 v[144:145], v170 offset0:32 offset1:33
    ds_read2st64_b32 v[146:147], v170 offset0:34 offset1:35
    ds_read2st64_b32 v[148:149], v170 offset0:36 offset1:37
    ds_read2st64_b32 v[150:151], v170 offset0:38 offset1:39
    ds_read2st64_b32 v[152:153], v170 offset0:40 offset1:41
    ds_read2st64_b32 v[154:155], v170 offset0:42 offset1:43
    ds_read2st64_b32 v[156:157], v170 offset0:44 offset1:45
    ds_read2st64_b32 v[158:159], v170 offset0:46 offset1:47
    v_perm_b32 v236, v129, v128, s31
    v_perm_b32 v252, v129, v128, s32
    v_perm_b32 v237, v131, v130, s31
    v_perm_b32 v253, v131, v130, s32
    v_perm_b32 v124, v133, v132, s31
    v_accvgpr_write_b32 a174, v124
    v_perm_b32 v125, v133, v132, s32
    v_accvgpr_write_b32 a190, v125
    v_perm_b32 v126, v135, v134, s31
    v_accvgpr_write_b32 a175, v126
    v_perm_b32 v127, v135, v134, s32
    v_accvgpr_write_b32 a191, v127
    v_perm_b32 v120, v137, v136, s31
    v_accvgpr_write_b32 a206, v120
    v_perm_b32 v121, v137, v136, s32
    v_accvgpr_write_b32 a222, v121
    v_perm_b32 v122, v139, v138, s31
    v_accvgpr_write_b32 a207, v122
    v_perm_b32 v123, v139, v138, s32
    v_accvgpr_write_b32 a223, v123
    v_perm_b32 v124, v141, v140, s31
    v_accvgpr_write_b32 a238, v124
    v_perm_b32 v125, v141, v140, s32
    v_accvgpr_write_b32 a254, v125
    v_perm_b32 v126, v143, v142, s31
    v_accvgpr_write_b32 a239, v126
    v_perm_b32 v127, v143, v142, s32
    v_accvgpr_write_b32 a255, v127
    s_waitcnt lgkmcnt(0)
    s_waitcnt vmcnt(14)
    ds_read2st64_b32 v[128:129], v170 offset0:48 offset1:49
    ds_read2st64_b32 v[130:131], v170 offset0:50 offset1:51
    ds_read2st64_b32 v[132:133], v170 offset0:52 offset1:53
    ds_read2st64_b32 v[134:135], v170 offset0:54 offset1:55
    ds_read2st64_b32 v[136:137], v170 offset0:56 offset1:57
    ds_read2st64_b32 v[138:139], v170 offset0:58 offset1:59
    ds_read2st64_b32 v[140:141], v170 offset0:60 offset1:61
    ds_read2st64_b32 v[142:143], v170 offset0:62 offset1:63
    v_perm_b32 v206, v145, v144, s31
    v_perm_b32 v222, v145, v144, s32
    v_perm_b32 v207, v147, v146, s31
    v_perm_b32 v223, v147, v146, s32
    v_perm_b32 v238, v149, v148, s31
    v_perm_b32 v254, v149, v148, s32
    v_perm_b32 v239, v151, v150, s31
    v_perm_b32 v255, v151, v150, s32
    v_perm_b32 v120, v153, v152, s31
    v_accvgpr_write_b32 a168, v120
    v_perm_b32 v121, v153, v152, s32
    v_accvgpr_write_b32 a184, v121
    v_perm_b32 v122, v155, v154, s31
    v_accvgpr_write_b32 a169, v122
    v_perm_b32 v123, v155, v154, s32
    v_accvgpr_write_b32 a185, v123
    v_perm_b32 v124, v157, v156, s31
    v_accvgpr_write_b32 a200, v124
    v_perm_b32 v125, v157, v156, s32
    v_accvgpr_write_b32 a216, v125
    v_perm_b32 v126, v159, v158, s31
    v_accvgpr_write_b32 a201, v126
    v_perm_b32 v127, v159, v158, s32
    v_accvgpr_write_b32 a217, v127
    s_waitcnt lgkmcnt(0)
    s_waitcnt vmcnt(10)
    ds_read2st64_b32 v[144:145], v170 offset0:64 offset1:65
    ds_read2st64_b32 v[146:147], v170 offset0:66 offset1:67
    ds_read2st64_b32 v[148:149], v170 offset0:68 offset1:69
    ds_read2st64_b32 v[150:151], v170 offset0:70 offset1:71
    ds_read2st64_b32 v[152:153], v170 offset0:72 offset1:73
    ds_read2st64_b32 v[154:155], v170 offset0:74 offset1:75
    ds_read2st64_b32 v[156:157], v170 offset0:76 offset1:77
    ds_read2st64_b32 v[158:159], v170 offset0:78 offset1:79
    v_perm_b32 v120, v129, v128, s31
    v_accvgpr_write_b32 a232, v120
    v_perm_b32 v121, v129, v128, s32
    v_accvgpr_write_b32 a248, v121
    v_perm_b32 v122, v131, v130, s31
    v_accvgpr_write_b32 a233, v122
    v_perm_b32 v123, v131, v130, s32
    v_accvgpr_write_b32 a249, v123
    v_perm_b32 v200, v133, v132, s31
    v_perm_b32 v216, v133, v132, s32
    v_perm_b32 v201, v135, v134, s31
    v_perm_b32 v217, v135, v134, s32
    v_perm_b32 v232, v137, v136, s31
    v_perm_b32 v248, v137, v136, s32
    v_perm_b32 v233, v139, v138, s31
    v_perm_b32 v249, v139, v138, s32
    v_perm_b32 v124, v141, v140, s31
    v_accvgpr_write_b32 a170, v124
    v_perm_b32 v125, v141, v140, s32
    v_accvgpr_write_b32 a186, v125
    v_perm_b32 v126, v143, v142, s31
    v_accvgpr_write_b32 a171, v126
    v_perm_b32 v127, v143, v142, s32
    v_accvgpr_write_b32 a187, v127
    s_waitcnt lgkmcnt(0)
    v_perm_b32 v120, v145, v144, s31
    v_accvgpr_write_b32 a202, v120
    v_perm_b32 v121, v145, v144, s32
    v_accvgpr_write_b32 a218, v121
    v_perm_b32 v122, v147, v146, s31
    v_accvgpr_write_b32 a203, v122
    v_perm_b32 v123, v147, v146, s32
    v_accvgpr_write_b32 a219, v123
    v_perm_b32 v124, v149, v148, s31
    v_accvgpr_write_b32 a234, v124
    v_perm_b32 v125, v149, v148, s32
    v_accvgpr_write_b32 a250, v125
    v_perm_b32 v126, v151, v150, s31
    v_accvgpr_write_b32 a235, v126
    v_perm_b32 v127, v151, v150, s32
    v_accvgpr_write_b32 a251, v127
    v_perm_b32 v202, v153, v152, s31
    v_perm_b32 v218, v153, v152, s32
    v_perm_b32 v203, v155, v154, s31
    v_perm_b32 v219, v155, v154, s32
    v_perm_b32 v234, v157, v156, s31
    v_perm_b32 v250, v157, v156, s32
    v_perm_b32 v235, v159, v158, s31
    v_perm_b32 v251, v159, v158, s32
    s_branch rev_5_b
rev_5_a:
    v_bfe_u32 v160, v1, 2, 2
    v_lshlrev_b32 v160, 6, v160
    v_and_b32 v161, 3, v1
    v_lshl_add_u32 v160, v161, 4, v160
    v_bfe_u32 v161, v1, 4, 1
    v_lshrrev_b32 v162, 5, v1
    ds_bpermute_b32 v164, v160, v9
    v_mul_u32_u24 v163, 8192, v161
    v_mul_u32_u24 v170, 16384, v162
    s_waitcnt lgkmcnt(0)
    v_add3_u32 v164, v164, v163, v170
    ds_bpermute_b32 v165, v160, v10
    v_mul_u32_u24 v163, 2560, v161
    v_mul_u32_u24 v170, 1280, v162
    s_waitcnt lgkmcnt(0)
    v_add3_u32 v165, v165, v163, v170
    s_mul_i32 s29, s18, 20480
    s_add_u32 s29, s29, 40960
    v_lshl_add_u32 v170, v1, 2, s29
    s_add_u32 m0, s29, 0
    s_mov_b32 s30, 0
    buffer_load_dwordx4 v164, s[12:15], s30 offen lds
    s_add_u32 m0, s29, 1024
    s_mov_b32 s30, 32768
    buffer_load_dwordx4 v164, s[12:15], s30 offen lds
    s_add_u32 m0, s29, 2048
    s_mov_b32 s30, 262144
    buffer_load_dwordx4 v164, s[12:15], s30 offen lds
    s_add_u32 m0, s29, 3072
    s_mov_b32 s30, 294912
    buffer_load_dwordx4 v164, s[12:15], s30 offen lds
    s_add_u32 m0, s29, 4096
    s_mov_b32 s30, 524288
    buffer_load_dwordx4 v164, s[12:15], s30 offen lds
    s_add_u32 m0, s29, 5120
    s_mov_b32 s30, 557056
    buffer_load_dwordx4 v164, s[12:15], s30 offen lds
    s_add_u32 m0, s29, 6144
    s_mov_b32 s30, 786432
    buffer_load_dwordx4 v164, s[12:15], s30 offen lds
    s_add_u32 m0, s29, 7168
    s_mov_b32 s30, 819200
    buffer_load_dwordx4 v164, s[12:15], s30 offen lds
    s_add_u32 m0, s29, 8192
    s_mov_b32 s30, 1048576
    buffer_load_dwordx4 v164, s[12:15], s30 offen lds
    s_add_u32 m0, s29, 9216
    s_mov_b32 s30, 1081344
    buffer_load_dwordx4 v164, s[12:15], s30 offen lds
    s_add_u32 m0, s29, 10240
    s_mov_b32 s30, 1310720
    buffer_load_dwordx4 v164, s[12:15], s30 offen lds
    s_add_u32 m0, s29, 11264
    s_mov_b32 s30, 1343488
    buffer_load_dwordx4 v164, s[12:15], s30 offen lds
    s_add_u32 m0, s29, 12288
    s_mov_b32 s30, 1572864
    buffer_load_dwordx4 v164, s[12:15], s30 offen lds
    s_add_u32 m0, s29, 13312
    s_mov_b32 s30, 1605632
    buffer_load_dwordx4 v164, s[12:15], s30 offen lds
    s_add_u32 m0, s29, 14336
    s_mov_b32 s30, 1835008
    buffer_load_dwordx4 v164, s[12:15], s30 offen lds
    s_add_u32 m0, s29, 15360
    s_mov_b32 s30, 1867776
    buffer_load_dwordx4 v164, s[12:15], s30 offen lds
    s_add_u32 m0, s29, 16384
    s_mov_b32 s30, 2097152
    buffer_load_dwordx4 v164, s[12:15], s30 offen lds
    s_add_u32 m0, s29, 17408
    s_mov_b32 s30, 2129920
    buffer_load_dwordx4 v164, s[12:15], s30 offen lds
    s_add_u32 m0, s29, 18432
    s_mov_b32 s30, 2359296
    buffer_load_dwordx4 v164, s[12:15], s30 offen lds
    s_add_u32 m0, s29, 19456
    s_mov_b32 s30, 2392064
    buffer_load_dwordx4 v164, s[12:15], s30 offen lds
    s_waitcnt vmcnt(16)
    ds_read2st64_b32 v[128:129], v170 offset0:0 offset1:1
    ds_read2st64_b32 v[130:131], v170 offset0:2 offset1:3
    ds_read2st64_b32 v[132:133], v170 offset0:4 offset1:5
    ds_read2st64_b32 v[134:135], v170 offset0:6 offset1:7
    ds_read2st64_b32 v[136:137], v170 offset0:8 offset1:9
    ds_read2st64_b32 v[138:139], v170 offset0:10 offset1:11
    ds_read2st64_b32 v[140:141], v170 offset0:12 offset1:13
    ds_read2st64_b32 v[142:143], v170 offset0:14 offset1:15
    s_waitcnt lgkmcnt(0)
    s_add_u32 m0, s29, 0
    s_mov_b32 s30, 2621440
    buffer_load_dwordx4 v164, s[12:15], s30 offen lds
    s_add_u32 m0, s29, 1024
    s_mov_b32 s30, 2654208
    buffer_load_dwordx4 v164, s[12:15], s30 offen lds
    s_add_u32 m0, s29, 2048
    s_mov_b32 s30, 2883584
    buffer_load_dwordx4 v164, s[12:15], s30 offen lds
    s_add_u32 m0, s29, 3072
    s_mov_b32 s30, 2916352
    buffer_load_dwordx4 v164, s[12:15], s30 offen lds
    s_waitcnt vmcnt(16)
    ds_read2st64_b32 v[144:145], v170 offset0:16 offset1:17
    ds_read2st64_b32 v[146:147], v170 offset0:18 offset1:19
    ds_read2st64_b32 v[148:149], v170 offset0:20 offset1:21
    ds_read2st64_b32 v[150:151], v170 offset0:22 offset1:23
    ds_read2st64_b32 v[152:153], v170 offset0:24 offset1:25
    ds_read2st64_b32 v[154:155], v170 offset0:26 offset1:27
    ds_read2st64_b32 v[156:157], v170 offset0:28 offset1:29
    ds_read2st64_b32 v[158:159], v170 offset0:30 offset1:31
    v_perm_b32 v120, v129, v128, s31
    v_accvgpr_write_b32 a0, v120
    v_perm_b32 v121, v129, v128, s32
    v_accvgpr_write_b32 a8, v121
    v_perm_b32 v122, v131, v130, s31
    v_accvgpr_write_b32 a1, v122
    v_perm_b32 v123, v131, v130, s32
    v_accvgpr_write_b32 a9, v123
    v_perm_b32 v124, v133, v132, s31
    v_accvgpr_write_b32 a2, v124
    v_perm_b32 v125, v133, v132, s32
    v_accvgpr_write_b32 a10, v125
    v_perm_b32 v126, v135, v134, s31
    v_accvgpr_write_b32 a3, v126
    v_perm_b32 v127, v135, v134, s32
    v_accvgpr_write_b32 a11, v127
    v_perm_b32 v120, v137, v136, s31
    v_accvgpr_write_b32 a4, v120
    v_perm_b32 v121, v137, v136, s32
    v_accvgpr_write_b32 a12, v121
    v_perm_b32 v122, v139, v138, s31
    v_accvgpr_write_b32 a5, v122
    v_perm_b32 v123, v139, v138, s32
    v_accvgpr_write_b32 a13, v123
    v_perm_b32 v124, v141, v140, s31
    v_accvgpr_write_b32 a6, v124
    v_perm_b32 v125, v141, v140, s32
    v_accvgpr_write_b32 a14, v125
    v_perm_b32 v126, v143, v142, s31
    v_accvgpr_write_b32 a7, v126
    v_perm_b32 v127, v143, v142, s32
    v_accvgpr_write_b32 a15, v127
    s_waitcnt lgkmcnt(0)
    s_add_u32 m0, s29, 4096
    s_mov_b32 s30, 3145728
    buffer_load_dwordx4 v164, s[12:15], s30 offen lds
    s_add_u32 m0, s29, 5120
    s_mov_b32 s30, 3178496
    buffer_load_dwordx4 v164, s[12:15], s30 offen lds
    s_add_u32 m0, s29, 6144
    s_mov_b32 s30, 3407872
    buffer_load_dwordx4 v164, s[12:15], s30 offen lds
    s_add_u32 m0, s29, 7168
    s_mov_b32 s30, 3440640
    buffer_load_dwordx4 v164, s[12:15], s30 offen lds
    buffer_load_dword v185, v184, s[12:15], 0 offen
    s_waitcnt vmcnt(17)
    ds_read2st64_b32 v[128:129], v170 offset0:32 offset1:33
    ds_read2st64_b32 v[130:131], v170 offset0:34 offset1:35
    ds_read2st64_b32 v[132:133], v170 offset0:36 offset1:37
    ds_read2st64_b32 v[134:135], v170 offset0:38 offset1:39
    ds_read2st64_b32 v[136:137], v170 offset0:40 offset1:41
    ds_read2st64_b32 v[138:139], v170 offset0:42 offset1:43
    ds_read2st64_b32 v[140:141], v170 offset0:44 offset1:45
    ds_read2st64_b32 v[142:143], v170 offset0:46 offset1:47
    v_perm_b32 v120, v145, v144, s31
    v_accvgpr_write_b32 a16, v120
    v_perm_b32 v121, v145, v144, s32
    v_accvgpr_write_b32 a24, v121
    v_perm_b32 v122, v147, v146, s31
    v_accvgpr_write_b32 a17, v122
    v_perm_b32 v123, v147, v146, s32
    v_accvgpr_write_b32 a25, v123
    v_perm_b32 v124, v149, v148, s31
    v_accvgpr_write_b32 a18, v124
    v_perm_b32 v125, v149, v148, s32
    v_accvgpr_write_b32 a26, v125
    v_perm_b32 v126, v151, v150, s31
    v_accvgpr_write_b32 a19, v126
    v_perm_b32 v127, v151, v150, s32
    v_accvgpr_write_b32 a27, v127
    v_perm_b32 v120, v153, v152, s31
    v_accvgpr_write_b32 a20, v120
    v_perm_b32 v121, v153, v152, s32
    v_accvgpr_write_b32 a28, v121
    v_perm_b32 v122, v155, v154, s31
    v_accvgpr_write_b32 a21, v122
    v_perm_b32 v123, v155, v154, s32
    v_accvgpr_write_b32 a29, v123
    v_perm_b32 v124, v157, v156, s31
    v_accvgpr_write_b32 a22, v124
    v_perm_b32 v125, v157, v156, s32
    v_accvgpr_write_b32 a30, v125
    v_perm_b32 v126, v159, v158, s31
    v_accvgpr_write_b32 a23, v126
    v_perm_b32 v127, v159, v158, s32
    v_accvgpr_write_b32 a31, v127
    s_waitcnt lgkmcnt(0)
    s_add_u32 m0, s29, 8192
    s_mov_b32 s30, 3670016
    buffer_load_dwordx4 v164, s[12:15], s30 offen lds
    s_add_u32 m0, s29, 9216
    s_mov_b32 s30, 3702784
    buffer_load_dwordx4 v164, s[12:15], s30 offen lds
    s_add_u32 m0, s29, 10240
    s_mov_b32 s30, 3932160
    buffer_load_dwordx4 v164, s[12:15], s30 offen lds
    s_add_u32 m0, s29, 11264
    s_mov_b32 s30, 3964928
    buffer_load_dwordx4 v164, s[12:15], s30 offen lds
    s_waitcnt vmcnt(17)
    ds_read2st64_b32 v[144:145], v170 offset0:48 offset1:49
    ds_read2st64_b32 v[146:147], v170 offset0:50 offset1:51
    ds_read2st64_b32 v[148:149], v170 offset0:52 offset1:53
    ds_read2st64_b32 v[150:151], v170 offset0:54 offset1:55
    ds_read2st64_b32 v[152:153], v170 offset0:56 offset1:57
    ds_read2st64_b32 v[154:155], v170 offset0:58 offset1:59
    ds_read2st64_b32 v[156:157], v170 offset0:60 offset1:61
    ds_read2st64_b32 v[158:159], v170 offset0:62 offset1:63
    v_perm_b32 v120, v129, v128, s31
    v_accvgpr_write_b32 a32, v120
    v_perm_b32 v121, v129, v128, s32
    v_accvgpr_write_b32 a40, v121
    v_perm_b32 v122, v131, v130, s31
    v_accvgpr_write_b32 a33, v122
    v_perm_b32 v123, v131, v130, s32
    v_accvgpr_write_b32 a41, v123
    v_perm_b32 v124, v133, v132, s31
    v_accvgpr_write_b32 a34, v124
    v_perm_b32 v125, v133, v132, s32
    v_accvgpr_write_b32 a42, v125
    v_perm_b32 v126, v135, v134, s31
    v_accvgpr_write_b32 a35, v126
    v_perm_b32 v127, v135, v134, s32
    v_accvgpr_write_b32 a43, v127
    v_perm_b32 v120, v137, v136, s31
    v_accvgpr_write_b32 a36, v120
    v_perm_b32 v121, v137, v136, s32
    v_accvgpr_write_b32 a44, v121
    v_perm_b32 v122, v139, v138, s31
    v_accvgpr_write_b32 a37, v122
    v_perm_b32 v123, v139, v138, s32
    v_accvgpr_write_b32 a45, v123
    v_perm_b32 v124, v141, v140, s31
    v_accvgpr_write_b32 a38, v124
    v_perm_b32 v125, v141, v140, s32
    v_accvgpr_write_b32 a46, v125
    v_perm_b32 v126, v143, v142, s31
    v_accvgpr_write_b32 a39, v126
    v_perm_b32 v127, v143, v142, s32
    v_accvgpr_write_b32 a47, v127
    s_waitcnt lgkmcnt(0)
    s_add_u32 m0, s29, 12288
    s_mov_b32 s30, 4194304
    buffer_load_dwordx4 v164, s[12:15], s30 offen lds
    s_add_u32 m0, s29, 13312
    s_mov_b32 s30, 4227072
    buffer_load_dwordx4 v164, s[12:15], s30 offen lds
    s_add_u32 m0, s29, 14336
    s_mov_b32 s30, 4456448
    buffer_load_dwordx4 v164, s[12:15], s30 offen lds
    s_add_u32 m0, s29, 15360
    s_mov_b32 s30, 4489216
    buffer_load_dwordx4 v164, s[12:15], s30 offen lds
    s_waitcnt vmcnt(17)
    ds_read2st64_b32 v[128:129], v170 offset0:64 offset1:65
    ds_read2st64_b32 v[130:131], v170 offset0:66 offset1:67
    ds_read2st64_b32 v[132:133], v170 offset0:68 offset1:69
    ds_read2st64_b32 v[134:135], v170 offset0:70 offset1:71
    ds_read2st64_b32 v[136:137], v170 offset0:72 offset1:73
    ds_read2st64_b32 v[138:139], v170 offset0:74 offset1:75
    ds_read2st64_b32 v[140:141], v170 offset0:76 offset1:77
    ds_read2st64_b32 v[142:143], v170 offset0:78 offset1:79
    v_perm_b32 v120, v145, v144, s31
    v_accvgpr_write_b32 a48, v120
    v_perm_b32 v121, v145, v144, s32
    v_accvgpr_write_b32 a56, v121
    v_perm_b32 v122, v147, v146, s31
    v_accvgpr_write_b32 a49, v122
    v_perm_b32 v123, v147, v146, s32
    v_accvgpr_write_b32 a57, v123
    v_perm_b32 v124, v149, v148, s31
    v_accvgpr_write_b32 a50, v124
    v_perm_b32 v125, v149, v148, s32
    v_accvgpr_write_b32 a58, v125
    v_perm_b32 v126, v151, v150, s31
    v_accvgpr_write_b32 a51, v126
    v_perm_b32 v127, v151, v150, s32
    v_accvgpr_write_b32 a59, v127
    v_perm_b32 v120, v153, v152, s31
    v_accvgpr_write_b32 a52, v120
    v_perm_b32 v121, v153, v152, s32
    v_accvgpr_write_b32 a60, v121
    v_perm_b32 v122, v155, v154, s31
    v_accvgpr_write_b32 a53, v122
    v_perm_b32 v123, v155, v154, s32
    v_accvgpr_write_b32 a61, v123
    v_perm_b32 v124, v157, v156, s31
    v_accvgpr_write_b32 a54, v124
    v_perm_b32 v125, v157, v156, s32
    v_accvgpr_write_b32 a62, v125
    v_perm_b32 v126, v159, v158, s31
    v_accvgpr_write_b32 a55, v126
    v_perm_b32 v127, v159, v158, s32
    v_accvgpr_write_b32 a63, v127
    s_waitcnt lgkmcnt(0)
    s_add_u32 m0, s29, 16384
    s_mov_b32 s30, 4718592
    buffer_load_dwordx4 v164, s[12:15], s30 offen lds
    s_add_u32 m0, s29, 17408
    s_mov_b32 s30, 4751360
    buffer_load_dwordx4 v164, s[12:15], s30 offen lds
    s_add_u32 m0, s29, 18432
    s_mov_b32 s30, 4980736
    buffer_load_dwordx4 v164, s[12:15], s30 offen lds
    s_add_u32 m0, s29, 19456
    s_mov_b32 s30, 5013504
    buffer_load_dwordx4 v164, s[12:15], s30 offen lds
    s_waitcnt vmcnt(17)
    ds_read2st64_b32 v[144:145], v170 offset0:0 offset1:1
    ds_read2st64_b32 v[146:147], v170 offset0:2 offset1:3
    ds_read2st64_b32 v[148:149], v170 offset0:4 offset1:5
    ds_read2st64_b32 v[150:151], v170 offset0:6 offset1:7
    ds_read2st64_b32 v[152:153], v170 offset0:8 offset1:9
    ds_read2st64_b32 v[154:155], v170 offset0:10 offset1:11
    ds_read2st64_b32 v[156:157], v170 offset0:12 offset1:13
    ds_read2st64_b32 v[158:159], v170 offset0:14 offset1:15
    v_perm_b32 v120, v129, v128, s31
    v_accvgpr_write_b32 a64, v120
    v_perm_b32 v121, v129, v128, s32
    v_accvgpr_write_b32 a72, v121
    v_perm_b32 v122, v131, v130, s31
    v_accvgpr_write_b32 a65, v122
    v_perm_b32 v123, v131, v130, s32
    v_accvgpr_write_b32 a73, v123
    v_perm_b32 v124, v133, v132, s31
    v_accvgpr_write_b32 a66, v124
    v_perm_b32 v125, v133, v132, s32
    v_accvgpr_write_b32 a74, v125
    v_perm_b32 v126, v135, v134, s31
    v_accvgpr_write_b32 a67, v126
    v_perm_b32 v127, v135, v134, s32
    v_accvgpr_write_b32 a75, v127
    v_perm_b32 v120, v137, v136, s31
    v_accvgpr_write_b32 a68, v120
    v_perm_b32 v121, v137, v136, s32
    v_accvgpr_write_b32 a76, v121
    v_perm_b32 v122, v139, v138, s31
    v_accvgpr_write_b32 a69, v122
    v_perm_b32 v123, v139, v138, s32
    v_accvgpr_write_b32 a77, v123
    v_perm_b32 v124, v141, v140, s31
    v_accvgpr_write_b32 a70, v124
    v_perm_b32 v125, v141, v140, s32
    v_accvgpr_write_b32 a78, v125
    v_perm_b32 v126, v143, v142, s31
    v_accvgpr_write_b32 a71, v126
    v_perm_b32 v127, v143, v142, s32
    v_accvgpr_write_b32 a79, v127
    s_waitcnt lgkmcnt(0)
    s_add_u32 m0, s29, 0
    s_mov_b32 s30, 0
    buffer_load_dwordx4 v165, s[92:95], s30 offen lds
    s_add_u32 m0, s29, 1024
    s_mov_b32 s30, 64
    buffer_load_dwordx4 v165, s[92:95], s30 offen lds
    s_add_u32 m0, s29, 2048
    s_mov_b32 s30, 128
    buffer_load_dwordx4 v165, s[92:95], s30 offen lds
    s_add_u32 m0, s29, 3072
    s_mov_b32 s30, 192
    buffer_load_dwordx4 v165, s[92:95], s30 offen lds
    s_waitcnt vmcnt(17)
    ds_read2st64_b32 v[128:129], v170 offset0:16 offset1:17
    ds_read2st64_b32 v[130:131], v170 offset0:18 offset1:19
    ds_read2st64_b32 v[132:133], v170 offset0:20 offset1:21
    ds_read2st64_b32 v[134:135], v170 offset0:22 offset1:23
    ds_read2st64_b32 v[136:137], v170 offset0:24 offset1:25
    ds_read2st64_b32 v[138:139], v170 offset0:26 offset1:27
    ds_read2st64_b32 v[140:141], v170 offset0:28 offset1:29
    ds_read2st64_b32 v[142:143], v170 offset0:30 offset1:31
    v_perm_b32 v120, v145, v144, s31
    v_accvgpr_write_b32 a80, v120
    v_perm_b32 v121, v145, v144, s32
    v_accvgpr_write_b32 a88, v121
    v_perm_b32 v122, v147, v146, s31
    v_accvgpr_write_b32 a81, v122
    v_perm_b32 v123, v147, v146, s32
    v_accvgpr_write_b32 a89, v123
    v_perm_b32 v124, v149, v148, s31
    v_accvgpr_write_b32 a82, v124
    v_perm_b32 v125, v149, v148, s32
    v_accvgpr_write_b32 a90, v125
    v_perm_b32 v126, v151, v150, s31
    v_accvgpr_write_b32 a83, v126
    v_perm_b32 v127, v151, v150, s32
    v_accvgpr_write_b32 a91, v127
    v_perm_b32 v120, v153, v152, s31
    v_accvgpr_write_b32 a84, v120
    v_perm_b32 v121, v153, v152, s32
    v_accvgpr_write_b32 a92, v121
    v_perm_b32 v122, v155, v154, s31
    v_accvgpr_write_b32 a85, v122
    v_perm_b32 v123, v155, v154, s32
    v_accvgpr_write_b32 a93, v123
    v_perm_b32 v124, v157, v156, s31
    v_accvgpr_write_b32 a86, v124
    v_perm_b32 v125, v157, v156, s32
    v_accvgpr_write_b32 a94, v125
    v_perm_b32 v126, v159, v158, s31
    v_accvgpr_write_b32 a87, v126
    v_perm_b32 v127, v159, v158, s32
    v_accvgpr_write_b32 a95, v127
    s_waitcnt lgkmcnt(0)
    s_add_u32 m0, s29, 4096
    s_mov_b32 s30, 256
    buffer_load_dwordx4 v165, s[92:95], s30 offen lds
    s_add_u32 m0, s29, 5120
    s_mov_b32 s30, 5120
    buffer_load_dwordx4 v165, s[92:95], s30 offen lds
    s_add_u32 m0, s29, 6144
    s_mov_b32 s30, 5184
    buffer_load_dwordx4 v165, s[92:95], s30 offen lds
    s_add_u32 m0, s29, 7168
    s_mov_b32 s30, 5248
    buffer_load_dwordx4 v165, s[92:95], s30 offen lds
    s_waitcnt vmcnt(16)
    ds_read2st64_b32 v[144:145], v170 offset0:32 offset1:33
    ds_read2st64_b32 v[146:147], v170 offset0:34 offset1:35
    ds_read2st64_b32 v[148:149], v170 offset0:36 offset1:37
    ds_read2st64_b32 v[150:151], v170 offset0:38 offset1:39
    ds_read2st64_b32 v[152:153], v170 offset0:40 offset1:41
    ds_read2st64_b32 v[154:155], v170 offset0:42 offset1:43
    ds_read2st64_b32 v[156:157], v170 offset0:44 offset1:45
    ds_read2st64_b32 v[158:159], v170 offset0:46 offset1:47
    v_perm_b32 v120, v129, v128, s31
    v_accvgpr_write_b32 a96, v120
    v_perm_b32 v121, v129, v128, s32
    v_accvgpr_write_b32 a104, v121
    v_perm_b32 v122, v131, v130, s31
    v_accvgpr_write_b32 a97, v122
    v_perm_b32 v123, v131, v130, s32
    v_accvgpr_write_b32 a105, v123
    v_perm_b32 v124, v133, v132, s31
    v_accvgpr_write_b32 a98, v124
    v_perm_b32 v125, v133, v132, s32
    v_accvgpr_write_b32 a106, v125
    v_perm_b32 v126, v135, v134, s31
    v_accvgpr_write_b32 a99, v126
    v_perm_b32 v127, v135, v134, s32
    v_accvgpr_write_b32 a107, v127
    v_perm_b32 v120, v137, v136, s31
    v_accvgpr_write_b32 a100, v120
    v_perm_b32 v121, v137, v136, s32
    v_accvgpr_write_b32 a108, v121
    v_perm_b32 v122, v139, v138, s31
    v_accvgpr_write_b32 a101, v122
    v_perm_b32 v123, v139, v138, s32
    v_accvgpr_write_b32 a109, v123
    v_perm_b32 v124, v141, v140, s31
    v_accvgpr_write_b32 a102, v124
    v_perm_b32 v125, v141, v140, s32
    v_accvgpr_write_b32 a110, v125
    v_perm_b32 v126, v143, v142, s31
    v_accvgpr_write_b32 a103, v126
    v_perm_b32 v127, v143, v142, s32
    v_accvgpr_write_b32 a111, v127
    s_waitcnt lgkmcnt(0)
    s_add_u32 m0, s29, 8192
    s_mov_b32 s30, 5312
    buffer_load_dwordx4 v165, s[92:95], s30 offen lds
    s_add_u32 m0, s29, 9216
    s_mov_b32 s30, 5376
    buffer_load_dwordx4 v165, s[92:95], s30 offen lds
    s_add_u32 m0, s29, 10240
    s_mov_b32 s30, 40960
    buffer_load_dwordx4 v165, s[92:95], s30 offen lds
    s_add_u32 m0, s29, 11264
    s_mov_b32 s30, 41024
    buffer_load_dwordx4 v165, s[92:95], s30 offen lds
    s_waitcnt vmcnt(16)
    ds_read2st64_b32 v[128:129], v170 offset0:48 offset1:49
    ds_read2st64_b32 v[130:131], v170 offset0:50 offset1:51
    ds_read2st64_b32 v[132:133], v170 offset0:52 offset1:53
    ds_read2st64_b32 v[134:135], v170 offset0:54 offset1:55
    ds_read2st64_b32 v[136:137], v170 offset0:56 offset1:57
    ds_read2st64_b32 v[138:139], v170 offset0:58 offset1:59
    ds_read2st64_b32 v[140:141], v170 offset0:60 offset1:61
    ds_read2st64_b32 v[142:143], v170 offset0:62 offset1:63
    v_perm_b32 v120, v145, v144, s31
    v_accvgpr_write_b32 a112, v120
    v_perm_b32 v121, v145, v144, s32
    v_accvgpr_write_b32 a120, v121
    v_perm_b32 v122, v147, v146, s31
    v_accvgpr_write_b32 a113, v122
    v_perm_b32 v123, v147, v146, s32
    v_accvgpr_write_b32 a121, v123
    v_perm_b32 v124, v149, v148, s31
    v_accvgpr_write_b32 a114, v124
    v_perm_b32 v125, v149, v148, s32
    v_accvgpr_write_b32 a122, v125
    v_perm_b32 v126, v151, v150, s31
    v_accvgpr_write_b32 a115, v126
    v_perm_b32 v127, v151, v150, s32
    v_accvgpr_write_b32 a123, v127
    v_perm_b32 v120, v153, v152, s31
    v_accvgpr_write_b32 a116, v120
    v_perm_b32 v121, v153, v152, s32
    v_accvgpr_write_b32 a124, v121
    v_perm_b32 v122, v155, v154, s31
    v_accvgpr_write_b32 a117, v122
    v_perm_b32 v123, v155, v154, s32
    v_accvgpr_write_b32 a125, v123
    v_perm_b32 v124, v157, v156, s31
    v_accvgpr_write_b32 a118, v124
    v_perm_b32 v125, v157, v156, s32
    v_accvgpr_write_b32 a126, v125
    v_perm_b32 v126, v159, v158, s31
    v_accvgpr_write_b32 a119, v126
    v_perm_b32 v127, v159, v158, s32
    v_accvgpr_write_b32 a127, v127
    s_waitcnt lgkmcnt(0)
    s_add_u32 m0, s29, 12288
    s_mov_b32 s30, 41088
    buffer_load_dwordx4 v165, s[92:95], s30 offen lds
    s_add_u32 m0, s29, 13312
    s_mov_b32 s30, 41152
    buffer_load_dwordx4 v165, s[92:95], s30 offen lds
    s_add_u32 m0, s29, 14336
    s_mov_b32 s30, 41216
    buffer_load_dwordx4 v165, s[92:95], s30 offen lds
    s_add_u32 m0, s29, 15360
    s_mov_b32 s30, 46080
    buffer_load_dwordx4 v165, s[92:95], s30 offen lds
    buffer_load_dword v171, off, s[88:91], 0 offset:128 sc1
    s_waitcnt vmcnt(17)
    ds_read2st64_b32 v[144:145], v170 offset0:64 offset1:65
    ds_read2st64_b32 v[146:147], v170 offset0:66 offset1:67
    ds_read2st64_b32 v[148:149], v170 offset0:68 offset1:69
    ds_read2st64_b32 v[150:151], v170 offset0:70 offset1:71
    ds_read2st64_b32 v[152:153], v170 offset0:72 offset1:73
    ds_read2st64_b32 v[154:155], v170 offset0:74 offset1:75
    ds_read2st64_b32 v[156:157], v170 offset0:76 offset1:77
    ds_read2st64_b32 v[158:159], v170 offset0:78 offset1:79
    v_perm_b32 v120, v129, v128, s31
    v_accvgpr_write_b32 a128, v120
    v_perm_b32 v121, v129, v128, s32
    v_accvgpr_write_b32 a136, v121
    v_perm_b32 v122, v131, v130, s31
    v_accvgpr_write_b32 a129, v122
    v_perm_b32 v123, v131, v130, s32
    v_accvgpr_write_b32 a137, v123
    v_perm_b32 v124, v133, v132, s31
    v_accvgpr_write_b32 a130, v124
    v_perm_b32 v125, v133, v132, s32
    v_accvgpr_write_b32 a138, v125
    v_perm_b32 v126, v135, v134, s31
    v_accvgpr_write_b32 a131, v126
    v_perm_b32 v127, v135, v134, s32
    v_accvgpr_write_b32 a139, v127
    v_perm_b32 v120, v137, v136, s31
    v_accvgpr_write_b32 a132, v120
    v_perm_b32 v121, v137, v136, s32
    v_accvgpr_write_b32 a140, v121
    v_perm_b32 v122, v139, v138, s31
    v_accvgpr_write_b32 a133, v122
    v_perm_b32 v123, v139, v138, s32
    v_accvgpr_write_b32 a141, v123
    v_perm_b32 v124, v141, v140, s31
    v_accvgpr_write_b32 a134, v124
    v_perm_b32 v125, v141, v140, s32
    v_accvgpr_write_b32 a142, v125
    v_perm_b32 v126, v143, v142, s31
    v_accvgpr_write_b32 a135, v126
    v_perm_b32 v127, v143, v142, s32
    v_accvgpr_write_b32 a143, v127
    s_waitcnt lgkmcnt(0)
    s_add_u32 m0, s29, 16384
    s_mov_b32 s30, 46144
    buffer_load_dwordx4 v165, s[92:95], s30 offen lds
    s_add_u32 m0, s29, 17408
    s_mov_b32 s30, 46208
    buffer_load_dwordx4 v165, s[92:95], s30 offen lds
    s_add_u32 m0, s29, 18432
    s_mov_b32 s30, 46272
    buffer_load_dwordx4 v165, s[92:95], s30 offen lds
    s_add_u32 m0, s29, 19456
    s_mov_b32 s30, 46336
    buffer_load_dwordx4 v165, s[92:95], s30 offen lds
    s_waitcnt vmcnt(17)
    ds_read2st64_b32 v[128:129], v170 offset0:0 offset1:1
    ds_read2st64_b32 v[130:131], v170 offset0:2 offset1:3
    ds_read2st64_b32 v[132:133], v170 offset0:4 offset1:5
    ds_read2st64_b32 v[134:135], v170 offset0:6 offset1:7
    ds_read2st64_b32 v[136:137], v170 offset0:8 offset1:9
    ds_read2st64_b32 v[138:139], v170 offset0:10 offset1:11
    ds_read2st64_b32 v[140:141], v170 offset0:12 offset1:13
    ds_read2st64_b32 v[142:143], v170 offset0:14 offset1:15
    v_perm_b32 v120, v145, v144, s31
    v_accvgpr_write_b32 a144, v120
    v_perm_b32 v121, v145, v144, s32
    v_accvgpr_write_b32 a152, v121
    v_perm_b32 v122, v147, v146, s31
    v_accvgpr_write_b32 a145, v122
    v_perm_b32 v123, v147, v146, s32
    v_accvgpr_write_b32 a153, v123
    v_perm_b32 v124, v149, v148, s31
    v_accvgpr_write_b32 a146, v124
    v_perm_b32 v125, v149, v148, s32
    v_accvgpr_write_b32 a154, v125
    v_perm_b32 v126, v151, v150, s31
    v_accvgpr_write_b32 a147, v126
    v_perm_b32 v127, v151, v150, s32
    v_accvgpr_write_b32 a155, v127
    v_perm_b32 v120, v153, v152, s31
    v_accvgpr_write_b32 a148, v120
    v_perm_b32 v121, v153, v152, s32
    v_accvgpr_write_b32 a156, v121
    v_perm_b32 v122, v155, v154, s31
    v_accvgpr_write_b32 a149, v122
    v_perm_b32 v123, v155, v154, s32
    v_accvgpr_write_b32 a157, v123
    v_perm_b32 v124, v157, v156, s31
    v_accvgpr_write_b32 a150, v124
    v_perm_b32 v125, v157, v156, s32
    v_accvgpr_write_b32 a158, v125
    v_perm_b32 v126, v159, v158, s31
    v_accvgpr_write_b32 a151, v126
    v_perm_b32 v127, v159, v158, s32
    v_accvgpr_write_b32 a159, v127
    s_waitcnt lgkmcnt(0)
    s_add_u32 m0, s29, 0
    s_mov_b32 s30, 81920
    buffer_load_dwordx4 v165, s[92:95], s30 offen lds
    s_add_u32 m0, s29, 1024
    s_mov_b32 s30, 81984
    buffer_load_dwordx4 v165, s[92:95], s30 offen lds
    s_add_u32 m0, s29, 2048
    s_mov_b32 s30, 82048
    buffer_load_dwordx4 v165, s[92:95], s30 offen lds
    s_add_u32 m0, s29, 3072
    s_mov_b32 s30, 82112
    buffer_load_dwordx4 v165, s[92:95], s30 offen lds
    s_waitcnt vmcnt(17)
    ds_read2st64_b32 v[144:145], v170 offset0:16 offset1:17
    ds_read2st64_b32 v[146:147], v170 offset0:18 offset1:19
    ds_read2st64_b32 v[148:149], v170 offset0:20 offset1:21
    ds_read2st64_b32 v[150:151], v170 offset0:22 offset1:23
    ds_read2st64_b32 v[152:153], v170 offset0:24 offset1:25
    ds_read2st64_b32 v[154:155], v170 offset0:26 offset1:27
    ds_read2st64_b32 v[156:157], v170 offset0:28 offset1:29
    ds_read2st64_b32 v[158:159], v170 offset0:30 offset1:31
    v_perm_b32 v120, v129, v128, s31
    v_accvgpr_write_b32 a160, v120
    v_perm_b32 v121, v129, v128, s32
    v_accvgpr_write_b32 a176, v121
    v_perm_b32 v122, v131, v130, s31
    v_accvgpr_write_b32 a161, v122
    v_perm_b32 v123, v131, v130, s32
    v_accvgpr_write_b32 a177, v123
    v_perm_b32 v124, v133, v132, s31
    v_accvgpr_write_b32 a192, v124
    v_perm_b32 v125, v133, v132, s32
    v_accvgpr_write_b32 a208, v125
    v_perm_b32 v126, v135, v134, s31
    v_accvgpr_write_b32 a193, v126
    v_perm_b32 v127, v135, v134, s32
    v_accvgpr_write_b32 a209, v127
    v_perm_b32 v120, v137, v136, s31
    v_accvgpr_write_b32 a224, v120
    v_perm_b32 v121, v137, v136, s32
    v_accvgpr_write_b32 a240, v121
    v_perm_b32 v122, v139, v138, s31
    v_accvgpr_write_b32 a225, v122
    v_perm_b32 v123, v139, v138, s32
    v_accvgpr_write_b32 a241, v123
    v_perm_b32 v192, v141, v140, s31
    v_perm_b32 v208, v141, v140, s32
    v_perm_b32 v193, v143, v142, s31
    v_perm_b32 v209, v143, v142, s32
    s_waitcnt lgkmcnt(0)
    s_add_u32 m0, s29, 4096
    s_mov_b32 s30, 82176
    buffer_load_dwordx4 v165, s[92:95], s30 offen lds
    s_add_u32 m0, s29, 5120
    s_mov_b32 s30, 87040
    buffer_load_dwordx4 v165, s[92:95], s30 offen lds
    s_add_u32 m0, s29, 6144
    s_mov_b32 s30, 87104
    buffer_load_dwordx4 v165, s[92:95], s30 offen lds
    s_add_u32 m0, s29, 7168
    s_mov_b32 s30, 87168
    buffer_load_dwordx4 v165, s[92:95], s30 offen lds
    s_waitcnt vmcnt(17)
    ds_read2st64_b32 v[128:129], v170 offset0:32 offset1:33
    ds_read2st64_b32 v[130:131], v170 offset0:34 offset1:35
    ds_read2st64_b32 v[132:133], v170 offset0:36 offset1:37
    ds_read2st64_b32 v[134:135], v170 offset0:38 offset1:39
    ds_read2st64_b32 v[136:137], v170 offset0:40 offset1:41
    ds_read2st64_b32 v[138:139], v170 offset0:42 offset1:43
    ds_read2st64_b32 v[140:141], v170 offset0:44 offset1:45
    ds_read2st64_b32 v[142:143], v170 offset0:46 offset1:47
    v_perm_b32 v224, v145, v144, s31
    v_perm_b32 v240, v145, v144, s32
    v_perm_b32 v225, v147, v146, s31
    v_perm_b32 v241, v147, v146, s32
    v_perm_b32 v124, v149, v148, s31
    v_accvgpr_write_b32 a162, v124
    v_perm_b32 v125, v149, v148, s32
    v_accvgpr_write_b32 a178, v125
    v_perm_b32 v126, v151, v150, s31
    v_accvgpr_write_b32 a163, v126
    v_perm_b32 v127, v151, v150, s32
    v_accvgpr_write_b32 a179, v127
    v_perm_b32 v120, v153, v152, s31
    v_accvgpr_write_b32 a194, v120
    v_perm_b32 v121, v153, v152, s32
    v_accvgpr_write_b32 a210, v121
    v_perm_b32 v122, v155, v154, s31
    v_accvgpr_write_b32 a195, v122
    v_perm_b32 v123, v155, v154, s32
    v_accvgpr_write_b32 a211, v123
    v_perm_b32 v124, v157, v156, s31
    v_accvgpr_write_b32 a226, v124
    v_perm_b32 v125, v157, v156, s32
    v_accvgpr_write_b32 a242, v125
    v_perm_b32 v126, v159, v158, s31
    v_accvgpr_write_b32 a227, v126
    v_perm_b32 v127, v159, v158, s32
    v_accvgpr_write_b32 a243, v127
    s_waitcnt lgkmcnt(0)
    s_add_u32 m0, s29, 8192
    s_mov_b32 s30, 87232
    buffer_load_dwordx4 v165, s[92:95], s30 offen lds
    s_add_u32 m0, s29, 9216
    s_mov_b32 s30, 87296
    buffer_load_dwordx4 v165, s[92:95], s30 offen lds
    s_add_u32 m0, s29, 10240
    s_mov_b32 s30, 122880
    buffer_load_dwordx4 v165, s[92:95], s30 offen lds
    s_add_u32 m0, s29, 11264
    s_mov_b32 s30, 122944
    buffer_load_dwordx4 v165, s[92:95], s30 offen lds
    s_waitcnt vmcnt(17)
    ds_read2st64_b32 v[144:145], v170 offset0:48 offset1:49
    ds_read2st64_b32 v[146:147], v170 offset0:50 offset1:51
    ds_read2st64_b32 v[148:149], v170 offset0:52 offset1:53
    ds_read2st64_b32 v[150:151], v170 offset0:54 offset1:55
    ds_read2st64_b32 v[152:153], v170 offset0:56 offset1:57
    ds_read2st64_b32 v[154:155], v170 offset0:58 offset1:59
    ds_read2st64_b32 v[156:157], v170 offset0:60 offset1:61
    ds_read2st64_b32 v[158:159], v170 offset0:62 offset1:63
    v_perm_b32 v194, v129, v128, s31
    v_perm_b32 v210, v129, v128, s32
    v_perm_b32 v195, v131, v130, s31
    v_perm_b32 v211, v131, v130, s32
    v_perm_b32 v226, v133, v132, s31
    v_perm_b32 v242, v133, v132, s32
    v_perm_b32 v227, v135, v134, s31
    v_perm_b32 v243, v135, v134, s32
    v_perm_b32 v120, v137, v136, s31
    v_accvgpr_write_b32 a164, v120
    v_perm_b32 v121, v137, v136, s32
    v_accvgpr_write_b32 a180, v121
    v_perm_b32 v122, v139, v138, s31
    v_accvgpr_write_b32 a165, v122
    v_perm_b32 v123, v139, v138, s32
    v_accvgpr_write_b32 a181, v123
    v_perm_b32 v124, v141, v140, s31
    v_accvgpr_write_b32 a196, v124
    v_perm_b32 v125, v141, v140, s32
    v_accvgpr_write_b32 a212, v125
    v_perm_b32 v126, v143, v142, s31
    v_accvgpr_write_b32 a197, v126
    v_perm_b32 v127, v143, v142, s32
    v_accvgpr_write_b32 a213, v127
    s_waitcnt lgkmcnt(0)
    s_add_u32 m0, s29, 12288
    s_mov_b32 s30, 123008
    buffer_load_dwordx4 v165, s[92:95], s30 offen lds
    s_add_u32 m0, s29, 13312
    s_mov_b32 s30, 123072
    buffer_load_dwordx4 v165, s[92:95], s30 offen lds
    s_add_u32 m0, s29, 14336
    s_mov_b32 s30, 123136
    buffer_load_dwordx4 v165, s[92:95], s30 offen lds
    s_add_u32 m0, s29, 15360
    s_mov_b32 s30, 128000
    buffer_load_dwordx4 v165, s[92:95], s30 offen lds
    s_waitcnt vmcnt(16)
    ds_read2st64_b32 v[128:129], v170 offset0:64 offset1:65
    ds_read2st64_b32 v[130:131], v170 offset0:66 offset1:67
    ds_read2st64_b32 v[132:133], v170 offset0:68 offset1:69
    ds_read2st64_b32 v[134:135], v170 offset0:70 offset1:71
    ds_read2st64_b32 v[136:137], v170 offset0:72 offset1:73
    ds_read2st64_b32 v[138:139], v170 offset0:74 offset1:75
    ds_read2st64_b32 v[140:141], v170 offset0:76 offset1:77
    ds_read2st64_b32 v[142:143], v170 offset0:78 offset1:79
    v_perm_b32 v120, v145, v144, s31
    v_accvgpr_write_b32 a228, v120
    v_perm_b32 v121, v145, v144, s32
    v_accvgpr_write_b32 a244, v121
    v_perm_b32 v122, v147, v146, s31
    v_accvgpr_write_b32 a229, v122
    v_perm_b32 v123, v147, v146, s32
    v_accvgpr_write_b32 a245, v123
    v_perm_b32 v196, v149, v148, s31
    v_perm_b32 v212, v149, v148, s32
    v_perm_b32 v197, v151, v150, s31
    v_perm_b32 v213, v151, v150, s32
    v_perm_b32 v228, v153, v152, s31
    v_perm_b32 v244, v153, v152, s32
    v_perm_b32 v229, v155, v154, s31
    v_perm_b32 v245, v155, v154, s32
    v_perm_b32 v124, v157, v156, s31
    v_accvgpr_write_b32 a166, v124
    v_perm_b32 v125, v157, v156, s32
    v_accvgpr_write_b32 a182, v125
    v_perm_b32 v126, v159, v158, s31
    v_accvgpr_write_b32 a167, v126
    v_perm_b32 v127, v159, v158, s32
    v_accvgpr_write_b32 a183, v127
    s_waitcnt lgkmcnt(0)
    s_add_u32 m0, s29, 16384
    s_mov_b32 s30, 128064
    buffer_load_dwordx4 v165, s[92:95], s30 offen lds
    s_add_u32 m0, s29, 17408
    s_mov_b32 s30, 128128
    buffer_load_dwordx4 v165, s[92:95], s30 offen lds
    s_add_u32 m0, s29, 18432
    s_mov_b32 s30, 128192
    buffer_load_dwordx4 v165, s[92:95], s30 offen lds
    s_add_u32 m0, s29, 19456
    s_mov_b32 s30, 128256
    buffer_load_dwordx4 v165, s[92:95], s30 offen lds
    s_mul_i32 s20, s16, 40960
    s_mul_i32 s21, s18, 10240
    s_add_u32 s20, s20, s21
    s_add_u32 s20, s20, 2097152
    s_add_u32 s21, s21, s40
    s_mov_b32 m0, s21
    s_nop 0
    buffer_load_dwordx4 v4, s[4:7], s20 offen offset:0 sc1 lds
    buffer_load_dwordx4 v4, s[4:7], s20 offen offset:1024 sc1 lds
    buffer_load_dwordx4 v4, s[4:7], s20 offen offset:2048 sc1 lds
    buffer_load_dwordx4 v4, s[4:7], s20 offen offset:3072 sc1 lds
    s_add_u32 s20, s20, 4096
    s_add_u32 s21, s21, 4096
    s_mov_b32 m0, s21
    s_nop 0
    buffer_load_dwordx4 v4, s[4:7], s20 offen offset:0 sc1 lds
    buffer_load_dwordx4 v4, s[4:7], s20 offen offset:1024 sc1 lds
    buffer_load_dwordx4 v4, s[4:7], s20 offen offset:2048 sc1 lds
    buffer_load_dwordx4 v4, s[4:7], s20 offen offset:3072 sc1 lds
    s_add_u32 s20, s20, 4096
    s_add_u32 s21, s21, 4096
    s_mov_b32 m0, s21
    s_nop 0
    buffer_load_dwordx4 v4, s[4:7], s20 offen offset:0 sc1 lds
    buffer_load_dwordx4 v4, s[4:7], s20 offen offset:1024 sc1 lds
    s_waitcnt vmcnt(26)
    ds_read2st64_b32 v[144:145], v170 offset0:0 offset1:1
    ds_read2st64_b32 v[146:147], v170 offset0:2 offset1:3
    ds_read2st64_b32 v[148:149], v170 offset0:4 offset1:5
    ds_read2st64_b32 v[150:151], v170 offset0:6 offset1:7
    ds_read2st64_b32 v[152:153], v170 offset0:8 offset1:9
    ds_read2st64_b32 v[154:155], v170 offset0:10 offset1:11
    ds_read2st64_b32 v[156:157], v170 offset0:12 offset1:13
    ds_read2st64_b32 v[158:159], v170 offset0:14 offset1:15
    v_perm_b32 v120, v129, v128, s31
    v_accvgpr_write_b32 a198, v120
    v_perm_b32 v121, v129, v128, s32
    v_accvgpr_write_b32 a214, v121
    v_perm_b32 v122, v131, v130, s31
    v_accvgpr_write_b32 a199, v122
    v_perm_b32 v123, v131, v130, s32
    v_accvgpr_write_b32 a215, v123
    v_perm_b32 v124, v133, v132, s31
    v_accvgpr_write_b32 a230, v124
    v_perm_b32 v125, v133, v132, s32
    v_accvgpr_write_b32 a246, v125
    v_perm_b32 v126, v135, v134, s31
    v_accvgpr_write_b32 a231, v126
    v_perm_b32 v127, v135, v134, s32
    v_accvgpr_write_b32 a247, v127
    v_perm_b32 v198, v137, v136, s31
    v_perm_b32 v214, v137, v136, s32
    v_perm_b32 v199, v139, v138, s31
    v_perm_b32 v215, v139, v138, s32
    v_perm_b32 v230, v141, v140, s31
    v_perm_b32 v246, v141, v140, s32
    v_perm_b32 v231, v143, v142, s31
    v_perm_b32 v247, v143, v142, s32
    s_waitcnt lgkmcnt(0)
    s_waitcnt vmcnt(22)
    ds_read2st64_b32 v[128:129], v170 offset0:16 offset1:17
    ds_read2st64_b32 v[130:131], v170 offset0:18 offset1:19
    ds_read2st64_b32 v[132:133], v170 offset0:20 offset1:21
    ds_read2st64_b32 v[134:135], v170 offset0:22 offset1:23
    ds_read2st64_b32 v[136:137], v170 offset0:24 offset1:25
    ds_read2st64_b32 v[138:139], v170 offset0:26 offset1:27
    ds_read2st64_b32 v[140:141], v170 offset0:28 offset1:29
    ds_read2st64_b32 v[142:143], v170 offset0:30 offset1:31
    v_perm_b32 v120, v145, v144, s31
    v_accvgpr_write_b32 a168, v120
    v_perm_b32 v121, v145, v144, s32
    v_accvgpr_write_b32 a184, v121
    v_perm_b32 v122, v147, v146, s31
    v_accvgpr_write_b32 a169, v122
    v_perm_b32 v123, v147, v146, s32
    v_accvgpr_write_b32 a185, v123
    v_perm_b32 v124, v149, v148, s31
    v_accvgpr_write_b32 a200, v124
    v_perm_b32 v125, v149, v148, s32
    v_accvgpr_write_b32 a216, v125
    v_perm_b32 v126, v151, v150, s31
    v_accvgpr_write_b32 a201, v126
    v_perm_b32 v127, v151, v150, s32
    v_accvgpr_write_b32 a217, v127
    v_perm_b32 v120, v153, v152, s31
    v_accvgpr_write_b32 a232, v120
    v_perm_b32 v121, v153, v152, s32
    v_accvgpr_write_b32 a248, v121
    v_perm_b32 v122, v155, v154, s31
    v_accvgpr_write_b32 a233, v122
    v_perm_b32 v123, v155, v154, s32
    v_accvgpr_write_b32 a249, v123
    v_perm_b32 v200, v157, v156, s31
    v_perm_b32 v216, v157, v156, s32
    v_perm_b32 v201, v159, v158, s31
    v_perm_b32 v217, v159, v158, s32
    s_waitcnt lgkmcnt(0)
    s_waitcnt vmcnt(18)
    ds_read2st64_b32 v[144:145], v170 offset0:32 offset1:33
    ds_read2st64_b32 v[146:147], v170 offset0:34 offset1:35
    ds_read2st64_b32 v[148:149], v170 offset0:36 offset1:37
    ds_read2st64_b32 v[150:151], v170 offset0:38 offset1:39
    ds_read2st64_b32 v[152:153], v170 offset0:40 offset1:41
    ds_read2st64_b32 v[154:155], v170 offset0:42 offset1:43
    ds_read2st64_b32 v[156:157], v170 offset0:44 offset1:45
    ds_read2st64_b32 v[158:159], v170 offset0:46 offset1:47
    v_perm_b32 v232, v129, v128, s31
    v_perm_b32 v248, v129, v128, s32
    v_perm_b32 v233, v131, v130, s31
    v_perm_b32 v249, v131, v130, s32
    v_perm_b32 v124, v133, v132, s31
    v_accvgpr_write_b32 a170, v124
    v_perm_b32 v125, v133, v132, s32
    v_accvgpr_write_b32 a186, v125
    v_perm_b32 v126, v135, v134, s31
    v_accvgpr_write_b32 a171, v126
    v_perm_b32 v127, v135, v134, s32
    v_accvgpr_write_b32 a187, v127
    v_perm_b32 v120, v137, v136, s31
    v_accvgpr_write_b32 a202, v120
    v_perm_b32 v121, v137, v136, s32
    v_accvgpr_write_b32 a218, v121
    v_perm_b32 v122, v139, v138, s31
    v_accvgpr_write_b32 a203, v122
    v_perm_b32 v123, v139, v138, s32
    v_accvgpr_write_b32 a219, v123
    v_perm_b32 v124, v141, v140, s31
    v_accvgpr_write_b32 a234, v124
    v_perm_b32 v125, v141, v140, s32
    v_accvgpr_write_b32 a250, v125
    v_perm_b32 v126, v143, v142, s31
    v_accvgpr_write_b32 a235, v126
    v_perm_b32 v127, v143, v142, s32
    v_accvgpr_write_b32 a251, v127
    s_waitcnt lgkmcnt(0)
    s_waitcnt vmcnt(14)
    ds_read2st64_b32 v[128:129], v170 offset0:48 offset1:49
    ds_read2st64_b32 v[130:131], v170 offset0:50 offset1:51
    ds_read2st64_b32 v[132:133], v170 offset0:52 offset1:53
    ds_read2st64_b32 v[134:135], v170 offset0:54 offset1:55
    ds_read2st64_b32 v[136:137], v170 offset0:56 offset1:57
    ds_read2st64_b32 v[138:139], v170 offset0:58 offset1:59
    ds_read2st64_b32 v[140:141], v170 offset0:60 offset1:61
    ds_read2st64_b32 v[142:143], v170 offset0:62 offset1:63
    v_perm_b32 v202, v145, v144, s31
    v_perm_b32 v218, v145, v144, s32
    v_perm_b32 v203, v147, v146, s31
    v_perm_b32 v219, v147, v146, s32
    v_perm_b32 v234, v149, v148, s31
    v_perm_b32 v250, v149, v148, s32
    v_perm_b32 v235, v151, v150, s31
    v_perm_b32 v251, v151, v150, s32
    v_perm_b32 v120, v153, v152, s31
    v_accvgpr_write_b32 a172, v120
    v_perm_b32 v121, v153, v152, s32
    v_accvgpr_write_b32 a188, v121
    v_perm_b32 v122, v155, v154, s31
    v_accvgpr_write_b32 a173, v122
    v_perm_b32 v123, v155, v154, s32
    v_accvgpr_write_b32 a189, v123
    v_perm_b32 v124, v157, v156, s31
    v_accvgpr_write_b32 a204, v124
    v_perm_b32 v125, v157, v156, s32
    v_accvgpr_write_b32 a220, v125
    v_perm_b32 v126, v159, v158, s31
    v_accvgpr_write_b32 a205, v126
    v_perm_b32 v127, v159, v158, s32
    v_accvgpr_write_b32 a221, v127
    s_waitcnt lgkmcnt(0)
    s_waitcnt vmcnt(10)
    ds_read2st64_b32 v[144:145], v170 offset0:64 offset1:65
    ds_read2st64_b32 v[146:147], v170 offset0:66 offset1:67
    ds_read2st64_b32 v[148:149], v170 offset0:68 offset1:69
    ds_read2st64_b32 v[150:151], v170 offset0:70 offset1:71
    ds_read2st64_b32 v[152:153], v170 offset0:72 offset1:73
    ds_read2st64_b32 v[154:155], v170 offset0:74 offset1:75
    ds_read2st64_b32 v[156:157], v170 offset0:76 offset1:77
    ds_read2st64_b32 v[158:159], v170 offset0:78 offset1:79
    v_perm_b32 v120, v129, v128, s31
    v_accvgpr_write_b32 a236, v120
    v_perm_b32 v121, v129, v128, s32
    v_accvgpr_write_b32 a252, v121
    v_perm_b32 v122, v131, v130, s31
    v_accvgpr_write_b32 a237, v122
    v_perm_b32 v123, v131, v130, s32
    v_accvgpr_write_b32 a253, v123
    v_perm_b32 v204, v133, v132, s31
    v_perm_b32 v220, v133, v132, s32
    v_perm_b32 v205, v135, v134, s31
    v_perm_b32 v221, v135, v134, s32
    v_perm_b32 v236, v137, v136, s31
    v_perm_b32 v252, v137, v136, s32
    v_perm_b32 v237, v139, v138, s31
    v_perm_b32 v253, v139, v138, s32
    v_perm_b32 v124, v141, v140, s31
    v_accvgpr_write_b32 a174, v124
    v_perm_b32 v125, v141, v140, s32
    v_accvgpr_write_b32 a190, v125
    v_perm_b32 v126, v143, v142, s31
    v_accvgpr_write_b32 a175, v126
    v_perm_b32 v127, v143, v142, s32
    v_accvgpr_write_b32 a191, v127
    s_waitcnt lgkmcnt(0)
    v_perm_b32 v120, v145, v144, s31
    v_accvgpr_write_b32 a206, v120
    v_perm_b32 v121, v145, v144, s32
    v_accvgpr_write_b32 a222, v121
    v_perm_b32 v122, v147, v146, s31
    v_accvgpr_write_b32 a207, v122
    v_perm_b32 v123, v147, v146, s32
    v_accvgpr_write_b32 a223, v123
    v_perm_b32 v124, v149, v148, s31
    v_accvgpr_write_b32 a238, v124
    v_perm_b32 v125, v149, v148, s32
    v_accvgpr_write_b32 a254, v125
    v_perm_b32 v126, v151, v150, s31
    v_accvgpr_write_b32 a239, v126
    v_perm_b32 v127, v151, v150, s32
    v_accvgpr_write_b32 a255, v127
    v_perm_b32 v206, v153, v152, s31
    v_perm_b32 v222, v153, v152, s32
    v_perm_b32 v207, v155, v154, s31
    v_perm_b32 v223, v155, v154, s32
    v_perm_b32 v238, v157, v156, s31
    v_perm_b32 v254, v157, v156, s32
    v_perm_b32 v239, v159, v158, s31
    v_perm_b32 v255, v159, v158, s32
rev_5_b:
    s_mov_b32 s21, 0
    v_readfirstlane_b32 s19, v171
    s_and_b32 s22, s19, 255
    s_xor_b32 s22, s22, 64
    v_mov_b32 v172, 40960
    s_cmp_eq_u32 s18, 0
    s_cbranch_scc0 wi_7_w
    s_branch wi_7_chk
wi_7:
    buffer_load_dword v171, off, s[88:91], 0 offset:128 sc1
    s_waitcnt vmcnt(0)
wi_7_chk:
    v_readfirstlane_b32 s19, v171
    s_and_b32 s20, s19, 255
    s_cmp_eq_u32 s20, 64
    s_cbranch_scc1 wi_7_ok
    s_sleep 2
    s_add_u32 s21, s21, 1
    s_cmp_lt_u32 s21, 200000
    s_cbranch_scc1 wi_7
wi_7_ok:
    ds_write_b32 v172, v171
wi_7_w:
    s_waitcnt vmcnt(0) lgkmcnt(0)
    s_barrier
    ds_read_b32 v171, v172
    s_waitcnt lgkmcnt(0)
    v_readfirstlane_b32 s19, v171
    s_cmp_gt_u32 s19, 33024
    s_cselect_b32 s19, 0x2000, 0
    s_xor_b32 s34, s19, 0x2000
    s_cmp_eq_u32 s22, 0
    s_cbranch_scc1 nbk_6
    s_mul_i32 s20, s16, 40960
    s_mul_i32 s21, s18, 10240
    s_add_u32 s20, s20, s21
    s_add_u32 s20, s20, 2097152
    s_add_u32 s21, s21, s40
    s_mov_b32 m0, s21
    s_nop 0
    buffer_load_dwordx4 v4, s[4:7], s20 offen offset:0 sc1 lds
    buffer_load_dwordx4 v4, s[4:7], s20 offen offset:1024 sc1 lds
    buffer_load_dwordx4 v4, s[4:7], s20 offen offset:2048 sc1 lds
    buffer_load_dwordx4 v4, s[4:7], s20 offen offset:3072 sc1 lds
    s_add_u32 s20, s20, 4096
    s_add_u32 s21, s21, 4096
    s_mov_b32 m0, s21
    s_nop 0
    buffer_load_dwordx4 v4, s[4:7], s20 offen offset:0 sc1 lds
    buffer_load_dwordx4 v4, s[4:7], s20 offen offset:1024 sc1 lds
    buffer_load_dwordx4 v4, s[4:7], s20 offen offset:2048 sc1 lds
    buffer_load_dwordx4 v4, s[4:7], s20 offen offset:3072 sc1 lds
    s_add_u32 s20, s20, 4096
    s_add_u32 s21, s21, 4096
    s_mov_b32 m0, s21
    s_nop 0
    buffer_load_dwordx4 v4, s[4:7], s20 offen offset:0 sc1 lds
    buffer_load_dwordx4 v4, s[4:7], s20 offen offset:1024 sc1 lds
nbk_6:
    s_lshr_b32 s45, s17, 3
    s_lshl_b32 s45, s45, 14
    s_and_b32 s20, s17, 7
    s_lshl_b32 s20, s20, 10
    s_add_u32 s45, s45, s20
    s_add_u32 s45, s45, 75497472
    s_lshl_b32 s35, s17, 10
    s_xor_b32 s35, s35, s34
    s_lshl_b32 s20, s18, 10
    s_add_u32 s20, s20, 81920
    v_add_u32 v6, s20, v4
    v_add_u32 v7, 81920, v4
    s_and_b32 s21, s42, 15
    s_lshl_b32 s21, s21, 2
    s_lshr_b32 s20, s42, 4
    s_lshl_b32 s20, s20, 7
    s_add_u32 s20, s20, s21
    s_add_u32 s20, s20, 1867776
    s_add_u32 s20, s20, s19
    s_cmp_eq_u32 s18, 0
    s_cselect_b32 s20, s20, 0x40000000
    v_mov_b32 v9, s20
    v_cmp_eq_u32 vcc, 0, v1
    v_mov_b32 v3, 0x40000000
    s_nop 0
    v_cndmask_b32 v9, v3, v9, vcc
    v_mov_b32 v2, v4
    s_mul_i32 s49, s18, 10240
    s_add_u32 s48, s49, 2093056
    s_mov_b32 s22, 0
    s_mov_b32 s23, 0
    s_mov_b32 s50, 0
    s_waitcnt vmcnt(0)
    s_barrier
    ds_read_b128 v[100:103], v2 offset:0
    ds_read_b128 v[104:107], v2 offset:1024
    ds_read_b128 v[108:111], v2 offset:2048
    ds_read_b128 v[112:115], v2 offset:3072
L_vox_loop:
    v_mov_b32 v5, v2
    s_waitcnt lgkmcnt(3)
    v_mfma_f32_16x16x32_bf16 v[16:19], a[0:3], v[100:103], 0
    ds_read_b128 v[116:119], v5 offset:4096
    v_xor_b32 v2, 40960, v2
    s_xor_b32 s40, s40, 40960
    v_mfma_f32_16x16x32_bf16 v[20:23], a[8:11], v[100:103], 0
    s_waitcnt lgkmcnt(3)
    s_add_u32 s47, s40, s49
    s_sub_u32 s20, s16, 1
    v_mfma_f32_16x16x32_bf16 v[16:19], a[4:7], v[104:107], v[16:19]
    ds_read_b128 v[100:103], v5 offset:5120
    v_mov_b32 v10, s20
    s_cmp_lt_u32 s16, 3
    v_mfma_f32_16x16x32_bf16 v[20:23], a[12:15], v[104:107], v[20:23]
    s_waitcnt lgkmcnt(3)
    s_cselect_b32 s20, 2, s41
    s_add_u32 s43, s16, s20
    v_mfma_f32_16x16x32_bf16 v[16:19], a[16:19], v[108:111], v[16:19]
    ds_read_b128 v[104:107], v5 offset:6144
    s_min_u32 s46, s43, 63
    s_mul_i32 s46, s46, 40960
    v_mfma_f32_16x16x32_bf16 v[20:23], a[24:27], v[108:111], v[20:23]
    s_waitcnt lgkmcnt(3)
    s_add_u32 s46, s46, s48
    v_cvt_pk_bf16_f32 v164, v176, v180
    v_mfma_f32_16x16x32_bf16 v[16:19], a[20:23], v[112:115], v[16:19]
    ds_read_b128 v[108:111], v5 offset:7168
    v_cvt_pk_bf16_f32 v165, v177, v181
    v_cvt_pk_bf16_f32 v166, v178, v182
    v_mfma_f32_16x16x32_bf16 v[20:23], a[28:31], v[112:115], v[20:23]
    s_waitcnt lgkmcnt(3)
    v_cvt_pk_bf16_f32 v167, v179, v183
    s_lshr_b32 s21, s23, 8
    v_mfma_f32_16x16x32_bf16 v[16:19], a[32:35], v[116:119], v[16:19]
    ds_read_b128 v[112:115], v5 offset:8192
    s_xor_b32 s21, s21, s35
    s_and_b32 s21, s21, 0x2000
    v_mfma_f32_16x16x32_bf16 v[20:23], a[40:43], v[116:119], v[20:23]
    s_waitcnt lgkmcnt(3)
    s_or_b32 s22, s23, s21
    v_mfma_f32_16x16x32_bf16 v[16:19], a[36:39], v[100:103], v[16:19]
    ds_read_b128 v[116:119], v5 offset:9216
    buffer_store_dwordx4 v[160:163], v3, s[4:7], s22 offen sc1
    v_mfma_f32_16x16x32_bf16 v[20:23], a[44:47], v[100:103], v[20:23]
    s_waitcnt lgkmcnt(3)
    s_add_u32 s23, s23, 65536
    v_mfma_f32_16x16x32_bf16 v[16:19], a[48:51], v[104:107], v[16:19]
    ds_read_b128 v[100:103], v5 offset:10240
    v_mfma_f32_16x16x32_bf16 v[20:23], a[56:59], v[104:107], v[20:23]
    s_waitcnt lgkmcnt(3)
    v_mfma_f32_16x16x32_bf16 v[16:19], a[52:55], v[108:111], v[16:19]
    ds_read_b128 v[104:107], v5 offset:11264
    v_mfma_f32_16x16x32_bf16 v[20:23], a[60:63], v[108:111], v[20:23]
    s_waitcnt lgkmcnt(3)
    s_add_u32 m0, s47, 0
    s_add_u32 s46, s46, 4096
    buffer_load_dwordx4 v4, s[4:7], s46 offen offset:0 sc1 lds
    v_mfma_f32_16x16x32_bf16 v[16:19], a[64:67], v[112:115], v[16:19]
    ds_read_b128 v[108:111], v5 offset:12288
    s_lshr_b32 s21, s23, 8
    s_xor_b32 s21, s21, s35
    v_mfma_f32_16x16x32_bf16 v[20:23], a[72:75], v[112:115], v[20:23]
    s_waitcnt lgkmcnt(3)
    s_and_b32 s21, s21, 0x2000
    s_or_b32 s22, s23, s21
    v_mfma_f32_16x16x32_bf16 v[16:19], a[68:71], v[116:119], v[16:19]
    ds_read_b128 v[112:115], v5 offset:13312
    buffer_store_dwordx4 v[164:167], v3, s[4:7], s22 offen sc1
    v_mfma_f32_16x16x32_bf16 v[20:23], a[76:79], v[116:119], v[20:23]
    s_waitcnt lgkmcnt(3)
    s_add_u32 s23, s23, 65536
    s_and_b32 s23, s16, 63
    v_mfma_f32_16x16x32_bf16 v[16:19], a[80:83], v[100:103], v[16:19]
    ds_read_b128 v[116:119], v5 offset:14336
    s_mul_i32 s23, s23, 40
    s_mul_i32 s21, s18, 10
    v_mfma_f32_16x16x32_bf16 v[20:23], a[88:91], v[100:103], v[20:23]
    s_waitcnt lgkmcnt(3)
    s_add_u32 s23, s23, s21
    s_lshl_b32 s23, s23, 16
    v_mfma_f32_16x16x32_bf16 v[16:19], a[84:87], v[104:107], v[16:19]
    ds_read_b128 v[100:103], v5 offset:15360
    s_add_u32 s23, s23, s45
    v_mov_b32 v3, v4
    v_mfma_f32_16x16x32_bf16 v[20:23], a[92:95], v[104:107], v[20:23]
    s_waitcnt lgkmcnt(3)
    v_mfma_f32_16x16x32_bf16 v[16:19], a[96:99], v[108:111], v[16:19]
    ds_read_b128 v[104:107], v5 offset:16384
    v_mfma_f32_16x16x32_bf16 v[20:23], a[104:107], v[108:111], v[20:23]
    s_waitcnt lgkmcnt(3)
    buffer_load_dwordx4 v4, s[4:7], s46 offen offset:1024 sc1 lds
    v_mfma_f32_16x16x32_bf16 v[16:19], a[100:103], v[112:115], v[16:19]
    ds_read_b128 v[108:111], v5 offset:17408
    v_mfma_f32_16x16x32_bf16 v[20:23], a[108:111], v[112:115], v[20:23]
    s_waitcnt lgkmcnt(3)
    v_mfma_f32_16x16x32_bf16 v[16:19], a[112:115], v[116:119], v[16:19]
    ds_read_b128 v[112:115], v5 offset:18432
    v_mfma_f32_16x16x32_bf16 v[20:23], a[120:123], v[116:119], v[20:23]
    s_waitcnt lgkmcnt(3)
    v_mfma_f32_16x16x32_bf16 v[16:19], a[116:119], v[100:103], v[16:19]
    ds_read_b128 v[116:119], v5 offset:19456
    v_mfma_f32_16x16x32_bf16 v[20:23], a[124:127], v[100:103], v[20:23]
    s_waitcnt lgkmcnt(3)
    v_mfma_f32_16x16x32_bf16 v[16:19], a[128:131], v[104:107], v[16:19]
    ds_read_b128 v[100:103], v5 offset:20480
    v_mfma_f32_16x16x32_bf16 v[20:23], a[136:139], v[104:107], v[20:23]
    s_waitcnt lgkmcnt(3)
    v_mfma_f32_16x16x32_bf16 v[16:19], a[132:135], v[108:111], v[16:19]
    ds_read_b128 v[104:107], v5 offset:21504
    v_mfma_f32_16x16x32_bf16 v[20:23], a[140:143], v[108:111], v[20:23]
    s_waitcnt lgkmcnt(3)
    buffer_load_dwordx4 v4, s[4:7], s46 offen offset:2048 sc1 lds
    v_mfma_f32_16x16x32_bf16 v[16:19], a[144:147], v[112:115], v[16:19]
    ds_read_b128 v[108:111], v5 offset:22528
    v_mfma_f32_16x16x32_bf16 v[20:23], a[152:155], v[112:115], v[20:23]
    s_waitcnt lgkmcnt(3)
    v_mfma_f32_16x16x32_bf16 v[16:19], a[148:151], v[116:119], v[16:19]
    ds_read_b128 v[112:115], v5 offset:23552
    v_mfma_f32_16x16x32_bf16 v[20:23], a[156:159], v[116:119], v[20:23]
    s_waitcnt lgkmcnt(3)
    v_mfma_f32_16x16x32_bf16 v[24:27], a[0:3], v[100:103], 0
    ds_read_b128 v[116:119], v5 offset:24576
    v_mfma_f32_16x16x32_bf16 v[28:31], a[8:11], v[100:103], 0
    s_waitcnt lgkmcnt(3)
    v_mfma_f32_16x16x32_bf16 v[24:27], a[4:7], v[104:107], v[24:27]
    ds_read_b128 v[100:103], v5 offset:25600
    v_cvt_pk_bf16_f32 v32, v16, v17
    v_cvt_pk_bf16_f32 v33, v20, v21
    v_mfma_f32_16x16x32_bf16 v[28:31], a[12:15], v[104:107], v[28:31]
    s_waitcnt lgkmcnt(3)
    v_cvt_pk_bf16_f32 v34, v18, v19
    v_cvt_pk_bf16_f32 v35, v22, v23
    v_mfma_f32_16x16x32_bf16 v[24:27], a[16:19], v[108:111], v[24:27]
    ds_read_b128 v[104:107], v5 offset:26624
    v_mfma_f32_16x16x32_bf16 v[28:31], a[24:27], v[108:111], v[28:31]
    s_waitcnt lgkmcnt(3)
    buffer_load_dwordx4 v4, s[4:7], s46 offen offset:3072 sc1 lds
    v_mfma_f32_16x16x32_bf16 v[24:27], a[20:23], v[112:115], v[24:27]
    ds_read_b128 v[108:111], v5 offset:27648
    ds_write_b128 v6, v[32:35] offset:0
    v_mfma_f32_16x16x32_bf16 v[28:31], a[28:31], v[112:115], v[28:31]
    s_waitcnt lgkmcnt(4)
    v_mfma_f32_16x16x32_bf16 v[24:27], a[32:35], v[116:119], v[24:27]
    ds_read_b128 v[112:115], v5 offset:28672
    v_mfma_f32_16x16x32_bf16 v[28:31], a[40:43], v[116:119], v[28:31]
    s_waitcnt lgkmcnt(4)
    v_mfma_f32_16x16x32_bf16 v[24:27], a[36:39], v[100:103], v[24:27]
    ds_read_b128 v[116:119], v5 offset:29696
    v_mfma_f32_16x16x32_bf16 v[28:31], a[44:47], v[100:103], v[28:31]
    s_waitcnt lgkmcnt(4)
    v_mfma_f32_16x16x32_bf16 v[24:27], a[48:51], v[104:107], v[24:27]
    ds_read_b128 v[100:103], v5 offset:30720
    v_mfma_f32_16x16x32_bf16 v[28:31], a[56:59], v[104:107], v[28:31]
    s_waitcnt lgkmcnt(4)
    v_mfma_f32_16x16x32_bf16 v[24:27], a[52:55], v[108:111], v[24:27]
    ds_read_b128 v[104:107], v5 offset:31744
    v_mfma_f32_16x16x32_bf16 v[28:31], a[60:63], v[108:111], v[28:31]
    s_waitcnt lgkmcnt(3)
    s_add_u32 m0, s47, 4096
    s_add_u32 s46, s46, 4096
    buffer_load_dwordx4 v4, s[4:7], s46 offen offset:0 sc1 lds
    v_mfma_f32_16x16x32_bf16 v[24:27], a[64:67], v[112:115], v[24:27]
    ds_read_b128 v[108:111], v5 offset:32768
    v_mfma_f32_16x16x32_bf16 v[28:31], a[72:75], v[112:115], v[28:31]
    s_waitcnt lgkmcnt(3)
    v_mfma_f32_16x16x32_bf16 v[24:27], a[68:71], v[116:119], v[24:27]
    ds_read_b128 v[112:115], v5 offset:33792
    v_mfma_f32_16x16x32_bf16 v[28:31], a[76:79], v[116:119], v[28:31]
    s_waitcnt lgkmcnt(3)
    v_mfma_f32_16x16x32_bf16 v[24:27], a[80:83], v[100:103], v[24:27]
    ds_read_b128 v[116:119], v5 offset:34816
    v_mfma_f32_16x16x32_bf16 v[28:31], a[88:91], v[100:103], v[28:31]
    s_waitcnt lgkmcnt(3)
    v_mfma_f32_16x16x32_bf16 v[24:27], a[84:87], v[104:107], v[24:27]
    ds_read_b128 v[100:103], v5 offset:35840
    v_mfma_f32_16x16x32_bf16 v[28:31], a[92:95], v[104:107], v[28:31]
    s_waitcnt lgkmcnt(3)
    v_mfma_f32_16x16x32_bf16 v[24:27], a[96:99], v[108:111], v[24:27]
    ds_read_b128 v[104:107], v5 offset:36864
    v_mfma_f32_16x16x32_bf16 v[28:31], a[104:107], v[108:111], v[28:31]
    s_waitcnt lgkmcnt(3)
    buffer_load_dwordx4 v4, s[4:7], s46 offen offset:1024 sc1 lds
    v_mfma_f32_16x16x32_bf16 v[24:27], a[100:103], v[112:115], v[24:27]
    ds_read_b128 v[108:111], v5 offset:37888
    v_mfma_f32_16x16x32_bf16 v[28:31], a[108:111], v[112:115], v[28:31]
    s_waitcnt lgkmcnt(3)
    v_mfma_f32_16x16x32_bf16 v[24:27], a[112:115], v[116:119], v[24:27]
    ds_read_b128 v[112:115], v5 offset:38912
    s_barrier
    v_mfma_f32_16x16x32_bf16 v[28:31], a[120:123], v[116:119], v[28:31]
    s_waitcnt lgkmcnt(3)
    v_mfma_f32_16x16x32_bf16 v[24:27], a[116:119], v[100:103], v[24:27]
    ds_read_b128 v[116:119], v5 offset:39936
    v_mfma_f32_16x16x32_bf16 v[28:31], a[124:127], v[100:103], v[28:31]
    s_waitcnt lgkmcnt(3)
    v_mfma_f32_16x16x32_bf16 v[24:27], a[128:131], v[104:107], v[24:27]
    ds_read_b128 v[40:43], v7 offset:0
    v_mfma_f32_16x16x32_bf16 v[28:31], a[136:139], v[104:107], v[28:31]
    s_waitcnt lgkmcnt(3)
    v_mfma_f32_16x16x32_bf16 v[24:27], a[132:135], v[108:111], v[24:27]
    ds_read_b128 v[44:47], v7 offset:1024
    v_mfma_f32_16x16x32_bf16 v[28:31], a[140:143], v[108:111], v[28:31]
    s_waitcnt lgkmcnt(3)
    buffer_load_dwordx4 v4, s[4:7], s46 offen offset:2048 sc1 lds
    v_mfma_f32_16x16x32_bf16 v[24:27], a[144:147], v[112:115], v[24:27]
    ds_read_b128 v[48:51], v7 offset:2048
    v_mfma_f32_16x16x32_bf16 v[28:31], a[152:155], v[112:115], v[28:31]
    s_waitcnt lgkmcnt(3)
    v_mfma_f32_16x16x32_bf16 v[24:27], a[148:151], v[116:119], v[24:27]
    ds_read_b128 v[52:55], v7 offset:3072
    v_mfma_f32_16x16x32_bf16 v[28:31], a[156:159], v[116:119], v[28:31]
    s_waitcnt lgkmcnt(3)
    v_mfma_f32_16x16x32_bf16 v[72:75], v[40:43], a[160:163], 0
    s_waitcnt lgkmcnt(2)
    v_mfma_f32_16x16x32_bf16 v[72:75], v[44:47], a[164:167], v[72:75]
    v_cvt_pk_bf16_f32 v36, v24, v25
    v_cvt_pk_bf16_f32 v37, v28, v29
    s_waitcnt lgkmcnt(1)
    v_mfma_f32_16x16x32_bf16 v[72:75], v[48:51], a[168:171], v[72:75]
    v_cvt_pk_bf16_f32 v38, v26, v27
    v_cvt_pk_bf16_f32 v39, v30, v31
    s_waitcnt lgkmcnt(0)
    v_mfma_f32_16x16x32_bf16 v[72:75], v[52:55], a[172:175], v[72:75]
    ds_write_b128 v6, v[36:39] offset:4096
    v_mfma_f32_16x16x32_bf16 v[80:83], v[40:43], a[176:179], 0
    v_mfma_f32_16x16x32_bf16 v[80:83], v[44:47], a[180:183], v[80:83]
    buffer_load_dwordx4 v4, s[4:7], s46 offen offset:3072 sc1 lds
    v_mfma_f32_16x16x32_bf16 v[80:83], v[48:51], a[184:187], v[80:83]
    v_mfma_f32_16x16x32_bf16 v[80:83], v[52:55], a[188:191], v[80:83]
    v_mfma_f32_16x16x32_bf16 v[88:91], v[40:43], a[192:195], 0
    v_mfma_f32_16x16x32_bf16 v[88:91], v[44:47], a[196:199], v[88:91]
    v_mfma_f32_16x16x32_bf16 v[88:91], v[48:51], a[200:203], v[88:91]
    v_mfma_f32_16x16x32_bf16 v[88:91], v[52:55], a[204:207], v[88:91]
    s_waitcnt lgkmcnt(0)
    s_barrier
    ds_read_b128 v[56:59], v7 offset:4096
    v_mfma_f32_16x16x32_bf16 v[168:171], v[40:43], a[208:211], 0
    ds_read_b128 v[60:63], v7 offset:5120
    v_mfma_f32_16x16x32_bf16 v[168:171], v[44:47], a[212:215], v[168:171]
    ds_read_b128 v[64:67], v7 offset:6144
    v_mfma_f32_16x16x32_bf16 v[168:171], v[48:51], a[216:219], v[168:171]
    ds_read_b128 v[68:71], v7 offset:7168
    v_mfma_f32_16x16x32_bf16 v[168:171], v[52:55], a[220:223], v[168:171]
    s_add_u32 m0, s47, 8192
    s_add_u32 s46, s46, 4096
    buffer_load_dwordx4 v4, s[4:7], s46 offen offset:0 sc1 lds
    v_mfma_f32_16x16x32_bf16 v[176:179], v[40:43], a[224:227], 0
    v_mfma_f32_16x16x32_bf16 v[176:179], v[44:47], a[228:231], v[176:179]
    v_mfma_f32_16x16x32_bf16 v[176:179], v[48:51], a[232:235], v[176:179]
    v_mfma_f32_16x16x32_bf16 v[176:179], v[52:55], a[236:239], v[176:179]
    s_waitcnt lgkmcnt(3)
    v_mfma_f32_16x16x32_bf16 v[76:79], v[56:59], a[160:163], 0
    s_waitcnt lgkmcnt(2)
    v_mfma_f32_16x16x32_bf16 v[76:79], v[60:63], a[164:167], v[76:79]
    s_waitcnt lgkmcnt(1)
    v_mfma_f32_16x16x32_bf16 v[76:79], v[64:67], a[168:171], v[76:79]
    s_waitcnt lgkmcnt(0)
    v_mfma_f32_16x16x32_bf16 v[76:79], v[68:71], a[172:175], v[76:79]
    v_mfma_f32_16x16x32_bf16 v[84:87], v[56:59], a[176:179], 0
    v_mfma_f32_16x16x32_bf16 v[84:87], v[60:63], a[180:183], v[84:87]
    buffer_load_dwordx4 v4, s[4:7], s46 offen offset:1024 sc1 lds
    v_mfma_f32_16x16x32_bf16 v[84:87], v[64:67], a[184:187], v[84:87]
    v_cvt_pk_bf16_f32 v128, v72, v76
    v_cvt_pk_bf16_f32 v129, v73, v77
    v_mfma_f32_16x16x32_bf16 v[84:87], v[68:71], a[188:191], v[84:87]
    v_cvt_pk_bf16_f32 v130, v74, v78
    v_cvt_pk_bf16_f32 v131, v75, v79
    v_mfma_f32_16x16x32_bf16 v[92:95], v[56:59], a[192:195], 0
    s_lshr_b32 s21, s23, 8
    s_xor_b32 s21, s21, s35
    s_and_b32 s21, s21, 0x2000
    v_mfma_f32_16x16x32_bf16 v[92:95], v[60:63], a[196:199], v[92:95]
    v_cvt_pk_bf16_f32 v132, v80, v84
    v_cvt_pk_bf16_f32 v133, v81, v85
    v_mfma_f32_16x16x32_bf16 v[92:95], v[64:67], a[200:203], v[92:95]
    v_cvt_pk_bf16_f32 v134, v82, v86
    v_cvt_pk_bf16_f32 v135, v83, v87
    v_mfma_f32_16x16x32_bf16 v[92:95], v[68:71], a[204:207], v[92:95]
    s_or_b32 s22, s23, s21
    buffer_store_dwordx4 v[128:131], v4, s[4:7], s22 offen sc1
    v_mfma_f32_16x16x32_bf16 v[172:175], v[56:59], a[208:211], 0
    s_add_u32 s23, s23, 65536
    s_lshr_b32 s21, s23, 8
    s_xor_b32 s21, s21, s35
    v_mfma_f32_16x16x32_bf16 v[172:175], v[60:63], a[212:215], v[172:175]
    v_cvt_pk_bf16_f32 v136, v88, v92
    v_cvt_pk_bf16_f32 v137, v89, v93
    v_mfma_f32_16x16x32_bf16 v[172:175], v[64:67], a[216:219], v[172:175]
    v_cvt_pk_bf16_f32 v138, v90, v94
    v_cvt_pk_bf16_f32 v139, v91, v95
    v_mfma_f32_16x16x32_bf16 v[172:175], v[68:71], a[220:223], v[172:175]
    s_and_b32 s21, s21, 0x2000
    s_or_b32 s22, s23, s21
    v_mfma_f32_16x16x32_bf16 v[180:183], v[56:59], a[224:227], 0
    buffer_store_dwordx4 v[132:135], v4, s[4:7], s22 offen sc1
    v_mfma_f32_16x16x32_bf16 v[180:183], v[60:63], a[228:231], v[180:183]
    v_cvt_pk_bf16_f32 v140, v168, v172
    v_cvt_pk_bf16_f32 v141, v169, v173
    v_mfma_f32_16x16x32_bf16 v[180:183], v[64:67], a[232:235], v[180:183]
    v_cvt_pk_bf16_f32 v142, v170, v174
    v_cvt_pk_bf16_f32 v143, v171, v175
    v_mfma_f32_16x16x32_bf16 v[180:183], v[68:71], a[236:239], v[180:183]
    s_add_u32 s23, s23, 65536
    s_lshr_b32 s21, s23, 8
    s_xor_b32 s21, s21, s35
    v_mfma_f32_16x16x32_bf16 v[72:75], v[40:43], a[240:243], 0
    s_and_b32 s21, s21, 0x2000
    s_or_b32 s22, s23, s21
    v_mfma_f32_16x16x32_bf16 v[72:75], v[44:47], a[244:247], v[72:75]
    v_cvt_pk_bf16_f32 v144, v176, v180
    v_cvt_pk_bf16_f32 v145, v177, v181
    v_mfma_f32_16x16x32_bf16 v[72:75], v[48:51], a[248:251], v[72:75]
    v_cvt_pk_bf16_f32 v146, v178, v182
    v_cvt_pk_bf16_f32 v147, v179, v183
    v_mfma_f32_16x16x32_bf16 v[72:75], v[52:55], a[252:255], v[72:75]
    buffer_store_dwordx4 v[136:139], v4, s[4:7], s22 offen sc1
    v_mfma_f32_16x16x32_bf16 v[76:79], v[56:59], a[240:243], 0
    s_add_u32 s23, s23, 65536
    v_mfma_f32_16x16x32_bf16 v[76:79], v[60:63], a[244:247], v[76:79]
    v_mfma_f32_16x16x32_bf16 v[76:79], v[64:67], a[248:251], v[76:79]
    s_lshr_b32 s21, s23, 8
    s_xor_b32 s21, s21, s35
    s_and_b32 s21, s21, 0x2000
    v_mfma_f32_16x16x32_bf16 v[76:79], v[68:71], a[252:255], v[76:79]
    s_or_b32 s22, s23, s21
    buffer_store_dwordx4 v[140:143], v4, s[4:7], s22 offen sc1
    v_mfma_f32_16x16x32_bf16 v[80:83], v[40:43], v[192:195], 0
    s_add_u32 s23, s23, 65536
    v_mfma_f32_16x16x32_bf16 v[80:83], v[44:47], v[196:199], v[80:83]
    v_cvt_pk_bf16_f32 v148, v72, v76
    v_cvt_pk_bf16_f32 v149, v73, v77
    v_mfma_f32_16x16x32_bf16 v[80:83], v[48:51], v[200:203], v[80:83]
    v_cvt_pk_bf16_f32 v150, v74, v78
    v_cvt_pk_bf16_f32 v151, v75, v79
    v_mfma_f32_16x16x32_bf16 v[80:83], v[52:55], v[204:207], v[80:83]
    v_mfma_f32_16x16x32_bf16 v[84:87], v[56:59], v[192:195], 0
    v_mfma_f32_16x16x32_bf16 v[84:87], v[60:63], v[196:199], v[84:87]
    s_lshr_b32 s21, s23, 8
    s_xor_b32 s21, s21, s35
    s_and_b32 s21, s21, 0x2000
    v_mfma_f32_16x16x32_bf16 v[84:87], v[64:67], v[200:203], v[84:87]
    s_or_b32 s22, s23, s21
    buffer_store_dwordx4 v[144:147], v4, s[4:7], s22 offen sc1
    v_mfma_f32_16x16x32_bf16 v[84:87], v[68:71], v[204:207], v[84:87]
    s_add_u32 s23, s23, 65536
    v_mfma_f32_16x16x32_bf16 v[88:91], v[40:43], v[208:211], 0
    v_mfma_f32_16x16x32_bf16 v[88:91], v[44:47], v[212:215], v[88:91]
    v_cvt_pk_bf16_f32 v152, v80, v84
    v_cvt_pk_bf16_f32 v153, v81, v85
    v_mfma_f32_16x16x32_bf16 v[88:91], v[48:51], v[216:219], v[88:91]
    v_cvt_pk_bf16_f32 v154, v82, v86
    v_cvt_pk_bf16_f32 v155, v83, v87
    v_mfma_f32_16x16x32_bf16 v[88:91], v[52:55], v[220:223], v[88:91]
    s_lshr_b32 s21, s23, 8
    s_xor_b32 s21, s21, s35
    s_and_b32 s21, s21, 0x2000
    v_mfma_f32_16x16x32_bf16 v[92:95], v[56:59], v[208:211], 0
    s_or_b32 s22, s23, s21
    buffer_store_dwordx4 v[148:151], v4, s[4:7], s22 offen sc1
    v_mfma_f32_16x16x32_bf16 v[92:95], v[60:63], v[212:215], v[92:95]
    s_add_u32 s23, s23, 65536
    v_mfma_f32_16x16x32_bf16 v[92:95], v[64:67], v[216:219], v[92:95]
    v_mfma_f32_16x16x32_bf16 v[92:95], v[68:71], v[220:223], v[92:95]
    v_mfma_f32_16x16x32_bf16 v[168:171], v[40:43], v[224:227], 0
    v_mfma_f32_16x16x32_bf16 v[168:171], v[44:47], v[228:231], v[168:171]
    v_cvt_pk_bf16_f32 v156, v88, v92
    v_cvt_pk_bf16_f32 v157, v89, v93
    v_mfma_f32_16x16x32_bf16 v[168:171], v[48:51], v[232:235], v[168:171]
    v_cvt_pk_bf16_f32 v158, v90, v94
    v_cvt_pk_bf16_f32 v159, v91, v95
    v_mfma_f32_16x16x32_bf16 v[168:171], v[52:55], v[236:239], v[168:171]
    s_lshr_b32 s21, s23, 8
    s_xor_b32 s21, s21, s35
    s_and_b32 s21, s21, 0x2000
    v_mfma_f32_16x16x32_bf16 v[172:175], v[56:59], v[224:227], 0
    s_or_b32 s22, s23, s21
    buffer_store_dwordx4 v[152:155], v4, s[4:7], s22 offen sc1
    v_mfma_f32_16x16x32_bf16 v[172:175], v[60:63], v[228:231], v[172:175]
    s_add_u32 s23, s23, 65536
    v_mfma_f32_16x16x32_bf16 v[172:175], v[64:67], v[232:235], v[172:175]
    s_waitcnt vmcnt(7)
    s_barrier
    buffer_store_dword v10, v9, s[8:11], 0 offen sc1
    v_mfma_f32_16x16x32_bf16 v[172:175], v[68:71], v[236:239], v[172:175]
    v_mfma_f32_16x16x32_bf16 v[176:179], v[40:43], v[240:243], 0
    ds_read_b128 v[100:103], v2 offset:0
    v_mfma_f32_16x16x32_bf16 v[176:179], v[44:47], v[244:247], v[176:179]
    ds_read_b128 v[104:107], v2 offset:1024
    v_cvt_pk_bf16_f32 v160, v168, v172
    v_cvt_pk_bf16_f32 v161, v169, v173
    v_mfma_f32_16x16x32_bf16 v[176:179], v[48:51], v[248:251], v[176:179]
    ds_read_b128 v[108:111], v2 offset:2048
    v_cvt_pk_bf16_f32 v162, v170, v174
    v_cvt_pk_bf16_f32 v163, v171, v175
    v_mfma_f32_16x16x32_bf16 v[176:179], v[52:55], v[252:255], v[176:179]
    ds_read_b128 v[112:115], v2 offset:3072
    s_lshr_b32 s21, s23, 8
    s_xor_b32 s21, s21, s35
    v_mfma_f32_16x16x32_bf16 v[180:183], v[56:59], v[240:243], 0
    s_and_b32 s21, s21, 0x2000
    s_or_b32 s22, s23, s21
    v_mfma_f32_16x16x32_bf16 v[180:183], v[60:63], v[244:247], v[180:183]
    buffer_store_dwordx4 v[156:159], v4, s[4:7], s22 offen sc1
    v_mfma_f32_16x16x32_bf16 v[180:183], v[64:67], v[248:251], v[180:183]
    s_add_u32 s23, s23, 65536
    v_mfma_f32_16x16x32_bf16 v[180:183], v[68:71], v[252:255], v[180:183]
    s_mov_b32 s16, s43
    s_cmp_lt_u32 s16, s50
    s_cbranch_scc1 L_vox_loop
    s_nop 7
    s_waitcnt lgkmcnt(0)
    v_cvt_pk_bf16_f32 v164, v176, v180
    v_cvt_pk_bf16_f32 v165, v177, v181
    v_cvt_pk_bf16_f32 v166, v178, v182
    v_cvt_pk_bf16_f32 v167, v179, v183
    s_lshr_b32 s21, s23, 8
    s_xor_b32 s21, s21, s35
    s_and_b32 s21, s21, 0x2000
    s_or_b32 s22, s23, s21
    buffer_store_dwordx4 v[160:163], v3, s[4:7], s22 offen sc1
    s_add_u32 s23, s23, 65536
    s_lshr_b32 s21, s23, 8
    s_xor_b32 s21, s21, s35
    s_and_b32 s21, s21, 0x2000
    s_or_b32 s22, s23, s21
    buffer_store_dwordx4 v[164:167], v3, s[4:7], s22 offen sc1
    s_add_u32 s23, s23, 65536
    s_cmp_lt_u32 s16, 4
    s_cselect_b32 s50, 0, 64
    s_sub_u32 s20, s16, 1
    s_cmp_lt_u32 s16, 64
    s_cselect_b32 s20, s20, 64
    v_mov_b32 v10, s20
    s_waitcnt vmcnt(0)
    s_barrier
    buffer_store_dword v10, v9, s[8:11], 0 offen sc1
    v_mov_b32 v3, 0x40000000
    s_cbranch_scc1 L_vox_loop
L_x_done:
    s_lshr_b32 s21, s2, 4
    s_mul_i32 s16, s21, 52
    s_lshr_b32 s16, s16, 8
    s_mul_i32 s20, s16, 5
    s_sub_u32 s17, s21, s20
    s_and_b32 s20, s2, 3
    s_mul_i32 s20, s20, 5
    s_add_u32 s17, s17, s20
    s_mov_b32 s41, 3
    s_bitcmp1_b32 s2, 3
    s_cselect_b32 s21, s21, 15
    s_cmp_lt_u32 s21, 15
    s_cbranch_scc1 L_x_fin
    s_endpgm
L_x_fin:
    v_and_b32 v1, 63, v0
    v_lshrrev_b32 v2, 6, v0
    s_nop 0
    v_readfirstlane_b32 s18, v2
    v_and_b32 v12, 15, v1
    v_lshrrev_b32 v13, 4, v1
    v_lshlrev_b32 v4, 4, v1
    v_mov_b32 v11, -1
    s_mov_b32 s31, 0x05040100
    s_mov_b32 s32, 0x07060302
    v_mul_u32_u24 v10, 10240, v13
    v_lshl_add_u32 v10, v12, 2, v10
    s_lshl_b32 s20, s17, 6
    s_mul_i32 s21, s18, 573440
    s_add_u32 s20, s20, s21
    v_add_u32 v10, s20, v10
    s_mul_i32 s51, s17, 52
    s_lshr_b32 s51, s51, 8
    s_mul_i32 s51, s51, 5
    s_sub_u32 s51, s17, s51
    s_add_u32 s20, s51, 0
    s_sub_u32 s21, s20, 6
    s_cselect_b32 s20, s20, s21
    s_sub_u32 s21, s20, 0
    s_mul_i32 s52, s21, 81920
    s_mul_i32 s21, s18, 7
    s_add_u32 s20, s20, s21
    s_and_b32 s21, s20, 1
    s_lshr_b32 s20, s20, 1
    s_lshl_b32 s20, s20, 14
    s_lshl_b32 s21, s21, 12
    s_add_u32 s60, s20, s21
    s_add_u32 s20, s51, 1
    s_sub_u32 s21, s20, 6
    s_cselect_b32 s20, s20, s21
    s_sub_u32 s21, s20, 1
    s_mul_i32 s53, s21, 81920
    s_mul_i32 s21, s18, 7
    s_add_u32 s20, s20, s21
    s_and_b32 s21, s20, 1
    s_lshr_b32 s20, s20, 1
    s_lshl_b32 s20, s20, 14
    s_lshl_b32 s21, s21, 12
    s_add_u32 s61, s20, s21
    s_add_u32 s20, s51, 2
    s_sub_u32 s21, s20, 6
    s_cselect_b32 s20, s20, s21
    s_sub_u32 s21, s20, 2
    s_mul_i32 s54, s21, 81920
    s_mul_i32 s21, s18, 7
    s_add_u32 s20, s20, s21
    s_and_b32 s21, s20, 1
    s_lshr_b32 s20, s20, 1
    s_lshl_b32 s20, s20, 14
    s_lshl_b32 s21, s21, 12
    s_add_u32 s62, s20, s21
    s_add_u32 s20, s51, 3
    s_sub_u32 s21, s20, 6
    s_cselect_b32 s20, s20, s21
    s_sub_u32 s21, s20, 3
    s_mul_i32 s55, s21, 81920
    s_mul_i32 s21, s18, 7
    s_add_u32 s20, s20, s21
    s_and_b32 s21, s20, 1
    s_lshr_b32 s20, s20, 1
    s_lshl_b32 s20, s20, 14
    s_lshl_b32 s21, s21, 12
    s_add_u32 s63, s20, s21
    s_add_u32 s20, s51, 4
    s_sub_u32 s21, s20, 6
    s_cselect_b32 s20, s20, s21
    s_sub_u32 s21, s20, 4
    s_mul_i32 s56, s21, 81920
    s_mul_i32 s21, s18, 7
    s_add_u32 s20, s20, s21
    s_and_b32 s21, s20, 1
    s_lshr_b32 s20, s20, 1
    s_lshl_b32 s20, s20, 14
    s_lshl_b32 s21, s21, 12
    s_add_u32 s64, s20, s21
    s_add_u32 s20, s51, 5
    s_sub_u32 s21, s20, 6
    s_cselect_b32 s20, s20, s21
    s_sub_u32 s21, s20, 5
    s_mul_i32 s57, s21, 81920
    s_mul_i32 s21, s18, 7
    s_add_u32 s20, s20, s21
    s_and_b32 s21, s20, 1
    s_lshr_b32 s20, s20, 1
    s_lshl_b32 s20, s20, 14
    s_lshl_b32 s21, s21, 12
    s_add_u32 s65, s20, s21
    s_mov_b32 s20, 6
    s_mul_i32 s21, s18, 7
    s_add_u32 s20, s20, s21
    s_and_b32 s21, s20, 1
    s_lshr_b32 s20, s20, 1
    s_lshl_b32 s20, s20, 14
    s_lshl_b32 s21, s21, 12
    s_add_u32 s66, s20, s21
    s_lshl_b32 s20, s51, 11
    s_lshl_b32 s51, s51, 8
    s_and_b32 s51, s51, 0x400
    s_and_b32 s20, s20, 0x1800
    s_or_b32 s51, s51, s20
    s_load_dwordx2 s[12:13], s[0:1], 72
    s_mov_b32 s14, 2211840
    s_mov_b32 s15, 0x20000
    s_waitcnt lgkmcnt(0)
    v_bfe_u32 v160, v1, 2, 2
    v_lshlrev_b32 v160, 6, v160
    v_and_b32 v161, 3, v1
    v_lshl_add_u32 v160, v161, 4, v160
    v_bfe_u32 v161, v1, 4, 1
    v_lshrrev_b32 v162, 5, v1
    ds_bpermute_b32 v164, v160, v10
    v_mul_u32_u24 v163, 2560, v161
    v_mul_u32_u24 v170, 1280, v162
    s_waitcnt lgkmcnt(0)
    v_add3_u32 v164, v164, v163, v170
    s_mul_i32 s29, s18, 20480
    s_add_u32 s29, s29, 40960
    v_lshl_add_u32 v170, v1, 2, s29
    s_add_u32 m0, s29, 0
    s_add_u32 s30, s52, 0
    buffer_load_dwordx4 v164, s[12:15], s30 offen lds
    s_add_u32 m0, s29, 1024
    s_add_u32 s30, s52, 5120
    buffer_load_dwordx4 v164, s[12:15], s30 offen lds
    s_add_u32 m0, s29, 2048
    s_add_u32 s30, s52, 40960
    buffer_load_dwordx4 v164, s[12:15], s30 offen lds
    s_add_u32 m0, s29, 3072
    s_add_u32 s30, s52, 46080
    buffer_load_dwordx4 v164, s[12:15], s30 offen lds
    s_add_u32 m0, s29, 4096
    s_add_u32 s30, s53, 81920
    buffer_load_dwordx4 v164, s[12:15], s30 offen lds
    s_add_u32 m0, s29, 5120
    s_add_u32 s30, s53, 87040
    buffer_load_dwordx4 v164, s[12:15], s30 offen lds
    s_add_u32 m0, s29, 6144
    s_add_u32 s30, s53, 122880
    buffer_load_dwordx4 v164, s[12:15], s30 offen lds
    s_add_u32 m0, s29, 7168
    s_add_u32 s30, s53, 128000
    buffer_load_dwordx4 v164, s[12:15], s30 offen lds
    s_add_u32 m0, s29, 8192
    s_add_u32 s30, s54, 163840
    buffer_load_dwordx4 v164, s[12:15], s30 offen lds
    s_add_u32 m0, s29, 9216
    s_add_u32 s30, s54, 168960
    buffer_load_dwordx4 v164, s[12:15], s30 offen lds
    s_add_u32 m0, s29, 10240
    s_add_u32 s30, s54, 204800
    buffer_load_dwordx4 v164, s[12:15], s30 offen lds
    s_add_u32 m0, s29, 11264
    s_add_u32 s30, s54, 209920
    buffer_load_dwordx4 v164, s[12:15], s30 offen lds
    s_add_u32 m0, s29, 12288
    s_add_u32 s30, s55, 245760
    buffer_load_dwordx4 v164, s[12:15], s30 offen lds
    s_add_u32 m0, s29, 13312
    s_add_u32 s30, s55, 250880
    buffer_load_dwordx4 v164, s[12:15], s30 offen lds
    s_add_u32 m0, s29, 14336
    s_add_u32 s30, s55, 286720
    buffer_load_dwordx4 v164, s[12:15], s30 offen lds
    s_add_u32 m0, s29, 15360
    s_add_u32 s30, s55, 291840
    buffer_load_dwordx4 v164, s[12:15], s30 offen lds
    s_add_u32 m0, s29, 16384
    s_add_u32 s30, s56, 327680
    buffer_load_dwordx4 v164, s[12:15], s30 offen lds
    s_add_u32 m0, s29, 17408
    s_add_u32 s30, s56, 332800
    buffer_load_dwordx4 v164, s[12:15], s30 offen lds
    s_add_u32 m0, s29, 18432
    s_add_u32 s30, s56, 368640
    buffer_load_dwordx4 v164, s[12:15], s30 offen lds
    s_add_u32 m0, s29, 19456
    s_add_u32 s30, s56, 373760
    buffer_load_dwordx4 v164, s[12:15], s30 offen lds
    s_waitcnt vmcnt(16)
    ds_read2st64_b32 v[128:129], v170 offset0:0 offset1:1
    ds_read2st64_b32 v[130:131], v170 offset0:2 offset1:3
    ds_read2st64_b32 v[132:133], v170 offset0:4 offset1:5
    ds_read2st64_b32 v[134:135], v170 offset0:6 offset1:7
    ds_read2st64_b32 v[136:137], v170 offset0:8 offset1:9
    ds_read2st64_b32 v[138:139], v170 offset0:10 offset1:11
    ds_read2st64_b32 v[140:141], v170 offset0:12 offset1:13
    ds_read2st64_b32 v[142:143], v170 offset0:14 offset1:15
    s_waitcnt lgkmcnt(0)
    s_add_u32 m0, s29, 0
    s_add_u32 s30, s57, 409600
    buffer_load_dwordx4 v164, s[12:15], s30 offen lds
    s_add_u32 m0, s29, 1024
    s_add_u32 s30, s57, 414720
    buffer_load_dwordx4 v164, s[12:15], s30 offen lds
    s_add_u32 m0, s29, 2048
    s_add_u32 s30, s57, 450560
    buffer_load_dwordx4 v164, s[12:15], s30 offen lds
    s_add_u32 m0, s29, 3072
    s_add_u32 s30, s57, 455680
    buffer_load_dwordx4 v164, s[12:15], s30 offen lds
    s_waitcnt vmcnt(16)
    ds_read2st64_b32 v[144:145], v170 offset0:16 offset1:17
    ds_read2st64_b32 v[146:147], v170 offset0:18 offset1:19
    ds_read2st64_b32 v[148:149], v170 offset0:20 offset1:21
    ds_read2st64_b32 v[150:151], v170 offset0:22 offset1:23
    ds_read2st64_b32 v[152:153], v170 offset0:24 offset1:25
    ds_read2st64_b32 v[154:155], v170 offset0:26 offset1:27
    ds_read2st64_b32 v[156:157], v170 offset0:28 offset1:29
    ds_read2st64_b32 v[158:159], v170 offset0:30 offset1:31
    v_perm_b32 v120, v129, v128, s31
    v_accvgpr_write_b32 a0, v120
    v_perm_b32 v121, v129, v128, s32
    v_accvgpr_write_b32 a8, v121
    v_perm_b32 v122, v131, v130, s31
    v_accvgpr_write_b32 a1, v122
    v_perm_b32 v123, v131, v130, s32
    v_accvgpr_write_b32 a9, v123
    v_perm_b32 v124, v133, v132, s31
    v_accvgpr_write_b32 a2, v124
    v_perm_b32 v125, v133, v132, s32
    v_accvgpr_write_b32 a10, v125
    v_perm_b32 v126, v135, v134, s31
    v_accvgpr_write_b32 a3, v126
    v_perm_b32 v127, v135, v134, s32
    v_accvgpr_write_b32 a11, v127
    v_perm_b32 v120, v137, v136, s31
    v_accvgpr_write_b32 a4, v120
    v_perm_b32 v121, v137, v136, s32
    v_accvgpr_write_b32 a12, v121
    v_perm_b32 v122, v139, v138, s31
    v_accvgpr_write_b32 a5, v122
    v_perm_b32 v123, v139, v138, s32
    v_accvgpr_write_b32 a13, v123
    v_perm_b32 v124, v141, v140, s31
    v_accvgpr_write_b32 a6, v124
    v_perm_b32 v125, v141, v140, s32
    v_accvgpr_write_b32 a14, v125
    v_perm_b32 v126, v143, v142, s31
    v_accvgpr_write_b32 a7, v126
    v_perm_b32 v127, v143, v142, s32
    v_accvgpr_write_b32 a15, v127
    s_waitcnt lgkmcnt(0)
    s_add_u32 m0, s29, 4096
    s_mov_b32 s30, 491520
    buffer_load_dwordx4 v164, s[12:15], s30 offen lds
    s_add_u32 m0, s29, 5120
    s_mov_b32 s30, 496640
    buffer_load_dwordx4 v164, s[12:15], s30 offen lds
    s_add_u32 m0, s29, 6144
    s_mov_b32 s30, 532480
    buffer_load_dwordx4 v164, s[12:15], s30 offen lds
    s_add_u32 m0, s29, 7168
    s_mov_b32 s30, 537600
    buffer_load_dwordx4 v164, s[12:15], s30 offen lds
    s_waitcnt vmcnt(16)
    ds_read2st64_b32 v[128:129], v170 offset0:32 offset1:33
    ds_read2st64_b32 v[130:131], v170 offset0:34 offset1:35
    ds_read2st64_b32 v[132:133], v170 offset0:36 offset1:37
    ds_read2st64_b32 v[134:135], v170 offset0:38 offset1:39
    ds_read2st64_b32 v[136:137], v170 offset0:40 offset1:41
    ds_read2st64_b32 v[138:139], v170 offset0:42 offset1:43
    ds_read2st64_b32 v[140:141], v170 offset0:44 offset1:45
    ds_read2st64_b32 v[142:143], v170 offset0:46 offset1:47
    v_perm_b32 v120, v145, v144, s31
    v_accvgpr_write_b32 a16, v120
    v_perm_b32 v121, v145, v144, s32
    v_accvgpr_write_b32 a24, v121
    v_perm_b32 v122, v147, v146, s31
    v_accvgpr_write_b32 a17, v122
    v_perm_b32 v123, v147, v146, s32
    v_accvgpr_write_b32 a25, v123
    v_perm_b32 v124, v149, v148, s31
    v_accvgpr_write_b32 a18, v124
    v_perm_b32 v125, v149, v148, s32
    v_accvgpr_write_b32 a26, v125
    v_perm_b32 v126, v151, v150, s31
    v_accvgpr_write_b32 a19, v126
    v_perm_b32 v127, v151, v150, s32
    v_accvgpr_write_b32 a27, v127
    v_perm_b32 v120, v153, v152, s31
    v_accvgpr_write_b32 a20, v120
    v_perm_b32 v121, v153, v152, s32
    v_accvgpr_write_b32 a28, v121
    v_perm_b32 v122, v155, v154, s31
    v_accvgpr_write_b32 a21, v122
    v_perm_b32 v123, v155, v154, s32
    v_accvgpr_write_b32 a29, v123
    v_perm_b32 v124, v157, v156, s31
    v_accvgpr_write_b32 a22, v124
    v_perm_b32 v125, v157, v156, s32
    v_accvgpr_write_b32 a30, v125
    v_perm_b32 v126, v159, v158, s31
    v_accvgpr_write_b32 a23, v126
    v_perm_b32 v127, v159, v158, s32
    v_accvgpr_write_b32 a31, v127
    s_waitcnt lgkmcnt(0)
    s_waitcnt vmcnt(12)
    ds_read2st64_b32 v[144:145], v170 offset0:48 offset1:49
    ds_read2st64_b32 v[146:147], v170 offset0:50 offset1:51
    ds_read2st64_b32 v[148:149], v170 offset0:52 offset1:53
    ds_read2st64_b32 v[150:151], v170 offset0:54 offset1:55
    ds_read2st64_b32 v[152:153], v170 offset0:56 offset1:57
    ds_read2st64_b32 v[154:155], v170 offset0:58 offset1:59
    ds_read2st64_b32 v[156:157], v170 offset0:60 offset1:61
    ds_read2st64_b32 v[158:159], v170 offset0:62 offset1:63
    v_perm_b32 v120, v129, v128, s31
    v_accvgpr_write_b32 a32, v120
    v_perm_b32 v121, v129, v128, s32
    v_accvgpr_write_b32 a40, v121
    v_perm_b32 v122, v131, v130, s31
    v_accvgpr_write_b32 a33, v122
    v_perm_b32 v123, v131, v130, s32
    v_accvgpr_write_b32 a41, v123
    v_perm_b32 v124, v133, v132, s31
    v_accvgpr_write_b32 a34, v124
    v_perm_b32 v125, v133, v132, s32
    v_accvgpr_write_b32 a42, v125
    v_perm_b32 v126, v135, v134, s31
    v_accvgpr_write_b32 a35, v126
    v_perm_b32 v127, v135, v134, s32
    v_accvgpr_write_b32 a43, v127
    v_perm_b32 v120, v137, v136, s31
    v_accvgpr_write_b32 a36, v120
    v_perm_b32 v121, v137, v136, s32
    v_accvgpr_write_b32 a44, v121
    v_perm_b32 v122, v139, v138, s31
    v_accvgpr_write_b32 a37, v122
    v_perm_b32 v123, v139, v138, s32
    v_accvgpr_write_b32 a45, v123
    v_perm_b32 v124, v141, v140, s31
    v_accvgpr_write_b32 a38, v124
    v_perm_b32 v125, v141, v140, s32
    v_accvgpr_write_b32 a46, v125
    v_perm_b32 v126, v143, v142, s31
    v_accvgpr_write_b32 a39, v126
    v_perm_b32 v127, v143, v142, s32
    v_accvgpr_write_b32 a47, v127
    s_waitcnt lgkmcnt(0)
    s_waitcnt vmcnt(8)
    ds_read2st64_b32 v[128:129], v170 offset0:64 offset1:65
    ds_read2st64_b32 v[130:131], v170 offset0:66 offset1:67
    ds_read2st64_b32 v[132:133], v170 offset0:68 offset1:69
    ds_read2st64_b32 v[134:135], v170 offset0:70 offset1:71
    ds_read2st64_b32 v[136:137], v170 offset0:72 offset1:73
    ds_read2st64_b32 v[138:139], v170 offset0:74 offset1:75
    ds_read2st64_b32 v[140:141], v170 offset0:76 offset1:77
    ds_read2st64_b32 v[142:143], v170 offset0:78 offset1:79
    v_perm_b32 v120, v145, v144, s31
    v_accvgpr_write_b32 a48, v120
    v_perm_b32 v121, v145, v144, s32
    v_accvgpr_write_b32 a56, v121
    v_perm_b32 v122, v147, v146, s31
    v_accvgpr_write_b32 a49, v122
    v_perm_b32 v123, v147, v146, s32
    v_accvgpr_write_b32 a57, v123
    v_perm_b32 v124, v149, v148, s31
    v_accvgpr_write_b32 a50, v124
    v_perm_b32 v125, v149, v148, s32
    v_accvgpr_write_b32 a58, v125
    v_perm_b32 v126, v151, v150, s31
    v_accvgpr_write_b32 a51, v126
    v_perm_b32 v127, v151, v150, s32
    v_accvgpr_write_b32 a59, v127
    v_perm_b32 v120, v153, v152, s31
    v_accvgpr_write_b32 a52, v120
    v_perm_b32 v121, v153, v152, s32
    v_accvgpr_write_b32 a60, v121
    v_perm_b32 v122, v155, v154, s31
    v_accvgpr_write_b32 a53, v122
    v_perm_b32 v123, v155, v154, s32
    v_accvgpr_write_b32 a61, v123
    v_perm_b32 v124, v157, v156, s31
    v_accvgpr_write_b32 a54, v124
    v_perm_b32 v125, v157, v156, s32
    v_accvgpr_write_b32 a62, v125
    v_perm_b32 v126, v159, v158, s31
    v_accvgpr_write_b32 a55, v126
    v_perm_b32 v127, v159, v158, s32
    v_accvgpr_write_b32 a63, v127
    s_waitcnt lgkmcnt(0)
    s_waitcnt vmcnt(4)
    ds_read2st64_b32 v[144:145], v170 offset0:0 offset1:1
    ds_read2st64_b32 v[146:147], v170 offset0:2 offset1:3
    ds_read2st64_b32 v[148:149], v170 offset0:4 offset1:5
    ds_read2st64_b32 v[150:151], v170 offset0:6 offset1:7
    ds_read2st64_b32 v[152:153], v170 offset0:8 offset1:9
    ds_read2st64_b32 v[154:155], v170 offset0:10 offset1:11
    ds_read2st64_b32 v[156:157], v170 offset0:12 offset1:13
    ds_read2st64_b32 v[158:159], v170 offset0:14 offset1:15
    v_perm_b32 v120, v129, v128, s31
    v_accvgpr_write_b32 a64, v120
    v_perm_b32 v121, v129, v128, s32
    v_accvgpr_write_b32 a72, v121
    v_perm_b32 v122, v131, v130, s31
    v_accvgpr_write_b32 a65, v122
    v_perm_b32 v123, v131, v130, s32
    v_accvgpr_write_b32 a73, v123
    v_perm_b32 v124, v133, v132, s31
    v_accvgpr_write_b32 a66, v124
    v_perm_b32 v125, v133, v132, s32
    v_accvgpr_write_b32 a74, v125
    v_perm_b32 v126, v135, v134, s31
    v_accvgpr_write_b32 a67, v126
    v_perm_b32 v127, v135, v134, s32
    v_accvgpr_write_b32 a75, v127
    v_perm_b32 v120, v137, v136, s31
    v_accvgpr_write_b32 a68, v120
    v_perm_b32 v121, v137, v136, s32
    v_accvgpr_write_b32 a76, v121
    v_perm_b32 v122, v139, v138, s31
    v_accvgpr_write_b32 a69, v122
    v_perm_b32 v123, v139, v138, s32
    v_accvgpr_write_b32 a77, v123
    v_perm_b32 v124, v141, v140, s31
    v_accvgpr_write_b32 a70, v124
    v_perm_b32 v125, v141, v140, s32
    v_accvgpr_write_b32 a78, v125
    v_perm_b32 v126, v143, v142, s31
    v_accvgpr_write_b32 a71, v126
    v_perm_b32 v127, v143, v142, s32
    v_accvgpr_write_b32 a79, v127
    s_waitcnt lgkmcnt(0)
    s_waitcnt vmcnt(0)
    ds_read2st64_b32 v[128:129], v170 offset0:16 offset1:17
    ds_read2st64_b32 v[130:131], v170 offset0:18 offset1:19
    ds_read2st64_b32 v[132:133], v170 offset0:20 offset1:21
    ds_read2st64_b32 v[134:135], v170 offset0:22 offset1:23
    ds_read2st64_b32 v[136:137], v170 offset0:24 offset1:25
    ds_read2st64_b32 v[138:139], v170 offset0:26 offset1:27
    ds_read2st64_b32 v[140:141], v170 offset0:28 offset1:29
    ds_read2st64_b32 v[142:143], v170 offset0:30 offset1:31
    v_perm_b32 v120, v145, v144, s31
    v_accvgpr_write_b32 a80, v120
    v_perm_b32 v121, v145, v144, s32
    v_accvgpr_write_b32 a88, v121
    v_perm_b32 v122, v147, v146, s31
    v_accvgpr_write_b32 a81, v122
    v_perm_b32 v123, v147, v146, s32
    v_accvgpr_write_b32 a89, v123
    v_perm_b32 v124, v149, v148, s31
    v_accvgpr_write_b32 a82, v124
    v_perm_b32 v125, v149, v148, s32
    v_accvgpr_write_b32 a90, v125
    v_perm_b32 v126, v151, v150, s31
    v_accvgpr_write_b32 a83, v126
    v_perm_b32 v127, v151, v150, s32
    v_accvgpr_write_b32 a91, v127
    v_perm_b32 v120, v153, v152, s31
    v_accvgpr_write_b32 a84, v120
    v_perm_b32 v121, v153, v152, s32
    v_accvgpr_write_b32 a92, v121
    v_perm_b32 v122, v155, v154, s31
    v_accvgpr_write_b32 a85, v122
    v_perm_b32 v123, v155, v154, s32
    v_accvgpr_write_b32 a93, v123
    v_perm_b32 v124, v157, v156, s31
    v_accvgpr_write_b32 a86, v124
    v_perm_b32 v125, v157, v156, s32
    v_accvgpr_write_b32 a94, v125
    v_perm_b32 v126, v159, v158, s31
    v_accvgpr_write_b32 a87, v126
    v_perm_b32 v127, v159, v158, s32
    v_accvgpr_write_b32 a95, v127
    s_waitcnt lgkmcnt(0)
    v_perm_b32 v120, v129, v128, s31
    v_accvgpr_write_b32 a96, v120
    v_perm_b32 v121, v129, v128, s32
    v_accvgpr_write_b32 a104, v121
    v_perm_b32 v122, v131, v130, s31
    v_accvgpr_write_b32 a97, v122
    v_perm_b32 v123, v131, v130, s32
    v_accvgpr_write_b32 a105, v123
    v_perm_b32 v124, v133, v132, s31
    v_accvgpr_write_b32 a98, v124
    v_perm_b32 v125, v133, v132, s32
    v_accvgpr_write_b32 a106, v125
    v_perm_b32 v126, v135, v134, s31
    v_accvgpr_write_b32 a99, v126
    v_perm_b32 v127, v135, v134, s32
    v_accvgpr_write_b32 a107, v127
    v_perm_b32 v120, v137, v136, s31
    v_accvgpr_write_b32 a100, v120
    v_perm_b32 v121, v137, v136, s32
    v_accvgpr_write_b32 a108, v121
    v_perm_b32 v122, v139, v138, s31
    v_accvgpr_write_b32 a101, v122
    v_perm_b32 v123, v139, v138, s32
    v_accvgpr_write_b32 a109, v123
    v_perm_b32 v124, v141, v140, s31
    v_accvgpr_write_b32 a102, v124
    v_perm_b32 v125, v141, v140, s32
    v_accvgpr_write_b32 a110, v125
    v_perm_b32 v126, v143, v142, s31
    v_accvgpr_write_b32 a103, v126
    v_perm_b32 v127, v143, v142, s32
    v_accvgpr_write_b32 a111, v127
    s_load_dwordx2 s[12:13], s[0:1], 0
    s_mov_b32 s14, 2621440
    s_mov_b32 s15, 0x20000
    s_waitcnt lgkmcnt(0)
    s_load_dwordx2 s[44:45], s[0:1], 80
    s_mov_b32 s46, 2621440
    s_mov_b32 s47, 0x20000
    s_waitcnt lgkmcnt(0)
    s_mov_b32 s33, 0xbfb8aa3b
    v_mul_u32_u24 v8, 1280, v12
    v_lshl_add_u32 v8, v13, 4, v8
    s_lshr_b32 s20, s18, 1
    s_mul_i32 s20, s20, 20480
    s_and_b32 s21, s18, 1
    s_lshl_b32 s21, s21, 3
    s_add_u32 s20, s20, s21
    s_lshl_b32 s21, s17, 6
    s_add_u32 s20, s20, s21
    v_add_u32 v8, s20, v8
    s_lshl_b32 s20, s18, 12
    v_add_u32 v6, s20, v4
    s_lshr_b32 s20, s18, 1
    s_lshl_b32 s20, s20, 11
    s_and_b32 s21, s18, 1
    s_lshl_b32 s21, s21, 3
    s_add_u32 s20, s20, s21
    v_add_u32 v7, s20, v4
    v_and_b32 v9, 15, v1
    v_lshrrev_b32 v2, 4, v1
    v_lshlrev_b32 v2, 7, v2
    v_lshl_add_u32 v2, v9, 2, v2
    v_lshlrev_b32 v9, 7, v1
    s_add_u32 s20, s19, 1867776
    v_add_u32 v2, s20, v2
    v_min_u32 v3, 6, v1
    v_and_b32 v14, 7, v3
    v_lshrrev_b32 v3, 3, v3
    v_lshlrev_b32 v3, 7, v3
    v_lshl_add_u32 v3, v14, 2, v3
    s_add_u32 s20, s19, 1884160
    v_add_u32 v3, s20, v3
    s_mov_b32 s36, -1
    s_mov_b32 s37, -1
    s_add_u32 s20, s19, 1835008
    v_add_u32 v9, s20, v9
    s_xor_b32 s20, s19, 0x2000
    s_add_u32 s20, s20, 1900544
    v_mov_b32 v10, s20
    s_mul_i32 s20, s18, 7
    s_and_b32 s21, s20, 1
    s_lshr_b32 s20, s20, 1
    s_lshl_b32 s20, s20, 14
    s_lshl_b32 s22, s21, 12
    s_add_u32 s50, s20, s22
    s_add_u32 s50, s50, 9207808
    s_lshl_b32 s21, s21, 13
    s_add_u32 s48, s21, 4096
    s_sub_u32 s49, 16384, s48
    s_lshl_b32 s35, s18, 13
    s_xor_b32 s35, s35, s34
    v_mov_b32 v5, v4
    s_mov_b32 s38, -1
    s_min_u32 s39, s16, 63
    s_cmp_ge_i32 s36, s39
    s_cbranch_scc1 mw_8_ok
    s_mov_b32 s21, 0
mw_8:
    buffer_load_dword v15, v3, s[8:11], 0 offen sc1
    s_waitcnt vmcnt(0)
    v_cmp_gt_i32 vcc, s39, v15
    s_cbranch_vccz mw_8_got
    s_sleep 4
    s_add_u32 s21, s21, 1
    s_cmp_lt_u32 s21, 200000
    s_cbranch_scc1 mw_8
mw_8_got:
    v_min_i32_dpp v15, v15, v15 row_ror:8 row_mask:0xf bank_mask:0xf
    s_nop 1
    v_min_i32_dpp v15, v15, v15 row_ror:4 row_mask:0xf bank_mask:0xf
    s_nop 1
    v_min_i32_dpp v15, v15, v15 row_ror:2 row_mask:0xf bank_mask:0xf
    s_nop 1
    v_min_i32_dpp v15, v15, v15 row_ror:1 row_mask:0xf bank_mask:0xf
    s_nop 0
    v_readlane_b32 s36, v15, 0
    v_readlane_b32 s20, v15, 16
    v_readlane_b32 s21, v15, 32
    s_min_i32 s36, s36, s20
    v_readlane_b32 s20, v15, 48
    s_min_i32 s36, s36, s21
    s_min_i32 s36, s36, s20
mw_8_ok:
    s_and_b32 s20, s16, 63
    s_lshl_b32 s20, s20, 20
    s_add_u32 s20, s20, 9207808
    s_lshr_b32 s21, s20, 8
    s_xor_b32 s21, s21, s34
    s_and_b32 s21, s21, 0x2000
    s_or_b32 s40, s20, s21
    s_cmp_eq_u32 s18, 3
    s_cselect_b32 s22, 0x40000000, 0
    v_add_u32 v14, s22, v5
    s_add_u32 s20, s40, s60
    buffer_load_dwordx4 v[64:67], v5, s[4:7], s20 offen offset:0 sc1
    buffer_load_dwordx4 v[68:71], v5, s[4:7], s20 offen offset:1024 sc1
    buffer_load_dwordx4 v[72:75], v5, s[4:7], s20 offen offset:2048 sc1
    buffer_load_dwordx4 v[76:79], v5, s[4:7], s20 offen offset:3072 sc1
    s_add_u32 s20, s40, s61
    buffer_load_dwordx4 v[80:83], v5, s[4:7], s20 offen offset:0 sc1
    buffer_load_dwordx4 v[84:87], v5, s[4:7], s20 offen offset:1024 sc1
    buffer_load_dwordx4 v[88:91], v5, s[4:7], s20 offen offset:2048 sc1
    buffer_load_dwordx4 v[92:95], v5, s[4:7], s20 offen offset:3072 sc1
    s_add_u32 s20, s40, s62
    buffer_load_dwordx4 v[96:99], v5, s[4:7], s20 offen offset:0 sc1
    buffer_load_dwordx4 v[100:103], v5, s[4:7], s20 offen offset:1024 sc1
    buffer_load_dwordx4 v[104:107], v5, s[4:7], s20 offen offset:2048 sc1
    buffer_load_dwordx4 v[108:111], v5, s[4:7], s20 offen offset:3072 sc1
    s_add_u32 s20, s40, s63
    buffer_load_dwordx4 v[112:115], v5, s[4:7], s20 offen offset:0 sc1
    buffer_load_dwordx4 v[116:119], v5, s[4:7], s20 offen offset:1024 sc1
    buffer_load_dwordx4 v[120:123], v5, s[4:7], s20 offen offset:2048 sc1
    buffer_load_dwordx4 v[124:127], v5, s[4:7], s20 offen offset:3072 sc1
    s_add_u32 s20, s40, s64
    buffer_load_dwordx4 v[128:131], v5, s[4:7], s20 offen offset:0 sc1
    buffer_load_dwordx4 v[132:135], v5, s[4:7], s20 offen offset:1024 sc1
    buffer_load_dwordx4 v[136:139], v5, s[4:7], s20 offen offset:2048 sc1
    buffer_load_dwordx4 v[140:143], v5, s[4:7], s20 offen offset:3072 sc1
    s_add_u32 s20, s40, s65
    buffer_load_dwordx4 v[144:147], v5, s[4:7], s20 offen offset:0 sc1
    buffer_load_dwordx4 v[148:151], v5, s[4:7], s20 offen offset:1024 sc1
    buffer_load_dwordx4 v[152:155], v5, s[4:7], s20 offen offset:2048 sc1
    buffer_load_dwordx4 v[156:159], v5, s[4:7], s20 offen offset:3072 sc1
    s_add_u32 s20, s40, s66
    buffer_load_dwordx4 v[160:163], v14, s[4:7], s20 offen offset:0 sc1
    buffer_load_dwordx4 v[164:167], v14, s[4:7], s20 offen offset:1024 sc1
    buffer_load_dwordx4 v[168:171], v14, s[4:7], s20 offen offset:2048 sc1
    buffer_load_dwordx4 v[172:175], v14, s[4:7], s20 offen offset:3072 sc1
    v_mov_b32 v15, 0x40000000
    buffer_load_dword v15, v15, s[4:7], 0 offen
L_fin_loop:
    s_min_u32 s39, s16, 63
    s_cmp_ge_i32 s37, s39
    s_cbranch_scc1 mw_9_ok
    s_mov_b32 s21, 0
mw_9:
    buffer_load_dword v15, v2, s[8:11], 0 offen sc1
    s_waitcnt vmcnt(0)
    v_cmp_gt_i32 vcc, s39, v15
    s_cbranch_vccz mw_9_got
    s_sleep 4
    s_add_u32 s21, s21, 1
    s_cmp_lt_u32 s21, 200000
    s_cbranch_scc1 mw_9
mw_9_got:
    v_min_i32_dpp v15, v15, v15 row_ror:8 row_mask:0xf bank_mask:0xf
    s_nop 1
    v_min_i32_dpp v15, v15, v15 row_ror:4 row_mask:0xf bank_mask:0xf
    s_nop 1
    v_min_i32_dpp v15, v15, v15 row_ror:2 row_mask:0xf bank_mask:0xf
    s_nop 1
    v_min_i32_dpp v15, v15, v15 row_ror:1 row_mask:0xf bank_mask:0xf
    s_nop 0
    v_readlane_b32 s37, v15, 0
    v_readlane_b32 s20, v15, 16
    v_readlane_b32 s21, v15, 32
    s_min_i32 s37, s37, s20
    v_readlane_b32 s20, v15, 48
    s_min_i32 s37, s37, s21
    s_min_i32 s37, s37, s20
mw_9_ok:
    s_and_b32 s22, s16, 63
    s_mul_i32 s22, s22, 20
    s_add_u32 s22, s22, s17
    s_lshl_b32 s22, s22, 17
    s_lshl_b32 s21, s18, 14
    s_add_u32 s22, s22, s21
    s_add_u32 s22, s22, 75497472
    s_lshr_b32 s21, s22, 8
    s_xor_b32 s21, s21, s35
    s_and_b32 s21, s21, 0x2000
    s_or_b32 s22, s22, s21
    s_add_u32 s20, s16, s41
    s_min_u32 s20, s20, 63
    s_cmp_ge_i32 s36, s20
    s_cselect_b32 s20, 0x40000000, 0
    v_add_u32 v46, s20, v3
    buffer_load_dword v46, v46, s[8:11], 0 offen sc1
    buffer_load_dword v48, v10, s[8:11], 0 offen sc1
    s_xor_b32 s22, s22, s51
    s_xor_b32 s20, s22, 0
    buffer_load_dwordx4 a[112:115], v5, s[4:7], s20 offen sc1
    s_xor_b32 s20, s22, 1024
    buffer_load_dwordx4 a[116:119], v5, s[4:7], s20 offen sc1
    s_xor_b32 s20, s22, 2048
    buffer_load_dwordx4 a[120:123], v5, s[4:7], s20 offen sc1
    s_xor_b32 s20, s22, 3072
    buffer_load_dwordx4 a[124:127], v5, s[4:7], s20 offen sc1
    s_xor_b32 s20, s22, 4096
    buffer_load_dwordx4 a[128:131], v5, s[4:7], s20 offen sc1
    s_xor_b32 s20, s22, 5120
    buffer_load_dwordx4 a[132:135], v5, s[4:7], s20 offen sc1
    s_xor_b32 s20, s22, 6144
    buffer_load_dwordx4 a[136:139], v5, s[4:7], s20 offen sc1
    s_xor_b32 s20, s22, 7168
    buffer_load_dwordx4 a[140:143], v5, s[4:7], s20 offen sc1
    s_xor_b32 s20, s22, 65536
    buffer_load_dwordx4 a[144:147], v5, s[4:7], s20 offen sc1
    s_xor_b32 s20, s22, 66560
    buffer_load_dwordx4 a[148:151], v5, s[4:7], s20 offen sc1
    s_xor_b32 s20, s22, 67584
    buffer_load_dwordx4 a[152:155], v5, s[4:7], s20 offen sc1
    s_xor_b32 s20, s22, 68608
    buffer_load_dwordx4 a[156:159], v5, s[4:7], s20 offen sc1
    s_xor_b32 s20, s22, 69632
    buffer_load_dwordx4 a[160:163], v5, s[4:7], s20 offen sc1
    s_xor_b32 s20, s22, 70656
    buffer_load_dwordx4 a[164:167], v5, s[4:7], s20 offen sc1
    s_xor_b32 s20, s22, 71680
    buffer_load_dwordx4 a[168:171], v5, s[4:7], s20 offen sc1
    s_xor_b32 s20, s22, 72704
    buffer_load_dwordx4 a[172:175], v5, s[4:7], s20 offen sc1
    s_waitcnt vmcnt(45)
    v_mfma_f32_16x16x32_bf16 v[16:19], a[0:3], v[64:67], 0
    v_mfma_f32_16x16x32_bf16 v[20:23], a[8:11], v[64:67], 0
    v_mfma_f32_16x16x32_bf16 v[24:27], a[0:3], v[68:71], 0
    v_mfma_f32_16x16x32_bf16 v[28:31], a[8:11], v[68:71], 0
    s_waitcnt vmcnt(43)
    v_mfma_f32_16x16x32_bf16 v[16:19], a[4:7], v[72:75], v[16:19]
    v_mfma_f32_16x16x32_bf16 v[20:23], a[12:15], v[72:75], v[20:23]
    v_mfma_f32_16x16x32_bf16 v[24:27], a[4:7], v[76:79], v[24:27]
    v_mfma_f32_16x16x32_bf16 v[28:31], a[12:15], v[76:79], v[28:31]
    s_waitcnt vmcnt(41)
    v_mfma_f32_16x16x32_bf16 v[16:19], a[16:19], v[80:83], v[16:19]
    v_mfma_f32_16x16x32_bf16 v[20:23], a[24:27], v[80:83], v[20:23]
    v_mfma_f32_16x16x32_bf16 v[24:27], a[16:19], v[84:87], v[24:27]
    v_mfma_f32_16x16x32_bf16 v[28:31], a[24:27], v[84:87], v[28:31]
    s_waitcnt vmcnt(39)
    v_mfma_f32_16x16x32_bf16 v[16:19], a[20:23], v[88:91], v[16:19]
    v_mfma_f32_16x16x32_bf16 v[20:23], a[28:31], v[88:91], v[20:23]
    v_mfma_f32_16x16x32_bf16 v[24:27], a[20:23], v[92:95], v[24:27]
    v_mfma_f32_16x16x32_bf16 v[28:31], a[28:31], v[92:95], v[28:31]
    s_waitcnt vmcnt(37)
    v_mfma_f32_16x16x32_bf16 v[16:19], a[32:35], v[96:99], v[16:19]
    v_mfma_f32_16x16x32_bf16 v[20:23], a[40:43], v[96:99], v[20:23]
    v_mfma_f32_16x16x32_bf16 v[24:27], a[32:35], v[100:103], v[24:27]
    v_mfma_f32_16x16x32_bf16 v[28:31], a[40:43], v[100:103], v[28:31]
    s_waitcnt vmcnt(35)
    v_mfma_f32_16x16x32_bf16 v[16:19], a[36:39], v[104:107], v[16:19]
    v_mfma_f32_16x16x32_bf16 v[20:23], a[44:47], v[104:107], v[20:23]
    v_mfma_f32_16x16x32_bf16 v[24:27], a[36:39], v[108:111], v[24:27]
    v_mfma_f32_16x16x32_bf16 v[28:31], a[44:47], v[108:111], v[28:31]
    s_waitcnt vmcnt(33)
    v_mfma_f32_16x16x32_bf16 v[16:19], a[48:51], v[112:115], v[16:19]
    v_mfma_f32_16x16x32_bf16 v[20:23], a[56:59], v[112:115], v[20:23]
    v_mfma_f32_16x16x32_bf16 v[24:27], a[48:51], v[116:119], v[24:27]
    v_mfma_f32_16x16x32_bf16 v[28:31], a[56:59], v[116:119], v[28:31]
    s_waitcnt vmcnt(31)
    v_mfma_f32_16x16x32_bf16 v[16:19], a[52:55], v[120:123], v[16:19]
    v_mfma_f32_16x16x32_bf16 v[20:23], a[60:63], v[120:123], v[20:23]
    v_mfma_f32_16x16x32_bf16 v[24:27], a[52:55], v[124:127], v[24:27]
    v_mfma_f32_16x16x32_bf16 v[28:31], a[60:63], v[124:127], v[28:31]
    s_waitcnt vmcnt(29)
    v_mfma_f32_16x16x32_bf16 v[16:19], a[64:67], v[128:131], v[16:19]
    v_mfma_f32_16x16x32_bf16 v[20:23], a[72:75], v[128:131], v[20:23]
    v_mfma_f32_16x16x32_bf16 v[24:27], a[64:67], v[132:135], v[24:27]
    v_mfma_f32_16x16x32_bf16 v[28:31], a[72:75], v[132:135], v[28:31]
    s_waitcnt vmcnt(27)
    v_mfma_f32_16x16x32_bf16 v[16:19], a[68:71], v[136:139], v[16:19]
    v_mfma_f32_16x16x32_bf16 v[20:23], a[76:79], v[136:139], v[20:23]
    v_mfma_f32_16x16x32_bf16 v[24:27], a[68:71], v[140:143], v[24:27]
    v_mfma_f32_16x16x32_bf16 v[28:31], a[76:79], v[140:143], v[28:31]
    s_waitcnt vmcnt(25)
    v_mfma_f32_16x16x32_bf16 v[16:19], a[80:83], v[144:147], v[16:19]
    v_mfma_f32_16x16x32_bf16 v[20:23], a[88:91], v[144:147], v[20:23]
    v_mfma_f32_16x16x32_bf16 v[24:27], a[80:83], v[148:151], v[24:27]
    v_mfma_f32_16x16x32_bf16 v[28:31], a[88:91], v[148:151], v[28:31]
    s_waitcnt vmcnt(23)
    v_mfma_f32_16x16x32_bf16 v[16:19], a[84:87], v[152:155], v[16:19]
    v_mfma_f32_16x16x32_bf16 v[20:23], a[92:95], v[152:155], v[20:23]
    v_mfma_f32_16x16x32_bf16 v[24:27], a[84:87], v[156:159], v[24:27]
    v_mfma_f32_16x16x32_bf16 v[28:31], a[92:95], v[156:159], v[28:31]
    s_waitcnt vmcnt(21)
    v_mfma_f32_16x16x32_bf16 v[16:19], a[96:99], v[160:163], v[16:19]
    v_mfma_f32_16x16x32_bf16 v[20:23], a[104:107], v[160:163], v[20:23]
    v_mfma_f32_16x16x32_bf16 v[24:27], a[96:99], v[164:167], v[24:27]
    v_mfma_f32_16x16x32_bf16 v[28:31], a[104:107], v[164:167], v[28:31]
    s_waitcnt vmcnt(19)
    v_mfma_f32_16x16x32_bf16 v[16:19], a[100:103], v[168:171], v[16:19]
    v_mfma_f32_16x16x32_bf16 v[20:23], a[108:111], v[168:171], v[20:23]
    v_mfma_f32_16x16x32_bf16 v[24:27], a[100:103], v[172:175], v[24:27]
    v_mfma_f32_16x16x32_bf16 v[28:31], a[108:111], v[172:175], v[28:31]
    s_nop 4
    ds_write_b128 v6, v[16:19] offset:0
    ds_write_b128 v6, v[20:23] offset:1024
    ds_write_b128 v6, v[24:27] offset:2048
    ds_write_b128 v6, v[28:31] offset:3072
    s_waitcnt lgkmcnt(0)
    s_barrier
    ds_read_b64 v[16:17], v7 offset:0
    ds_read_b64 v[18:19], v7 offset:1024
    ds_read_b64 v[20:21], v7 offset:4096
    ds_read_b64 v[22:23], v7 offset:5120
    ds_read_b64 v[24:25], v7 offset:8192
    ds_read_b64 v[26:27], v7 offset:9216
    ds_read_b64 v[28:29], v7 offset:12288
    ds_read_b64 v[30:31], v7 offset:13312
    s_waitcnt lgkmcnt(0)
    v_add_f32 v16, v16, v20
    v_add_f32 v24, v24, v28
    v_add_f32 v17, v17, v21
    v_add_f32 v25, v25, v29
    v_add_f32 v18, v18, v22
    v_add_f32 v26, v26, v30
    v_add_f32 v19, v19, v23
    v_add_f32 v27, v27, v31
    v_add_f32 v32, v16, v24
    v_add_f32 v33, v17, v25
    v_add_f32 v34, v18, v26
    v_add_f32 v35, v19, v27
    v_mul_f32 v36, s33, v32
    v_mul_f32 v37, s33, v33
    v_mul_f32 v38, s33, v34
    v_mul_f32 v39, s33, v35
    v_exp_f32 v36, v36
    v_exp_f32 v37, v37
    v_exp_f32 v38, v38
    v_exp_f32 v39, v39
    v_add_f32 v36, 1.0, v36
    v_add_f32 v37, 1.0, v37
    v_add_f32 v38, 1.0, v38
    v_add_f32 v39, 1.0, v39
    v_rcp_f32 v36, v36
    v_rcp_f32 v37, v37
    v_rcp_f32 v38, v38
    v_rcp_f32 v39, v39
    v_mul_f32 v32, v32, v36
    v_mul_f32 v33, v33, v37
    v_mul_f32 v34, v34, v38
    v_mul_f32 v35, v35, v39
    s_waitcnt vmcnt(16)
    v_min_i32_dpp v46, v46, v46 row_ror:8 row_mask:0xf bank_mask:0xf
    s_nop 1
    v_min_i32_dpp v46, v46, v46 row_ror:4 row_mask:0xf bank_mask:0xf
    s_nop 1
    v_min_i32_dpp v46, v46, v46 row_ror:2 row_mask:0xf bank_mask:0xf
    s_nop 1
    v_min_i32_dpp v46, v46, v46 row_ror:1 row_mask:0xf bank_mask:0xf
    s_nop 0
    v_readlane_b32 s39, v46, 0
    v_readlane_b32 s20, v46, 16
    v_readlane_b32 s21, v46, 32
    s_min_i32 s39, s39, s20
    v_readlane_b32 s20, v46, 48
    s_min_i32 s39, s39, s21
    s_min_i32 s39, s39, s20
    s_max_i32 s36, s36, s39
    v_readfirstlane_b32 s38, v48
    s_and_b32 s22, s16, 63
    s_lshl_b32 s22, s22, 20
    s_add_u32 s22, s22, 8388608
    s_lshr_b32 s20, s22, 8
    s_xor_b32 s20, s20, s34
    s_and_b32 s20, s20, 0x2000
    s_or_b32 s22, s22, s20
    s_lshl_b32 s21, s18, 11
    s_add_u32 s21, s21, s22
    s_lshl_b32 s23, s17, 15
    s_add_u32 s23, s23, s21
    s_add_u32 s24, s23, 16384
    s_add_u32 s25, s21, 786432
    s_add_u32 s26, s25, 16384
    s_lshl_b32 s21, s18, 14
    s_add_u32 s27, s22, s21
    s_add_u32 s27, s27, 655360
    s_xor_b32 s27, s27, s51
    s_add_u32 s28, s27, 65536
    s_mul_i32 s29, s16, 40960
    s_add_u32 s43, s16, s41
    s_cmp_lt_u32 s43, 64
    s_cselect_b32 s20, 0, 0x40000000
    v_add_u32 v5, s20, v4
    s_cmp_eq_u32 s18, 0
    s_cbranch_scc0 L_fin_go
    s_add_u32 s39, s16, 1
    s_min_u32 s39, s39, 62
    s_cmp_ge_i32 s38, s39
    s_cbranch_scc1 mw_10_ok
    s_mov_b32 s21, 0
mw_10:
    buffer_load_dword v15, v10, s[8:11], 0 offen sc1
    s_waitcnt vmcnt(0)
    v_cmp_gt_i32 vcc, s39, v15
    s_cbranch_vccz mw_10_got
    s_sleep 4
    s_add_u32 s21, s21, 1
    s_cmp_lt_u32 s21, 200000
    s_cbranch_scc1 mw_10
mw_10_got:
    v_min_i32_dpp v15, v15, v15 row_ror:8 row_mask:0xf bank_mask:0xf
    s_nop 1
    v_min_i32_dpp v15, v15, v15 row_ror:4 row_mask:0xf bank_mask:0xf
    s_nop 1
    v_min_i32_dpp v15, v15, v15 row_ror:2 row_mask:0xf bank_mask:0xf
    s_nop 1
    v_min_i32_dpp v15, v15, v15 row_ror:1 row_mask:0xf bank_mask:0xf
    s_nop 0
    v_readlane_b32 s38, v15, 0
    v_readlane_b32 s20, v15, 16
    v_readlane_b32 s21, v15, 32
    s_min_i32 s38, s38, s20
    v_readlane_b32 s20, v15, 48
    s_min_i32 s38, s38, s21
    s_min_i32 s38, s38, s20
mw_10_ok:
    s_cmp_lt_u32 s16, 62
    s_cbranch_scc1 L_fin_go
    s_mov_b32 s21, 0
wf_11:
    buffer_load_dword v15, v9, s[8:11], 0 offen sc1
    s_waitcnt vmcnt(0)
    v_cmp_gt_i32 vcc, 63, v15
    s_cbranch_vccz wf_11_ok
    s_sleep 1
    s_add_u32 s21, s21, 1
    s_cmp_lt_u32 s21, 200000
    s_cbranch_scc1 wf_11
wf_11_ok:
L_fin_go:
    s_barrier
    buffer_load_dword v47, v10, s[8:11], 0 offen offset:4 sc1
    s_xor_b32 s20, s27, 0
    buffer_load_dwordx4 v[176:179], v4, s[4:7], s20 offen sc1
    s_xor_b32 s20, s28, 0
    buffer_load_dwordx4 v[180:183], v4, s[4:7], s20 offen sc1
    s_xor_b32 s20, s27, 1024
    buffer_load_dwordx4 v[184:187], v4, s[4:7], s20 offen sc1
    s_xor_b32 s20, s28, 1024
    buffer_load_dwordx4 v[188:191], v4, s[4:7], s20 offen sc1
    s_xor_b32 s20, s27, 2048
    buffer_load_dwordx4 v[192:195], v4, s[4:7], s20 offen sc1
    s_xor_b32 s20, s28, 2048
    buffer_load_dwordx4 v[196:199], v4, s[4:7], s20 offen sc1
    s_xor_b32 s20, s27, 3072
    buffer_load_dwordx4 v[200:203], v4, s[4:7], s20 offen sc1
    s_xor_b32 s20, s28, 3072
    buffer_load_dwordx4 v[204:207], v4, s[4:7], s20 offen sc1
    s_xor_b32 s20, s27, 4096
    buffer_load_dwordx4 v[208:211], v4, s[4:7], s20 offen sc1
    s_xor_b32 s20, s28, 4096
    buffer_load_dwordx4 v[212:215], v4, s[4:7], s20 offen sc1
    s_xor_b32 s20, s27, 5120
    buffer_load_dwordx4 v[216:219], v4, s[4:7], s20 offen sc1
    s_xor_b32 s20, s28, 5120
    buffer_load_dwordx4 v[220:223], v4, s[4:7], s20 offen sc1
    s_xor_b32 s20, s27, 6144
    buffer_load_dwordx4 v[224:227], v4, s[4:7], s20 offen sc1
    s_xor_b32 s20, s28, 6144
    buffer_load_dwordx4 v[228:231], v4, s[4:7], s20 offen sc1
    s_xor_b32 s20, s27, 7168
    buffer_load_dwordx4 v[232:235], v4, s[4:7], s20 offen sc1
    s_xor_b32 s20, s28, 7168
    buffer_load_dwordx4 v[236:239], v4, s[4:7], s20 offen sc1
    buffer_load_dwordx4 a[176:179], v4, s[4:7], s25 offen offset:0 sc1
    buffer_load_dwordx4 a[180:183], v4, s[4:7], s26 offen offset:0 sc1
    buffer_load_dwordx4 a[184:187], v4, s[4:7], s23 offen offset:0 sc1
    buffer_load_dwordx4 a[188:191], v4, s[4:7], s24 offen offset:0 sc1
    buffer_load_dwordx4 a[192:195], v4, s[4:7], s25 offen offset:1024 sc1
    buffer_load_dwordx4 a[196:199], v4, s[4:7], s26 offen offset:1024 sc1
    buffer_load_dwordx4 a[200:203], v4, s[4:7], s23 offen offset:1024 sc1
    buffer_load_dwordx4 a[204:207], v4, s[4:7], s24 offen offset:1024 sc1
    buffer_load_dwordx2 v[40:41], v8, s[12:15], s29 offen
    s_waitcnt vmcnt(25)
    v_readfirstlane_b32 s20, v47
    s_max_i32 s37, s37, s20
    s_cmp_lt_u32 s43, 64
    s_cbranch_scc1 L_fin_more
    s_waitcnt vmcnt(23)
    v_mfma_f32_16x16x32_bf16 v[16:19], a[112:115], v[176:179], 0
    v_mfma_f32_16x16x32_bf16 v[20:23], a[144:147], v[176:179], 0
    v_mfma_f32_16x16x32_bf16 v[24:27], a[112:115], v[180:183], 0
    v_mfma_f32_16x16x32_bf16 v[28:31], a[144:147], v[180:183], 0
    s_waitcnt vmcnt(21)
    v_mfma_f32_16x16x32_bf16 v[16:19], a[116:119], v[184:187], v[16:19]
    v_mfma_f32_16x16x32_bf16 v[20:23], a[148:151], v[184:187], v[20:23]
    v_mfma_f32_16x16x32_bf16 v[24:27], a[116:119], v[188:191], v[24:27]
    v_mfma_f32_16x16x32_bf16 v[28:31], a[148:151], v[188:191], v[28:31]
    s_waitcnt vmcnt(19)
    v_mfma_f32_16x16x32_bf16 v[16:19], a[120:123], v[192:195], v[16:19]
    v_mfma_f32_16x16x32_bf16 v[20:23], a[152:155], v[192:195], v[20:23]
    v_mfma_f32_16x16x32_bf16 v[24:27], a[120:123], v[196:199], v[24:27]
    v_mfma_f32_16x16x32_bf16 v[28:31], a[152:155], v[196:199], v[28:31]
    s_waitcnt vmcnt(17)
    v_mfma_f32_16x16x32_bf16 v[16:19], a[124:127], v[200:203], v[16:19]
    v_mfma_f32_16x16x32_bf16 v[20:23], a[156:159], v[200:203], v[20:23]
    v_mfma_f32_16x16x32_bf16 v[24:27], a[124:127], v[204:207], v[24:27]
    v_mfma_f32_16x16x32_bf16 v[28:31], a[156:159], v[204:207], v[28:31]
    s_waitcnt vmcnt(15)
    v_mfma_f32_16x16x32_bf16 v[16:19], a[128:131], v[208:211], v[16:19]
    v_mfma_f32_16x16x32_bf16 v[20:23], a[160:163], v[208:211], v[20:23]
    v_mfma_f32_16x16x32_bf16 v[24:27], a[128:131], v[212:215], v[24:27]
    v_mfma_f32_16x16x32_bf16 v[28:31], a[160:163], v[212:215], v[28:31]
    s_waitcnt vmcnt(13)
    v_mfma_f32_16x16x32_bf16 v[16:19], a[132:135], v[216:219], v[16:19]
    v_mfma_f32_16x16x32_bf16 v[20:23], a[164:167], v[216:219], v[20:23]
    v_mfma_f32_16x16x32_bf16 v[24:27], a[132:135], v[220:223], v[24:27]
    v_mfma_f32_16x16x32_bf16 v[28:31], a[164:167], v[220:223], v[28:31]
    s_waitcnt vmcnt(11)
    v_mfma_f32_16x16x32_bf16 v[16:19], a[136:139], v[224:227], v[16:19]
    v_mfma_f32_16x16x32_bf16 v[20:23], a[168:171], v[224:227], v[20:23]
    v_mfma_f32_16x16x32_bf16 v[24:27], a[136:139], v[228:231], v[24:27]
    v_mfma_f32_16x16x32_bf16 v[28:31], a[168:171], v[228:231], v[28:31]
    s_waitcnt vmcnt(9)
    v_mfma_f32_16x16x32_bf16 v[16:19], a[140:143], v[232:235], v[16:19]
    v_mfma_f32_16x16x32_bf16 v[20:23], a[172:175], v[232:235], v[20:23]
    v_mfma_f32_16x16x32_bf16 v[24:27], a[140:143], v[236:239], v[24:27]
    v_mfma_f32_16x16x32_bf16 v[28:31], a[172:175], v[236:239], v[28:31]
    s_waitcnt vmcnt(5)
    v_mfma_f32_16x16x32_bf16 v[16:19], a[184:187], a[176:179], v[16:19]
    v_mfma_f32_16x16x32_bf16 v[20:23], a[188:191], a[176:179], v[20:23]
    v_mfma_f32_16x16x32_bf16 v[24:27], a[184:187], a[180:183], v[24:27]
    v_mfma_f32_16x16x32_bf16 v[28:31], a[188:191], a[180:183], v[28:31]
    s_waitcnt vmcnt(0)
    v_mfma_f32_16x16x32_bf16 v[16:19], a[200:203], a[192:195], v[16:19]
    v_mfma_f32_16x16x32_bf16 v[20:23], a[204:207], a[192:195], v[20:23]
    v_mfma_f32_16x16x32_bf16 v[24:27], a[200:203], a[196:199], v[24:27]
    v_mfma_f32_16x16x32_bf16 v[28:31], a[204:207], a[196:199], v[28:31]
    s_branch L_fin_red
L_fin_more:
    s_min_u32 s39, s43, 63
    s_cmp_ge_i32 s36, s39
    s_cbranch_scc1 mw_12_ok
    s_mov_b32 s21, 0
mw_12:
    buffer_load_dword v15, v3, s[8:11], 0 offen sc1
    s_waitcnt vmcnt(0)
    v_cmp_gt_i32 vcc, s39, v15
    s_cbranch_vccz mw_12_got
    s_sleep 4
    s_add_u32 s21, s21, 1
    s_cmp_lt_u32 s21, 200000
    s_cbranch_scc1 mw_12
mw_12_got:
    v_min_i32_dpp v15, v15, v15 row_ror:8 row_mask:0xf bank_mask:0xf
    s_nop 1
    v_min_i32_dpp v15, v15, v15 row_ror:4 row_mask:0xf bank_mask:0xf
    s_nop 1
    v_min_i32_dpp v15, v15, v15 row_ror:2 row_mask:0xf bank_mask:0xf
    s_nop 1
    v_min_i32_dpp v15, v15, v15 row_ror:1 row_mask:0xf bank_mask:0xf
    s_nop 0
    v_readlane_b32 s36, v15, 0
    v_readlane_b32 s20, v15, 16
    v_readlane_b32 s21, v15, 32
    s_min_i32 s36, s36, s20
    v_readlane_b32 s20, v15, 48
    s_min_i32 s36, s36, s21
    s_min_i32 s36, s36, s20
mw_12_ok:
    s_and_b32 s20, s43, 63
    s_lshl_b32 s20, s20, 20
    s_add_u32 s20, s20, 9207808
    s_lshr_b32 s21, s20, 8
    s_xor_b32 s21, s21, s34
    s_and_b32 s21, s21, 0x2000
    s_or_b32 s40, s20, s21
    s_cmp_eq_u32 s18, 3
    s_cselect_b32 s22, 0x40000000, 0
    v_add_u32 v14, s22, v5
    s_add_u32 s20, s40, s60
    buffer_load_dwordx4 v[64:67], v5, s[4:7], s20 offen offset:0 sc1
    buffer_load_dwordx4 v[68:71], v5, s[4:7], s20 offen offset:1024 sc1
    buffer_load_dwordx4 v[72:75], v5, s[4:7], s20 offen offset:2048 sc1
    buffer_load_dwordx4 v[76:79], v5, s[4:7], s20 offen offset:3072 sc1
    s_add_u32 s20, s40, s61
    buffer_load_dwordx4 v[80:83], v5, s[4:7], s20 offen offset:0 sc1
    buffer_load_dwordx4 v[84:87], v5, s[4:7], s20 offen offset:1024 sc1
    buffer_load_dwordx4 v[88:91], v5, s[4:7], s20 offen offset:2048 sc1
    buffer_load_dwordx4 v[92:95], v5, s[4:7], s20 offen offset:3072 sc1
    s_add_u32 s20, s40, s62
    buffer_load_dwordx4 v[96:99], v5, s[4:7], s20 offen offset:0 sc1
    buffer_load_dwordx4 v[100:103], v5, s[4:7], s20 offen offset:1024 sc1
    buffer_load_dwordx4 v[104:107], v5, s[4:7], s20 offen offset:2048 sc1
    buffer_load_dwordx4 v[108:111], v5, s[4:7], s20 offen offset:3072 sc1
    s_add_u32 s20, s40, s63
    buffer_load_dwordx4 v[112:115], v5, s[4:7], s20 offen offset:0 sc1
    buffer_load_dwordx4 v[116:119], v5, s[4:7], s20 offen offset:1024 sc1
    buffer_load_dwordx4 v[120:123], v5, s[4:7], s20 offen offset:2048 sc1
    buffer_load_dwordx4 v[124:127], v5, s[4:7], s20 offen offset:3072 sc1
    s_add_u32 s20, s40, s64
    buffer_load_dwordx4 v[128:131], v5, s[4:7], s20 offen offset:0 sc1
    buffer_load_dwordx4 v[132:135], v5, s[4:7], s20 offen offset:1024 sc1
    buffer_load_dwordx4 v[136:139], v5, s[4:7], s20 offen offset:2048 sc1
    buffer_load_dwordx4 v[140:143], v5, s[4:7], s20 offen offset:3072 sc1
    s_add_u32 s20, s40, s65
    buffer_load_dwordx4 v[144:147], v5, s[4:7], s20 offen offset:0 sc1
    buffer_load_dwordx4 v[148:151], v5, s[4:7], s20 offen offset:1024 sc1
    buffer_load_dwordx4 v[152:155], v5, s[4:7], s20 offen offset:2048 sc1
    buffer_load_dwordx4 v[156:159], v5, s[4:7], s20 offen offset:3072 sc1
    s_add_u32 s20, s40, s66
    buffer_load_dwordx4 v[160:163], v14, s[4:7], s20 offen offset:0 sc1
    buffer_load_dwordx4 v[164:167], v14, s[4:7], s20 offen offset:1024 sc1
    buffer_load_dwordx4 v[168:171], v14, s[4:7], s20 offen offset:2048 sc1
    buffer_load_dwordx4 v[172:175], v14, s[4:7], s20 offen offset:3072 sc1
    s_waitcnt vmcnt(51)
    v_mfma_f32_16x16x32_bf16 v[16:19], a[112:115], v[176:179], 0
    v_mfma_f32_16x16x32_bf16 v[20:23], a[144:147], v[176:179], 0
    v_mfma_f32_16x16x32_bf16 v[24:27], a[112:115], v[180:183], 0
    v_mfma_f32_16x16x32_bf16 v[28:31], a[144:147], v[180:183], 0
    s_waitcnt vmcnt(49)
    v_mfma_f32_16x16x32_bf16 v[16:19], a[116:119], v[184:187], v[16:19]
    v_mfma_f32_16x16x32_bf16 v[20:23], a[148:151], v[184:187], v[20:23]
    v_mfma_f32_16x16x32_bf16 v[24:27], a[116:119], v[188:191], v[24:27]
    v_mfma_f32_16x16x32_bf16 v[28:31], a[148:151], v[188:191], v[28:31]
    s_waitcnt vmcnt(47)
    v_mfma_f32_16x16x32_bf16 v[16:19], a[120:123], v[192:195], v[16:19]
    v_mfma_f32_16x16x32_bf16 v[20:23], a[152:155], v[192:195], v[20:23]
    v_mfma_f32_16x16x32_bf16 v[24:27], a[120:123], v[196:199], v[24:27]
    v_mfma_f32_16x16x32_bf16 v[28:31], a[152:155], v[196:199], v[28:31]
    s_waitcnt vmcnt(45)
    v_mfma_f32_16x16x32_bf16 v[16:19], a[124:127], v[200:203], v[16:19]
    v_mfma_f32_16x16x32_bf16 v[20:23], a[156:159], v[200:203], v[20:23]
    v_mfma_f32_16x16x32_bf16 v[24:27], a[124:127], v[204:207], v[24:27]
    v_mfma_f32_16x16x32_bf16 v[28:31], a[156:159], v[204:207], v[28:31]
    s_waitcnt vmcnt(43)
    v_mfma_f32_16x16x32_bf16 v[16:19], a[128:131], v[208:211], v[16:19]
    v_mfma_f32_16x16x32_bf16 v[20:23], a[160:163], v[208:211], v[20:23]
    v_mfma_f32_16x16x32_bf16 v[24:27], a[128:131], v[212:215], v[24:27]
    v_mfma_f32_16x16x32_bf16 v[28:31], a[160:163], v[212:215], v[28:31]
    s_waitcnt vmcnt(41)
    v_mfma_f32_16x16x32_bf16 v[16:19], a[132:135], v[216:219], v[16:19]
    v_mfma_f32_16x16x32_bf16 v[20:23], a[164:167], v[216:219], v[20:23]
    v_mfma_f32_16x16x32_bf16 v[24:27], a[132:135], v[220:223], v[24:27]
    v_mfma_f32_16x16x32_bf16 v[28:31], a[164:167], v[220:223], v[28:31]
    s_waitcnt vmcnt(39)
    v_mfma_f32_16x16x32_bf16 v[16:19], a[136:139], v[224:227], v[16:19]
    v_mfma_f32_16x16x32_bf16 v[20:23], a[168:171], v[224:227], v[20:23]
    v_mfma_f32_16x16x32_bf16 v[24:27], a[136:139], v[228:231], v[24:27]
    v_mfma_f32_16x16x32_bf16 v[28:31], a[168:171], v[228:231], v[28:31]
    s_waitcnt vmcnt(37)
    v_mfma_f32_16x16x32_bf16 v[16:19], a[140:143], v[232:235], v[16:19]
    v_mfma_f32_16x16x32_bf16 v[20:23], a[172:175], v[232:235], v[20:23]
    v_mfma_f32_16x16x32_bf16 v[24:27], a[140:143], v[236:239], v[24:27]
    v_mfma_f32_16x16x32_bf16 v[28:31], a[172:175], v[236:239], v[28:31]
    s_waitcnt vmcnt(33)
    v_mfma_f32_16x16x32_bf16 v[16:19], a[184:187], a[176:179], v[16:19]
    v_mfma_f32_16x16x32_bf16 v[20:23], a[188:191], a[176:179], v[20:23]
    v_mfma_f32_16x16x32_bf16 v[24:27], a[184:187], a[180:183], v[24:27]
    v_mfma_f32_16x16x32_bf16 v[28:31], a[188:191], a[180:183], v[28:31]
    s_waitcnt vmcnt(28)
    v_mfma_f32_16x16x32_bf16 v[16:19], a[200:203], a[192:195], v[16:19]
    v_mfma_f32_16x16x32_bf16 v[20:23], a[204:207], a[192:195], v[20:23]
    v_mfma_f32_16x16x32_bf16 v[24:27], a[200:203], a[196:199], v[24:27]
    v_mfma_f32_16x16x32_bf16 v[28:31], a[204:207], a[196:199], v[28:31]
L_fin_red:
    s_nop 7
    ds_write_b128 v6, v[16:19] offset:16384
    ds_write_b128 v6, v[20:23] offset:17408
    ds_write_b128 v6, v[24:27] offset:18432
    ds_write_b128 v6, v[28:31] offset:19456
    s_waitcnt lgkmcnt(0)
    s_barrier
    ds_read_b64 v[16:17], v7 offset:16384
    ds_read_b64 v[18:19], v7 offset:17408
    ds_read_b64 v[20:21], v7 offset:20480
    ds_read_b64 v[22:23], v7 offset:21504
    ds_read_b64 v[24:25], v7 offset:24576
    ds_read_b64 v[26:27], v7 offset:25600
    ds_read_b64 v[28:29], v7 offset:28672
    ds_read_b64 v[30:31], v7 offset:29696
    s_waitcnt lgkmcnt(0)
    v_add_f32 v16, v16, v20
    v_add_f32 v24, v24, v28
    v_add_f32 v17, v17, v21
    v_add_f32 v25, v25, v29
    v_add_f32 v18, v18, v22
    v_add_f32 v26, v26, v30
    v_add_f32 v19, v19, v23
    v_add_f32 v27, v27, v31
    v_add_f32 v36, v16, v24
    v_add_f32 v37, v17, v25
    v_add_f32 v38, v18, v26
    v_add_f32 v39, v19, v27
    v_lshlrev_b32 v42, 16, v40
    v_lshlrev_b32 v43, 16, v41
    v_and_b32 v44, 0xffff0000, v40
    v_and_b32 v45, 0xffff0000, v41
    v_fmac_f32 v42, v32, v36
    v_fmac_f32 v43, v33, v37
    v_fmac_f32 v44, v34, v38
    v_fmac_f32 v45, v35, v39
    v_cvt_pk_bf16_f32 v40, v42, v44
    v_cvt_pk_bf16_f32 v41, v43, v45
    buffer_store_dwordx2 v[40:41], v8, s[44:47], s29 offen
    s_mov_b32 s16, s43
    s_cmp_lt_u32 s16, 64
    s_cbranch_scc1 L_fin_loop
    s_endpgm
L_x_ffn:
    v_and_b32 v1, 63, v0
    v_lshrrev_b32 v2, 6, v0
    s_nop 0
    v_readfirstlane_b32 s18, v2
    v_and_b32 v12, 15, v1
    v_lshrrev_b32 v13, 4, v1
    v_lshlrev_b32 v4, 4, v1
    v_mov_b32 v11, -1
    s_mov_b32 s31, 0x05040100
    s_mov_b32 s32, 0x07060302
    v_mul_u32_u24 v10, 27648, v13
    v_lshl_add_u32 v10, v12, 2, v10
    s_lshl_b32 s20, s17, 9
    s_lshl_b32 s21, s18, 7
    s_add_u32 s20, s20, s21
    v_add_u32 v10, s20, v10
    s_load_dwordx2 s[12:13], s[0:1], 64
    s_mov_b32 s14, 2211840
    s_mov_b32 s15, 0x20000
    s_waitcnt lgkmcnt(0)
    s_mov_b32 s40, 0
    v_bfe_u32 v160, v1, 2, 2
    v_lshlrev_b32 v160, 6, v160
    v_and_b32 v161, 3, v1
    v_lshl_add_u32 v160, v161, 4, v160
    v_bfe_u32 v161, v1, 4, 1
    v_lshrrev_b32 v162, 5, v1
    ds_bpermute_b32 v164, v160, v10
    v_mul_u32_u24 v163, 3456, v161
    v_mul_u32_u24 v170, 6912, v162
    s_waitcnt lgkmcnt(0)
    v_add3_u32 v164, v164, v163, v170
    s_mul_i32 s29, s18, 20480
    s_add_u32 s29, s29, 40960
    v_lshl_add_u32 v170, v1, 2, s29
    s_add_u32 m0, s29, 0
    s_mov_b32 s30, 0
    buffer_load_dwordx4 v164, s[12:15], s30 offen lds
    s_add_u32 m0, s29, 1024
    s_mov_b32 s30, 64
    buffer_load_dwordx4 v164, s[12:15], s30 offen lds
    s_add_u32 m0, s29, 2048
    s_mov_b32 s30, 13824
    buffer_load_dwordx4 v164, s[12:15], s30 offen lds
    s_add_u32 m0, s29, 3072
    s_mov_b32 s30, 13888
    buffer_load_dwordx4 v164, s[12:15], s30 offen lds
    s_add_u32 m0, s29, 4096
    s_mov_b32 s30, 110592
    buffer_load_dwordx4 v164, s[12:15], s30 offen lds
    s_add_u32 m0, s29, 5120
    s_mov_b32 s30, 110656
    buffer_load_dwordx4 v164, s[12:15], s30 offen lds
    s_add_u32 m0, s29, 6144
    s_mov_b32 s30, 124416
    buffer_load_dwordx4 v164, s[12:15], s30 offen lds
    s_add_u32 m0, s29, 7168
    s_mov_b32 s30, 124480
    buffer_load_dwordx4 v164, s[12:15], s30 offen lds
    s_add_u32 m0, s29, 8192
    s_mov_b32 s30, 221184
    buffer_load_dwordx4 v164, s[12:15], s30 offen lds
    s_add_u32 m0, s29, 9216
    s_mov_b32 s30, 221248
    buffer_load_dwordx4 v164, s[12:15], s30 offen lds
    s_add_u32 m0, s29, 10240
    s_mov_b32 s30, 235008
    buffer_load_dwordx4 v164, s[12:15], s30 offen lds
    s_add_u32 m0, s29, 11264
    s_mov_b32 s30, 235072
    buffer_load_dwordx4 v164, s[12:15], s30 offen lds
    s_add_u32 m0, s29, 12288
    s_mov_b32 s30, 331776
    buffer_load_dwordx4 v164, s[12:15], s30 offen lds
    s_add_u32 m0, s29, 13312
    s_mov_b32 s30, 331840
    buffer_load_dwordx4 v164, s[12:15], s30 offen lds
    s_add_u32 m0, s29, 14336
    s_mov_b32 s30, 345600
    buffer_load_dwordx4 v164, s[12:15], s30 offen lds
    s_add_u32 m0, s29, 15360
    s_mov_b32 s30, 345664
    buffer_load_dwordx4 v164, s[12:15], s30 offen lds
    s_add_u32 m0, s29, 16384
    s_mov_b32 s30, 442368
    buffer_load_dwordx4 v164, s[12:15], s30 offen lds
    s_add_u32 m0, s29, 17408
    s_mov_b32 s30, 442432
    buffer_load_dwordx4 v164, s[12:15], s30 offen lds
    s_add_u32 m0, s29, 18432
    s_mov_b32 s30, 456192
    buffer_load_dwordx4 v164, s[12:15], s30 offen lds
    s_add_u32 m0, s29, 19456
    s_mov_b32 s30, 456256
    buffer_load_dwordx4 v164, s[12:15], s30 offen lds
    s_waitcnt vmcnt(16)
    ds_read2st64_b32 v[128:129], v170 offset0:0 offset1:1
    ds_read2st64_b32 v[130:131], v170 offset0:2 offset1:3
    ds_read2st64_b32 v[132:133], v170 offset0:4 offset1:5
    ds_read2st64_b32 v[134:135], v170 offset0:6 offset1:7
    ds_read2st64_b32 v[136:137], v170 offset0:8 offset1:9
    ds_read2st64_b32 v[138:139], v170 offset0:10 offset1:11
    ds_read2st64_b32 v[140:141], v170 offset0:12 offset1:13
    ds_read2st64_b32 v[142:143], v170 offset0:14 offset1:15
    s_waitcnt lgkmcnt(0)
    s_add_u32 m0, s29, 0
    s_mov_b32 s30, 552960
    buffer_load_dwordx4 v164, s[12:15], s30 offen lds
    s_add_u32 m0, s29, 1024
    s_mov_b32 s30, 553024
    buffer_load_dwordx4 v164, s[12:15], s30 offen lds
    s_add_u32 m0, s29, 2048
    s_mov_b32 s30, 566784
    buffer_load_dwordx4 v164, s[12:15], s30 offen lds
    s_add_u32 m0, s29, 3072
    s_mov_b32 s30, 566848
    buffer_load_dwordx4 v164, s[12:15], s30 offen lds
    s_waitcnt vmcnt(16)
    ds_read2st64_b32 v[144:145], v170 offset0:16 offset1:17
    ds_read2st64_b32 v[146:147], v170 offset0:18 offset1:19
    ds_read2st64_b32 v[148:149], v170 offset0:20 offset1:21
    ds_read2st64_b32 v[150:151], v170 offset0:22 offset1:23
    ds_read2st64_b32 v[152:153], v170 offset0:24 offset1:25
    ds_read2st64_b32 v[154:155], v170 offset0:26 offset1:27
    ds_read2st64_b32 v[156:157], v170 offset0:28 offset1:29
    ds_read2st64_b32 v[158:159], v170 offset0:30 offset1:31
    v_perm_b32 v120, v129, v128, s31
    v_accvgpr_write_b32 a0, v120
    v_perm_b32 v121, v129, v128, s32
    v_accvgpr_write_b32 a8, v121
    v_perm_b32 v122, v131, v130, s31
    v_accvgpr_write_b32 a1, v122
    v_perm_b32 v123, v131, v130, s32
    v_accvgpr_write_b32 a9, v123
    v_perm_b32 v124, v133, v132, s31
    v_accvgpr_write_b32 a160, v124
    v_perm_b32 v125, v133, v132, s32
    v_accvgpr_write_b32 a168, v125
    v_perm_b32 v126, v135, v134, s31
    v_accvgpr_write_b32 a161, v126
    v_perm_b32 v127, v135, v134, s32
    v_accvgpr_write_b32 a169, v127
    v_perm_b32 v120, v137, v136, s31
    v_accvgpr_write_b32 a2, v120
    v_perm_b32 v121, v137, v136, s32
    v_accvgpr_write_b32 a10, v121
    v_perm_b32 v122, v139, v138, s31
    v_accvgpr_write_b32 a3, v122
    v_perm_b32 v123, v139, v138, s32
    v_accvgpr_write_b32 a11, v123
    v_perm_b32 v124, v141, v140, s31
    v_accvgpr_write_b32 a162, v124
    v_perm_b32 v125, v141, v140, s32
    v_accvgpr_write_b32 a170, v125
    v_perm_b32 v126, v143, v142, s31
    v_accvgpr_write_b32 a163, v126
    v_perm_b32 v127, v143, v142, s32
    v_accvgpr_write_b32 a171, v127
    s_waitcnt lgkmcnt(0)
    s_add_u32 m0, s29, 4096
    s_mov_b32 s30, 663552
    buffer_load_dwordx4 v164, s[12:15], s30 offen lds
    s_add_u32 m0, s29, 5120
    s_mov_b32 s30, 663616
    buffer_load_dwordx4 v164, s[12:15], s30 offen lds
    s_add_u32 m0, s29, 6144
    s_mov_b32 s30, 677376
    buffer_load_dwordx4 v164, s[12:15], s30 offen lds
    s_add_u32 m0, s29, 7168
    s_mov_b32 s30, 677440
    buffer_load_dwordx4 v164, s[12:15], s30 offen lds
    s_waitcnt vmcnt(16)
    ds_read2st64_b32 v[128:129], v170 offset0:32 offset1:33
    ds_read2st64_b32 v[130:131], v170 offset0:34 offset1:35
    ds_read2st64_b32 v[132:133], v170 offset0:36 offset1:37
    ds_read2st64_b32 v[134:135], v170 offset0:38 offset1:39
    ds_read2st64_b32 v[136:137], v170 offset0:40 offset1:41
    ds_read2st64_b32 v[138:139], v170 offset0:42 offset1:43
    ds_read2st64_b32 v[140:141], v170 offset0:44 offset1:45
    ds_read2st64_b32 v[142:143], v170 offset0:46 offset1:47
    v_perm_b32 v120, v145, v144, s31
    v_accvgpr_write_b32 a4, v120
    v_perm_b32 v121, v145, v144, s32
    v_accvgpr_write_b32 a12, v121
    v_perm_b32 v122, v147, v146, s31
    v_accvgpr_write_b32 a5, v122
    v_perm_b32 v123, v147, v146, s32
    v_accvgpr_write_b32 a13, v123
    v_perm_b32 v124, v149, v148, s31
    v_accvgpr_write_b32 a164, v124
    v_perm_b32 v125, v149, v148, s32
    v_accvgpr_write_b32 a172, v125
    v_perm_b32 v126, v151, v150, s31
    v_accvgpr_write_b32 a165, v126
    v_perm_b32 v127, v151, v150, s32
    v_accvgpr_write_b32 a173, v127
    v_perm_b32 v120, v153, v152, s31
    v_accvgpr_write_b32 a6, v120
    v_perm_b32 v121, v153, v152, s32
    v_accvgpr_write_b32 a14, v121
    v_perm_b32 v122, v155, v154, s31
    v_accvgpr_write_b32 a7, v122
    v_perm_b32 v123, v155, v154, s32
    v_accvgpr_write_b32 a15, v123
    v_perm_b32 v124, v157, v156, s31
    v_accvgpr_write_b32 a166, v124
    v_perm_b32 v125, v157, v156, s32
    v_accvgpr_write_b32 a174, v125
    v_perm_b32 v126, v159, v158, s31
    v_accvgpr_write_b32 a167, v126
    v_perm_b32 v127, v159, v158, s32
    v_accvgpr_write_b32 a175, v127
    s_waitcnt lgkmcnt(0)
    s_add_u32 m0, s29, 8192
    s_mov_b32 s30, 774144
    buffer_load_dwordx4 v164, s[12:15], s30 offen lds
    s_add_u32 m0, s29, 9216
    s_mov_b32 s30, 774208
    buffer_load_dwordx4 v164, s[12:15], s30 offen lds
    s_add_u32 m0, s29, 10240
    s_mov_b32 s30, 787968
    buffer_load_dwordx4 v164, s[12:15], s30 offen lds
    s_add_u32 m0, s29, 11264
    s_mov_b32 s30, 788032
    buffer_load_dwordx4 v164, s[12:15], s30 offen lds
    s_waitcnt vmcnt(16)
    ds_read2st64_b32 v[144:145], v170 offset0:48 offset1:49
    ds_read2st64_b32 v[146:147], v170 offset0:50 offset1:51
    ds_read2st64_b32 v[148:149], v170 offset0:52 offset1:53
    ds_read2st64_b32 v[150:151], v170 offset0:54 offset1:55
    ds_read2st64_b32 v[152:153], v170 offset0:56 offset1:57
    ds_read2st64_b32 v[154:155], v170 offset0:58 offset1:59
    ds_read2st64_b32 v[156:157], v170 offset0:60 offset1:61
    ds_read2st64_b32 v[158:159], v170 offset0:62 offset1:63
    v_perm_b32 v120, v129, v128, s31
    v_accvgpr_write_b32 a16, v120
    v_perm_b32 v121, v129, v128, s32
    v_accvgpr_write_b32 a24, v121
    v_perm_b32 v122, v131, v130, s31
    v_accvgpr_write_b32 a17, v122
    v_perm_b32 v123, v131, v130, s32
    v_accvgpr_write_b32 a25, v123
    v_perm_b32 v124, v133, v132, s31
    v_accvgpr_write_b32 a176, v124
    v_perm_b32 v125, v133, v132, s32
    v_accvgpr_write_b32 a184, v125
    v_perm_b32 v126, v135, v134, s31
    v_accvgpr_write_b32 a177, v126
    v_perm_b32 v127, v135, v134, s32
    v_accvgpr_write_b32 a185, v127
    v_perm_b32 v120, v137, v136, s31
    v_accvgpr_write_b32 a18, v120
    v_perm_b32 v121, v137, v136, s32
    v_accvgpr_write_b32 a26, v121
    v_perm_b32 v122, v139, v138, s31
    v_accvgpr_write_b32 a19, v122
    v_perm_b32 v123, v139, v138, s32
    v_accvgpr_write_b32 a27, v123
    v_perm_b32 v124, v141, v140, s31
    v_accvgpr_write_b32 a178, v124
    v_perm_b32 v125, v141, v140, s32
    v_accvgpr_write_b32 a186, v125
    v_perm_b32 v126, v143, v142, s31
    v_accvgpr_write_b32 a179, v126
    v_perm_b32 v127, v143, v142, s32
    v_accvgpr_write_b32 a187, v127
    s_waitcnt lgkmcnt(0)
    s_add_u32 m0, s29, 12288
    s_mov_b32 s30, 884736
    buffer_load_dwordx4 v164, s[12:15], s30 offen lds
    s_add_u32 m0, s29, 13312
    s_mov_b32 s30, 884800
    buffer_load_dwordx4 v164, s[12:15], s30 offen lds
    s_add_u32 m0, s29, 14336
    s_mov_b32 s30, 898560
    buffer_load_dwordx4 v164, s[12:15], s30 offen lds
    s_add_u32 m0, s29, 15360
    s_mov_b32 s30, 898624
    buffer_load_dwordx4 v164, s[12:15], s30 offen lds
    s_waitcnt vmcnt(16)
    ds_read2st64_b32 v[128:129], v170 offset0:64 offset1:65
    ds_read2st64_b32 v[130:131], v170 offset0:66 offset1:67
    ds_read2st64_b32 v[132:133], v170 offset0:68 offset1:69
    ds_read2st64_b32 v[134:135], v170 offset0:70 offset1:71
    ds_read2st64_b32 v[136:137], v170 offset0:72 offset1:73
    ds_read2st64_b32 v[138:139], v170 offset0:74 offset1:75
    ds_read2st64_b32 v[140:141], v170 offset0:76 offset1:77
    ds_read2st64_b32 v[142:143], v170 offset0:78 offset1:79
    v_perm_b32 v120, v145, v144, s31
    v_accvgpr_write_b32 a20, v120
    v_perm_b32 v121, v145, v144, s32
    v_accvgpr_write_b32 a28, v121
    v_perm_b32 v122, v147, v146, s31
    v_accvgpr_write_b32 a21, v122
    v_perm_b32 v123, v147, v146, s32
    v_accvgpr_write_b32 a29, v123
    v_perm_b32 v124, v149, v148, s31
    v_accvgpr_write_b32 a180, v124
    v_perm_b32 v125, v149, v148, s32
    v_accvgpr_write_b32 a188, v125
    v_perm_b32 v126, v151, v150, s31
    v_accvgpr_write_b32 a181, v126
    v_perm_b32 v127, v151, v150, s32
    v_accvgpr_write_b32 a189, v127
    v_perm_b32 v120, v153, v152, s31
    v_accvgpr_write_b32 a22, v120
    v_perm_b32 v121, v153, v152, s32
    v_accvgpr_write_b32 a30, v121
    v_perm_b32 v122, v155, v154, s31
    v_accvgpr_write_b32 a23, v122
    v_perm_b32 v123, v155, v154, s32
    v_accvgpr_write_b32 a31, v123
    v_perm_b32 v124, v157, v156, s31
    v_accvgpr_write_b32 a182, v124
    v_perm_b32 v125, v157, v156, s32
    v_accvgpr_write_b32 a190, v125
    v_perm_b32 v126, v159, v158, s31
    v_accvgpr_write_b32 a183, v126
    v_perm_b32 v127, v159, v158, s32
    v_accvgpr_write_b32 a191, v127
    s_waitcnt lgkmcnt(0)
    s_add_u32 m0, s29, 16384
    s_mov_b32 s30, 995328
    buffer_load_dwordx4 v164, s[12:15], s30 offen lds
    s_add_u32 m0, s29, 17408
    s_mov_b32 s30, 995392
    buffer_load_dwordx4 v164, s[12:15], s30 offen lds
    s_add_u32 m0, s29, 18432
    s_mov_b32 s30, 1009152
    buffer_load_dwordx4 v164, s[12:15], s30 offen lds
    s_add_u32 m0, s29, 19456
    s_mov_b32 s30, 1009216
    buffer_load_dwordx4 v164, s[12:15], s30 offen lds
    s_waitcnt vmcnt(16)
    ds_read2st64_b32 v[144:145], v170 offset0:0 offset1:1
    ds_read2st64_b32 v[146:147], v170 offset0:2 offset1:3
    ds_read2st64_b32 v[148:149], v170 offset0:4 offset1:5
    ds_read2st64_b32 v[150:151], v170 offset0:6 offset1:7
    ds_read2st64_b32 v[152:153], v170 offset0:8 offset1:9
    ds_read2st64_b32 v[154:155], v170 offset0:10 offset1:11
    ds_read2st64_b32 v[156:157], v170 offset0:12 offset1:13
    ds_read2st64_b32 v[158:159], v170 offset0:14 offset1:15
    v_perm_b32 v120, v129, v128, s31
    v_accvgpr_write_b32 a32, v120
    v_perm_b32 v121, v129, v128, s32
    v_accvgpr_write_b32 a40, v121
    v_perm_b32 v122, v131, v130, s31
    v_accvgpr_write_b32 a33, v122
    v_perm_b32 v123, v131, v130, s32
    v_accvgpr_write_b32 a41, v123
    v_perm_b32 v124, v133, v132, s31
    v_accvgpr_write_b32 a192, v124
    v_perm_b32 v125, v133, v132, s32
    v_accvgpr_write_b32 a200, v125
    v_perm_b32 v126, v135, v134, s31
    v_accvgpr_write_b32 a193, v126
    v_perm_b32 v127, v135, v134, s32
    v_accvgpr_write_b32 a201, v127
    v_perm_b32 v120, v137, v136, s31
    v_accvgpr_write_b32 a34, v120
    v_perm_b32 v121, v137, v136, s32
    v_accvgpr_write_b32 a42, v121
    v_perm_b32 v122, v139, v138, s31
    v_accvgpr_write_b32 a35, v122
    v_perm_b32 v123, v139, v138, s32
    v_accvgpr_write_b32 a43, v123
    v_perm_b32 v124, v141, v140, s31
    v_accvgpr_write_b32 a194, v124
    v_perm_b32 v125, v141, v140, s32
    v_accvgpr_write_b32 a202, v125
    v_perm_b32 v126, v143, v142, s31
    v_accvgpr_write_b32 a195, v126
    v_perm_b32 v127, v143, v142, s32
    v_accvgpr_write_b32 a203, v127
    s_waitcnt lgkmcnt(0)
    s_add_u32 m0, s29, 0
    s_mov_b32 s30, 1105920
    buffer_load_dwordx4 v164, s[12:15], s30 offen lds
    s_add_u32 m0, s29, 1024
    s_mov_b32 s30, 1105984
    buffer_load_dwordx4 v164, s[12:15], s30 offen lds
    s_add_u32 m0, s29, 2048
    s_mov_b32 s30, 1119744
    buffer_load_dwordx4 v164, s[12:15], s30 offen lds
    s_add_u32 m0, s29, 3072
    s_mov_b32 s30, 1119808
    buffer_load_dwordx4 v164, s[12:15], s30 offen lds
    s_waitcnt vmcnt(16)
    ds_read2st64_b32 v[128:129], v170 offset0:16 offset1:17
    ds_read2st64_b32 v[130:131], v170 offset0:18 offset1:19
    ds_read2st64_b32 v[132:133], v170 offset0:20 offset1:21
    ds_read2st64_b32 v[134:135], v170 offset0:22 offset1:23
    ds_read2st64_b32 v[136:137], v170 offset0:24 offset1:25
    ds_read2st64_b32 v[138:139], v170 offset0:26 offset1:27
    ds_read2st64_b32 v[140:141], v170 offset0:28 offset1:29
    ds_read2st64_b32 v[142:143], v170 offset0:30 offset1:31
    v_perm_b32 v120, v145, v144, s31
    v_accvgpr_write_b32 a36, v120
    v_perm_b32 v121, v145, v144, s32
    v_accvgpr_write_b32 a44, v121
    v_perm_b32 v122, v147, v146, s31
    v_accvgpr_write_b32 a37, v122
    v_perm_b32 v123, v147, v146, s32
    v_accvgpr_write_b32 a45, v123
    v_perm_b32 v124, v149, v148, s31
    v_accvgpr_write_b32 a196, v124
    v_perm_b32 v125, v149, v148, s32
    v_accvgpr_write_b32 a204, v125
    v_perm_b32 v126, v151, v150, s31
    v_accvgpr_write_b32 a197, v126
    v_perm_b32 v127, v151, v150, s32
    v_accvgpr_write_b32 a205, v127
    v_perm_b32 v120, v153, v152, s31
    v_accvgpr_write_b32 a38, v120
    v_perm_b32 v121, v153, v152, s32
    v_accvgpr_write_b32 a46, v121
    v_perm_b32 v122, v155, v154, s31
    v_accvgpr_write_b32 a39, v122
    v_perm_b32 v123, v155, v154, s32
    v_accvgpr_write_b32 a47, v123
    v_perm_b32 v124, v157, v156, s31
    v_accvgpr_write_b32 a198, v124
    v_perm_b32 v125, v157, v156, s32
    v_accvgpr_write_b32 a206, v125
    v_perm_b32 v126, v159, v158, s31
    v_accvgpr_write_b32 a199, v126
    v_perm_b32 v127, v159, v158, s32
    v_accvgpr_write_b32 a207, v127
    s_waitcnt lgkmcnt(0)
    s_add_u32 m0, s29, 4096
    s_mov_b32 s30, 1216512
    buffer_load_dwordx4 v164, s[12:15], s30 offen lds
    s_add_u32 m0, s29, 5120
    s_mov_b32 s30, 1216576
    buffer_load_dwordx4 v164, s[12:15], s30 offen lds
    s_add_u32 m0, s29, 6144
    s_mov_b32 s30, 1230336
    buffer_load_dwordx4 v164, s[12:15], s30 offen lds
    s_add_u32 m0, s29, 7168
    s_mov_b32 s30, 1230400
    buffer_load_dwordx4 v164, s[12:15], s30 offen lds
    s_waitcnt vmcnt(16)
    ds_read2st64_b32 v[144:145], v170 offset0:32 offset1:33
    ds_read2st64_b32 v[146:147], v170 offset0:34 offset1:35
    ds_read2st64_b32 v[148:149], v170 offset0:36 offset1:37
    ds_read2st64_b32 v[150:151], v170 offset0:38 offset1:39
    ds_read2st64_b32 v[152:153], v170 offset0:40 offset1:41
    ds_read2st64_b32 v[154:155], v170 offset0:42 offset1:43
    ds_read2st64_b32 v[156:157], v170 offset0:44 offset1:45
    ds_read2st64_b32 v[158:159], v170 offset0:46 offset1:47
    v_perm_b32 v120, v129, v128, s31
    v_accvgpr_write_b32 a48, v120
    v_perm_b32 v121, v129, v128, s32
    v_accvgpr_write_b32 a56, v121
    v_perm_b32 v122, v131, v130, s31
    v_accvgpr_write_b32 a49, v122
    v_perm_b32 v123, v131, v130, s32
    v_accvgpr_write_b32 a57, v123
    v_perm_b32 v124, v133, v132, s31
    v_accvgpr_write_b32 a208, v124
    v_perm_b32 v125, v133, v132, s32
    v_accvgpr_write_b32 a216, v125
    v_perm_b32 v126, v135, v134, s31
    v_accvgpr_write_b32 a209, v126
    v_perm_b32 v127, v135, v134, s32
    v_accvgpr_write_b32 a217, v127
    v_perm_b32 v120, v137, v136, s31
    v_accvgpr_write_b32 a50, v120
    v_perm_b32 v121, v137, v136, s32
    v_accvgpr_write_b32 a58, v121
    v_perm_b32 v122, v139, v138, s31
    v_accvgpr_write_b32 a51, v122
    v_perm_b32 v123, v139, v138, s32
    v_accvgpr_write_b32 a59, v123
    v_perm_b32 v124, v141, v140, s31
    v_accvgpr_write_b32 a210, v124
    v_perm_b32 v125, v141, v140, s32
    v_accvgpr_write_b32 a218, v125
    v_perm_b32 v126, v143, v142, s31
    v_accvgpr_write_b32 a211, v126
    v_perm_b32 v127, v143, v142, s32
    v_accvgpr_write_b32 a219, v127
    s_waitcnt lgkmcnt(0)
    s_add_u32 m0, s29, 8192
    s_mov_b32 s30, 1327104
    buffer_load_dwordx4 v164, s[12:15], s30 offen lds
    s_add_u32 m0, s29, 9216
    s_mov_b32 s30, 1327168
    buffer_load_dwordx4 v164, s[12:15], s30 offen lds
    s_add_u32 m0, s29, 10240
    s_mov_b32 s30, 1340928
    buffer_load_dwordx4 v164, s[12:15], s30 offen lds
    s_add_u32 m0, s29, 11264
    s_mov_b32 s30, 1340992
    buffer_load_dwordx4 v164, s[12:15], s30 offen lds
    s_waitcnt vmcnt(16)
    ds_read2st64_b32 v[128:129], v170 offset0:48 offset1:49
    ds_read2st64_b32 v[130:131], v170 offset0:50 offset1:51
    ds_read2st64_b32 v[132:133], v170 offset0:52 offset1:53
    ds_read2st64_b32 v[134:135], v170 offset0:54 offset1:55
    ds_read2st64_b32 v[136:137], v170 offset0:56 offset1:57
    ds_read2st64_b32 v[138:139], v170 offset0:58 offset1:59
    ds_read2st64_b32 v[140:141], v170 offset0:60 offset1:61
    ds_read2st64_b32 v[142:143], v170 offset0:62 offset1:63
    v_perm_b32 v120, v145, v144, s31
    v_accvgpr_write_b32 a52, v120
    v_perm_b32 v121, v145, v144, s32
    v_accvgpr_write_b32 a60, v121
    v_perm_b32 v122, v147, v146, s31
    v_accvgpr_write_b32 a53, v122
    v_perm_b32 v123, v147, v146, s32
    v_accvgpr_write_b32 a61, v123
    v_perm_b32 v124, v149, v148, s31
    v_accvgpr_write_b32 a212, v124
    v_perm_b32 v125, v149, v148, s32
    v_accvgpr_write_b32 a220, v125
    v_perm_b32 v126, v151, v150, s31
    v_accvgpr_write_b32 a213, v126
    v_perm_b32 v127, v151, v150, s32
    v_accvgpr_write_b32 a221, v127
    v_perm_b32 v120, v153, v152, s31
    v_accvgpr_write_b32 a54, v120
    v_perm_b32 v121, v153, v152, s32
    v_accvgpr_write_b32 a62, v121
    v_perm_b32 v122, v155, v154, s31
    v_accvgpr_write_b32 a55, v122
    v_perm_b32 v123, v155, v154, s32
    v_accvgpr_write_b32 a63, v123
    v_perm_b32 v124, v157, v156, s31
    v_accvgpr_write_b32 a214, v124
    v_perm_b32 v125, v157, v156, s32
    v_accvgpr_write_b32 a222, v125
    v_perm_b32 v126, v159, v158, s31
    v_accvgpr_write_b32 a215, v126
    v_perm_b32 v127, v159, v158, s32
    v_accvgpr_write_b32 a223, v127
    s_waitcnt lgkmcnt(0)
    s_add_u32 m0, s29, 12288
    s_mov_b32 s30, 1437696
    buffer_load_dwordx4 v164, s[12:15], s30 offen lds
    s_add_u32 m0, s29, 13312
    s_mov_b32 s30, 1437760
    buffer_load_dwordx4 v164, s[12:15], s30 offen lds
    s_add_u32 m0, s29, 14336
    s_mov_b32 s30, 1451520
    buffer_load_dwordx4 v164, s[12:15], s30 offen lds
    s_add_u32 m0, s29, 15360
    s_mov_b32 s30, 1451584
    buffer_load_dwordx4 v164, s[12:15], s30 offen lds
    buffer_load_dword v171, off, s[88:91], 0 offset:128 sc1
    s_waitcnt vmcnt(17)
    ds_read2st64_b32 v[144:145], v170 offset0:64 offset1:65
    ds_read2st64_b32 v[146:147], v170 offset0:66 offset1:67
    ds_read2st64_b32 v[148:149], v170 offset0:68 offset1:69
    ds_read2st64_b32 v[150:151], v170 offset0:70 offset1:71
    ds_read2st64_b32 v[152:153], v170 offset0:72 offset1:73
    ds_read2st64_b32 v[154:155], v170 offset0:74 offset1:75
    ds_read2st64_b32 v[156:157], v170 offset0:76 offset1:77
    ds_read2st64_b32 v[158:159], v170 offset0:78 offset1:79
    v_perm_b32 v120, v129, v128, s31
    v_accvgpr_write_b32 a64, v120
    v_perm_b32 v121, v129, v128, s32
    v_accvgpr_write_b32 a72, v121
    v_perm_b32 v122, v131, v130, s31
    v_accvgpr_write_b32 a65, v122
    v_perm_b32 v123, v131, v130, s32
    v_accvgpr_write_b32 a73, v123
    v_perm_b32 v124, v133, v132, s31
    v_accvgpr_write_b32 a224, v124
    v_perm_b32 v125, v133, v132, s32
    v_accvgpr_write_b32 a232, v125
    v_perm_b32 v126, v135, v134, s31
    v_accvgpr_write_b32 a225, v126
    v_perm_b32 v127, v135, v134, s32
    v_accvgpr_write_b32 a233, v127
    v_perm_b32 v120, v137, v136, s31
    v_accvgpr_write_b32 a66, v120
    v_perm_b32 v121, v137, v136, s32
    v_accvgpr_write_b32 a74, v121
    v_perm_b32 v122, v139, v138, s31
    v_accvgpr_write_b32 a67, v122
    v_perm_b32 v123, v139, v138, s32
    v_accvgpr_write_b32 a75, v123
    v_perm_b32 v124, v141, v140, s31
    v_accvgpr_write_b32 a226, v124
    v_perm_b32 v125, v141, v140, s32
    v_accvgpr_write_b32 a234, v125
    v_perm_b32 v126, v143, v142, s31
    v_accvgpr_write_b32 a227, v126
    v_perm_b32 v127, v143, v142, s32
    v_accvgpr_write_b32 a235, v127
    s_waitcnt lgkmcnt(0)
    s_add_u32 m0, s29, 16384
    s_mov_b32 s30, 1548288
    buffer_load_dwordx4 v164, s[12:15], s30 offen lds
    s_add_u32 m0, s29, 17408
    s_mov_b32 s30, 1548352
    buffer_load_dwordx4 v164, s[12:15], s30 offen lds
    s_add_u32 m0, s29, 18432
    s_mov_b32 s30, 1562112
    buffer_load_dwordx4 v164, s[12:15], s30 offen lds
    s_add_u32 m0, s29, 19456
    s_mov_b32 s30, 1562176
    buffer_load_dwordx4 v164, s[12:15], s30 offen lds
    s_waitcnt vmcnt(17)
    ds_read2st64_b32 v[128:129], v170 offset0:0 offset1:1
    ds_read2st64_b32 v[130:131], v170 offset0:2 offset1:3
    ds_read2st64_b32 v[132:133], v170 offset0:4 offset1:5
    ds_read2st64_b32 v[134:135], v170 offset0:6 offset1:7
    ds_read2st64_b32 v[136:137], v170 offset0:8 offset1:9
    ds_read2st64_b32 v[138:139], v170 offset0:10 offset1:11
    ds_read2st64_b32 v[140:141], v170 offset0:12 offset1:13
    ds_read2st64_b32 v[142:143], v170 offset0:14 offset1:15
    v_perm_b32 v120, v145, v144, s31
    v_accvgpr_write_b32 a68, v120
    v_perm_b32 v121, v145, v144, s32
    v_accvgpr_write_b32 a76, v121
    v_perm_b32 v122, v147, v146, s31
    v_accvgpr_write_b32 a69, v122
    v_perm_b32 v123, v147, v146, s32
    v_accvgpr_write_b32 a77, v123
    v_perm_b32 v124, v149, v148, s31
    v_accvgpr_write_b32 a228, v124
    v_perm_b32 v125, v149, v148, s32
    v_accvgpr_write_b32 a236, v125
    v_perm_b32 v126, v151, v150, s31
    v_accvgpr_write_b32 a229, v126
    v_perm_b32 v127, v151, v150, s32
    v_accvgpr_write_b32 a237, v127
    v_perm_b32 v120, v153, v152, s31
    v_accvgpr_write_b32 a70, v120
    v_perm_b32 v121, v153, v152, s32
    v_accvgpr_write_b32 a78, v121
    v_perm_b32 v122, v155, v154, s31
    v_accvgpr_write_b32 a71, v122
    v_perm_b32 v123, v155, v154, s32
    v_accvgpr_write_b32 a79, v123
    v_perm_b32 v124, v157, v156, s31
    v_accvgpr_write_b32 a230, v124
    v_perm_b32 v125, v157, v156, s32
    v_accvgpr_write_b32 a238, v125
    v_perm_b32 v126, v159, v158, s31
    v_accvgpr_write_b32 a231, v126
    v_perm_b32 v127, v159, v158, s32
    v_accvgpr_write_b32 a239, v127
    s_waitcnt lgkmcnt(0)
    s_add_u32 m0, s29, 0
    s_mov_b32 s30, 1658880
    buffer_load_dwordx4 v164, s[12:15], s30 offen lds
    s_add_u32 m0, s29, 1024
    s_mov_b32 s30, 1658944
    buffer_load_dwordx4 v164, s[12:15], s30 offen lds
    s_add_u32 m0, s29, 2048
    s_mov_b32 s30, 1672704
    buffer_load_dwordx4 v164, s[12:15], s30 offen lds
    s_add_u32 m0, s29, 3072
    s_mov_b32 s30, 1672768
    buffer_load_dwordx4 v164, s[12:15], s30 offen lds
    s_waitcnt vmcnt(17)
    ds_read2st64_b32 v[144:145], v170 offset0:16 offset1:17
    ds_read2st64_b32 v[146:147], v170 offset0:18 offset1:19
    ds_read2st64_b32 v[148:149], v170 offset0:20 offset1:21
    ds_read2st64_b32 v[150:151], v170 offset0:22 offset1:23
    ds_read2st64_b32 v[152:153], v170 offset0:24 offset1:25
    ds_read2st64_b32 v[154:155], v170 offset0:26 offset1:27
    ds_read2st64_b32 v[156:157], v170 offset0:28 offset1:29
    ds_read2st64_b32 v[158:159], v170 offset0:30 offset1:31
    v_perm_b32 v120, v129, v128, s31
    v_accvgpr_write_b32 a80, v120
    v_perm_b32 v121, v129, v128, s32
    v_accvgpr_write_b32 a88, v121
    v_perm_b32 v122, v131, v130, s31
    v_accvgpr_write_b32 a81, v122
    v_perm_b32 v123, v131, v130, s32
    v_accvgpr_write_b32 a89, v123
    v_perm_b32 v124, v133, v132, s31
    v_accvgpr_write_b32 a240, v124
    v_perm_b32 v125, v133, v132, s32
    v_accvgpr_write_b32 a248, v125
    v_perm_b32 v126, v135, v134, s31
    v_accvgpr_write_b32 a241, v126
    v_perm_b32 v127, v135, v134, s32
    v_accvgpr_write_b32 a249, v127
    v_perm_b32 v120, v137, v136, s31
    v_accvgpr_write_b32 a82, v120
    v_perm_b32 v121, v137, v136, s32
    v_accvgpr_write_b32 a90, v121
    v_perm_b32 v122, v139, v138, s31
    v_accvgpr_write_b32 a83, v122
    v_perm_b32 v123, v139, v138, s32
    v_accvgpr_write_b32 a91, v123
    v_perm_b32 v124, v141, v140, s31
    v_accvgpr_write_b32 a242, v124
    v_perm_b32 v125, v141, v140, s32
    v_accvgpr_write_b32 a250, v125
    v_perm_b32 v126, v143, v142, s31
    v_accvgpr_write_b32 a243, v126
    v_perm_b32 v127, v143, v142, s32
    v_accvgpr_write_b32 a251, v127
    s_waitcnt lgkmcnt(0)
    s_add_u32 m0, s29, 4096
    s_mov_b32 s30, 1769472
    buffer_load_dwordx4 v164, s[12:15], s30 offen lds
    s_add_u32 m0, s29, 5120
    s_mov_b32 s30, 1769536
    buffer_load_dwordx4 v164, s[12:15], s30 offen lds
    s_add_u32 m0, s29, 6144
    s_mov_b32 s30, 1783296
    buffer_load_dwordx4 v164, s[12:15], s30 offen lds
    s_add_u32 m0, s29, 7168
    s_mov_b32 s30, 1783360
    buffer_load_dwordx4 v164, s[12:15], s30 offen lds
    s_waitcnt vmcnt(17)
    ds_read2st64_b32 v[128:129], v170 offset0:32 offset1:33
    ds_read2st64_b32 v[130:131], v170 offset0:34 offset1:35
    ds_read2st64_b32 v[132:133], v170 offset0:36 offset1:37
    ds_read2st64_b32 v[134:135], v170 offset0:38 offset1:39
    ds_read2st64_b32 v[136:137], v170 offset0:40 offset1:41
    ds_read2st64_b32 v[138:139], v170 offset0:42 offset1:43
    ds_read2st64_b32 v[140:141], v170 offset0:44 offset1:45
    ds_read2st64_b32 v[142:143], v170 offset0:46 offset1:47
    v_perm_b32 v120, v145, v144, s31
    v_accvgpr_write_b32 a84, v120
    v_perm_b32 v121, v145, v144, s32
    v_accvgpr_write_b32 a92, v121
    v_perm_b32 v122, v147, v146, s31
    v_accvgpr_write_b32 a85, v122
    v_perm_b32 v123, v147, v146, s32
    v_accvgpr_write_b32 a93, v123
    v_perm_b32 v124, v149, v148, s31
    v_accvgpr_write_b32 a244, v124
    v_perm_b32 v125, v149, v148, s32
    v_accvgpr_write_b32 a252, v125
    v_perm_b32 v126, v151, v150, s31
    v_accvgpr_write_b32 a245, v126
    v_perm_b32 v127, v151, v150, s32
    v_accvgpr_write_b32 a253, v127
    v_perm_b32 v120, v153, v152, s31
    v_accvgpr_write_b32 a86, v120
    v_perm_b32 v121, v153, v152, s32
    v_accvgpr_write_b32 a94, v121
    v_perm_b32 v122, v155, v154, s31
    v_accvgpr_write_b32 a87, v122
    v_perm_b32 v123, v155, v154, s32
    v_accvgpr_write_b32 a95, v123
    v_perm_b32 v124, v157, v156, s31
    v_accvgpr_write_b32 a246, v124
    v_perm_b32 v125, v157, v156, s32
    v_accvgpr_write_b32 a254, v125
    v_perm_b32 v126, v159, v158, s31
    v_accvgpr_write_b32 a247, v126
    v_perm_b32 v127, v159, v158, s32
    v_accvgpr_write_b32 a255, v127
    s_waitcnt lgkmcnt(0)
    s_add_u32 m0, s29, 8192
    s_mov_b32 s30, 1880064
    buffer_load_dwordx4 v164, s[12:15], s30 offen lds
    s_add_u32 m0, s29, 9216
    s_mov_b32 s30, 1880128
    buffer_load_dwordx4 v164, s[12:15], s30 offen lds
    s_add_u32 m0, s29, 10240
    s_mov_b32 s30, 1893888
    buffer_load_dwordx4 v164, s[12:15], s30 offen lds
    s_add_u32 m0, s29, 11264
    s_mov_b32 s30, 1893952
    buffer_load_dwordx4 v164, s[12:15], s30 offen lds
    s_waitcnt vmcnt(17)
    ds_read2st64_b32 v[144:145], v170 offset0:48 offset1:49
    ds_read2st64_b32 v[146:147], v170 offset0:50 offset1:51
    ds_read2st64_b32 v[148:149], v170 offset0:52 offset1:53
    ds_read2st64_b32 v[150:151], v170 offset0:54 offset1:55
    ds_read2st64_b32 v[152:153], v170 offset0:56 offset1:57
    ds_read2st64_b32 v[154:155], v170 offset0:58 offset1:59
    ds_read2st64_b32 v[156:157], v170 offset0:60 offset1:61
    ds_read2st64_b32 v[158:159], v170 offset0:62 offset1:63
    v_perm_b32 v120, v129, v128, s31
    v_accvgpr_write_b32 a96, v120
    v_perm_b32 v121, v129, v128, s32
    v_accvgpr_write_b32 a104, v121
    v_perm_b32 v122, v131, v130, s31
    v_accvgpr_write_b32 a97, v122
    v_perm_b32 v123, v131, v130, s32
    v_accvgpr_write_b32 a105, v123
    v_perm_b32 v192, v133, v132, s31
    v_perm_b32 v200, v133, v132, s32
    v_perm_b32 v193, v135, v134, s31
    v_perm_b32 v201, v135, v134, s32
    v_perm_b32 v120, v137, v136, s31
    v_accvgpr_write_b32 a98, v120
    v_perm_b32 v121, v137, v136, s32
    v_accvgpr_write_b32 a106, v121
    v_perm_b32 v122, v139, v138, s31
    v_accvgpr_write_b32 a99, v122
    v_perm_b32 v123, v139, v138, s32
    v_accvgpr_write_b32 a107, v123
    v_perm_b32 v194, v141, v140, s31
    v_perm_b32 v202, v141, v140, s32
    v_perm_b32 v195, v143, v142, s31
    v_perm_b32 v203, v143, v142, s32
    s_waitcnt lgkmcnt(0)
    s_add_u32 m0, s29, 12288
    s_mov_b32 s30, 1990656
    buffer_load_dwordx4 v164, s[12:15], s30 offen lds
    s_add_u32 m0, s29, 13312
    s_mov_b32 s30, 1990720
    buffer_load_dwordx4 v164, s[12:15], s30 offen lds
    s_add_u32 m0, s29, 14336
    s_mov_b32 s30, 2004480
    buffer_load_dwordx4 v164, s[12:15], s30 offen lds
    s_add_u32 m0, s29, 15360
    s_mov_b32 s30, 2004544
    buffer_load_dwordx4 v164, s[12:15], s30 offen lds
    s_waitcnt vmcnt(16)
    ds_read2st64_b32 v[128:129], v170 offset0:64 offset1:65
    ds_read2st64_b32 v[130:131], v170 offset0:66 offset1:67
    ds_read2st64_b32 v[132:133], v170 offset0:68 offset1:69
    ds_read2st64_b32 v[134:135], v170 offset0:70 offset1:71
    ds_read2st64_b32 v[136:137], v170 offset0:72 offset1:73
    ds_read2st64_b32 v[138:139], v170 offset0:74 offset1:75
    ds_read2st64_b32 v[140:141], v170 offset0:76 offset1:77
    ds_read2st64_b32 v[142:143], v170 offset0:78 offset1:79
    v_perm_b32 v120, v145, v144, s31
    v_accvgpr_write_b32 a100, v120
    v_perm_b32 v121, v145, v144, s32
    v_accvgpr_write_b32 a108, v121
    v_perm_b32 v122, v147, v146, s31
    v_accvgpr_write_b32 a101, v122
    v_perm_b32 v123, v147, v146, s32
    v_accvgpr_write_b32 a109, v123
    v_perm_b32 v196, v149, v148, s31
    v_perm_b32 v204, v149, v148, s32
    v_perm_b32 v197, v151, v150, s31
    v_perm_b32 v205, v151, v150, s32
    v_perm_b32 v120, v153, v152, s31
    v_accvgpr_write_b32 a102, v120
    v_perm_b32 v121, v153, v152, s32
    v_accvgpr_write_b32 a110, v121
    v_perm_b32 v122, v155, v154, s31
    v_accvgpr_write_b32 a103, v122
    v_perm_b32 v123, v155, v154, s32
    v_accvgpr_write_b32 a111, v123
    v_perm_b32 v198, v157, v156, s31
    v_perm_b32 v206, v157, v156, s32
    v_perm_b32 v199, v159, v158, s31
    v_perm_b32 v207, v159, v158, s32
    s_waitcnt lgkmcnt(0)
    s_add_u32 m0, s29, 16384
    s_mov_b32 s30, 2101248
    buffer_load_dwordx4 v164, s[12:15], s30 offen lds
    s_add_u32 m0, s29, 17408
    s_mov_b32 s30, 2101312
    buffer_load_dwordx4 v164, s[12:15], s30 offen lds
    s_add_u32 m0, s29, 18432
    s_mov_b32 s30, 2115072
    buffer_load_dwordx4 v164, s[12:15], s30 offen lds
    s_add_u32 m0, s29, 19456
    s_mov_b32 s30, 2115136
    buffer_load_dwordx4 v164, s[12:15], s30 offen lds
    s_mul_i32 s20, s16, 40960
    s_mul_i32 s21, s18, 10240
    s_add_u32 s20, s20, s21
    s_add_u32 s20, s20, 2097152
    s_add_u32 s21, s21, s40
    s_mov_b32 m0, s21
    s_nop 0
    buffer_load_dwordx4 v4, s[4:7], s20 offen offset:0 sc1 lds
    buffer_load_dwordx4 v4, s[4:7], s20 offen offset:1024 sc1 lds
    buffer_load_dwordx4 v4, s[4:7], s20 offen offset:2048 sc1 lds
    buffer_load_dwordx4 v4, s[4:7], s20 offen offset:3072 sc1 lds
    s_add_u32 s20, s20, 4096
    s_add_u32 s21, s21, 4096
    s_mov_b32 m0, s21
    s_nop 0
    buffer_load_dwordx4 v4, s[4:7], s20 offen offset:0 sc1 lds
    buffer_load_dwordx4 v4, s[4:7], s20 offen offset:1024 sc1 lds
    buffer_load_dwordx4 v4, s[4:7], s20 offen offset:2048 sc1 lds
    buffer_load_dwordx4 v4, s[4:7], s20 offen offset:3072 sc1 lds
    s_add_u32 s20, s20, 4096
    s_add_u32 s21, s21, 4096
    s_mov_b32 m0, s21
    s_nop 0
    buffer_load_dwordx4 v4, s[4:7], s20 offen offset:0 sc1 lds
    buffer_load_dwordx4 v4, s[4:7], s20 offen offset:1024 sc1 lds
    s_waitcnt vmcnt(26)
    ds_read2st64_b32 v[144:145], v170 offset0:0 offset1:1
    ds_read2st64_b32 v[146:147], v170 offset0:2 offset1:3
    ds_read2st64_b32 v[148:149], v170 offset0:4 offset1:5
    ds_read2st64_b32 v[150:151], v170 offset0:6 offset1:7
    ds_read2st64_b32 v[152:153], v170 offset0:8 offset1:9
    ds_read2st64_b32 v[154:155], v170 offset0:10 offset1:11
    ds_read2st64_b32 v[156:157], v170 offset0:12 offset1:13
    ds_read2st64_b32 v[158:159], v170 offset0:14 offset1:15
    v_perm_b32 v120, v129, v128, s31
    v_accvgpr_write_b32 a112, v120
    v_perm_b32 v121, v129, v128, s32
    v_accvgpr_write_b32 a120, v121
    v_perm_b32 v122, v131, v130, s31
    v_accvgpr_write_b32 a113, v122
    v_perm_b32 v123, v131, v130, s32
    v_accvgpr_write_b32 a121, v123
    v_perm_b32 v208, v133, v132, s31
    v_perm_b32 v216, v133, v132, s32
    v_perm_b32 v209, v135, v134, s31
    v_perm_b32 v217, v135, v134, s32
    v_perm_b32 v120, v137, v136, s31
    v_accvgpr_write_b32 a114, v120
    v_perm_b32 v121, v137, v136, s32
    v_accvgpr_write_b32 a122, v121
    v_perm_b32 v122, v139, v138, s31
    v_accvgpr_write_b32 a115, v122
    v_perm_b32 v123, v139, v138, s32
    v_accvgpr_write_b32 a123, v123
    v_perm_b32 v210, v141, v140, s31
    v_perm_b32 v218, v141, v140, s32
    v_perm_b32 v211, v143, v142, s31
    v_perm_b32 v219, v143, v142, s32
    s_waitcnt lgkmcnt(0)
    s_waitcnt vmcnt(22)
    ds_read2st64_b32 v[128:129], v170 offset0:16 offset1:17
    ds_read2st64_b32 v[130:131], v170 offset0:18 offset1:19
    ds_read2st64_b32 v[132:133], v170 offset0:20 offset1:21
    ds_read2st64_b32 v[134:135], v170 offset0:22 offset1:23
    ds_read2st64_b32 v[136:137], v170 offset0:24 offset1:25
    ds_read2st64_b32 v[138:139], v170 offset0:26 offset1:27
    ds_read2st64_b32 v[140:141], v170 offset0:28 offset1:29
    ds_read2st64_b32 v[142:143], v170 offset0:30 offset1:31
    v_perm_b32 v120, v145, v144, s31
    v_accvgpr_write_b32 a116, v120
    v_perm_b32 v121, v145, v144, s32
    v_accvgpr_write_b32 a124, v121
    v_perm_b32 v122, v147, v146, s31
    v_accvgpr_write_b32 a117, v122
    v_perm_b32 v123, v147, v146, s32
    v_accvgpr_write_b32 a125, v123
    v_perm_b32 v212, v149, v148, s31
    v_perm_b32 v220, v149, v148, s32
    v_perm_b32 v213, v151, v150, s31
    v_perm_b32 v221, v151, v150, s32
    v_perm_b32 v120, v153, v152, s31
    v_accvgpr_write_b32 a118, v120
    v_perm_b32 v121, v153, v152, s32
    v_accvgpr_write_b32 a126, v121
    v_perm_b32 v122, v155, v154, s31
    v_accvgpr_write_b32 a119, v122
    v_perm_b32 v123, v155, v154, s32
    v_accvgpr_write_b32 a127, v123
    v_perm_b32 v214, v157, v156, s31
    v_perm_b32 v222, v157, v156, s32
    v_perm_b32 v215, v159, v158, s31
    v_perm_b32 v223, v159, v158, s32
    s_waitcnt lgkmcnt(0)
    s_waitcnt vmcnt(18)
    ds_read2st64_b32 v[144:145], v170 offset0:32 offset1:33
    ds_read2st64_b32 v[146:147], v170 offset0:34 offset1:35
    ds_read2st64_b32 v[148:149], v170 offset0:36 offset1:37
    ds_read2st64_b32 v[150:151], v170 offset0:38 offset1:39
    ds_read2st64_b32 v[152:153], v170 offset0:40 offset1:41
    ds_read2st64_b32 v[154:155], v170 offset0:42 offset1:43
    ds_read2st64_b32 v[156:157], v170 offset0:44 offset1:45
    ds_read2st64_b32 v[158:159], v170 offset0:46 offset1:47
    v_perm_b32 v120, v129, v128, s31
    v_accvgpr_write_b32 a128, v120
    v_perm_b32 v121, v129, v128, s32
    v_accvgpr_write_b32 a136, v121
    v_perm_b32 v122, v131, v130, s31
    v_accvgpr_write_b32 a129, v122
    v_perm_b32 v123, v131, v130, s32
    v_accvgpr_write_b32 a137, v123
    v_perm_b32 v224, v133, v132, s31
    v_perm_b32 v232, v133, v132, s32
    v_perm_b32 v225, v135, v134, s31
    v_perm_b32 v233, v135, v134, s32
    v_perm_b32 v120, v137, v136, s31
    v_accvgpr_write_b32 a130, v120
    v_perm_b32 v121, v137, v136, s32
    v_accvgpr_write_b32 a138, v121
    v_perm_b32 v122, v139, v138, s31
    v_accvgpr_write_b32 a131, v122
    v_perm_b32 v123, v139, v138, s32
    v_accvgpr_write_b32 a139, v123
    v_perm_b32 v226, v141, v140, s31
    v_perm_b32 v234, v141, v140, s32
    v_perm_b32 v227, v143, v142, s31
    v_perm_b32 v235, v143, v142, s32
    s_waitcnt lgkmcnt(0)
    s_waitcnt vmcnt(14)
    ds_read2st64_b32 v[128:129], v170 offset0:48 offset1:49
    ds_read2st64_b32 v[130:131], v170 offset0:50 offset1:51
    ds_read2st64_b32 v[132:133], v170 offset0:52 offset1:53
    ds_read2st64_b32 v[134:135], v170 offset0:54 offset1:55
    ds_read2st64_b32 v[136:137], v170 offset0:56 offset1:57
    ds_read2st64_b32 v[138:139], v170 offset0:58 offset1:59
    ds_read2st64_b32 v[140:141], v170 offset0:60 offset1:61
    ds_read2st64_b32 v[142:143], v170 offset0:62 offset1:63
    v_perm_b32 v120, v145, v144, s31
    v_accvgpr_write_b32 a132, v120
    v_perm_b32 v121, v145, v144, s32
    v_accvgpr_write_b32 a140, v121
    v_perm_b32 v122, v147, v146, s31
    v_accvgpr_write_b32 a133, v122
    v_perm_b32 v123, v147, v146, s32
    v_accvgpr_write_b32 a141, v123
    v_perm_b32 v228, v149, v148, s31
    v_perm_b32 v236, v149, v148, s32
    v_perm_b32 v229, v151, v150, s31
    v_perm_b32 v237, v151, v150, s32
    v_perm_b32 v120, v153, v152, s31
    v_accvgpr_write_b32 a134, v120
    v_perm_b32 v121, v153, v152, s32
    v_accvgpr_write_b32 a142, v121
    v_perm_b32 v122, v155, v154, s31
    v_accvgpr_write_b32 a135, v122
    v_perm_b32 v123, v155, v154, s32
    v_accvgpr_write_b32 a143, v123
    v_perm_b32 v230, v157, v156, s31
    v_perm_b32 v238, v157, v156, s32
    v_perm_b32 v231, v159, v158, s31
    v_perm_b32 v239, v159, v158, s32
    s_waitcnt lgkmcnt(0)
    s_waitcnt vmcnt(10)
    ds_read2st64_b32 v[144:145], v170 offset0:64 offset1:65
    ds_read2st64_b32 v[146:147], v170 offset0:66 offset1:67
    ds_read2st64_b32 v[148:149], v170 offset0:68 offset1:69
    ds_read2st64_b32 v[150:151], v170 offset0:70 offset1:71
    ds_read2st64_b32 v[152:153], v170 offset0:72 offset1:73
    ds_read2st64_b32 v[154:155], v170 offset0:74 offset1:75
    ds_read2st64_b32 v[156:157], v170 offset0:76 offset1:77
    ds_read2st64_b32 v[158:159], v170 offset0:78 offset1:79
    v_perm_b32 v120, v129, v128, s31
    v_accvgpr_write_b32 a144, v120
    v_perm_b32 v121, v129, v128, s32
    v_accvgpr_write_b32 a152, v121
    v_perm_b32 v122, v131, v130, s31
    v_accvgpr_write_b32 a145, v122
    v_perm_b32 v123, v131, v130, s32
    v_accvgpr_write_b32 a153, v123
    v_perm_b32 v240, v133, v132, s31
    v_perm_b32 v248, v133, v132, s32
    v_perm_b32 v241, v135, v134, s31
    v_perm_b32 v249, v135, v134, s32
    v_perm_b32 v120, v137, v136, s31
    v_accvgpr_write_b32 a146, v120
    v_perm_b32 v121, v137, v136, s32
    v_accvgpr_write_b32 a154, v121
    v_perm_b32 v122, v139, v138, s31
    v_accvgpr_write_b32 a147, v122
    v_perm_b32 v123, v139, v138, s32
    v_accvgpr_write_b32 a155, v123
    v_perm_b32 v242, v141, v140, s31
    v_perm_b32 v250, v141, v140, s32
    v_perm_b32 v243, v143, v142, s31
    v_perm_b32 v251, v143, v142, s32
    s_waitcnt lgkmcnt(0)
    v_perm_b32 v120, v145, v144, s31
    v_accvgpr_write_b32 a148, v120
    v_perm_b32 v121, v145, v144, s32
    v_accvgpr_write_b32 a156, v121
    v_perm_b32 v122, v147, v146, s31
    v_accvgpr_write_b32 a149, v122
    v_perm_b32 v123, v147, v146, s32
    v_accvgpr_write_b32 a157, v123
    v_perm_b32 v244, v149, v148, s31
    v_perm_b32 v252, v149, v148, s32
    v_perm_b32 v245, v151, v150, s31
    v_perm_b32 v253, v151, v150, s32
    v_perm_b32 v120, v153, v152, s31
    v_accvgpr_write_b32 a150, v120
    v_perm_b32 v121, v153, v152, s32
    v_accvgpr_write_b32 a158, v121
    v_perm_b32 v122, v155, v154, s31
    v_accvgpr_write_b32 a151, v122
    v_perm_b32 v123, v155, v154, s32
    v_accvgpr_write_b32 a159, v123
    v_perm_b32 v246, v157, v156, s31
    v_perm_b32 v254, v157, v156, s32
    v_perm_b32 v247, v159, v158, s31
    v_perm_b32 v255, v159, v158, s32
    s_mov_b32 s21, 0
    v_readfirstlane_b32 s19, v171
    s_and_b32 s22, s19, 255
    s_xor_b32 s22, s22, 64
    v_mov_b32 v172, 40960
    s_cmp_eq_u32 s18, 0
    s_cbranch_scc0 wi_14_w
    s_branch wi_14_chk
wi_14:
    buffer_load_dword v171, off, s[88:91], 0 offset:128 sc1
    s_waitcnt vmcnt(0)
wi_14_chk:
    v_readfirstlane_b32 s19, v171
    s_and_b32 s20, s19, 255
    s_cmp_eq_u32 s20, 64
    s_cbranch_scc1 wi_14_ok
    s_sleep 2
    s_add_u32 s21, s21, 1
    s_cmp_lt_u32 s21, 200000
    s_cbranch_scc1 wi_14
wi_14_ok:
    ds_write_b32 v172, v171
wi_14_w:
    s_waitcnt vmcnt(0) lgkmcnt(0)
    s_barrier
    ds_read_b32 v171, v172
    s_waitcnt lgkmcnt(0)
    v_readfirstlane_b32 s19, v171
    s_cmp_gt_u32 s19, 33024
    s_cselect_b32 s19, 0x2000, 0
    s_xor_b32 s34, s19, 0x2000
    s_cmp_eq_u32 s22, 0
    s_cbranch_scc1 nbk_13
    s_mul_i32 s20, s16, 40960
    s_mul_i32 s21, s18, 10240
    s_add_u32 s20, s20, s21
    s_add_u32 s20, s20, 2097152
    s_add_u32 s21, s21, s40
    s_mov_b32 m0, s21
    s_nop 0
    buffer_load_dwordx4 v4, s[4:7], s20 offen offset:0 sc1 lds
    buffer_load_dwordx4 v4, s[4:7], s20 offen offset:1024 sc1 lds
    buffer_load_dwordx4 v4, s[4:7], s20 offen offset:2048 sc1 lds
    buffer_load_dwordx4 v4, s[4:7], s20 offen offset:3072 sc1 lds
    s_add_u32 s20, s20, 4096
    s_add_u32 s21, s21, 4096
    s_mov_b32 m0, s21
    s_nop 0
    buffer_load_dwordx4 v4, s[4:7], s20 offen offset:0 sc1 lds
    buffer_load_dwordx4 v4, s[4:7], s20 offen offset:1024 sc1 lds
    buffer_load_dwordx4 v4, s[4:7], s20 offen offset:2048 sc1 lds
    buffer_load_dwordx4 v4, s[4:7], s20 offen offset:3072 sc1 lds
    s_add_u32 s20, s20, 4096
    s_add_u32 s21, s21, 4096
    s_mov_b32 m0, s21
    s_nop 0
    buffer_load_dwordx4 v4, s[4:7], s20 offen offset:0 sc1 lds
    buffer_load_dwordx4 v4, s[4:7], s20 offen offset:1024 sc1 lds
nbk_13:
    s_lshl_b32 s20, s17, 2
    s_add_u32 s20, s20, s18
    s_cmp_lt_u32 s20, 27
    s_cselect_b32 s20, s20, 0x20000
    s_and_b32 s21, s20, 1
    s_lshr_b32 s20, s20, 1
    s_lshl_b32 s20, s20, 14
    s_lshl_b32 s21, s21, 12
    s_add_u32 s20, s20, s21
    v_add_u32 v8, s20, v4
    s_mov_b32 s33, 0xbfb8aa3b
    s_and_b32 s21, s42, 7
    s_lshl_b32 s21, s21, 2
    s_lshr_b32 s20, s42, 3
    s_lshl_b32 s20, s20, 7
    s_add_u32 s20, s20, s21
    s_add_u32 s20, s20, 1884160
    s_add_u32 s20, s20, s19
    s_cmp_eq_u32 s18, 0
    s_cselect_b32 s20, s20, 0x40000000
    v_mov_b32 v9, s20
    v_cmp_eq_u32 vcc, 0, v1
    v_mov_b32 v3, 0x40000000
    s_nop 0
    v_cndmask_b32 v9, v3, v9, vcc
    v_mov_b32 v2, v4
    s_mul_i32 s49, s18, 10240
    s_add_u32 s48, s49, 2093056
    s_mov_b32 s22, 0
    s_mov_b32 s23, 0
    s_mov_b32 s50, 64
    s_waitcnt vmcnt(0)
    s_barrier
    ds_read_b128 v[100:103], v2 offset:0
    ds_read_b128 v[104:107], v2 offset:1024
    ds_read_b128 v[108:111], v2 offset:2048
    ds_read_b128 v[112:115], v2 offset:3072
L_ffn1_loop:
    v_mov_b32 v5, v2
    s_waitcnt lgkmcnt(3)
    v_mfma_f32_16x16x32_bf16 v[16:19], a[0:3], v[100:103], 0
    ds_read_b128 v[116:119], v5 offset:4096
    s_barrier
    v_mfma_f32_16x16x32_bf16 v[20:23], a[8:11], v[100:103], 0
    v_xor_b32 v2, 40960, v2
    s_xor_b32 s40, s40, 40960
    v_mfma_f32_16x16x32_bf16 v[24:27], a[160:163], v[100:103], 0
    s_add_u32 s47, s40, s49
    s_sub_u32 s20, s16, 1
    v_mov_b32 v10, s20
    v_mfma_f32_16x16x32_bf16 v[28:31], a[168:171], v[100:103], 0
    s_waitcnt lgkmcnt(3)
    s_add_u32 s43, s16, s41
    s_min_u32 s46, s43, 63
    v_mfma_f32_16x16x32_bf16 v[16:19], a[4:7], v[104:107], v[16:19]
    ds_read_b128 v[100:103], v5 offset:5120
    s_mul_i32 s46, s46, 40960
    s_add_u32 s46, s46, s48
    v_mfma_f32_16x16x32_bf16 v[20:23], a[12:15], v[104:107], v[20:23]
    v_mul_f32 v64, s33, v32
    v_mul_f32 v65, s33, v33
    v_mfma_f32_16x16x32_bf16 v[24:27], a[164:167], v[104:107], v[24:27]
    v_mul_f32 v66, s33, v34
    v_mul_f32 v67, s33, v35
    v_mfma_f32_16x16x32_bf16 v[28:31], a[172:175], v[104:107], v[28:31]
    s_waitcnt lgkmcnt(3)
    v_mul_f32 v68, s33, v36
    v_mul_f32 v69, s33, v37
    v_mfma_f32_16x16x32_bf16 v[16:19], a[16:19], v[108:111], v[16:19]
    ds_read_b128 v[104:107], v5 offset:6144
    v_mul_f32 v70, s33, v38
    v_mul_f32 v71, s33, v39
    v_mfma_f32_16x16x32_bf16 v[20:23], a[24:27], v[108:111], v[20:23]
    v_exp_f32 v64, v64
    v_mfma_f32_16x16x32_bf16 v[24:27], a[176:179], v[108:111], v[24:27]
    s_add_u32 m0, s47, 0
    s_add_u32 s46, s46, 4096
    buffer_load_dwordx4 v4, s[4:7], s46 offen offset:0 sc1 lds
    v_mfma_f32_16x16x32_bf16 v[28:31], a[184:187], v[108:111], v[28:31]
    s_waitcnt lgkmcnt(3)
    v_exp_f32 v65, v65
    v_mfma_f32_16x16x32_bf16 v[16:19], a[20:23], v[112:115], v[16:19]
    ds_read_b128 v[108:111], v5 offset:7168
    v_exp_f32 v66, v66
    v_mfma_f32_16x16x32_bf16 v[20:23], a[28:31], v[112:115], v[20:23]
    v_exp_f32 v67, v67
    v_mfma_f32_16x16x32_bf16 v[24:27], a[180:183], v[112:115], v[24:27]
    buffer_load_dwordx4 v4, s[4:7], s46 offen offset:1024 sc1 lds
    v_exp_f32 v68, v68
    v_mfma_f32_16x16x32_bf16 v[28:31], a[188:191], v[112:115], v[28:31]
    s_waitcnt lgkmcnt(3)
    v_exp_f32 v69, v69
    v_mfma_f32_16x16x32_bf16 v[16:19], a[32:35], v[116:119], v[16:19]
    ds_read_b128 v[112:115], v5 offset:8192
    v_exp_f32 v70, v70
    v_mfma_f32_16x16x32_bf16 v[20:23], a[40:43], v[116:119], v[20:23]
    v_exp_f32 v71, v71
    v_mfma_f32_16x16x32_bf16 v[24:27], a[192:195], v[116:119], v[24:27]
    buffer_load_dwordx4 v4, s[4:7], s46 offen offset:2048 sc1 lds
    v_add_f32 v64, 1.0, v64
    v_add_f32 v65, 1.0, v65
    v_mfma_f32_16x16x32_bf16 v[28:31], a[200:203], v[116:119], v[28:31]
    s_waitcnt lgkmcnt(3)
    v_add_f32 v66, 1.0, v66
    v_add_f32 v67, 1.0, v67
    v_mfma_f32_16x16x32_bf16 v[16:19], a[36:39], v[100:103], v[16:19]
    ds_read_b128 v[116:119], v5 offset:9216
    v_add_f32 v68, 1.0, v68
    v_add_f32 v69, 1.0, v69
    v_mfma_f32_16x16x32_bf16 v[20:23], a[44:47], v[100:103], v[20:23]
    v_add_f32 v70, 1.0, v70
    v_add_f32 v71, 1.0, v71
    v_mfma_f32_16x16x32_bf16 v[24:27], a[196:199], v[100:103], v[24:27]
    buffer_load_dwordx4 v4, s[4:7], s46 offen offset:3072 sc1 lds
    v_rcp_f32 v64, v64
    v_mfma_f32_16x16x32_bf16 v[28:31], a[204:207], v[100:103], v[28:31]
    s_waitcnt lgkmcnt(3)
    v_rcp_f32 v65, v65
    v_mfma_f32_16x16x32_bf16 v[16:19], a[48:51], v[104:107], v[16:19]
    ds_read_b128 v[100:103], v5 offset:10240
    v_rcp_f32 v66, v66
    v_mfma_f32_16x16x32_bf16 v[20:23], a[56:59], v[104:107], v[20:23]
    v_rcp_f32 v67, v67
    v_mfma_f32_16x16x32_bf16 v[24:27], a[208:211], v[104:107], v[24:27]
    s_add_u32 m0, s47, 4096
    s_add_u32 s46, s46, 4096
    buffer_load_dwordx4 v4, s[4:7], s46 offen offset:0 sc1 lds
    v_mfma_f32_16x16x32_bf16 v[28:31], a[216:219], v[104:107], v[28:31]
    s_waitcnt lgkmcnt(3)
    v_rcp_f32 v68, v68
    v_mfma_f32_16x16x32_bf16 v[16:19], a[52:55], v[108:111], v[16:19]
    ds_read_b128 v[104:107], v5 offset:11264
    v_rcp_f32 v69, v69
    v_mfma_f32_16x16x32_bf16 v[20:23], a[60:63], v[108:111], v[20:23]
    v_rcp_f32 v70, v70
    v_mfma_f32_16x16x32_bf16 v[24:27], a[212:215], v[108:111], v[24:27]
    buffer_load_dwordx4 v4, s[4:7], s46 offen offset:1024 sc1 lds
    v_rcp_f32 v71, v71
    v_mfma_f32_16x16x32_bf16 v[28:31], a[220:223], v[108:111], v[28:31]
    s_waitcnt lgkmcnt(3)
    v_mul_f32 v32, v32, v64
    v_mul_f32 v33, v33, v65
    v_mfma_f32_16x16x32_bf16 v[16:19], a[64:67], v[112:115], v[16:19]
    ds_read_b128 v[108:111], v5 offset:12288
    v_mul_f32 v34, v34, v66
    v_mul_f32 v35, v35, v67
    v_mfma_f32_16x16x32_bf16 v[20:23], a[72:75], v[112:115], v[20:23]
    v_mul_f32 v36, v36, v68
    v_mul_f32 v37, v37, v69
    v_mfma_f32_16x16x32_bf16 v[24:27], a[224:227], v[112:115], v[24:27]
    buffer_load_dwordx4 v4, s[4:7], s46 offen offset:2048 sc1 lds
    v_mul_f32 v38, v38, v70
    v_mul_f32 v39, v39, v71
    v_mfma_f32_16x16x32_bf16 v[28:31], a[232:235], v[112:115], v[28:31]
    s_waitcnt lgkmcnt(3)
    v_cvt_pk_bf16_f32 v48, v32, v33
    v_cvt_pk_bf16_f32 v49, v36, v37
    v_mfma_f32_16x16x32_bf16 v[16:19], a[68:71], v[116:119], v[16:19]
    ds_read_b128 v[112:115], v5 offset:13312
    v_cvt_pk_bf16_f32 v50, v34, v35
    v_cvt_pk_bf16_f32 v51, v38, v39
    v_mfma_f32_16x16x32_bf16 v[20:23], a[76:79], v[116:119], v[20:23]
    buffer_store_dwordx4 v[48:51], v3, s[4:7], s22 offen offset:1024 sc1
    v_mfma_f32_16x16x32_bf16 v[24:27], a[228:231], v[116:119], v[24:27]
    buffer_load_dwordx4 v4, s[4:7], s46 offen offset:3072 sc1 lds
    v_mul_f32 v64, s33, v40
    v_mul_f32 v65, s33, v41
    v_mfma_f32_16x16x32_bf16 v[28:31], a[236:239], v[116:119], v[28:31]
    s_waitcnt lgkmcnt(3)
    v_mul_f32 v66, s33, v42
    v_mul_f32 v67, s33, v43
    v_mfma_f32_16x16x32_bf16 v[16:19], a[80:83], v[100:103], v[16:19]
    ds_read_b128 v[116:119], v5 offset:14336
    v_mul_f32 v68, s33, v44
    v_mul_f32 v69, s33, v45
    v_mfma_f32_16x16x32_bf16 v[20:23], a[88:91], v[100:103], v[20:23]
    v_mul_f32 v70, s33, v46
    v_mul_f32 v71, s33, v47
    v_mfma_f32_16x16x32_bf16 v[24:27], a[240:243], v[100:103], v[24:27]
    s_add_u32 m0, s47, 8192
    s_add_u32 s46, s46, 4096
    buffer_load_dwordx4 v4, s[4:7], s46 offen offset:0 sc1 lds
    v_mfma_f32_16x16x32_bf16 v[28:31], a[248:251], v[100:103], v[28:31]
    s_waitcnt lgkmcnt(3)
    v_exp_f32 v64, v64
    v_mfma_f32_16x16x32_bf16 v[16:19], a[84:87], v[104:107], v[16:19]
    ds_read_b128 v[100:103], v5 offset:15360
    v_exp_f32 v65, v65
    v_mfma_f32_16x16x32_bf16 v[20:23], a[92:95], v[104:107], v[20:23]
    v_exp_f32 v66, v66
    v_mfma_f32_16x16x32_bf16 v[24:27], a[244:247], v[104:107], v[24:27]
    buffer_load_dwordx4 v4, s[4:7], s46 offen offset:1024 sc1 lds
    v_exp_f32 v67, v67
    v_mfma_f32_16x16x32_bf16 v[28:31], a[252:255], v[104:107], v[28:31]
    s_waitcnt lgkmcnt(3)
    v_exp_f32 v68, v68
    v_mfma_f32_16x16x32_bf16 v[16:19], a[96:99], v[108:111], v[16:19]
    ds_read_b128 v[104:107], v5 offset:16384
    v_exp_f32 v69, v69
    v_mfma_f32_16x16x32_bf16 v[20:23], a[104:107], v[108:111], v[20:23]
    v_exp_f32 v70, v70
    v_mfma_f32_16x16x32_bf16 v[24:27], v[192:195], v[108:111], v[24:27]
    v_exp_f32 v71, v71
    v_mfma_f32_16x16x32_bf16 v[28:31], v[200:203], v[108:111], v[28:31]
    s_waitcnt lgkmcnt(3)
    v_add_f32 v64, 1.0, v64
    v_add_f32 v65, 1.0, v65
    v_mfma_f32_16x16x32_bf16 v[16:19], a[100:103], v[112:115], v[16:19]
    ds_read_b128 v[108:111], v5 offset:17408
    v_add_f32 v66, 1.0, v66
    v_add_f32 v67, 1.0, v67
    v_mfma_f32_16x16x32_bf16 v[20:23], a[108:111], v[112:115], v[20:23]
    v_add_f32 v68, 1.0, v68
    v_add_f32 v69, 1.0, v69
    v_mfma_f32_16x16x32_bf16 v[24:27], v[196:199], v[112:115], v[24:27]
    v_add_f32 v70, 1.0, v70
    v_add_f32 v71, 1.0, v71
    v_mfma_f32_16x16x32_bf16 v[28:31], v[204:207], v[112:115], v[28:31]
    s_waitcnt lgkmcnt(3)
    v_rcp_f32 v64, v64
    v_mfma_f32_16x16x32_bf16 v[16:19], a[112:115], v[116:119], v[16:19]
    ds_read_b128 v[112:115], v5 offset:18432
    v_rcp_f32 v65, v65
    v_mfma_f32_16x16x32_bf16 v[20:23], a[120:123], v[116:119], v[20:23]
    v_rcp_f32 v66, v66
    v_mfma_f32_16x16x32_bf16 v[24:27], v[208:211], v[116:119], v[24:27]
    v_rcp_f32 v67, v67
    v_mfma_f32_16x16x32_bf16 v[28:31], v[216:219], v[116:119], v[28:31]
    s_waitcnt lgkmcnt(3)
    v_rcp_f32 v68, v68
    v_mfma_f32_16x16x32_bf16 v[16:19], a[116:119], v[100:103], v[16:19]
    ds_read_b128 v[116:119], v5 offset:19456
    v_rcp_f32 v69, v69
    v_mfma_f32_16x16x32_bf16 v[20:23], a[124:127], v[100:103], v[20:23]
    v_rcp_f32 v70, v70
    v_mfma_f32_16x16x32_bf16 v[24:27], v[212:215], v[100:103], v[24:27]
    v_rcp_f32 v71, v71
    v_mfma_f32_16x16x32_bf16 v[28:31], v[220:223], v[100:103], v[28:31]
    s_waitcnt lgkmcnt(3)
    v_mul_f32 v40, v40, v64
    v_mul_f32 v41, v41, v65
    v_mfma_f32_16x16x32_bf16 v[16:19], a[128:131], v[104:107], v[16:19]
    ds_read_b128 v[100:103], v5 offset:20480
    v_mul_f32 v42, v42, v66
    v_mul_f32 v43, v43, v67
    v_mfma_f32_16x16x32_bf16 v[20:23], a[136:139], v[104:107], v[20:23]
    v_mul_f32 v44, v44, v68
    v_mul_f32 v45, v45, v69
    v_mfma_f32_16x16x32_bf16 v[24:27], v[224:227], v[104:107], v[24:27]
    v_mul_f32 v46, v46, v70
    v_mul_f32 v47, v47, v71
    v_mfma_f32_16x16x32_bf16 v[28:31], v[232:235], v[104:107], v[28:31]
    s_waitcnt lgkmcnt(3)
    v_cvt_pk_bf16_f32 v52, v40, v41
    v_cvt_pk_bf16_f32 v53, v44, v45
    v_mfma_f32_16x16x32_bf16 v[16:19], a[132:135], v[108:111], v[16:19]
    ds_read_b128 v[104:107], v5 offset:21504
    v_cvt_pk_bf16_f32 v54, v42, v43
    v_cvt_pk_bf16_f32 v55, v46, v47
    v_mfma_f32_16x16x32_bf16 v[20:23], a[140:143], v[108:111], v[20:23]
    buffer_store_dwordx4 v[52:55], v3, s[4:7], s22 offen offset:3072 sc1
    v_mfma_f32_16x16x32_bf16 v[24:27], v[228:231], v[108:111], v[24:27]
    s_and_b32 s22, s16, 63
    s_lshl_b32 s22, s22, 20
    s_add_u32 s22, s22, 9207808
    v_mfma_f32_16x16x32_bf16 v[28:31], v[236:239], v[108:111], v[28:31]
    s_waitcnt lgkmcnt(3)
    s_lshr_b32 s21, s22, 8
    s_xor_b32 s21, s21, s34
    v_mfma_f32_16x16x32_bf16 v[16:19], a[144:147], v[112:115], v[16:19]
    ds_read_b128 v[108:111], v5 offset:22528
    s_and_b32 s21, s21, 0x2000
    s_or_b32 s22, s22, s21
    v_mfma_f32_16x16x32_bf16 v[20:23], a[152:155], v[112:115], v[20:23]
    v_mov_b32 v3, v8
    v_mfma_f32_16x16x32_bf16 v[24:27], v[240:243], v[112:115], v[24:27]
    v_mfma_f32_16x16x32_bf16 v[28:31], v[248:251], v[112:115], v[28:31]
    s_waitcnt lgkmcnt(3)
    v_mfma_f32_16x16x32_bf16 v[16:19], a[148:151], v[116:119], v[16:19]
    ds_read_b128 v[112:115], v5 offset:23552
    v_mfma_f32_16x16x32_bf16 v[20:23], a[156:159], v[116:119], v[20:23]
    v_mfma_f32_16x16x32_bf16 v[24:27], v[244:247], v[116:119], v[24:27]
    v_mfma_f32_16x16x32_bf16 v[28:31], v[252:255], v[116:119], v[28:31]
    s_waitcnt lgkmcnt(3)
    v_mfma_f32_16x16x32_bf16 v[32:35], a[0:3], v[100:103], 0
    ds_read_b128 v[116:119], v5 offset:24576
    v_mfma_f32_16x16x32_bf16 v[36:39], a[8:11], v[100:103], 0
    v_mfma_f32_16x16x32_bf16 v[40:43], a[160:163], v[100:103], 0
    v_mul_f32 v64, s33, v16
    v_mul_f32 v65, s33, v17
    v_mfma_f32_16x16x32_bf16 v[44:47], a[168:171], v[100:103], 0
    s_waitcnt lgkmcnt(3)
    v_mul_f32 v66, s33, v18
    v_mul_f32 v67, s33, v19
    v_mfma_f32_16x16x32_bf16 v[32:35], a[4:7], v[104:107], v[32:35]
    ds_read_b128 v[100:103], v5 offset:25600
    v_mul_f32 v68, s33, v20
    v_mul_f32 v69, s33, v21
    v_mfma_f32_16x16x32_bf16 v[36:39], a[12:15], v[104:107], v[36:39]
    v_mul_f32 v70, s33, v22
    v_mul_f32 v71, s33, v23
    v_mfma_f32_16x16x32_bf16 v[40:43], a[164:167], v[104:107], v[40:43]
    v_exp_f32 v64, v64
    v_mfma_f32_16x16x32_bf16 v[44:47], a[172:175], v[104:107], v[44:47]
    s_waitcnt lgkmcnt(3)
    v_exp_f32 v65, v65
    v_mfma_f32_16x16x32_bf16 v[32:35], a[16:19], v[108:111], v[32:35]
    ds_read_b128 v[104:107], v5 offset:26624
    v_exp_f32 v66, v66
    v_mfma_f32_16x16x32_bf16 v[36:39], a[24:27], v[108:111], v[36:39]
    v_exp_f32 v67, v67
    v_mfma_f32_16x16x32_bf16 v[40:43], a[176:179], v[108:111], v[40:43]
    v_exp_f32 v68, v68
    v_mfma_f32_16x16x32_bf16 v[44:47], a[184:187], v[108:111], v[44:47]
    s_waitcnt lgkmcnt(3)
    v_exp_f32 v69, v69
    v_mfma_f32_16x16x32_bf16 v[32:35], a[20:23], v[112:115], v[32:35]
    ds_read_b128 v[108:111], v5 offset:27648
    v_exp_f32 v70, v70
    v_mfma_f32_16x16x32_bf16 v[36:39], a[28:31], v[112:115], v[36:39]
    v_exp_f32 v71, v71
    v_mfma_f32_16x16x32_bf16 v[40:43], a[180:183], v[112:115], v[40:43]
    v_add_f32 v64, 1.0, v64
    v_add_f32 v65, 1.0, v65
    v_mfma_f32_16x16x32_bf16 v[44:47], a[188:191], v[112:115], v[44:47]
    s_waitcnt lgkmcnt(3)
    v_add_f32 v66, 1.0, v66
    v_add_f32 v67, 1.0, v67
    v_mfma_f32_16x16x32_bf16 v[32:35], a[32:35], v[116:119], v[32:35]
    ds_read_b128 v[112:115], v5 offset:28672
    v_add_f32 v68, 1.0, v68
    v_add_f32 v69, 1.0, v69
    v_mfma_f32_16x16x32_bf16 v[36:39], a[40:43], v[116:119], v[36:39]
    v_add_f32 v70, 1.0, v70
    v_add_f32 v71, 1.0, v71
    v_mfma_f32_16x16x32_bf16 v[40:43], a[192:195], v[116:119], v[40:43]
    v_rcp_f32 v64, v64
    v_mfma_f32_16x16x32_bf16 v[44:47], a[200:203], v[116:119], v[44:47]
    s_waitcnt lgkmcnt(3)
    v_rcp_f32 v65, v65
    v_mfma_f32_16x16x32_bf16 v[32:35], a[36:39], v[100:103], v[32:35]
    ds_read_b128 v[116:119], v5 offset:29696
    v_rcp_f32 v66, v66
    v_mfma_f32_16x16x32_bf16 v[36:39], a[44:47], v[100:103], v[36:39]
    v_rcp_f32 v67, v67
    v_mfma_f32_16x16x32_bf16 v[40:43], a[196:199], v[100:103], v[40:43]
    v_rcp_f32 v68, v68
    v_mfma_f32_16x16x32_bf16 v[44:47], a[204:207], v[100:103], v[44:47]
    s_waitcnt lgkmcnt(3)
    v_rcp_f32 v69, v69
    v_mfma_f32_16x16x32_bf16 v[32:35], a[48:51], v[104:107], v[32:35]
    ds_read_b128 v[100:103], v5 offset:30720
    v_rcp_f32 v70, v70
    v_mfma_f32_16x16x32_bf16 v[36:39], a[56:59], v[104:107], v[36:39]
    v_rcp_f32 v71, v71
    v_mfma_f32_16x16x32_bf16 v[40:43], a[208:211], v[104:107], v[40:43]
    v_mul_f32 v16, v16, v64
    v_mul_f32 v17, v17, v65
    v_mfma_f32_16x16x32_bf16 v[44:47], a[216:219], v[104:107], v[44:47]
    s_waitcnt lgkmcnt(3)
    v_mul_f32 v18, v18, v66
    v_mul_f32 v19, v19, v67
    v_mfma_f32_16x16x32_bf16 v[32:35], a[52:55], v[108:111], v[32:35]
    ds_read_b128 v[104:107], v5 offset:31744
    v_mul_f32 v20, v20, v68
    v_mul_f32 v21, v21, v69
    v_mfma_f32_16x16x32_bf16 v[36:39], a[60:63], v[108:111], v[36:39]
    v_mul_f32 v22, v22, v70
    v_mul_f32 v23, v23, v71
    v_mfma_f32_16x16x32_bf16 v[40:43], a[212:215], v[108:111], v[40:43]
    v_cvt_pk_bf16_f32 v48, v16, v17
    v_cvt_pk_bf16_f32 v49, v20, v21
    v_mfma_f32_16x16x32_bf16 v[44:47], a[220:223], v[108:111], v[44:47]
    s_waitcnt lgkmcnt(3)
    v_cvt_pk_bf16_f32 v50, v18, v19
    v_cvt_pk_bf16_f32 v51, v22, v23
    v_mfma_f32_16x16x32_bf16 v[32:35], a[64:67], v[112:115], v[32:35]
    ds_read_b128 v[108:111], v5 offset:32768
    buffer_store_dwordx4 v[48:51], v8, s[4:7], s22 offen offset:0 sc1
    v_mfma_f32_16x16x32_bf16 v[36:39], a[72:75], v[112:115], v[36:39]
    v_mul_f32 v64, s33, v24
    v_mul_f32 v65, s33, v25
    v_mfma_f32_16x16x32_bf16 v[40:43], a[224:227], v[112:115], v[40:43]
    v_mul_f32 v66, s33, v26
    v_mul_f32 v67, s33, v27
    v_mfma_f32_16x16x32_bf16 v[44:47], a[232:235], v[112:115], v[44:47]
    s_waitcnt lgkmcnt(3)
    v_mul_f32 v68, s33, v28
    v_mul_f32 v69, s33, v29
    v_mfma_f32_16x16x32_bf16 v[32:35], a[68:71], v[116:119], v[32:35]
    ds_read_b128 v[112:115], v5 offset:33792
    v_mul_f32 v70, s33, v30
    v_mul_f32 v71, s33, v31
    v_mfma_f32_16x16x32_bf16 v[36:39], a[76:79], v[116:119], v[36:39]
    v_exp_f32 v64, v64
    v_mfma_f32_16x16x32_bf16 v[40:43], a[228:231], v[116:119], v[40:43]
    v_exp_f32 v65, v65
    v_mfma_f32_16x16x32_bf16 v[44:47], a[236:239], v[116:119], v[44:47]
    s_waitcnt lgkmcnt(3)
    v_exp_f32 v66, v66
    v_mfma_f32_16x16x32_bf16 v[32:35], a[80:83], v[100:103], v[32:35]
    ds_read_b128 v[116:119], v5 offset:34816
    v_exp_f32 v67, v67
    v_mfma_f32_16x16x32_bf16 v[36:39], a[88:91], v[100:103], v[36:39]
    v_exp_f32 v68, v68
    v_mfma_f32_16x16x32_bf16 v[40:43], a[240:243], v[100:103], v[40:43]
    v_exp_f32 v69, v69
    v_mfma_f32_16x16x32_bf16 v[44:47], a[248:251], v[100:103], v[44:47]
    s_waitcnt lgkmcnt(3)
    v_exp_f32 v70, v70
    v_mfma_f32_16x16x32_bf16 v[32:35], a[84:87], v[104:107], v[32:35]
    ds_read_b128 v[100:103], v5 offset:35840
    v_exp_f32 v71, v71
    v_mfma_f32_16x16x32_bf16 v[36:39], a[92:95], v[104:107], v[36:39]
    v_add_f32 v64, 1.0, v64
    v_add_f32 v65, 1.0, v65
    v_mfma_f32_16x16x32_bf16 v[40:43], a[244:247], v[104:107], v[40:43]
    v_add_f32 v66, 1.0, v66
    v_add_f32 v67, 1.0, v67
    v_mfma_f32_16x16x32_bf16 v[44:47], a[252:255], v[104:107], v[44:47]
    s_waitcnt lgkmcnt(3)
    v_add_f32 v68, 1.0, v68
    v_add_f32 v69, 1.0, v69
    v_mfma_f32_16x16x32_bf16 v[32:35], a[96:99], v[108:111], v[32:35]
    ds_read_b128 v[104:107], v5 offset:36864
    v_add_f32 v70, 1.0, v70
    v_add_f32 v71, 1.0, v71
    v_mfma_f32_16x16x32_bf16 v[36:39], a[104:107], v[108:111], v[36:39]
    v_rcp_f32 v64, v64
    v_mfma_f32_16x16x32_bf16 v[40:43], v[192:195], v[108:111], v[40:43]
    v_rcp_f32 v65, v65
    v_mfma_f32_16x16x32_bf16 v[44:47], v[200:203], v[108:111], v[44:47]
    s_waitcnt lgkmcnt(3)
    v_rcp_f32 v66, v66
    v_mfma_f32_16x16x32_bf16 v[32:35], a[100:103], v[112:115], v[32:35]
    ds_read_b128 v[108:111], v5 offset:37888
    v_rcp_f32 v67, v67
    v_mfma_f32_16x16x32_bf16 v[36:39], a[108:111], v[112:115], v[36:39]
    v_rcp_f32 v68, v68
    v_mfma_f32_16x16x32_bf16 v[40:43], v[196:199], v[112:115], v[40:43]
    v_rcp_f32 v69, v69
    v_mfma_f32_16x16x32_bf16 v[44:47], v[204:207], v[112:115], v[44:47]
    s_waitcnt lgkmcnt(3)
    v_rcp_f32 v70, v70
    v_mfma_f32_16x16x32_bf16 v[32:35], a[112:115], v[116:119], v[32:35]
    ds_read_b128 v[112:115], v5 offset:38912
    v_rcp_f32 v71, v71
    v_mfma_f32_16x16x32_bf16 v[36:39], a[120:123], v[116:119], v[36:39]
    v_mul_f32 v24, v24, v64
    v_mul_f32 v25, v25, v65
    v_mfma_f32_16x16x32_bf16 v[40:43], v[208:211], v[116:119], v[40:43]
    v_mul_f32 v26, v26, v66
    v_mul_f32 v27, v27, v67
    v_mfma_f32_16x16x32_bf16 v[44:47], v[216:219], v[116:119], v[44:47]
    s_waitcnt lgkmcnt(3)
    v_mul_f32 v28, v28, v68
    v_mul_f32 v29, v29, v69
    v_mfma_f32_16x16x32_bf16 v[32:35], a[116:119], v[100:103], v[32:35]
    ds_read_b128 v[116:119], v5 offset:39936
    v_mul_f32 v30, v30, v70
    v_mul_f32 v31, v31, v71
    v_mfma_f32_16x16x32_bf16 v[36:39], a[124:127], v[100:103], v[36:39]
    v_cvt_pk_bf16_f32 v52, v24, v25
    v_cvt_pk_bf16_f32 v53, v28, v29
    v_mfma_f32_16x16x32_bf16 v[40:43], v[212:215], v[100:103], v[40:43]
    s_waitcnt vmcnt(1)
    s_barrier
    buffer_store_dword v10, v9, s[8:11], 0 offen sc1
    v_mfma_f32_16x16x32_bf16 v[44:47], v[220:223], v[100:103], v[44:47]
    s_waitcnt lgkmcnt(3)
    v_cvt_pk_bf16_f32 v54, v26, v27
    v_cvt_pk_bf16_f32 v55, v30, v31
    v_mfma_f32_16x16x32_bf16 v[32:35], a[128:131], v[104:107], v[32:35]
    ds_read_b128 v[100:103], v2 offset:0
    buffer_store_dwordx4 v[52:55], v8, s[4:7], s22 offen offset:2048 sc1
    v_mfma_f32_16x16x32_bf16 v[36:39], a[136:139], v[104:107], v[36:39]
    v_mfma_f32_16x16x32_bf16 v[40:43], v[224:227], v[104:107], v[40:43]
    v_mfma_f32_16x16x32_bf16 v[44:47], v[232:235], v[104:107], v[44:47]
    s_waitcnt lgkmcnt(3)
    v_mfma_f32_16x16x32_bf16 v[32:35], a[132:135], v[108:111], v[32:35]
    ds_read_b128 v[104:107], v2 offset:1024
    v_mfma_f32_16x16x32_bf16 v[36:39], a[140:143], v[108:111], v[36:39]
    v_mfma_f32_16x16x32_bf16 v[40:43], v[228:231], v[108:111], v[40:43]
    v_mfma_f32_16x16x32_bf16 v[44:47], v[236:239], v[108:111], v[44:47]
    s_waitcnt lgkmcnt(3)
    v_mfma_f32_16x16x32_bf16 v[32:35], a[144:147], v[112:115], v[32:35]
    ds_read_b128 v[108:111], v2 offset:2048
    v_mfma_f32_16x16x32_bf16 v[36:39], a[152:155], v[112:115], v[36:39]
    v_mfma_f32_16x16x32_bf16 v[40:43], v[240:243], v[112:115], v[40:43]
    v_mfma_f32_16x16x32_bf16 v[44:47], v[248:251], v[112:115], v[44:47]
    s_waitcnt lgkmcnt(3)
    v_mfma_f32_16x16x32_bf16 v[32:35], a[148:151], v[116:119], v[32:35]
    ds_read_b128 v[112:115], v2 offset:3072
    v_mfma_f32_16x16x32_bf16 v[36:39], a[156:159], v[116:119], v[36:39]
    v_mfma_f32_16x16x32_bf16 v[40:43], v[244:247], v[116:119], v[40:43]
    s_mov_b32 s16, s43
    s_cmp_lt_u32 s16, s50
    v_mfma_f32_16x16x32_bf16 v[44:47], v[252:255], v[116:119], v[44:47]
    s_cbranch_scc1 L_ffn1_loop
    s_nop 7
    s_waitcnt lgkmcnt(0)
    v_mul_f32 v64, s33, v32
    v_mul_f32 v65, s33, v33
    v_mul_f32 v66, s33, v34
    v_mul_f32 v67, s33, v35
    v_mul_f32 v68, s33, v36
    v_mul_f32 v69, s33, v37
    v_mul_f32 v70, s33, v38
    v_mul_f32 v71, s33, v39
    v_exp_f32 v64, v64
    v_exp_f32 v65, v65
    v_exp_f32 v66, v66
    v_exp_f32 v67, v67
    v_exp_f32 v68, v68
    v_exp_f32 v69, v69
    v_exp_f32 v70, v70
    v_exp_f32 v71, v71
    v_add_f32 v64, 1.0, v64
    v_add_f32 v65, 1.0, v65
    v_add_f32 v66, 1.0, v66
    v_add_f32 v67, 1.0, v67
    v_add_f32 v68, 1.0, v68
    v_add_f32 v69, 1.0, v69
    v_add_f32 v70, 1.0, v70
    v_add_f32 v71, 1.0, v71
    v_rcp_f32 v64, v64
    v_rcp_f32 v65, v65
    v_rcp_f32 v66, v66
    v_rcp_f32 v67, v67
    v_rcp_f32 v68, v68
    v_rcp_f32 v69, v69
    v_rcp_f32 v70, v70
    v_rcp_f32 v71, v71
    v_mul_f32 v32, v32, v64
    v_mul_f32 v33, v33, v65
    v_mul_f32 v34, v34, v66
    v_mul_f32 v35, v35, v67
    v_mul_f32 v36, v36, v68
    v_mul_f32 v37, v37, v69
    v_mul_f32 v38, v38, v70
    v_mul_f32 v39, v39, v71
    v_cvt_pk_bf16_f32 v48, v32, v33
    v_cvt_pk_bf16_f32 v49, v36, v37
    v_cvt_pk_bf16_f32 v50, v34, v35
    v_cvt_pk_bf16_f32 v51, v38, v39
    buffer_store_dwordx4 v[48:51], v3, s[4:7], s22 offen offset:1024 sc1
    v_mul_f32 v64, s33, v40
    v_mul_f32 v65, s33, v41
    v_mul_f32 v66, s33, v42
    v_mul_f32 v67, s33, v43
    v_mul_f32 v68, s33, v44
    v_mul_f32 v69, s33, v45
    v_mul_f32 v70, s33, v46
    v_mul_f32 v71, s33, v47
    v_exp_f32 v64, v64
    v_exp_f32 v65, v65
    v_exp_f32 v66, v66
    v_exp_f32 v67, v67
    v_exp_f32 v68, v68
    v_exp_f32 v69, v69
    v_exp_f32 v70, v70
    v_exp_f32 v71, v71
    v_add_f32 v64, 1.0, v64
    v_add_f32 v65, 1.0, v65
    v_add_f32 v66, 1.0, v66
    v_add_f32 v67, 1.0, v67
    v_add_f32 v68, 1.0, v68
    v_add_f32 v69, 1.0, v69
    v_add_f32 v70, 1.0, v70
    v_add_f32 v71, 1.0, v71
    v_rcp_f32 v64, v64
    v_rcp_f32 v65, v65
    v_rcp_f32 v66, v66
    v_rcp_f32 v67, v67
    v_rcp_f32 v68, v68
    v_rcp_f32 v69, v69
    v_rcp_f32 v70, v70
    v_rcp_f32 v71, v71
    v_mul_f32 v40, v40, v64
    v_mul_f32 v41, v41, v65
    v_mul_f32 v42, v42, v66
    v_mul_f32 v43, v43, v67
    v_mul_f32 v44, v44, v68
    v_mul_f32 v45, v45, v69
    v_mul_f32 v46, v46, v70
    v_mul_f32 v47, v47, v71
    v_cvt_pk_bf16_f32 v52, v40, v41
    v_cvt_pk_bf16_f32 v53, v44, v45
    v_cvt_pk_bf16_f32 v54, v42, v43
    v_cvt_pk_bf16_f32 v55, v46, v47
    buffer_store_dwordx4 v[52:55], v3, s[4:7], s22 offen offset:3072 sc1
    v_mov_b32 v10, 64
    s_waitcnt vmcnt(0)
    s_barrier
    buffer_store_dword v10, v9, s[8:11], 0 offen sc1
    s_endpgm
L_qk:
    v_and_b32 v1, 63, v0
    v_lshrrev_b32 v2, 6, v0
    s_nop 0
    v_readfirstlane_b32 s18, v2
    v_and_b32 v12, 15, v1
    v_lshrrev_b32 v13, 4, v1
    v_lshlrev_b32 v4, 4, v1
    v_mov_b32 v11, -1
    s_mov_b32 s31, 0x05040100
    s_mov_b32 s32, 0x07060302
    v_and_b32 v3, 2, v1
    v_cmp_eq_u32 vcc, 0, v3
    v_mov_b32 v3, 0xeeee
    v_mov_b32 v5, 0x4444
    v_cndmask_b32 v3, v3, v5, vcc
    v_lshrrev_b32 v2, 1, v13
    v_lshlrev_b32 v2, 8, v2
    v_and_b32 v14, 3, v12
    v_lshl_add_u32 v2, v14, 6, v2
    v_and_b32 v14, 1, v13
    v_lshl_add_u32 v2, v14, 5, v2
    v_lshrrev_b32 v14, 2, v12
    v_lshl_add_u32 v2, v14, 3, v2
    v_and_b32 v14, 1, v13
    v_lshlrev_b32 v14, 18, v14
    v_lshrrev_b32 v15, 1, v13
    v_lshlrev_b32 v15, 17, v15
    v_add_u32 v14, v14, v15
    v_lshl_add_u32 v14, v12, 2, v14
    s_lshl_b32 s20, s17, 8
    s_lshl_b32 s21, s18, 6
    s_add_u32 s20, s20, s21
    v_add_u32 v10, s20, v14
    s_mul_i32 s20, s18, 768
    s_add_u32 s20, s20, 10240
    v_mul_u32_u24 v5, 192, v13
    v_lshl_add_u32 v5, v12, 3, v5
    v_add_u32 v5, s20, v5
    s_load_dwordx2 s[12:13], s[0:1], 16
    s_mov_b32 s14, 5242880
    s_mov_b32 s15, 0x20000
    s_waitcnt lgkmcnt(0)
    s_load_dwordx2 s[92:93], s[0:1], 24
    s_mov_b32 s94, 5242880
    s_mov_b32 s95, 0x20000
    s_waitcnt lgkmcnt(0)
    s_and_b32 s20, s17, 3
    s_lshr_b32 s21, s20, 1
    s_sub_u32 s21, s20, s21
    s_lshl_b32 s21, s21, 2
    s_add_u32 s21, s21, s18
    s_mul_i32 s21, s21, 262144
    s_and_b32 s22, s17, 28
    s_lshl_b32 s22, s22, 8
    s_add_u32 s21, s21, s22
    s_add_u32 s21, s21, 2097408
    s_cmp_eq_u32 s20, 1
    s_cselect_b32 s21, 0x40000000, s21
    v_lshrrev_b32 v184, 1, v1
    v_lshlrev_b32 v184, 13, v184
    v_and_b32 v185, 1, v1
    v_lshl_add_u32 v184, v185, 7, v184
    v_add_u32 v184, s21, v184
    v_cmp_gt_u32 vcc, 64, v1
    v_mov_b32 v185, 0x40000000
    s_nop 0
    v_cndmask_b32 v184, v185, v184, vcc
    v_bfe_u32 v160, v1, 2, 2
    v_lshlrev_b32 v160, 6, v160
    v_and_b32 v161, 3, v1
    v_lshl_add_u32 v160, v161, 4, v160
    v_bfe_u32 v161, v1, 4, 1
    v_lshrrev_b32 v162, 5, v1
    ds_bpermute_b32 v164, v160, v10
    v_mul_u32_u24 v163, 32768, v161
    v_mul_u32_u24 v170, 16384, v162
    s_waitcnt lgkmcnt(0)
    v_add3_u32 v164, v164, v163, v170
    ds_bpermute_b32 v165, v160, v10
    v_mul_u32_u24 v163, 32768, v161
    v_mul_u32_u24 v170, 16384, v162
    s_waitcnt lgkmcnt(0)
    v_add3_u32 v165, v165, v163, v170
    s_mul_i32 s29, s18, 20480
    s_add_u32 s29, s29, 40960
    v_lshl_add_u32 v170, v1, 2, s29
    s_add_u32 m0, s29, 0
    s_mov_b32 s30, 0
    buffer_load_dwordx4 v164, s[12:15], s30 offen lds
    s_add_u32 m0, s29, 1024
    s_mov_b32 s30, 65536
    buffer_load_dwordx4 v164, s[12:15], s30 offen lds
    s_add_u32 m0, s29, 2048
    s_mov_b32 s30, 8192
    buffer_load_dwordx4 v164, s[12:15], s30 offen lds
    s_add_u32 m0, s29, 3072
    s_mov_b32 s30, 73728
    buffer_load_dwordx4 v164, s[12:15], s30 offen lds
    s_add_u32 m0, s29, 4096
    s_mov_b32 s30, 524288
    buffer_load_dwordx4 v164, s[12:15], s30 offen lds
    s_add_u32 m0, s29, 5120
    s_mov_b32 s30, 589824
    buffer_load_dwordx4 v164, s[12:15], s30 offen lds
    s_add_u32 m0, s29, 6144
    s_mov_b32 s30, 532480
    buffer_load_dwordx4 v164, s[12:15], s30 offen lds
    s_add_u32 m0, s29, 7168
    s_mov_b32 s30, 598016
    buffer_load_dwordx4 v164, s[12:15], s30 offen lds
    s_add_u32 m0, s29, 8192
    s_mov_b32 s30, 1048576
    buffer_load_dwordx4 v164, s[12:15], s30 offen lds
    s_add_u32 m0, s29, 9216
    s_mov_b32 s30, 1114112
    buffer_load_dwordx4 v164, s[12:15], s30 offen lds
    s_add_u32 m0, s29, 10240
    s_mov_b32 s30, 1056768
    buffer_load_dwordx4 v164, s[12:15], s30 offen lds
    s_add_u32 m0, s29, 11264
    s_mov_b32 s30, 1122304
    buffer_load_dwordx4 v164, s[12:15], s30 offen lds
    s_add_u32 m0, s29, 12288
    s_mov_b32 s30, 1572864
    buffer_load_dwordx4 v164, s[12:15], s30 offen lds
    s_add_u32 m0, s29, 13312
    s_mov_b32 s30, 1638400
    buffer_load_dwordx4 v164, s[12:15], s30 offen lds
    s_add_u32 m0, s29, 14336
    s_mov_b32 s30, 1581056
    buffer_load_dwordx4 v164, s[12:15], s30 offen lds
    s_add_u32 m0, s29, 15360
    s_mov_b32 s30, 1646592
    buffer_load_dwordx4 v164, s[12:15], s30 offen lds
    s_add_u32 m0, s29, 16384
    s_mov_b32 s30, 2097152
    buffer_load_dwordx4 v164, s[12:15], s30 offen lds
    s_add_u32 m0, s29, 17408
    s_mov_b32 s30, 2162688
    buffer_load_dwordx4 v164, s[12:15], s30 offen lds
    s_add_u32 m0, s29, 18432
    s_mov_b32 s30, 2105344
    buffer_load_dwordx4 v164, s[12:15], s30 offen lds
    s_add_u32 m0, s29, 19456
    s_mov_b32 s30, 2170880
    buffer_load_dwordx4 v164, s[12:15], s30 offen lds
    s_waitcnt vmcnt(16)
    ds_read2st64_b32 v[128:129], v170 offset0:0 offset1:1
    ds_read2st64_b32 v[130:131], v170 offset0:2 offset1:3
    ds_read2st64_b32 v[132:133], v170 offset0:4 offset1:5
    ds_read2st64_b32 v[134:135], v170 offset0:6 offset1:7
    ds_read2st64_b32 v[136:137], v170 offset0:8 offset1:9
    ds_read2st64_b32 v[138:139], v170 offset0:10 offset1:11
    ds_read2st64_b32 v[140:141], v170 offset0:12 offset1:13
    ds_read2st64_b32 v[142:143], v170 offset0:14 offset1:15
    s_waitcnt lgkmcnt(0)
    s_add_u32 m0, s29, 0
    s_mov_b32 s30, 2621440
    buffer_load_dwordx4 v164, s[12:15], s30 offen lds
    s_add_u32 m0, s29, 1024
    s_mov_b32 s30, 2686976
    buffer_load_dwordx4 v164, s[12:15], s30 offen lds
    s_add_u32 m0, s29, 2048
    s_mov_b32 s30, 2629632
    buffer_load_dwordx4 v164, s[12:15], s30 offen lds
    s_add_u32 m0, s29, 3072
    s_mov_b32 s30, 2695168
    buffer_load_dwordx4 v164, s[12:15], s30 offen lds
    s_waitcnt vmcnt(16)
    ds_read2st64_b32 v[144:145], v170 offset0:16 offset1:17
    ds_read2st64_b32 v[146:147], v170 offset0:18 offset1:19
    ds_read2st64_b32 v[148:149], v170 offset0:20 offset1:21
    ds_read2st64_b32 v[150:151], v170 offset0:22 offset1:23
    ds_read2st64_b32 v[152:153], v170 offset0:24 offset1:25
    ds_read2st64_b32 v[154:155], v170 offset0:26 offset1:27
    ds_read2st64_b32 v[156:157], v170 offset0:28 offset1:29
    ds_read2st64_b32 v[158:159], v170 offset0:30 offset1:31
    v_perm_b32 v120, v129, v128, s31
    v_accvgpr_write_b32 a0, v120
    v_perm_b32 v121, v129, v128, s32
    v_accvgpr_write_b32 a8, v121
    v_perm_b32 v122, v131, v130, s31
    v_accvgpr_write_b32 a1, v122
    v_perm_b32 v123, v131, v130, s32
    v_accvgpr_write_b32 a9, v123
    v_perm_b32 v124, v133, v132, s31
    v_accvgpr_write_b32 a2, v124
    v_perm_b32 v125, v133, v132, s32
    v_accvgpr_write_b32 a10, v125
    v_perm_b32 v126, v135, v134, s31
    v_accvgpr_write_b32 a3, v126
    v_perm_b32 v127, v135, v134, s32
    v_accvgpr_write_b32 a11, v127
    v_perm_b32 v120, v137, v136, s31
    v_accvgpr_write_b32 a4, v120
    v_perm_b32 v121, v137, v136, s32
    v_accvgpr_write_b32 a12, v121
    v_perm_b32 v122, v139, v138, s31
    v_accvgpr_write_b32 a5, v122
    v_perm_b32 v123, v139, v138, s32
    v_accvgpr_write_b32 a13, v123
    v_perm_b32 v124, v141, v140, s31
    v_accvgpr_write_b32 a6, v124
    v_perm_b32 v125, v141, v140, s32
    v_accvgpr_write_b32 a14, v125
    v_perm_b32 v126, v143, v142, s31
    v_accvgpr_write_b32 a7, v126
    v_perm_b32 v127, v143, v142, s32
    v_accvgpr_write_b32 a15, v127
    s_waitcnt lgkmcnt(0)
    s_add_u32 m0, s29, 4096
    s_mov_b32 s30, 3145728
    buffer_load_dwordx4 v164, s[12:15], s30 offen lds
    s_add_u32 m0, s29, 5120
    s_mov_b32 s30, 3211264
    buffer_load_dwordx4 v164, s[12:15], s30 offen lds
    s_add_u32 m0, s29, 6144
    s_mov_b32 s30, 3153920
    buffer_load_dwordx4 v164, s[12:15], s30 offen lds
    s_add_u32 m0, s29, 7168
    s_mov_b32 s30, 3219456
    buffer_load_dwordx4 v164, s[12:15], s30 offen lds
    s_waitcnt vmcnt(16)
    ds_read2st64_b32 v[128:129], v170 offset0:32 offset1:33
    ds_read2st64_b32 v[130:131], v170 offset0:34 offset1:35
    ds_read2st64_b32 v[132:133], v170 offset0:36 offset1:37
    ds_read2st64_b32 v[134:135], v170 offset0:38 offset1:39
    ds_read2st64_b32 v[136:137], v170 offset0:40 offset1:41
    ds_read2st64_b32 v[138:139], v170 offset0:42 offset1:43
    ds_read2st64_b32 v[140:141], v170 offset0:44 offset1:45
    ds_read2st64_b32 v[142:143], v170 offset0:46 offset1:47
    v_perm_b32 v120, v145, v144, s31
    v_accvgpr_write_b32 a16, v120
    v_perm_b32 v121, v145, v144, s32
    v_accvgpr_write_b32 a24, v121
    v_perm_b32 v122, v147, v146, s31
    v_accvgpr_write_b32 a17, v122
    v_perm_b32 v123, v147, v146, s32
    v_accvgpr_write_b32 a25, v123
    v_perm_b32 v124, v149, v148, s31
    v_accvgpr_write_b32 a18, v124
    v_perm_b32 v125, v149, v148, s32
    v_accvgpr_write_b32 a26, v125
    v_perm_b32 v126, v151, v150, s31
    v_accvgpr_write_b32 a19, v126
    v_perm_b32 v127, v151, v150, s32
    v_accvgpr_write_b32 a27, v127
    v_perm_b32 v120, v153, v152, s31
    v_accvgpr_write_b32 a20, v120
    v_perm_b32 v121, v153, v152, s32
    v_accvgpr_write_b32 a28, v121
    v_perm_b32 v122, v155, v154, s31
    v_accvgpr_write_b32 a21, v122
    v_perm_b32 v123, v155, v154, s32
    v_accvgpr_write_b32 a29, v123
    v_perm_b32 v124, v157, v156, s31
    v_accvgpr_write_b32 a22, v124
    v_perm_b32 v125, v157, v156, s32
    v_accvgpr_write_b32 a30, v125
    v_perm_b32 v126, v159, v158, s31
    v_accvgpr_write_b32 a23, v126
    v_perm_b32 v127, v159, v158, s32
    v_accvgpr_write_b32 a31, v127
    s_waitcnt lgkmcnt(0)
    s_add_u32 m0, s29, 8192
    s_mov_b32 s30, 3670016
    buffer_load_dwordx4 v164, s[12:15], s30 offen lds
    s_add_u32 m0, s29, 9216
    s_mov_b32 s30, 3735552
    buffer_load_dwordx4 v164, s[12:15], s30 offen lds
    s_add_u32 m0, s29, 10240
    s_mov_b32 s30, 3678208
    buffer_load_dwordx4 v164, s[12:15], s30 offen lds
    s_add_u32 m0, s29, 11264
    s_mov_b32 s30, 3743744
    buffer_load_dwordx4 v164, s[12:15], s30 offen lds
    s_waitcnt vmcnt(16)
    ds_read2st64_b32 v[144:145], v170 offset0:48 offset1:49
    ds_read2st64_b32 v[146:147], v170 offset0:50 offset1:51
    ds_read2st64_b32 v[148:149], v170 offset0:52 offset1:53
    ds_read2st64_b32 v[150:151], v170 offset0:54 offset1:55
    ds_read2st64_b32 v[152:153], v170 offset0:56 offset1:57
    ds_read2st64_b32 v[154:155], v170 offset0:58 offset1:59
    ds_read2st64_b32 v[156:157], v170 offset0:60 offset1:61
    ds_read2st64_b32 v[158:159], v170 offset0:62 offset1:63
    v_perm_b32 v120, v129, v128, s31
    v_accvgpr_write_b32 a32, v120
    v_perm_b32 v121, v129, v128, s32
    v_accvgpr_write_b32 a40, v121
    v_perm_b32 v122, v131, v130, s31
    v_accvgpr_write_b32 a33, v122
    v_perm_b32 v123, v131, v130, s32
    v_accvgpr_write_b32 a41, v123
    v_perm_b32 v124, v133, v132, s31
    v_accvgpr_write_b32 a34, v124
    v_perm_b32 v125, v133, v132, s32
    v_accvgpr_write_b32 a42, v125
    v_perm_b32 v126, v135, v134, s31
    v_accvgpr_write_b32 a35, v126
    v_perm_b32 v127, v135, v134, s32
    v_accvgpr_write_b32 a43, v127
    v_perm_b32 v120, v137, v136, s31
    v_accvgpr_write_b32 a36, v120
    v_perm_b32 v121, v137, v136, s32
    v_accvgpr_write_b32 a44, v121
    v_perm_b32 v122, v139, v138, s31
    v_accvgpr_write_b32 a37, v122
    v_perm_b32 v123, v139, v138, s32
    v_accvgpr_write_b32 a45, v123
    v_perm_b32 v124, v141, v140, s31
    v_accvgpr_write_b32 a38, v124
    v_perm_b32 v125, v141, v140, s32
    v_accvgpr_write_b32 a46, v125
    v_perm_b32 v126, v143, v142, s31
    v_accvgpr_write_b32 a39, v126
    v_perm_b32 v127, v143, v142, s32
    v_accvgpr_write_b32 a47, v127
    s_waitcnt lgkmcnt(0)
    s_add_u32 m0, s29, 12288
    s_mov_b32 s30, 4194304
    buffer_load_dwordx4 v164, s[12:15], s30 offen lds
    s_add_u32 m0, s29, 13312
    s_mov_b32 s30, 4259840
    buffer_load_dwordx4 v164, s[12:15], s30 offen lds
    s_add_u32 m0, s29, 14336
    s_mov_b32 s30, 4202496
    buffer_load_dwordx4 v164, s[12:15], s30 offen lds
    s_add_u32 m0, s29, 15360
    s_mov_b32 s30, 4268032
    buffer_load_dwordx4 v164, s[12:15], s30 offen lds
    s_waitcnt vmcnt(16)
    ds_read2st64_b32 v[128:129], v170 offset0:64 offset1:65
    ds_read2st64_b32 v[130:131], v170 offset0:66 offset1:67
    ds_read2st64_b32 v[132:133], v170 offset0:68 offset1:69
    ds_read2st64_b32 v[134:135], v170 offset0:70 offset1:71
    ds_read2st64_b32 v[136:137], v170 offset0:72 offset1:73
    ds_read2st64_b32 v[138:139], v170 offset0:74 offset1:75
    ds_read2st64_b32 v[140:141], v170 offset0:76 offset1:77
    ds_read2st64_b32 v[142:143], v170 offset0:78 offset1:79
    v_perm_b32 v120, v145, v144, s31
    v_accvgpr_write_b32 a48, v120
    v_perm_b32 v121, v145, v144, s32
    v_accvgpr_write_b32 a56, v121
    v_perm_b32 v122, v147, v146, s31
    v_accvgpr_write_b32 a49, v122
    v_perm_b32 v123, v147, v146, s32
    v_accvgpr_write_b32 a57, v123
    v_perm_b32 v124, v149, v148, s31
    v_accvgpr_write_b32 a50, v124
    v_perm_b32 v125, v149, v148, s32
    v_accvgpr_write_b32 a58, v125
    v_perm_b32 v126, v151, v150, s31
    v_accvgpr_write_b32 a51, v126
    v_perm_b32 v127, v151, v150, s32
    v_accvgpr_write_b32 a59, v127
    v_perm_b32 v120, v153, v152, s31
    v_accvgpr_write_b32 a52, v120
    v_perm_b32 v121, v153, v152, s32
    v_accvgpr_write_b32 a60, v121
    v_perm_b32 v122, v155, v154, s31
    v_accvgpr_write_b32 a53, v122
    v_perm_b32 v123, v155, v154, s32
    v_accvgpr_write_b32 a61, v123
    v_perm_b32 v124, v157, v156, s31
    v_accvgpr_write_b32 a54, v124
    v_perm_b32 v125, v157, v156, s32
    v_accvgpr_write_b32 a62, v125
    v_perm_b32 v126, v159, v158, s31
    v_accvgpr_write_b32 a55, v126
    v_perm_b32 v127, v159, v158, s32
    v_accvgpr_write_b32 a63, v127
    s_waitcnt lgkmcnt(0)
    s_add_u32 m0, s29, 16384
    s_mov_b32 s30, 4718592
    buffer_load_dwordx4 v164, s[12:15], s30 offen lds
    s_add_u32 m0, s29, 17408
    s_mov_b32 s30, 4784128
    buffer_load_dwordx4 v164, s[12:15], s30 offen lds
    s_add_u32 m0, s29, 18432
    s_mov_b32 s30, 4726784
    buffer_load_dwordx4 v164, s[12:15], s30 offen lds
    s_add_u32 m0, s29, 19456
    s_mov_b32 s30, 4792320
    buffer_load_dwordx4 v164, s[12:15], s30 offen lds
    s_waitcnt vmcnt(16)
    ds_read2st64_b32 v[144:145], v170 offset0:0 offset1:1
    ds_read2st64_b32 v[146:147], v170 offset0:2 offset1:3
    ds_read2st64_b32 v[148:149], v170 offset0:4 offset1:5
    ds_read2st64_b32 v[150:151], v170 offset0:6 offset1:7
    ds_read2st64_b32 v[152:153], v170 offset0:8 offset1:9
    ds_read2st64_b32 v[154:155], v170 offset0:10 offset1:11
    ds_read2st64_b32 v[156:157], v170 offset0:12 offset1:13
    ds_read2st64_b32 v[158:159], v170 offset0:14 offset1:15
    v_perm_b32 v120, v129, v128, s31
    v_accvgpr_write_b32 a64, v120
    v_perm_b32 v121, v129, v128, s32
    v_accvgpr_write_b32 a72, v121
    v_perm_b32 v122, v131, v130, s31
    v_accvgpr_write_b32 a65, v122
    v_perm_b32 v123, v131, v130, s32
    v_accvgpr_write_b32 a73, v123
    v_perm_b32 v124, v133, v132, s31
    v_accvgpr_write_b32 a66, v124
    v_perm_b32 v125, v133, v132, s32
    v_accvgpr_write_b32 a74, v125
    v_perm_b32 v126, v135, v134, s31
    v_accvgpr_write_b32 a67, v126
    v_perm_b32 v127, v135, v134, s32
    v_accvgpr_write_b32 a75, v127
    v_perm_b32 v120, v137, v136, s31
    v_accvgpr_write_b32 a68, v120
    v_perm_b32 v121, v137, v136, s32
    v_accvgpr_write_b32 a76, v121
    v_perm_b32 v122, v139, v138, s31
    v_accvgpr_write_b32 a69, v122
    v_perm_b32 v123, v139, v138, s32
    v_accvgpr_write_b32 a77, v123
    v_perm_b32 v124, v141, v140, s31
    v_accvgpr_write_b32 a70, v124
    v_perm_b32 v125, v141, v140, s32
    v_accvgpr_write_b32 a78, v125
    v_perm_b32 v126, v143, v142, s31
    v_accvgpr_write_b32 a71, v126
    v_perm_b32 v127, v143, v142, s32
    v_accvgpr_write_b32 a79, v127
    s_waitcnt lgkmcnt(0)
    s_add_u32 m0, s29, 0
    s_mov_b32 s30, 0
    buffer_load_dwordx4 v165, s[92:95], s30 offen lds
    s_add_u32 m0, s29, 1024
    s_mov_b32 s30, 65536
    buffer_load_dwordx4 v165, s[92:95], s30 offen lds
    s_add_u32 m0, s29, 2048
    s_mov_b32 s30, 8192
    buffer_load_dwordx4 v165, s[92:95], s30 offen lds
    s_add_u32 m0, s29, 3072
    s_mov_b32 s30, 73728
    buffer_load_dwordx4 v165, s[92:95], s30 offen lds
    s_waitcnt vmcnt(16)
    ds_read2st64_b32 v[128:129], v170 offset0:16 offset1:17
    ds_read2st64_b32 v[130:131], v170 offset0:18 offset1:19
    ds_read2st64_b32 v[132:133], v170 offset0:20 offset1:21
    ds_read2st64_b32 v[134:135], v170 offset0:22 offset1:23
    ds_read2st64_b32 v[136:137], v170 offset0:24 offset1:25
    ds_read2st64_b32 v[138:139], v170 offset0:26 offset1:27
    ds_read2st64_b32 v[140:141], v170 offset0:28 offset1:29
    ds_read2st64_b32 v[142:143], v170 offset0:30 offset1:31
    v_perm_b32 v120, v145, v144, s31
    v_accvgpr_write_b32 a80, v120
    v_perm_b32 v121, v145, v144, s32
    v_accvgpr_write_b32 a88, v121
    v_perm_b32 v122, v147, v146, s31
    v_accvgpr_write_b32 a81, v122
    v_perm_b32 v123, v147, v146, s32
    v_accvgpr_write_b32 a89, v123
    v_perm_b32 v124, v149, v148, s31
    v_accvgpr_write_b32 a82, v124
    v_perm_b32 v125, v149, v148, s32
    v_accvgpr_write_b32 a90, v125
    v_perm_b32 v126, v151, v150, s31
    v_accvgpr_write_b32 a83, v126
    v_perm_b32 v127, v151, v150, s32
    v_accvgpr_write_b32 a91, v127
    v_perm_b32 v120, v153, v152, s31
    v_accvgpr_write_b32 a84, v120
    v_perm_b32 v121, v153, v152, s32
    v_accvgpr_write_b32 a92, v121
    v_perm_b32 v122, v155, v154, s31
    v_accvgpr_write_b32 a85, v122
    v_perm_b32 v123, v155, v154, s32
    v_accvgpr_write_b32 a93, v123
    v_perm_b32 v124, v157, v156, s31
    v_accvgpr_write_b32 a86, v124
    v_perm_b32 v125, v157, v156, s32
    v_accvgpr_write_b32 a94, v125
    v_perm_b32 v126, v159, v158, s31
    v_accvgpr_write_b32 a87, v126
    v_perm_b32 v127, v159, v158, s32
    v_accvgpr_write_b32 a95, v127
    s_waitcnt lgkmcnt(0)
    s_add_u32 m0, s29, 4096
    s_mov_b32 s30, 524288
    buffer_load_dwordx4 v165, s[92:95], s30 offen lds
    s_add_u32 m0, s29, 5120
    s_mov_b32 s30, 589824
    buffer_load_dwordx4 v165, s[92:95], s30 offen lds
    s_add_u32 m0, s29, 6144
    s_mov_b32 s30, 532480
    buffer_load_dwordx4 v165, s[92:95], s30 offen lds
    s_add_u32 m0, s29, 7168
    s_mov_b32 s30, 598016
    buffer_load_dwordx4 v165, s[92:95], s30 offen lds
    s_waitcnt vmcnt(16)
    ds_read2st64_b32 v[144:145], v170 offset0:32 offset1:33
    ds_read2st64_b32 v[146:147], v170 offset0:34 offset1:35
    ds_read2st64_b32 v[148:149], v170 offset0:36 offset1:37
    ds_read2st64_b32 v[150:151], v170 offset0:38 offset1:39
    ds_read2st64_b32 v[152:153], v170 offset0:40 offset1:41
    ds_read2st64_b32 v[154:155], v170 offset0:42 offset1:43
    ds_read2st64_b32 v[156:157], v170 offset0:44 offset1:45
    ds_read2st64_b32 v[158:159], v170 offset0:46 offset1:47
    v_perm_b32 v120, v129, v128, s31
    v_accvgpr_write_b32 a96, v120
    v_perm_b32 v121, v129, v128, s32
    v_accvgpr_write_b32 a104, v121
    v_perm_b32 v122, v131, v130, s31
    v_accvgpr_write_b32 a97, v122
    v_perm_b32 v123, v131, v130, s32
    v_accvgpr_write_b32 a105, v123
    v_perm_b32 v124, v133, v132, s31
    v_accvgpr_write_b32 a98, v124
    v_perm_b32 v125, v133, v132, s32
    v_accvgpr_write_b32 a106, v125
    v_perm_b32 v126, v135, v134, s31
    v_accvgpr_write_b32 a99, v126
    v_perm_b32 v127, v135, v134, s32
    v_accvgpr_write_b32 a107, v127
    v_perm_b32 v120, v137, v136, s31
    v_accvgpr_write_b32 a100, v120
    v_perm_b32 v121, v137, v136, s32
    v_accvgpr_write_b32 a108, v121
    v_perm_b32 v122, v139, v138, s31
    v_accvgpr_write_b32 a101, v122
    v_perm_b32 v123, v139, v138, s32
    v_accvgpr_write_b32 a109, v123
    v_perm_b32 v124, v141, v140, s31
    v_accvgpr_write_b32 a102, v124
    v_perm_b32 v125, v141, v140, s32
    v_accvgpr_write_b32 a110, v125
    v_perm_b32 v126, v143, v142, s31
    v_accvgpr_write_b32 a103, v126
    v_perm_b32 v127, v143, v142, s32
    v_accvgpr_write_b32 a111, v127
    s_waitcnt lgkmcnt(0)
    s_add_u32 m0, s29, 8192
    s_mov_b32 s30, 1048576
    buffer_load_dwordx4 v165, s[92:95], s30 offen lds
    s_add_u32 m0, s29, 9216
    s_mov_b32 s30, 1114112
    buffer_load_dwordx4 v165, s[92:95], s30 offen lds
    s_add_u32 m0, s29, 10240
    s_mov_b32 s30, 1056768
    buffer_load_dwordx4 v165, s[92:95], s30 offen lds
    s_add_u32 m0, s29, 11264
    s_mov_b32 s30, 1122304
    buffer_load_dwordx4 v165, s[92:95], s30 offen lds
    s_waitcnt vmcnt(16)
    ds_read2st64_b32 v[128:129], v170 offset0:48 offset1:49
    ds_read2st64_b32 v[130:131], v170 offset0:50 offset1:51
    ds_read2st64_b32 v[132:133], v170 offset0:52 offset1:53
    ds_read2st64_b32 v[134:135], v170 offset0:54 offset1:55
    ds_read2st64_b32 v[136:137], v170 offset0:56 offset1:57
    ds_read2st64_b32 v[138:139], v170 offset0:58 offset1:59
    ds_read2st64_b32 v[140:141], v170 offset0:60 offset1:61
    ds_read2st64_b32 v[142:143], v170 offset0:62 offset1:63
    v_perm_b32 v120, v145, v144, s31
    v_accvgpr_write_b32 a112, v120
    v_perm_b32 v121, v145, v144, s32
    v_accvgpr_write_b32 a120, v121
    v_perm_b32 v122, v147, v146, s31
    v_accvgpr_write_b32 a113, v122
    v_perm_b32 v123, v147, v146, s32
    v_accvgpr_write_b32 a121, v123
    v_perm_b32 v124, v149, v148, s31
    v_accvgpr_write_b32 a114, v124
    v_perm_b32 v125, v149, v148, s32
    v_accvgpr_write_b32 a122, v125
    v_perm_b32 v126, v151, v150, s31
    v_accvgpr_write_b32 a115, v126
    v_perm_b32 v127, v151, v150, s32
    v_accvgpr_write_b32 a123, v127
    v_perm_b32 v120, v153, v152, s31
    v_accvgpr_write_b32 a116, v120
    v_perm_b32 v121, v153, v152, s32
    v_accvgpr_write_b32 a124, v121
    v_perm_b32 v122, v155, v154, s31
    v_accvgpr_write_b32 a117, v122
    v_perm_b32 v123, v155, v154, s32
    v_accvgpr_write_b32 a125, v123
    v_perm_b32 v124, v157, v156, s31
    v_accvgpr_write_b32 a118, v124
    v_perm_b32 v125, v157, v156, s32
    v_accvgpr_write_b32 a126, v125
    v_perm_b32 v126, v159, v158, s31
    v_accvgpr_write_b32 a119, v126
    v_perm_b32 v127, v159, v158, s32
    v_accvgpr_write_b32 a127, v127
    s_waitcnt lgkmcnt(0)
    s_add_u32 m0, s29, 12288
    s_mov_b32 s30, 1572864
    buffer_load_dwordx4 v165, s[92:95], s30 offen lds
    s_add_u32 m0, s29, 13312
    s_mov_b32 s30, 1638400
    buffer_load_dwordx4 v165, s[92:95], s30 offen lds
    s_add_u32 m0, s29, 14336
    s_mov_b32 s30, 1581056
    buffer_load_dwordx4 v165, s[92:95], s30 offen lds
    s_add_u32 m0, s29, 15360
    s_mov_b32 s30, 1646592
    buffer_load_dwordx4 v165, s[92:95], s30 offen lds
    s_waitcnt vmcnt(16)
    ds_read2st64_b32 v[144:145], v170 offset0:64 offset1:65
    ds_read2st64_b32 v[146:147], v170 offset0:66 offset1:67
    ds_read2st64_b32 v[148:149], v170 offset0:68 offset1:69
    ds_read2st64_b32 v[150:151], v170 offset0:70 offset1:71
    ds_read2st64_b32 v[152:153], v170 offset0:72 offset1:73
    ds_read2st64_b32 v[154:155], v170 offset0:74 offset1:75
    ds_read2st64_b32 v[156:157], v170 offset0:76 offset1:77
    ds_read2st64_b32 v[158:159], v170 offset0:78 offset1:79
    v_perm_b32 v120, v129, v128, s31
    v_accvgpr_write_b32 a128, v120
    v_perm_b32 v121, v129, v128, s32
    v_accvgpr_write_b32 a136, v121
    v_perm_b32 v122, v131, v130, s31
    v_accvgpr_write_b32 a129, v122
    v_perm_b32 v123, v131, v130, s32
    v_accvgpr_write_b32 a137, v123
    v_perm_b32 v124, v133, v132, s31
    v_accvgpr_write_b32 a130, v124
    v_perm_b32 v125, v133, v132, s32
    v_accvgpr_write_b32 a138, v125
    v_perm_b32 v126, v135, v134, s31
    v_accvgpr_write_b32 a131, v126
    v_perm_b32 v127, v135, v134, s32
    v_accvgpr_write_b32 a139, v127
    v_perm_b32 v120, v137, v136, s31
    v_accvgpr_write_b32 a132, v120
    v_perm_b32 v121, v137, v136, s32
    v_accvgpr_write_b32 a140, v121
    v_perm_b32 v122, v139, v138, s31
    v_accvgpr_write_b32 a133, v122
    v_perm_b32 v123, v139, v138, s32
    v_accvgpr_write_b32 a141, v123
    v_perm_b32 v124, v141, v140, s31
    v_accvgpr_write_b32 a134, v124
    v_perm_b32 v125, v141, v140, s32
    v_accvgpr_write_b32 a142, v125
    v_perm_b32 v126, v143, v142, s31
    v_accvgpr_write_b32 a135, v126
    v_perm_b32 v127, v143, v142, s32
    v_accvgpr_write_b32 a143, v127
    s_waitcnt lgkmcnt(0)
    s_add_u32 m0, s29, 16384
    s_mov_b32 s30, 2097152
    buffer_load_dwordx4 v165, s[92:95], s30 offen lds
    s_add_u32 m0, s29, 17408
    s_mov_b32 s30, 2162688
    buffer_load_dwordx4 v165, s[92:95], s30 offen lds
    s_add_u32 m0, s29, 18432
    s_mov_b32 s30, 2105344
    buffer_load_dwordx4 v165, s[92:95], s30 offen lds
    s_add_u32 m0, s29, 19456
    s_mov_b32 s30, 2170880
    buffer_load_dwordx4 v165, s[92:95], s30 offen lds
    buffer_load_dword v185, v184, s[92:95], 0 offen
    s_waitcnt vmcnt(17)
    ds_read2st64_b32 v[128:129], v170 offset0:0 offset1:1
    ds_read2st64_b32 v[130:131], v170 offset0:2 offset1:3
    ds_read2st64_b32 v[132:133], v170 offset0:4 offset1:5
    ds_read2st64_b32 v[134:135], v170 offset0:6 offset1:7
    ds_read2st64_b32 v[136:137], v170 offset0:8 offset1:9
    ds_read2st64_b32 v[138:139], v170 offset0:10 offset1:11
    ds_read2st64_b32 v[140:141], v170 offset0:12 offset1:13
    ds_read2st64_b32 v[142:143], v170 offset0:14 offset1:15
    v_perm_b32 v120, v145, v144, s31
    v_accvgpr_write_b32 a144, v120
    v_perm_b32 v121, v145, v144, s32
    v_accvgpr_write_b32 a152, v121
    v_perm_b32 v122, v147, v146, s31
    v_accvgpr_write_b32 a145, v122
    v_perm_b32 v123, v147, v146, s32
    v_accvgpr_write_b32 a153, v123
    v_perm_b32 v124, v149, v148, s31
    v_accvgpr_write_b32 a146, v124
    v_perm_b32 v125, v149, v148, s32
    v_accvgpr_write_b32 a154, v125
    v_perm_b32 v126, v151, v150, s31
    v_accvgpr_write_b32 a147, v126
    v_perm_b32 v127, v151, v150, s32
    v_accvgpr_write_b32 a155, v127
    v_perm_b32 v120, v153, v152, s31
    v_accvgpr_write_b32 a148, v120
    v_perm_b32 v121, v153, v152, s32
    v_accvgpr_write_b32 a156, v121
    v_perm_b32 v122, v155, v154, s31
    v_accvgpr_write_b32 a149, v122
    v_perm_b32 v123, v155, v154, s32
    v_accvgpr_write_b32 a157, v123
    v_perm_b32 v124, v157, v156, s31
    v_accvgpr_write_b32 a150, v124
    v_perm_b32 v125, v157, v156, s32
    v_accvgpr_write_b32 a158, v125
    v_perm_b32 v126, v159, v158, s31
    v_accvgpr_write_b32 a151, v126
    v_perm_b32 v127, v159, v158, s32
    v_accvgpr_write_b32 a159, v127
    s_waitcnt lgkmcnt(0)
    s_add_u32 m0, s29, 0
    s_mov_b32 s30, 2621440
    buffer_load_dwordx4 v165, s[92:95], s30 offen lds
    s_add_u32 m0, s29, 1024
    s_mov_b32 s30, 2686976
    buffer_load_dwordx4 v165, s[92:95], s30 offen lds
    s_add_u32 m0, s29, 2048
    s_mov_b32 s30, 2629632
    buffer_load_dwordx4 v165, s[92:95], s30 offen lds
    s_add_u32 m0, s29, 3072
    s_mov_b32 s30, 2695168
    buffer_load_dwordx4 v165, s[92:95], s30 offen lds
    s_waitcnt vmcnt(17)
    ds_read2st64_b32 v[144:145], v170 offset0:16 offset1:17
    ds_read2st64_b32 v[146:147], v170 offset0:18 offset1:19
    ds_read2st64_b32 v[148:149], v170 offset0:20 offset1:21
    ds_read2st64_b32 v[150:151], v170 offset0:22 offset1:23
    ds_read2st64_b32 v[152:153], v170 offset0:24 offset1:25
    ds_read2st64_b32 v[154:155], v170 offset0:26 offset1:27
    ds_read2st64_b32 v[156:157], v170 offset0:28 offset1:29
    ds_read2st64_b32 v[158:159], v170 offset0:30 offset1:31
    v_perm_b32 v120, v129, v128, s31
    v_accvgpr_write_b32 a160, v120
    v_perm_b32 v121, v129, v128, s32
    v_accvgpr_write_b32 a168, v121
    v_perm_b32 v122, v131, v130, s31
    v_accvgpr_write_b32 a161, v122
    v_perm_b32 v123, v131, v130, s32
    v_accvgpr_write_b32 a169, v123
    v_perm_b32 v124, v133, v132, s31
    v_accvgpr_write_b32 a162, v124
    v_perm_b32 v125, v133, v132, s32
    v_accvgpr_write_b32 a170, v125
    v_perm_b32 v126, v135, v134, s31
    v_accvgpr_write_b32 a163, v126
    v_perm_b32 v127, v135, v134, s32
    v_accvgpr_write_b32 a171, v127
    v_perm_b32 v120, v137, v136, s31
    v_accvgpr_write_b32 a164, v120
    v_perm_b32 v121, v137, v136, s32
    v_accvgpr_write_b32 a172, v121
    v_perm_b32 v122, v139, v138, s31
    v_accvgpr_write_b32 a165, v122
    v_perm_b32 v123, v139, v138, s32
    v_accvgpr_write_b32 a173, v123
    v_perm_b32 v124, v141, v140, s31
    v_accvgpr_write_b32 a166, v124
    v_perm_b32 v125, v141, v140, s32
    v_accvgpr_write_b32 a174, v125
    v_perm_b32 v126, v143, v142, s31
    v_accvgpr_write_b32 a167, v126
    v_perm_b32 v127, v143, v142, s32
    v_accvgpr_write_b32 a175, v127
    s_waitcnt lgkmcnt(0)
    s_add_u32 m0, s29, 4096
    s_mov_b32 s30, 3145728
    buffer_load_dwordx4 v165, s[92:95], s30 offen lds
    s_add_u32 m0, s29, 5120
    s_mov_b32 s30, 3211264
    buffer_load_dwordx4 v165, s[92:95], s30 offen lds
    s_add_u32 m0, s29, 6144
    s_mov_b32 s30, 3153920
    buffer_load_dwordx4 v165, s[92:95], s30 offen lds
    s_add_u32 m0, s29, 7168
    s_mov_b32 s30, 3219456
    buffer_load_dwordx4 v165, s[92:95], s30 offen lds
    s_waitcnt vmcnt(17)
    ds_read2st64_b32 v[128:129], v170 offset0:32 offset1:33
    ds_read2st64_b32 v[130:131], v170 offset0:34 offset1:35
    ds_read2st64_b32 v[132:133], v170 offset0:36 offset1:37
    ds_read2st64_b32 v[134:135], v170 offset0:38 offset1:39
    ds_read2st64_b32 v[136:137], v170 offset0:40 offset1:41
    ds_read2st64_b32 v[138:139], v170 offset0:42 offset1:43
    ds_read2st64_b32 v[140:141], v170 offset0:44 offset1:45
    ds_read2st64_b32 v[142:143], v170 offset0:46 offset1:47
    v_perm_b32 v120, v145, v144, s31
    v_accvgpr_write_b32 a176, v120
    v_perm_b32 v121, v145, v144, s32
    v_accvgpr_write_b32 a184, v121
    v_perm_b32 v122, v147, v146, s31
    v_accvgpr_write_b32 a177, v122
    v_perm_b32 v123, v147, v146, s32
    v_accvgpr_write_b32 a185, v123
    v_perm_b32 v124, v149, v148, s31
    v_accvgpr_write_b32 a178, v124
    v_perm_b32 v125, v149, v148, s32
    v_accvgpr_write_b32 a186, v125
    v_perm_b32 v126, v151, v150, s31
    v_accvgpr_write_b32 a179, v126
    v_perm_b32 v127, v151, v150, s32
    v_accvgpr_write_b32 a187, v127
    v_perm_b32 v120, v153, v152, s31
    v_accvgpr_write_b32 a180, v120
    v_perm_b32 v121, v153, v152, s32
    v_accvgpr_write_b32 a188, v121
    v_perm_b32 v122, v155, v154, s31
    v_accvgpr_write_b32 a181, v122
    v_perm_b32 v123, v155, v154, s32
    v_accvgpr_write_b32 a189, v123
    v_perm_b32 v124, v157, v156, s31
    v_accvgpr_write_b32 a182, v124
    v_perm_b32 v125, v157, v156, s32
    v_accvgpr_write_b32 a190, v125
    v_perm_b32 v126, v159, v158, s31
    v_accvgpr_write_b32 a183, v126
    v_perm_b32 v127, v159, v158, s32
    v_accvgpr_write_b32 a191, v127
    s_waitcnt lgkmcnt(0)
    s_add_u32 m0, s29, 8192
    s_mov_b32 s30, 3670016
    buffer_load_dwordx4 v165, s[92:95], s30 offen lds
    s_add_u32 m0, s29, 9216
    s_mov_b32 s30, 3735552
    buffer_load_dwordx4 v165, s[92:95], s30 offen lds
    s_add_u32 m0, s29, 10240
    s_mov_b32 s30, 3678208
    buffer_load_dwordx4 v165, s[92:95], s30 offen lds
    s_add_u32 m0, s29, 11264
    s_mov_b32 s30, 3743744
    buffer_load_dwordx4 v165, s[92:95], s30 offen lds
    s_waitcnt vmcnt(17)
    ds_read2st64_b32 v[144:145], v170 offset0:48 offset1:49
    ds_read2st64_b32 v[146:147], v170 offset0:50 offset1:51
    ds_read2st64_b32 v[148:149], v170 offset0:52 offset1:53
    ds_read2st64_b32 v[150:151], v170 offset0:54 offset1:55
    ds_read2st64_b32 v[152:153], v170 offset0:56 offset1:57
    ds_read2st64_b32 v[154:155], v170 offset0:58 offset1:59
    ds_read2st64_b32 v[156:157], v170 offset0:60 offset1:61
    ds_read2st64_b32 v[158:159], v170 offset0:62 offset1:63
    v_perm_b32 v120, v129, v128, s31
    v_accvgpr_write_b32 a192, v120
    v_perm_b32 v121, v129, v128, s32
    v_accvgpr_write_b32 a200, v121
    v_perm_b32 v122, v131, v130, s31
    v_accvgpr_write_b32 a193, v122
    v_perm_b32 v123, v131, v130, s32
    v_accvgpr_write_b32 a201, v123
    v_perm_b32 v124, v133, v132, s31
    v_accvgpr_write_b32 a194, v124
    v_perm_b32 v125, v133, v132, s32
    v_accvgpr_write_b32 a202, v125
    v_perm_b32 v126, v135, v134, s31
    v_accvgpr_write_b32 a195, v126
    v_perm_b32 v127, v135, v134, s32
    v_accvgpr_write_b32 a203, v127
    v_perm_b32 v120, v137, v136, s31
    v_accvgpr_write_b32 a196, v120
    v_perm_b32 v121, v137, v136, s32
    v_accvgpr_write_b32 a204, v121
    v_perm_b32 v122, v139, v138, s31
    v_accvgpr_write_b32 a197, v122
    v_perm_b32 v123, v139, v138, s32
    v_accvgpr_write_b32 a205, v123
    v_perm_b32 v124, v141, v140, s31
    v_accvgpr_write_b32 a198, v124
    v_perm_b32 v125, v141, v140, s32
    v_accvgpr_write_b32 a206, v125
    v_perm_b32 v126, v143, v142, s31
    v_accvgpr_write_b32 a199, v126
    v_perm_b32 v127, v143, v142, s32
    v_accvgpr_write_b32 a207, v127
    s_waitcnt lgkmcnt(0)
    s_add_u32 m0, s29, 12288
    s_mov_b32 s30, 4194304
    buffer_load_dwordx4 v165, s[92:95], s30 offen lds
    s_add_u32 m0, s29, 13312
    s_mov_b32 s30, 4259840
    buffer_load_dwordx4 v165, s[92:95], s30 offen lds
    s_add_u32 m0, s29, 14336
    s_mov_b32 s30, 4202496
    buffer_load_dwordx4 v165, s[92:95], s30 offen lds
    s_add_u32 m0, s29, 15360
    s_mov_b32 s30, 4268032
    buffer_load_dwordx4 v165, s[92:95], s30 offen lds
    s_waitcnt vmcnt(17)
    ds_read2st64_b32 v[128:129], v170 offset0:64 offset1:65
    ds_read2st64_b32 v[130:131], v170 offset0:66 offset1:67
    ds_read2st64_b32 v[132:133], v170 offset0:68 offset1:69
    ds_read2st64_b32 v[134:135], v170 offset0:70 offset1:71
    ds_read2st64_b32 v[136:137], v170 offset0:72 offset1:73
    ds_read2st64_b32 v[138:139], v170 offset0:74 offset1:75
    ds_read2st64_b32 v[140:141], v170 offset0:76 offset1:77
    ds_read2st64_b32 v[142:143], v170 offset0:78 offset1:79
    v_perm_b32 v120, v145, v144, s31
    v_accvgpr_write_b32 a208, v120
    v_perm_b32 v121, v145, v144, s32
    v_accvgpr_write_b32 a216, v121
    v_perm_b32 v122, v147, v146, s31
    v_accvgpr_write_b32 a209, v122
    v_perm_b32 v123, v147, v146, s32
    v_accvgpr_write_b32 a217, v123
    v_perm_b32 v124, v149, v148, s31
    v_accvgpr_write_b32 a210, v124
    v_perm_b32 v125, v149, v148, s32
    v_accvgpr_write_b32 a218, v125
    v_perm_b32 v126, v151, v150, s31
    v_accvgpr_write_b32 a211, v126
    v_perm_b32 v127, v151, v150, s32
    v_accvgpr_write_b32 a219, v127
    v_perm_b32 v120, v153, v152, s31
    v_accvgpr_write_b32 a212, v120
    v_perm_b32 v121, v153, v152, s32
    v_accvgpr_write_b32 a220, v121
    v_perm_b32 v122, v155, v154, s31
    v_accvgpr_write_b32 a213, v122
    v_perm_b32 v123, v155, v154, s32
    v_accvgpr_write_b32 a221, v123
    v_perm_b32 v124, v157, v156, s31
    v_accvgpr_write_b32 a214, v124
    v_perm_b32 v125, v157, v156, s32
    v_accvgpr_write_b32 a222, v125
    v_perm_b32 v126, v159, v158, s31
    v_accvgpr_write_b32 a215, v126
    v_perm_b32 v127, v159, v158, s32
    v_accvgpr_write_b32 a223, v127
    s_waitcnt lgkmcnt(0)
    s_add_u32 m0, s29, 16384
    s_mov_b32 s30, 4718592
    buffer_load_dwordx4 v165, s[92:95], s30 offen lds
    s_add_u32 m0, s29, 17408
    s_mov_b32 s30, 4784128
    buffer_load_dwordx4 v165, s[92:95], s30 offen lds
    s_add_u32 m0, s29, 18432
    s_mov_b32 s30, 4726784
    buffer_load_dwordx4 v165, s[92:95], s30 offen lds
    s_add_u32 m0, s29, 19456
    s_mov_b32 s30, 4792320
    buffer_load_dwordx4 v165, s[92:95], s30 offen lds
    s_waitcnt vmcnt(16)
    ds_read2st64_b32 v[144:145], v170 offset0:0 offset1:1
    ds_read2st64_b32 v[146:147], v170 offset0:2 offset1:3
    ds_read2st64_b32 v[148:149], v170 offset0:4 offset1:5
    ds_read2st64_b32 v[150:151], v170 offset0:6 offset1:7
    ds_read2st64_b32 v[152:153], v170 offset0:8 offset1:9
    ds_read2st64_b32 v[154:155], v170 offset0:10 offset1:11
    ds_read2st64_b32 v[156:157], v170 offset0:12 offset1:13
    ds_read2st64_b32 v[158:159], v170 offset0:14 offset1:15
    v_perm_b32 v120, v129, v128, s31
    v_accvgpr_write_b32 a224, v120
    v_perm_b32 v121, v129, v128, s32
    v_accvgpr_write_b32 a232, v121
    v_perm_b32 v122, v131, v130, s31
    v_accvgpr_write_b32 a225, v122
    v_perm_b32 v123, v131, v130, s32
    v_accvgpr_write_b32 a233, v123
    v_perm_b32 v124, v133, v132, s31
    v_accvgpr_write_b32 a226, v124
    v_perm_b32 v125, v133, v132, s32
    v_accvgpr_write_b32 a234, v125
    v_perm_b32 v126, v135, v134, s31
    v_accvgpr_write_b32 a227, v126
    v_perm_b32 v127, v135, v134, s32
    v_accvgpr_write_b32 a235, v127
    v_perm_b32 v120, v137, v136, s31
    v_accvgpr_write_b32 a228, v120
    v_perm_b32 v121, v137, v136, s32
    v_accvgpr_write_b32 a236, v121
    v_perm_b32 v122, v139, v138, s31
    v_accvgpr_write_b32 a229, v122
    v_perm_b32 v123, v139, v138, s32
    v_accvgpr_write_b32 a237, v123
    v_perm_b32 v124, v141, v140, s31
    v_accvgpr_write_b32 a230, v124
    v_perm_b32 v125, v141, v140, s32
    v_accvgpr_write_b32 a238, v125
    v_perm_b32 v126, v143, v142, s31
    v_accvgpr_write_b32 a231, v126
    v_perm_b32 v127, v143, v142, s32
    v_accvgpr_write_b32 a239, v127
    s_waitcnt lgkmcnt(0)
    s_waitcnt vmcnt(12)
    ds_read2st64_b32 v[128:129], v170 offset0:16 offset1:17
    ds_read2st64_b32 v[130:131], v170 offset0:18 offset1:19
    ds_read2st64_b32 v[132:133], v170 offset0:20 offset1:21
    ds_read2st64_b32 v[134:135], v170 offset0:22 offset1:23
    ds_read2st64_b32 v[136:137], v170 offset0:24 offset1:25
    ds_read2st64_b32 v[138:139], v170 offset0:26 offset1:27
    ds_read2st64_b32 v[140:141], v170 offset0:28 offset1:29
    ds_read2st64_b32 v[142:143], v170 offset0:30 offset1:31
    v_perm_b32 v120, v145, v144, s31
    v_accvgpr_write_b32 a240, v120
    v_perm_b32 v121, v145, v144, s32
    v_accvgpr_write_b32 a248, v121
    v_perm_b32 v122, v147, v146, s31
    v_accvgpr_write_b32 a241, v122
    v_perm_b32 v123, v147, v146, s32
    v_accvgpr_write_b32 a249, v123
    v_perm_b32 v124, v149, v148, s31
    v_accvgpr_write_b32 a242, v124
    v_perm_b32 v125, v149, v148, s32
    v_accvgpr_write_b32 a250, v125
    v_perm_b32 v126, v151, v150, s31
    v_accvgpr_write_b32 a243, v126
    v_perm_b32 v127, v151, v150, s32
    v_accvgpr_write_b32 a251, v127
    v_perm_b32 v120, v153, v152, s31
    v_accvgpr_write_b32 a244, v120
    v_perm_b32 v121, v153, v152, s32
    v_accvgpr_write_b32 a252, v121
    v_perm_b32 v122, v155, v154, s31
    v_accvgpr_write_b32 a245, v122
    v_perm_b32 v123, v155, v154, s32
    v_accvgpr_write_b32 a253, v123
    v_perm_b32 v124, v157, v156, s31
    v_accvgpr_write_b32 a246, v124
    v_perm_b32 v125, v157, v156, s32
    v_accvgpr_write_b32 a254, v125
    v_perm_b32 v126, v159, v158, s31
    v_accvgpr_write_b32 a247, v126
    v_perm_b32 v127, v159, v158, s32
    v_accvgpr_write_b32 a255, v127
    s_waitcnt lgkmcnt(0)
    s_waitcnt vmcnt(8)
    ds_read2st64_b32 v[144:145], v170 offset0:32 offset1:33
    ds_read2st64_b32 v[146:147], v170 offset0:34 offset1:35
    ds_read2st64_b32 v[148:149], v170 offset0:36 offset1:37
    ds_read2st64_b32 v[150:151], v170 offset0:38 offset1:39
    ds_read2st64_b32 v[152:153], v170 offset0:40 offset1:41
    ds_read2st64_b32 v[154:155], v170 offset0:42 offset1:43
    ds_read2st64_b32 v[156:157], v170 offset0:44 offset1:45
    ds_read2st64_b32 v[158:159], v170 offset0:46 offset1:47
    v_perm_b32 v192, v129, v128, s31
    v_perm_b32 v200, v129, v128, s32
    v_perm_b32 v193, v131, v130, s31
    v_perm_b32 v201, v131, v130, s32
    v_perm_b32 v194, v133, v132, s31
    v_perm_b32 v202, v133, v132, s32
    v_perm_b32 v195, v135, v134, s31
    v_perm_b32 v203, v135, v134, s32
    v_perm_b32 v196, v137, v136, s31
    v_perm_b32 v204, v137, v136, s32
    v_perm_b32 v197, v139, v138, s31
    v_perm_b32 v205, v139, v138, s32
    v_perm_b32 v198, v141, v140, s31
    v_perm_b32 v206, v141, v140, s32
    v_perm_b32 v199, v143, v142, s31
    v_perm_b32 v207, v143, v142, s32
    s_waitcnt lgkmcnt(0)
    s_waitcnt vmcnt(4)
    ds_read2st64_b32 v[128:129], v170 offset0:48 offset1:49
    ds_read2st64_b32 v[130:131], v170 offset0:50 offset1:51
    ds_read2st64_b32 v[132:133], v170 offset0:52 offset1:53
    ds_read2st64_b32 v[134:135], v170 offset0:54 offset1:55
    ds_read2st64_b32 v[136:137], v170 offset0:56 offset1:57
    ds_read2st64_b32 v[138:139], v170 offset0:58 offset1:59
    ds_read2st64_b32 v[140:141], v170 offset0:60 offset1:61
    ds_read2st64_b32 v[142:143], v170 offset0:62 offset1:63
    v_perm_b32 v208, v145, v144, s31
    v_perm_b32 v216, v145, v144, s32
    v_perm_b32 v209, v147, v146, s31
    v_perm_b32 v217, v147, v146, s32
    v_perm_b32 v210, v149, v148, s31
    v_perm_b32 v218, v149, v148, s32
    v_perm_b32 v211, v151, v150, s31
    v_perm_b32 v219, v151, v150, s32
    v_perm_b32 v212, v153, v152, s31
    v_perm_b32 v220, v153, v152, s32
    v_perm_b32 v213, v155, v154, s31
    v_perm_b32 v221, v155, v154, s32
    v_perm_b32 v214, v157, v156, s31
    v_perm_b32 v222, v157, v156, s32
    v_perm_b32 v215, v159, v158, s31
    v_perm_b32 v223, v159, v158, s32
    s_waitcnt lgkmcnt(0)
    s_waitcnt vmcnt(0)
    ds_read2st64_b32 v[144:145], v170 offset0:64 offset1:65
    ds_read2st64_b32 v[146:147], v170 offset0:66 offset1:67
    ds_read2st64_b32 v[148:149], v170 offset0:68 offset1:69
    ds_read2st64_b32 v[150:151], v170 offset0:70 offset1:71
    ds_read2st64_b32 v[152:153], v170 offset0:72 offset1:73
    ds_read2st64_b32 v[154:155], v170 offset0:74 offset1:75
    ds_read2st64_b32 v[156:157], v170 offset0:76 offset1:77
    ds_read2st64_b32 v[158:159], v170 offset0:78 offset1:79
    v_perm_b32 v224, v129, v128, s31
    v_perm_b32 v232, v129, v128, s32
    v_perm_b32 v225, v131, v130, s31
    v_perm_b32 v233, v131, v130, s32
    v_perm_b32 v226, v133, v132, s31
    v_perm_b32 v234, v133, v132, s32
    v_perm_b32 v227, v135, v134, s31
    v_perm_b32 v235, v135, v134, s32
    v_perm_b32 v228, v137, v136, s31
    v_perm_b32 v236, v137, v136, s32
    v_perm_b32 v229, v139, v138, s31
    v_perm_b32 v237, v139, v138, s32
    v_perm_b32 v230, v141, v140, s31
    v_perm_b32 v238, v141, v140, s32
    v_perm_b32 v231, v143, v142, s31
    v_perm_b32 v239, v143, v142, s32
    s_waitcnt lgkmcnt(0)
    v_perm_b32 v240, v145, v144, s31
    v_perm_b32 v248, v145, v144, s32
    v_perm_b32 v241, v147, v146, s31
    v_perm_b32 v249, v147, v146, s32
    v_perm_b32 v242, v149, v148, s31
    v_perm_b32 v250, v149, v148, s32
    v_perm_b32 v243, v151, v150, s31
    v_perm_b32 v251, v151, v150, s32
    v_perm_b32 v244, v153, v152, s31
    v_perm_b32 v252, v153, v152, s32
    v_perm_b32 v245, v155, v154, s31
    v_perm_b32 v253, v155, v154, s32
    v_perm_b32 v246, v157, v156, s31
    v_perm_b32 v254, v157, v156, s32
    v_perm_b32 v247, v159, v158, s31
    v_perm_b32 v255, v159, v158, s32
    s_mov_b32 s21, 0
    v_mov_b32 v172, 40960
    s_cmp_eq_u32 s18, 0
    s_cbranch_scc0 wi_15_w
wi_15:
    buffer_load_dword v171, off, s[88:91], 0 offset:132 sc1
    s_waitcnt vmcnt(0)
wi_15_chk:
    v_readfirstlane_b32 s19, v171
    s_and_b32 s20, s19, 255
    s_cmp_eq_u32 s20, 40
    s_cbranch_scc1 wi_15_ok
    s_sleep 2
    s_add_u32 s21, s21, 1
    s_cmp_lt_u32 s21, 200000
    s_cbranch_scc1 wi_15
wi_15_ok:
    ds_write_b32 v172, v171
wi_15_w:
    s_waitcnt vmcnt(0) lgkmcnt(0)
    s_barrier
    ds_read_b32 v171, v172
    s_waitcnt lgkmcnt(0)
    v_readfirstlane_b32 s19, v171
    s_and_b32 s46, s19, 0x7000
    s_and_b32 s45, s19, 0x800
    s_and_b32 s19, s19, 0x2000
    s_xor_b32 s34, s19, 0x2000
    s_mul_i32 s20, s18, 576
    s_add_u32 s20, s20, 13312
    v_lshlrev_b32 v6, 4, v12
    v_and_b32 v14, 1, v13
    v_lshl_add_u32 v6, v14, 3, v6
    v_lshrrev_b32 v14, 1, v13
    v_lshl_add_u32 v6, v14, 2, v6
    v_add_u32 v6, s20, v6
    s_lshl_b32 s20, s18, 8
    s_add_u32 s20, s20, 10240
    v_lshl_add_u32 v5, v1, 2, s20
    v_and_b32 v14, 3, v1
    v_lshlrev_b32 v176, 6, v14
    v_bfe_u32 v14, v1, 2, 3
    v_lshl_add_u32 v176, v14, 3, v176
    v_lshrrev_b32 v14, 5, v1
    v_lshl_add_u32 v176, v14, 8, v176
    v_and_b32 v14, 1, v13
    v_mul_u32_u24 v7, 1152, v14
    v_lshrrev_b32 v14, 1, v13
    v_lshl_add_u32 v7, v14, 7, v7
    v_bfe_u32 v14, v12, 2, 1
    v_lshl_add_u32 v7, v14, 5, v7
    v_lshrrev_b32 v14, 3, v12
    v_lshl_add_u32 v7, v14, 4, v7
    v_and_b32 v14, 1, v12
    v_lshl_add_u32 v7, v14, 3, v7
    v_lshrrev_b32 v8, 3, v12
    v_lshlrev_b32 v8, 8, v8
    v_lshl_add_u32 v8, v13, 5, v8
    v_and_b32 v15, 7, v12
    v_lshl_add_u32 v8, v15, 2, v8
    v_and_b32 v14, 1, v13
    v_mul_u32_u24 v14, 16384, v14
    v_bfe_u32 v187, v13, 1, 1
    v_mul_u32_u24 v187, 4096, v187
    v_xor_b32 v187, v187, v14
    v_xor_b32 v187, s46, v187
    v_lshl_add_u32 v187, v12, 4, v187
    v_lshl_add_u32 v187, v13, 9, v187
    s_lshr_b32 s20, s17, 3
    s_bitcmp1_b32 s20, 0
    s_cselect_b32 s21, 16384, 0
    s_bitcmp1_b32 s20, 1
    s_cselect_b32 s47, 4096, 0
    s_xor_b32 s47, s47, s21
    s_xor_b32 s47, s47, s46
    s_and_b32 s20, s17, 7
    s_lshl_b32 s20, s20, 9
    s_lshl_b32 s21, s18, 7
    s_add_u32 s20, s20, s21
    s_add_u32 s20, s20, s47
    v_add_u32 v8, s20, v8
    v_lshlrev_b32 v9, 5, v13
    v_lshrrev_b32 v14, 2, v12
    v_lshl_add_u32 v9, v14, 4, v9
    v_and_b32 v14, 2, v12
    v_lshl_add_u32 v9, v14, 1, v9
    s_and_b32 s20, s17, 6
    s_lshl_b32 s20, s20, 7
    s_add_u32 s20, s20, s47
    s_lshl_b32 s21, s18, 7
    s_add_u32 s20, s20, s21
    s_and_b32 s21, s17, 1
    s_lshl_b32 s21, s21, 3
    s_add_u32 s20, s20, s21
    v_add_u32 v9, s20, v9
    v_and_b32 v15, 9, v12
    v_cmp_eq_u32 vcc, 0, v15
    v_mov_b32 v15, 0x40000000
    s_nop 0
    v_cndmask_b32 v9, v15, v9, vcc
    v_and_b32 v10, 8, v12
    v_and_b32 v14, 3, v12
    v_lshl_add_u32 v10, v14, 1, v10
    v_bfe_u32 v14, v12, 2, 1
    v_add_u32 v10, v10, v14
    v_lshlrev_b32 v10, 4, v10
    v_lshl_add_u32 v10, v13, 8, v10
    s_cmp_lt_u32 s18, 2
    s_cbranch_scc1 L_qk_i0
    v_mov_b32 v10, v4
L_qk_i0:
    s_and_b32 s20, s18, 1
    s_lshl_b32 s20, s20, 12
    v_add_u32 v177, s20, v4
    v_add_u32 v190, 8, v10
    v_add_u32 v191, 8, v177
    s_and_b32 s20, s18, 1
    s_lshl_b32 s20, s20, 4
    v_add_u32 v14, s20, v12
    v_lshlrev_b32 v15, 2, v13
    v_sub_u32 v14, v14, v15
    v_cmp_le_i32 s[64:65], 0, v14
    v_cmp_le_i32 s[66:67], 1, v14
    v_cmp_le_i32 s[68:69], 2, v14
    v_cmp_le_i32 s[70:71], 3, v14
    v_cmp_le_i32 s[72:73], 16, v14
    v_cmp_le_i32 s[74:75], 17, v14
    v_cmp_le_i32 s[76:77], 18, v14
    v_cmp_le_i32 s[78:79], 19, v14
    v_mov_b32 v178, 0xceabfb8f
    v_cmp_gt_u32 vcc, 16, v1
    v_mov_b32 v15, 0x40000000
    s_nop 0
    v_cndmask_b32 v179, v15, v4, vcc
    s_and_b32 s20, s18, 1
    s_lshl_b32 s37, s20, 14
    s_lshl_b32 s36, s20, 16
    s_lshl_b32 s20, s17, 8
    s_add_u32 s37, s37, s20
    s_add_u32 s37, s37, 9175040
    s_lshr_b32 s20, s17, 3
    s_lshl_b32 s20, s20, 14
    s_add_u32 s36, s36, s20
    s_and_b32 s20, s17, 7
    s_lshl_b32 s20, s20, 10
    s_add_u32 s36, s36, s20
    s_add_u32 s36, s36, 9043968
    s_mov_b32 s33, 0x3e0293ee
    s_lshl_b32 s25, s17, 15
    s_add_u32 s25, s25, 8388608
    s_mov_b32 s16, 0
    s_mov_b32 s51, -1
    s_mov_b32 s24, 0
    s_mov_b32 s26, 0
    s_mov_b32 s27, 0
    s_mov_b32 s38, -1
    s_mov_b32 s39, -1
    s_and_b32 s21, s2, 0x3b
    s_add_u32 s21, s21, 0
    v_mov_b32 v142, v1
    v_mov_b32 v14, v142
    v_and_b32 v15, 1, v14
    v_mul_u32_u24 v15, 16384, v15
    v_bfe_u32 v142, v14, 1, 1
    v_mul_u32_u24 v142, 4096, v142
    v_xor_b32 v142, v142, v15
    v_xor_b32 v142, s46, v142
    v_xor_b32 v142, s45, v142
    v_cmp_eq_u32 vcc, 0, v14
    v_xor_b32 v15, 22528, v142
    s_nop 0
    v_cndmask_b32 v142, v142, v15, vcc
    v_cmp_eq_u32 vcc, 1, v14
    v_xor_b32 v15, 6272, v142
    s_nop 0
    v_cndmask_b32 v142, v142, v15, vcc
    v_cmp_eq_u32 vcc, 2, v14
    v_xor_b32 v15, 18688, v142
    s_nop 0
    v_cndmask_b32 v142, v142, v15, vcc
    v_cmp_eq_u32 vcc, 3, v14
    v_xor_b32 v15, 2432, v142
    s_nop 0
    v_cndmask_b32 v142, v142, v15, vcc
    s_cmp_eq_u32 s21, 0
    s_mov_b32 s20, 1933312
    s_cselect_b32 s20, s20, 0x40000000
    s_cmp_eq_u32 s18, 3
    s_cselect_b32 s20, s20, 0x40000000
    v_add_u32 v142, s20, v142
    v_cmp_gt_u32 vcc, 4, v1
    v_mov_b32 v15, 0x40000000
    s_nop 0
    v_cndmask_b32 v142, v15, v142, vcc
    s_and_b32 s20, s2, 3
    v_mov_b32 v143, s20
    v_mov_b32 v14, v143
    v_and_b32 v15, 1, v14
    v_mul_u32_u24 v15, 16384, v15
    v_bfe_u32 v143, v14, 1, 1
    v_mul_u32_u24 v143, 4096, v143
    v_xor_b32 v143, v143, v15
    v_xor_b32 v143, s46, v143
    v_xor_b32 v143, s45, v143
    v_cmp_eq_u32 vcc, 0, v14
    v_xor_b32 v15, 22528, v143
    s_nop 0
    v_cndmask_b32 v143, v143, v15, vcc
    v_cmp_eq_u32 vcc, 1, v14
    v_xor_b32 v15, 6272, v143
    s_nop 0
    v_cndmask_b32 v143, v143, v15, vcc
    v_cmp_eq_u32 vcc, 2, v14
    v_xor_b32 v15, 18688, v143
    s_nop 0
    v_cndmask_b32 v143, v143, v15, vcc
    v_cmp_eq_u32 vcc, 3, v14
    v_xor_b32 v15, 2432, v143
    s_nop 0
    v_cndmask_b32 v143, v143, v15, vcc
    v_add_u32 v143, 1966080, v143
    s_lshl_b32 s20, s17, 1
    s_lshl_b32 s20, s20, 7
    s_add_u32 s20, s20, 1835008
    s_add_u32 s20, s20, s19
    s_cmp_eq_u32 s18, 3
    s_cselect_b32 s20, s20, 0x40000000
    v_mov_b32 v180, s20
    v_cmp_eq_u32 vcc, 0, v1
    v_mov_b32 v15, 0x40000000
    s_nop 0
    v_cndmask_b32 v180, v15, v180, vcc
    v_and_b32 v181, 1, v1
    v_lshl_add_u32 v181, s17, 1, v181
    v_and_b32 v14, 1, v181
    v_lshrrev_b32 v181, 1, v181
    v_lshlrev_b32 v181, 7, v181
    v_lshl_add_u32 v181, v14, 2, v181
    s_add_u32 s20, s19, 1851392
    v_add_u32 v181, s20, v181
    s_lshl_b32 s20, s18, 12
    s_add_u32 s25, s25, s20
    s_add_u32 s40, s20, 16384
    s_and_b32 s20, s20, 0x2000
    s_add_u32 s25, s25, s20
    v_mov_b32 v144, -1
    s_lshl_b32 s20, s17, 1
    s_add_u32 s20, s20, s18
    s_lshl_b32 s20, s20, 7
    s_add_u32 s20, s20, 0
    s_add_u32 s20, s20, s19
    s_cmp_lt_u32 s18, 2
    s_cselect_b32 s20, s20, 0x40000000
    v_mov_b32 v186, s20
    v_cmp_eq_u32 vcc, 0, v1
    v_mov_b32 v15, 0x40000000
    s_nop 0
    v_cndmask_b32 v186, v15, v186, vcc
    s_cmp_eq_u32 s18, 1
    s_cbranch_scc0 L_qk_first
    s_max_i32 s20, s16, 0
    s_and_b32 s20, s20, 3
    s_lshl_b32 s22, s20, 15
    s_add_u32 s52, s22, 32768
    s_add_u32 s53, s22, 32000
    s_add_u32 s54, s22, 31232
    s_add_u32 s55, s22, 30464
    s_add_u32 s56, s22, 33792
    s_add_u32 s57, s22, 33024
    s_add_u32 s58, s22, 32256
    s_add_u32 s59, s22, 31488
    s_add_u32 s60, s22, 34816
    s_add_u32 s61, s22, 34048
    s_mov_b32 m0, 0
    s_nop 0
    buffer_load_dwordx4 v187, s[8:11], s52 offen offset:0 sc1 lds
    buffer_load_dwordx4 v187, s[8:11], s53 offen offset:1024 sc1 lds
    buffer_load_dwordx4 v187, s[8:11], s54 offen offset:2048 sc1 lds
    buffer_load_dwordx4 v187, s[8:11], s55 offen offset:3072 sc1 lds
    s_mov_b32 m0, 4096
    s_nop 0
    buffer_load_dwordx4 v187, s[8:11], s56 offen offset:0 sc1 lds
    buffer_load_dwordx4 v187, s[8:11], s57 offen offset:1024 sc1 lds
    buffer_load_dwordx4 v187, s[8:11], s58 offen offset:2048 sc1 lds
    buffer_load_dwordx4 v187, s[8:11], s59 offen offset:3072 sc1 lds
    s_mov_b32 m0, 8192
    s_nop 0
    buffer_load_dwordx4 v187, s[8:11], s60 offen offset:0 sc1 lds
    buffer_load_dwordx4 v187, s[8:11], s61 offen offset:1024 sc1 lds
L_qk_first:
    s_mov_b32 s16, 0
    s_cmp_ge_i32 s38, 1
    s_cbranch_scc1 mw_16_ok
    s_mov_b32 s21, 0
mw_16:
    buffer_load_dword v144, v181, s[8:11], 0 offen sc1
    s_waitcnt vmcnt(0)
    v_cmp_gt_i32 vcc, 1, v144
    s_cbranch_vccz mw_16_got
    s_sleep 2
    s_add_u32 s21, s21, 1
    s_cmp_lt_u32 s21, 200000
    s_cbranch_scc1 mw_16
mw_16_got:
    v_min_i32_dpp v144, v144, v144 row_ror:8 row_mask:0xf bank_mask:0xf
    s_nop 1
    v_min_i32_dpp v144, v144, v144 row_ror:4 row_mask:0xf bank_mask:0xf
    s_nop 1
    v_min_i32_dpp v144, v144, v144 row_ror:2 row_mask:0xf bank_mask:0xf
    s_nop 1
    v_min_i32_dpp v144, v144, v144 row_ror:1 row_mask:0xf bank_mask:0xf
    s_nop 0
    v_readlane_b32 s38, v144, 0
    v_readlane_b32 s20, v144, 16
    v_readlane_b32 s21, v144, 32
    s_min_i32 s38, s38, s20
    v_readlane_b32 s20, v144, 48
    s_min_i32 s38, s38, s21
    s_min_i32 s38, s38, s20
mw_16_ok:
    s_mov_b32 m0, s40
    s_lshr_b32 s20, s25, 8
    s_xor_b32 s20, s20, s19
    s_and_b32 s20, s20, 0x2000
    s_or_b32 s42, s25, s20
    buffer_load_dwordx4 v4, s[4:7], s42 offen offset:0 sc1 lds
    buffer_load_dwordx4 v4, s[4:7], s42 offen offset:1024 sc1 lds
    buffer_load_dwordx4 v4, s[4:7], s42 offen offset:2048 sc1 lds
    buffer_load_dwordx4 v4, s[4:7], s42 offen offset:3072 sc1 lds
    s_waitcnt vmcnt(0)
L_qk_next:
    s_add_u32 s21, s16, 1
    s_and_b32 s21, s21, 63
    s_lshl_b32 s21, s21, 20
    s_add_u32 s42, s25, s21
    s_lshr_b32 s20, s42, 8
    s_xor_b32 s20, s20, s19
    s_and_b32 s20, s20, 0x2000
    s_or_b32 s42, s42, s20
    s_and_b32 s21, s16, 63
    s_lshl_b32 s21, s21, 20
    s_add_u32 s43, s36, s21
    s_add_u32 s44, s37, s21
    s_lshr_b32 s20, s43, 8
    s_xor_b32 s20, s20, s34
    s_and_b32 s20, s20, 0x2000
    s_or_b32 s43, s43, s20
    s_or_b32 s44, s44, s20
    s_cmp_eq_u32 s18, 0
    s_cbranch_scc0 L_qk_nokq
    s_add_u32 s41, s16, 1
    v_readlane_b32 s38, v144, 0
    v_readlane_b32 s20, v144, 1
    s_min_i32 s38, s38, s20
    s_cmp_ge_i32 s38, s41
    s_cbranch_scc1 mw_17_ok
    s_mov_b32 s21, 0
mw_17:
    buffer_load_dword v144, v181, s[8:11], 0 offen sc1
    s_waitcnt vmcnt(0)
    v_cmp_gt_i32 vcc, s41, v144
    s_cbranch_vccz mw_17_got
    s_sleep 2
    s_add_u32 s21, s21, 1
    s_cmp_lt_u32 s21, 200000
    s_cbranch_scc1 mw_17
mw_17_got:
    v_min_i32_dpp v144, v144, v144 row_ror:8 row_mask:0xf bank_mask:0xf
    s_nop 1
    v_min_i32_dpp v144, v144, v144 row_ror:4 row_mask:0xf bank_mask:0xf
    s_nop 1
    v_min_i32_dpp v144, v144, v144 row_ror:2 row_mask:0xf bank_mask:0xf
    s_nop 1
    v_min_i32_dpp v144, v144, v144 row_ror:1 row_mask:0xf bank_mask:0xf
    s_nop 0
    v_readlane_b32 s38, v144, 0
    v_readlane_b32 s20, v144, 16
    v_readlane_b32 s21, v144, 32
    s_min_i32 s38, s38, s20
    v_readlane_b32 s20, v144, 48
    s_min_i32 s38, s38, s21
    s_min_i32 s38, s38, s20
mw_17_ok:
    buffer_load_dword v144, v181, s[8:11], 0 offen sc1
L_qk_nokq:
    v_mov_b32 v149, s16
    s_cmp_eq_u32 s18, 1
    s_cbranch_scc1 L_qk_w1
L_qk_rd:
    s_barrier
    ds_read2st64_b64 v[68:71], v10 offset0:32 offset1:34
    ds_read2st64_b64 v[72:75], v10 offset0:36 offset1:38
    ds_read2st64_b64 v[76:79], v190 offset0:32 offset1:34
    ds_read2st64_b64 v[80:83], v190 offset0:36 offset1:38
    ds_read2st64_b64 v[84:87], v10 offset0:40 offset1:42
    ds_read2st64_b64 v[88:91], v10 offset0:44 offset1:46
    ds_read2st64_b64 v[92:95], v190 offset0:40 offset1:42
    ds_read2st64_b64 v[96:99], v190 offset0:44 offset1:46
    s_cmp_lt_u32 s18, 2
    s_cbranch_scc1 L_qk_rd1
    ds_read2st64_b64 v[160:163], v177 offset0:48 offset1:50
    ds_read2st64_b64 v[164:167], v177 offset0:52 offset1:54
    ds_read2st64_b64 v[168:171], v191 offset0:48 offset1:50
    ds_read2st64_b64 v[172:175], v191 offset0:52 offset1:54
L_qk_rd1:
    s_waitcnt lgkmcnt(0)
    s_branch L_qk_nodma
L_qk_w1:
    s_max_i32 s20, s16, 0
    s_and_b32 s20, s20, 3
    s_lshl_b32 s22, s20, 15
    s_add_u32 s52, s22, 32768
    s_add_u32 s53, s22, 32000
    s_add_u32 s54, s22, 31232
    s_add_u32 s55, s22, 30464
    s_add_u32 s56, s22, 33792
    s_add_u32 s57, s22, 33024
    s_add_u32 s58, s22, 32256
    s_add_u32 s59, s22, 31488
    s_add_u32 s60, s22, 34816
    s_add_u32 s61, s22, 34048
    s_cmp_eq_u32 s16, 0
    s_cbranch_scc1 L_qk_rd
    s_sub_u32 s35, s16, 1
    s_barrier
    s_mov_b32 s21, 0
    buffer_load_dword v182, v143, s[8:11], 0 offen sc1
    ds_read2st64_b64 v[68:71], v10 offset0:32 offset1:34
    ds_read2st64_b64 v[72:75], v10 offset0:36 offset1:38
    ds_read2st64_b64 v[76:79], v190 offset0:32 offset1:34
    s_waitcnt lgkmcnt(0)
    buffer_load_dword v183, v143, s[8:11], 0 offen sc1
    ds_read2st64_b64 v[80:83], v190 offset0:36 offset1:38
    ds_read2st64_b64 v[84:87], v10 offset0:40 offset1:42
    ds_read2st64_b64 v[88:91], v10 offset0:44 offset1:46
    s_waitcnt lgkmcnt(0)
    buffer_load_dword v184, v143, s[8:11], 0 offen sc1
    ds_read2st64_b64 v[92:95], v190 offset0:40 offset1:42
    ds_read2st64_b64 v[96:99], v190 offset0:44 offset1:46
    s_waitcnt lgkmcnt(0)
    buffer_load_dword v185, v143, s[8:11], 0 offen sc1
poll_18:
    s_waitcnt vmcnt(3)
    v_cmp_gt_i32 vcc, s35, v182
    s_cbranch_vccz poll_18_got
    buffer_load_dword v182, v143, s[8:11], 0 offen sc1
    s_waitcnt vmcnt(3)
    v_cmp_gt_i32 vcc, s35, v183
    s_cbranch_vccz poll_18_got
    buffer_load_dword v183, v143, s[8:11], 0 offen sc1
    s_waitcnt vmcnt(3)
    v_cmp_gt_i32 vcc, s35, v184
    s_cbranch_vccz poll_18_got
    buffer_load_dword v184, v143, s[8:11], 0 offen sc1
    s_waitcnt vmcnt(3)
    v_cmp_gt_i32 vcc, s35, v185
    s_cbranch_vccz poll_18_got
    buffer_load_dword v185, v143, s[8:11], 0 offen sc1
    s_add_u32 s21, s21, 1
    s_cmp_lt_u32 s21, 100000
    s_cbranch_scc1 poll_18
    s_mov_b32 s24, 0x7000000
poll_18_got:
    s_branch L_qk_dma
L_qk_retry:
    s_cmp_eq_u32 s18, 1
    s_cbranch_scc0 L_qk_nodma
L_qk_dma:
    s_mov_b32 m0, 0
    s_nop 0
    buffer_load_dwordx4 v187, s[8:11], s52 offen offset:0 sc1 lds
    buffer_load_dwordx4 v187, s[8:11], s53 offen offset:1024 sc1 lds
    buffer_load_dwordx4 v187, s[8:11], s54 offen offset:2048 sc1 lds
    buffer_load_dwordx4 v187, s[8:11], s55 offen offset:3072 sc1 lds
    s_mov_b32 m0, 4096
    s_nop 0
    buffer_load_dwordx4 v187, s[8:11], s56 offen offset:0 sc1 lds
    buffer_load_dwordx4 v187, s[8:11], s57 offen offset:1024 sc1 lds
    buffer_load_dwordx4 v187, s[8:11], s58 offen offset:2048 sc1 lds
    buffer_load_dwordx4 v187, s[8:11], s59 offen offset:3072 sc1 lds
    s_mov_b32 m0, 8192
    s_nop 0
    buffer_load_dwordx4 v187, s[8:11], s60 offen offset:0 sc1 lds
    buffer_load_dwordx4 v187, s[8:11], s61 offen offset:1024 sc1 lds
L_qk_nodma:
    v_mov_b32 v16, 0
    v_mov_b32 v17, 0
    v_mov_b32 v18, 0
    v_mov_b32 v19, 0
    v_mov_b32 v20, 0
    v_mov_b32 v21, 0
    v_mov_b32 v22, 0
    v_mov_b32 v23, 0
    v_mov_b32 v24, 0
    v_mov_b32 v25, 0
    v_mov_b32 v26, 0
    v_mov_b32 v27, 0
    v_mov_b32 v28, 0
    v_mov_b32 v29, 0
    v_mov_b32 v30, 0
    v_mov_b32 v31, 0
    v_mov_b32 v32, 0
    v_mov_b32 v33, 0
    v_mov_b32 v34, 0
    v_mov_b32 v35, 0
    v_mov_b32 v36, 0
    v_mov_b32 v37, 0
    v_mov_b32 v38, 0
    v_mov_b32 v39, 0
    v_mov_b32 v40, 0
    v_mov_b32 v41, 0
    v_mov_b32 v42, 0
    v_mov_b32 v43, 0
    s_and_b32 s20, s16, 3
    s_lshl_b32 s28, s20, 15
    s_add_u32 s28, s28, 262144
    s_lshl_b32 s29, s20, 10
    s_add_u32 s29, s29, 163840
    s_barrier
    s_mov_b32 m0, s40
    s_nop 0
    buffer_load_dwordx4 v4, s[4:7], s42 offen offset:0 sc1 lds
    buffer_load_dwordx4 v4, s[4:7], s42 offen offset:1024 sc1 lds
    buffer_load_dwordx4 v4, s[4:7], s42 offen offset:2048 sc1 lds
    buffer_load_dwordx4 v4, s[4:7], s42 offen offset:3072 sc1 lds
    s_waitcnt vmcnt(13)
    s_barrier
    ds_read_b64_tr_b16 v[100:101], v2 offset:0
    ds_read_b64_tr_b16 v[102:103], v2 offset:512
    s_waitcnt vmcnt(11)
    s_barrier
    ds_read_b64_tr_b16 v[104:105], v2 offset:1024
    ds_read_b64_tr_b16 v[106:107], v2 offset:1536
    ds_read_b64_tr_b16 v[108:109], v2 offset:2048
    ds_read_b64_tr_b16 v[110:111], v2 offset:2560
    s_waitcnt lgkmcnt(4)
    v_smfmac_f32_16x16x64_bf16 v[16:19], v[100:103], a[0:7], v3
    s_waitcnt vmcnt(8)
    s_barrier
    ds_read_b64_tr_b16 v[112:113], v2 offset:3072
    ds_read_b64_tr_b16 v[114:115], v2 offset:3584
    v_smfmac_f32_16x16x64_bf16 v[20:23], v[100:103], a[8:15], v3
    s_waitcnt lgkmcnt(4)
    v_smfmac_f32_16x16x64_bf16 v[16:19], v[104:107], a[16:23], v3
    ds_read_b64_tr_b16 v[116:117], v2 offset:4096
    ds_read_b64_tr_b16 v[118:119], v2 offset:4608
    v_smfmac_f32_16x16x64_bf16 v[20:23], v[104:107], a[24:31], v3
    s_waitcnt lgkmcnt(4)
    v_smfmac_f32_16x16x64_bf16 v[16:19], v[108:111], a[32:39], v3
    s_waitcnt vmcnt(4)
    s_barrier
    ds_read_b64_tr_b16 v[120:121], v2 offset:5120
    ds_read_b64_tr_b16 v[122:123], v2 offset:5632
    v_smfmac_f32_16x16x64_bf16 v[20:23], v[108:111], a[40:47], v3
    s_waitcnt lgkmcnt(4)
    v_smfmac_f32_16x16x64_bf16 v[16:19], v[112:115], a[48:55], v3
    ds_read_b64_tr_b16 v[124:125], v2 offset:6144
    ds_read_b64_tr_b16 v[126:127], v2 offset:6656
    v_smfmac_f32_16x16x64_bf16 v[20:23], v[112:115], a[56:63], v3
    s_waitcnt lgkmcnt(4)
    v_smfmac_f32_16x16x64_bf16 v[16:19], v[116:119], a[64:71], v3
    ds_read_b64_tr_b16 v[128:129], v2 offset:7168
    ds_read_b64_tr_b16 v[130:131], v2 offset:7680
    v_smfmac_f32_16x16x64_bf16 v[20:23], v[116:119], a[72:79], v3
    s_waitcnt lgkmcnt(4)
    v_smfmac_f32_16x16x64_bf16 v[16:19], v[120:123], a[80:87], v3
    ds_read_b64_tr_b16 v[132:133], v2 offset:8192
    ds_read_b64_tr_b16 v[134:135], v2 offset:8704
    v_smfmac_f32_16x16x64_bf16 v[20:23], v[120:123], a[88:95], v3
    s_waitcnt lgkmcnt(4)
    v_smfmac_f32_16x16x64_bf16 v[16:19], v[124:127], a[96:103], v3
    ds_read_b64_tr_b16 v[136:137], v2 offset:9216
    ds_read_b64_tr_b16 v[138:139], v2 offset:9728
    v_smfmac_f32_16x16x64_bf16 v[20:23], v[124:127], a[104:111], v3
    s_waitcnt lgkmcnt(4)
    v_smfmac_f32_16x16x64_bf16 v[16:19], v[128:131], a[112:119], v3
    v_smfmac_f32_16x16x64_bf16 v[20:23], v[128:131], a[120:127], v3
    s_waitcnt lgkmcnt(2)
    v_smfmac_f32_16x16x64_bf16 v[16:19], v[132:135], a[128:135], v3
    v_smfmac_f32_16x16x64_bf16 v[20:23], v[132:135], a[136:143], v3
    s_waitcnt lgkmcnt(0)
    v_smfmac_f32_16x16x64_bf16 v[16:19], v[136:139], a[144:151], v3
    v_smfmac_f32_16x16x64_bf16 v[20:23], v[136:139], a[152:159], v3
    v_smfmac_f32_16x16x64_bf16 v[24:27], v[100:103], a[160:167], v3
    v_smfmac_f32_16x16x64_bf16 v[24:27], v[104:107], a[176:183], v3
    v_add_f32 v16, v16, v18
    v_smfmac_f32_16x16x64_bf16 v[24:27], v[108:111], a[192:199], v3
    v_add_f32 v17, v17, v19
    v_smfmac_f32_16x16x64_bf16 v[24:27], v[112:115], a[208:215], v3
    v_add_f32 v20, v20, v22
    v_smfmac_f32_16x16x64_bf16 v[24:27], v[116:119], a[224:231], v3
    v_add_f32 v21, v21, v23
    v_smfmac_f32_16x16x64_bf16 v[24:27], v[120:123], a[240:247], v3
    v_cvt_pk_bf16_f32 v18, v16, v17
    v_smfmac_f32_16x16x64_bf16 v[24:27], v[124:127], v[192:199], v3
    v_cvt_pk_bf16_f32 v19, v20, v21
    v_smfmac_f32_16x16x64_bf16 v[24:27], v[128:131], v[208:215], v3
    ds_write2st64_b32 v5, v18, v19 offset0:0 offset1:4
    v_smfmac_f32_16x16x64_bf16 v[24:27], v[132:135], v[224:231], v3
    v_cmp_u_f32 vcc, v16, v17
    v_smfmac_f32_16x16x64_bf16 v[24:27], v[136:139], v[240:247], v3
    v_smfmac_f32_16x16x64_bf16 v[28:31], v[100:103], a[168:175], v3
    s_cbranch_vccnz L_qk_slow
L_qk_back:
    v_smfmac_f32_16x16x64_bf16 v[28:31], v[104:107], a[184:191], v3
    v_add_f32 v24, v24, v26
    v_smfmac_f32_16x16x64_bf16 v[28:31], v[108:111], a[200:207], v3
    v_add_f32 v25, v25, v27
    v_smfmac_f32_16x16x64_bf16 v[28:31], v[112:115], a[216:223], v3
    s_waitcnt lgkmcnt(0)
    s_barrier
    v_cvt_pk_bf16_f32 v24, v24, v25
    v_smfmac_f32_16x16x64_bf16 v[28:31], v[116:119], a[232:239], v3
    ds_write_b32 v6, v24
    v_smfmac_f32_16x16x64_bf16 v[28:31], v[120:123], a[248:255], v3
    ds_read_b64_tr_b16 v[60:61], v176 offset:10240
    ds_read_b64_tr_b16 v[62:63], v176 offset:10752
    v_smfmac_f32_16x16x64_bf16 v[28:31], v[124:127], v[200:207], v3
    ds_read_b64_tr_b16 v[64:65], v176 offset:11264
    ds_read_b64_tr_b16 v[66:67], v176 offset:11776
    v_smfmac_f32_16x16x64_bf16 v[28:31], v[128:131], v[216:223], v3
    s_add_u32 s16, s16, 1
    s_cmp_lt_u32 s18, 2
    v_smfmac_f32_16x16x64_bf16 v[28:31], v[132:135], v[232:239], v3
    s_waitcnt lgkmcnt(4)
    s_barrier
    v_smfmac_f32_16x16x64_bf16 v[28:31], v[136:139], v[248:255], v3
    ds_read_b64_tr_b16 v[44:45], v7 offset:13312
    ds_read_b64_tr_b16 v[46:47], v7 offset:13376
    s_waitcnt lgkmcnt(4)
    v_smfmac_f32_16x16x64_bf16 v[32:35], v[60:63], v[68:75], v3
    ds_read_b64_tr_b16 v[48:49], v7 offset:13888
    ds_read_b64_tr_b16 v[50:51], v7 offset:13952
    s_nop 1
    v_add_f32 v28, v28, v30
    v_add_f32 v29, v29, v31
    v_cvt_pk_bf16_f32 v25, v28, v29
    ds_write_b32 v6, v25 offset:288
    s_cbranch_scc0 L_qk_xa
    v_smfmac_f32_16x16x64_bf16 v[36:39], v[60:63], v[84:91], v3
    s_waitcnt lgkmcnt(5)
    v_smfmac_f32_16x16x64_bf16 v[32:35], v[64:67], v[76:83], v3
    v_smfmac_f32_16x16x64_bf16 v[36:39], v[64:67], v[92:99], v3
    s_waitcnt lgkmcnt(0)
    s_barrier
    ds_read_b64_tr_b16 v[52:53], v7 offset:13600
    ds_read_b64_tr_b16 v[54:55], v7 offset:13664
    ds_read_b64_tr_b16 v[56:57], v7 offset:14176
    ds_read_b64_tr_b16 v[58:59], v7 offset:14240
    v_smfmac_f32_16x16x64_bf16 v[40:43], v[60:63], v[44:51], v3
    s_cmp_eq_u32 s18, 0
    s_cbranch_scc0 L_qk_u1
    v_add_f32 v32, v32, v34
    v_add_f32 v36, v36, v38
    v_max_f32 v33, v32, v36
    s_waitcnt lgkmcnt(0)
    v_smfmac_f32_16x16x64_bf16 v[40:43], v[64:67], v[52:59], v3
    v_max_f32_dpp v33, v33, v33 row_ror:8 row_mask:0xf bank_mask:0xf
    v_mul_f32 v32, s33, v32
    v_mul_f32 v36, s33, v36
    s_nop 2
    v_add_f32 v40, v40, v42
    v_max_f32 v33, v33, v40
    v_mul_f32 v40, s33, v40
    s_nop 0
    v_max_f32_dpp v33, v33, v33 row_ror:4 row_mask:0xf bank_mask:0xf
    s_nop 1
    v_max_f32_dpp v33, v33, v33 row_ror:2 row_mask:0xf bank_mask:0xf
    s_nop 1
    v_max_f32_dpp v33, v33, v33 row_ror:1 row_mask:0xf bank_mask:0xf
    v_fma_f32 v32, -v33, s33, v32
    v_fma_f32 v36, -v33, s33, v36
    v_fma_f32 v40, -v33, s33, v40
    v_exp_f32 v32, v32
    v_exp_f32 v36, v36
    v_exp_f32 v40, v40
    v_add_f32 v33, v32, v36
    v_fma_f32 v33, v40, 0.5, v33
    v_mov_b32_dpp v41, v40 quad_perm:[1,0,3,2] row_mask:0xf bank_mask:0xf
    s_nop 0
    v_add_f32_dpp v33, v33, v33 row_ror:8 row_mask:0xf bank_mask:0xf
    s_nop 1
    v_add_f32_dpp v33, v33, v33 row_ror:4 row_mask:0xf bank_mask:0xf
    s_nop 1
    v_add_f32_dpp v33, v33, v33 row_ror:2 row_mask:0xf bank_mask:0xf
    s_nop 1
    v_add_f32_dpp v33, v33, v33 row_ror:1 row_mask:0xf bank_mask:0xf
    v_rcp_f32 v33, v33
    s_nop 0
    v_mul_f32 v32, v32, v33
    v_mul_f32 v36, v36, v33
    v_mul_f32 v40, v40, v33
    v_cvt_pk_bf16_f32 v32, v32, v36
    v_mul_f32 v41, v41, v33
    buffer_store_dword v32, v8, s[8:11], s28 offen sc1
    v_cvt_pk_bf16_f32 v40, v40, v41
    buffer_store_dword v40, v9, s[8:11], s29 offen sc1
    s_branch L_qk_sm
L_qk_u1:
    v_add_f32 v32, v33, v35
    v_add_f32 v36, v37, v39
    v_max_f32 v33, v32, v36
    s_waitcnt lgkmcnt(0)
    v_smfmac_f32_16x16x64_bf16 v[40:43], v[64:67], v[52:59], v3
    v_max_f32_dpp v33, v33, v33 row_ror:8 row_mask:0xf bank_mask:0xf
    v_mul_f32 v32, s33, v32
    v_mul_f32 v36, s33, v36
    s_nop 2
    v_add_f32 v40, v41, v43
    v_max_f32 v33, v33, v40
    v_mul_f32 v40, s33, v40
    s_nop 0
    v_max_f32_dpp v33, v33, v33 row_ror:4 row_mask:0xf bank_mask:0xf
    s_nop 1
    v_max_f32_dpp v33, v33, v33 row_ror:2 row_mask:0xf bank_mask:0xf
    s_nop 1
    v_max_f32_dpp v33, v33, v33 row_ror:1 row_mask:0xf bank_mask:0xf
    v_fma_f32 v32, -v33, s33, v32
    v_fma_f32 v36, -v33, s33, v36
    v_fma_f32 v40, -v33, s33, v40
    v_exp_f32 v32, v32
    v_exp_f32 v36, v36
    v_exp_f32 v40, v40
    v_add_f32 v33, v32, v36
    v_fma_f32 v33, v40, 0.5, v33
    v_mov_b32_dpp v41, v40 quad_perm:[1,0,3,2] row_mask:0xf bank_mask:0xf
    s_nop 0
    v_add_f32_dpp v33, v33, v33 row_ror:8 row_mask:0xf bank_mask:0xf
    s_nop 1
    v_add_f32_dpp v33, v33, v33 row_ror:4 row_mask:0xf bank_mask:0xf
    s_nop 1
    v_add_f32_dpp v33, v33, v33 row_ror:2 row_mask:0xf bank_mask:0xf
    s_nop 1
    v_add_f32_dpp v33, v33, v33 row_ror:1 row_mask:0xf bank_mask:0xf
    v_rcp_f32 v33, v33
    s_nop 0
    v_mul_f32 v32, v32, v33
    v_mul_f32 v36, v36, v33
    v_mul_f32 v40, v40, v33
    v_cvt_pk_bf16_f32 v32, v32, v36
    v_mul_f32 v41, v41, v33
    buffer_store_dword v32, v8, s[8:11], s28 offen sc1
    v_cvt_pk_bf16_f32 v40, v40, v41
    buffer_store_dword v40, v9, s[8:11], s29 offen sc1
L_qk_sm:
    s_cmp_le_u32 s16, 1
    s_cbranch_scc0 L_qk_s0
    buffer_store_dword v149, v186, s[8:11], 0 offen sc1
L_qk_s0:
    s_xor_b32 s28, s28, 65536
    s_xor_b32 s29, s29, 2048
    buffer_store_dword v11, v8, s[8:11], s28 offen sc1
    buffer_store_dword v11, v9, s[8:11], s29 offen sc1
    s_waitcnt vmcnt(4)
    s_cmp_lt_u32 s16, 64
    s_cbranch_scc1 L_qk_next
    s_branch L_qk_fin
L_qk_xa:
    v_mfma_f32_16x16x32_bf16 v[36:39], v[84:87], v[160:163], 0
    v_mfma_f32_16x16x32_bf16 v[32:35], v[68:71], v[160:163], 0
    s_waitcnt lgkmcnt(0)
    s_barrier
    v_mfma_f32_16x16x32_bf16 v[36:39], v[88:91], v[164:167], v[36:39]
    v_mfma_f32_16x16x32_bf16 v[32:35], v[72:75], v[164:167], v[32:35]
    ds_read_b64_tr_b16 v[52:53], v7 offset:13600
    ds_read_b64_tr_b16 v[54:55], v7 offset:13664
    v_mfma_f32_16x16x32_bf16 v[36:39], v[92:95], v[168:171], v[36:39]
    buffer_store_dword v149, v142, s[8:11], 0 offen sc1
    ds_read_b64_tr_b16 v[56:57], v7 offset:14176
    ds_read_b64_tr_b16 v[58:59], v7 offset:14240
    v_mfma_f32_16x16x32_bf16 v[32:35], v[76:79], v[168:171], v[32:35]
    v_mfma_f32_16x16x32_bf16 v[36:39], v[96:99], v[172:175], v[36:39]
    v_mfma_f32_16x16x32_bf16 v[32:35], v[80:83], v[172:175], v[32:35]
    v_mfma_f32_16x16x32_bf16 v[40:43], v[44:47], v[160:163], 0
    v_mfma_f32_16x16x32_bf16 v[40:43], v[48:51], v[164:167], v[40:43]
    s_waitcnt lgkmcnt(0)
    v_mfma_f32_16x16x32_bf16 v[40:43], v[52:55], v[168:171], v[40:43]
    v_mfma_f32_16x16x32_bf16 v[40:43], v[56:59], v[172:175], v[40:43]
    s_nop 2
    v_cndmask_b32 v32, v178, v32, s[64:65]
    v_cndmask_b32 v33, v178, v33, s[66:67]
    v_cndmask_b32 v34, v178, v34, s[68:69]
    v_cndmask_b32 v35, v178, v35, s[70:71]
    v_cndmask_b32 v36, v178, v36, s[72:73]
    v_cndmask_b32 v37, v178, v37, s[74:75]
    v_cndmask_b32 v38, v178, v38, s[76:77]
    v_cndmask_b32 v39, v178, v39, s[78:79]
    v_max3_f32 v16, v32, v33, v34
    v_max3_f32 v17, v35, v36, v37
    v_max3_f32 v16, v16, v38, v39
    v_max3_f32 v17, v17, v40, v41
    v_max3_f32 v16, v16, v42, v43
    v_max_f32 v16, v16, v17
    v_mov_b32 v17, v16
    s_nop 1
    v_permlane32_swap_b32 v16, v17
    v_max_f32 v16, v16, v17
    v_mov_b32 v17, v16
    s_nop 1
    v_permlane16_swap_b32 v16, v17
    v_max_f32 v16, v16, v17
    v_sub_f32 v32, v32, v16
    v_sub_f32 v33, v33, v16
    v_sub_f32 v34, v34, v16
    v_sub_f32 v35, v35, v16
    v_sub_f32 v36, v36, v16
    v_sub_f32 v37, v37, v16
    v_sub_f32 v38, v38, v16
    v_sub_f32 v39, v39, v16
    v_sub_f32 v40, v40, v16
    v_sub_f32 v41, v41, v16
    v_sub_f32 v42, v42, v16
    v_sub_f32 v43, v43, v16
    v_exp_f32 v32, v32
    v_exp_f32 v33, v33
    v_exp_f32 v34, v34
    v_exp_f32 v35, v35
    v_exp_f32 v36, v36
    v_exp_f32 v37, v37
    v_exp_f32 v38, v38
    v_exp_f32 v39, v39
    v_exp_f32 v40, v40
    v_exp_f32 v41, v41
    v_exp_f32 v42, v42
    v_exp_f32 v43, v43
    v_add_f32 v17, v40, v41
    v_add_f32 v18, v42, v43
    v_add_f32 v16, v32, v33
    v_add_f32 v17, v17, v18
    v_add_f32 v16, v16, v34
    v_add_f32 v16, v16, v35
    v_add_f32 v16, v16, v36
    v_add_f32 v16, v16, v37
    v_add_f32 v16, v16, v38
    v_add_f32 v16, v16, v39
    v_fma_f32 v16, v17, 0.5, v16
    v_mov_b32 v17, v16
    s_nop 1
    v_permlane32_swap_b32 v16, v17
    v_add_f32 v16, v16, v17
    v_mov_b32 v17, v16
    s_nop 1
    v_permlane16_swap_b32 v16, v17
    v_add_f32 v16, v16, v17
    v_rcp_f32 v16, v16
    s_nop 0
    v_mul_f32 v32, v32, v16
    v_mul_f32 v33, v33, v16
    v_mul_f32 v34, v34, v16
    v_mul_f32 v35, v35, v16
    v_mul_f32 v36, v36, v16
    v_mul_f32 v37, v37, v16
    v_mul_f32 v38, v38, v16
    v_mul_f32 v39, v39, v16
    v_mul_f32 v40, v40, v16
    v_mul_f32 v41, v41, v16
    v_mul_f32 v42, v42, v16
    v_mul_f32 v43, v43, v16
    v_cvt_pk_bf16_f32 v20, v32, v36
    v_cvt_pk_bf16_f32 v21, v33, v37
    v_cvt_pk_bf16_f32 v22, v34, v38
    v_cvt_pk_bf16_f32 v23, v35, v39
    v_cvt_pk_bf16_f32 v24, v40, v41
    v_cvt_pk_bf16_f32 v26, v42, v43
    v_cvt_pk_bf16_f32 v25, v40, v41
    v_cvt_pk_bf16_f32 v27, v42, v43
    s_nop 0
    v_permlane16_swap_b32 v24, v25
    v_permlane16_swap_b32 v26, v27
    buffer_store_dwordx4 v[20:23], v4, s[4:7], s43 offen sc1
    buffer_store_dwordx4 v[24:27], v179, s[4:7], s44 offen sc1
    s_waitcnt vmcnt(2)
    s_cmp_lt_u32 s16, 64
    s_cbranch_scc1 L_qk_next
L_qk_fin:
    s_waitcnt vmcnt(0)
    s_barrier
    s_cmp_eq_u32 s16, -1
    s_cbranch_scc1 L_qk_first
    buffer_store_dword v149, v180, s[8:11], 0 offen sc1
    s_branch L_qk_end
L_qk_slow:
    v_pk_max_u16 v140, v100, v101
    v_pk_max_u16 v140, v140, v102
    v_pk_max_u16 v140, v140, v103
    v_pk_max_u16 v140, v140, v104
    v_pk_max_u16 v140, v140, v105
    v_pk_max_u16 v140, v140, v106
    v_pk_max_u16 v140, v140, v107
    v_pk_max_u16 v140, v140, v108
    v_pk_max_u16 v140, v140, v109
    v_pk_max_u16 v140, v140, v110
    v_pk_max_u16 v140, v140, v111
    v_pk_max_u16 v140, v140, v112
    v_pk_max_u16 v140, v140, v113
    v_pk_max_u16 v140, v140, v114
    v_pk_max_u16 v140, v140, v115
    v_pk_max_u16 v140, v140, v116
    v_pk_max_u16 v140, v140, v117
    v_pk_max_u16 v140, v140, v118
    v_pk_max_u16 v140, v140, v119
    v_pk_max_u16 v140, v140, v120
    v_pk_max_u16 v140, v140, v121
    v_pk_max_u16 v140, v140, v122
    v_pk_max_u16 v140, v140, v123
    v_pk_max_u16 v140, v140, v124
    v_pk_max_u16 v140, v140, v125
    v_pk_max_u16 v140, v140, v126
    v_pk_max_u16 v140, v140, v127
    v_pk_max_u16 v140, v140, v128
    v_pk_max_u16 v140, v140, v129
    v_pk_max_u16 v140, v140, v130
    v_pk_max_u16 v140, v140, v131
    v_pk_max_u16 v140, v140, v132
    v_pk_max_u16 v140, v140, v133
    v_pk_max_u16 v140, v140, v134
    v_pk_max_u16 v140, v140, v135
    v_pk_max_u16 v140, v140, v136
    v_pk_max_u16 v140, v140, v137
    v_pk_max_u16 v140, v140, v138
    v_pk_max_u16 v140, v140, v139
    v_lshrrev_b32 v141, 16, v140
    v_max_u16 v140, v140, v141
    v_and_b32 v140, 0xffff, v140
    v_cmp_eq_u32 vcc, 0xffff, v140
    s_cbranch_vccz L_qk_back
L_qk_slow_r:
    s_add_u32 s24, s24, 1
    s_cmp_gt_u32 s24, 200000
    s_cbranch_scc1 L_qk_end
    s_waitcnt lgkmcnt(0)
    s_barrier
    s_branch L_qk_retry
L_qk_end:
    s_endpgm
L_vo:
    v_and_b32 v1, 63, v0
    v_lshrrev_b32 v2, 6, v0
    s_nop 0
    v_readfirstlane_b32 s18, v2
    v_and_b32 v12, 15, v1
    v_lshrrev_b32 v13, 4, v1
    v_lshlrev_b32 v4, 4, v1
    v_mov_b32 v11, -1
    s_mov_b32 s31, 0x05040100
    s_mov_b32 s32, 0x07060302
    v_and_b32 v3, 2, v1
    v_cmp_eq_u32 vcc, 0, v3
    v_mov_b32 v3, 0xeeee
    v_mov_b32 v5, 0x4444
    v_cndmask_b32 v3, v3, v5, vcc
    v_lshrrev_b32 v2, 1, v13
    v_lshlrev_b32 v2, 8, v2
    v_and_b32 v14, 3, v12
    v_lshl_add_u32 v2, v14, 6, v2
    v_and_b32 v14, 1, v13
    v_lshl_add_u32 v2, v14, 5, v2
    v_lshrrev_b32 v14, 2, v12
    v_lshl_add_u32 v2, v14, 3, v2
    v_and_b32 v14, 1, v13
    v_lshlrev_b32 v14, 18, v14
    v_lshrrev_b32 v15, 1, v13
    v_lshlrev_b32 v15, 17, v15
    v_add_u32 v14, v14, v15
    v_lshl_add_u32 v14, v12, 2, v14
    s_lshl_b32 s20, s17, 8
    s_lshl_b32 s21, s18, 6
    s_add_u32 s20, s20, s21
    v_add_u32 v10, s20, v14
    s_mul_i32 s20, s18, 768
    s_add_u32 s20, s20, 10240
    v_mul_u32_u24 v5, 192, v13
    v_lshl_add_u32 v5, v12, 3, v5
    v_add_u32 v5, s20, v5
    v_mov_b32 v9, v10
    v_mul_u32_u24 v10, 5120, v13
    v_lshl_add_u32 v10, v12, 2, v10
    s_mul_i32 s20, s17, 163840
    s_mul_i32 s21, s18, 320
    s_add_u32 s20, s20, s21
    v_add_u32 v10, s20, v10
    s_load_dwordx2 s[12:13], s[0:1], 32
    s_mov_b32 s14, 5242880
    s_mov_b32 s15, 0x20000
    s_waitcnt lgkmcnt(0)
    s_load_dwordx2 s[92:93], s[0:1], 40
    s_mov_b32 s94, 5242880
    s_mov_b32 s95, 0x20000
    s_waitcnt lgkmcnt(0)
    v_bfe_u32 v160, v1, 2, 2
    v_lshlrev_b32 v160, 6, v160
    v_and_b32 v161, 3, v1
    v_lshl_add_u32 v160, v161, 4, v160
    v_bfe_u32 v161, v1, 4, 1
    v_lshrrev_b32 v162, 5, v1
    ds_bpermute_b32 v164, v160, v9
    v_mul_u32_u24 v163, 32768, v161
    v_mul_u32_u24 v170, 16384, v162
    s_waitcnt lgkmcnt(0)
    v_add3_u32 v164, v164, v163, v170
    ds_bpermute_b32 v165, v160, v10
    v_mul_u32_u24 v163, 1280, v161
    v_mul_u32_u24 v170, 2560, v162
    s_waitcnt lgkmcnt(0)
    v_add3_u32 v165, v165, v163, v170
    s_mul_i32 s29, s18, 20480
    s_add_u32 s29, s29, 40960
    v_lshl_add_u32 v170, v1, 2, s29
    s_add_u32 m0, s29, 0
    s_mov_b32 s30, 0
    buffer_load_dwordx4 v164, s[12:15], s30 offen lds
    s_add_u32 m0, s29, 1024
    s_mov_b32 s30, 65536
    buffer_load_dwordx4 v164, s[12:15], s30 offen lds
    s_add_u32 m0, s29, 2048
    s_mov_b32 s30, 8192
    buffer_load_dwordx4 v164, s[12:15], s30 offen lds
    s_add_u32 m0, s29, 3072
    s_mov_b32 s30, 73728
    buffer_load_dwordx4 v164, s[12:15], s30 offen lds
    s_add_u32 m0, s29, 4096
    s_mov_b32 s30, 524288
    buffer_load_dwordx4 v164, s[12:15], s30 offen lds
    s_add_u32 m0, s29, 5120
    s_mov_b32 s30, 589824
    buffer_load_dwordx4 v164, s[12:15], s30 offen lds
    s_add_u32 m0, s29, 6144
    s_mov_b32 s30, 532480
    buffer_load_dwordx4 v164, s[12:15], s30 offen lds
    s_add_u32 m0, s29, 7168
    s_mov_b32 s30, 598016
    buffer_load_dwordx4 v164, s[12:15], s30 offen lds
    s_add_u32 m0, s29, 8192
    s_mov_b32 s30, 1048576
    buffer_load_dwordx4 v164, s[12:15], s30 offen lds
    s_add_u32 m0, s29, 9216
    s_mov_b32 s30, 1114112
    buffer_load_dwordx4 v164, s[12:15], s30 offen lds
    s_add_u32 m0, s29, 10240
    s_mov_b32 s30, 1056768
    buffer_load_dwordx4 v164, s[12:15], s30 offen lds
    s_add_u32 m0, s29, 11264
    s_mov_b32 s30, 1122304
    buffer_load_dwordx4 v164, s[12:15], s30 offen lds
    s_add_u32 m0, s29, 12288
    s_mov_b32 s30, 1572864
    buffer_load_dwordx4 v164, s[12:15], s30 offen lds
    s_add_u32 m0, s29, 13312
    s_mov_b32 s30, 1638400
    buffer_load_dwordx4 v164, s[12:15], s30 offen lds
    s_add_u32 m0, s29, 14336
    s_mov_b32 s30, 1581056
    buffer_load_dwordx4 v164, s[12:15], s30 offen lds
    s_add_u32 m0, s29, 15360
    s_mov_b32 s30, 1646592
    buffer_load_dwordx4 v164, s[12:15], s30 offen lds
    s_add_u32 m0, s29, 16384
    s_mov_b32 s30, 2097152
    buffer_load_dwordx4 v164, s[12:15], s30 offen lds
    s_add_u32 m0, s29, 17408
    s_mov_b32 s30, 2162688
    buffer_load_dwordx4 v164, s[12:15], s30 offen lds
    s_add_u32 m0, s29, 18432
    s_mov_b32 s30, 2105344
    buffer_load_dwordx4 v164, s[12:15], s30 offen lds
    s_add_u32 m0, s29, 19456
    s_mov_b32 s30, 2170880
    buffer_load_dwordx4 v164, s[12:15], s30 offen lds
    s_waitcnt vmcnt(16)
    ds_read2st64_b32 v[128:129], v170 offset0:0 offset1:1
    ds_read2st64_b32 v[130:131], v170 offset0:2 offset1:3
    ds_read2st64_b32 v[132:133], v170 offset0:4 offset1:5
    ds_read2st64_b32 v[134:135], v170 offset0:6 offset1:7
    ds_read2st64_b32 v[136:137], v170 offset0:8 offset1:9
    ds_read2st64_b32 v[138:139], v170 offset0:10 offset1:11
    ds_read2st64_b32 v[140:141], v170 offset0:12 offset1:13
    ds_read2st64_b32 v[142:143], v170 offset0:14 offset1:15
    s_waitcnt lgkmcnt(0)
    s_add_u32 m0, s29, 0
    s_mov_b32 s30, 2621440
    buffer_load_dwordx4 v164, s[12:15], s30 offen lds
    s_add_u32 m0, s29, 1024
    s_mov_b32 s30, 2686976
    buffer_load_dwordx4 v164, s[12:15], s30 offen lds
    s_add_u32 m0, s29, 2048
    s_mov_b32 s30, 2629632
    buffer_load_dwordx4 v164, s[12:15], s30 offen lds
    s_add_u32 m0, s29, 3072
    s_mov_b32 s30, 2695168
    buffer_load_dwordx4 v164, s[12:15], s30 offen lds
    s_waitcnt vmcnt(16)
    ds_read2st64_b32 v[144:145], v170 offset0:16 offset1:17
    ds_read2st64_b32 v[146:147], v170 offset0:18 offset1:19
    ds_read2st64_b32 v[148:149], v170 offset0:20 offset1:21
    ds_read2st64_b32 v[150:151], v170 offset0:22 offset1:23
    ds_read2st64_b32 v[152:153], v170 offset0:24 offset1:25
    ds_read2st64_b32 v[154:155], v170 offset0:26 offset1:27
    ds_read2st64_b32 v[156:157], v170 offset0:28 offset1:29
    ds_read2st64_b32 v[158:159], v170 offset0:30 offset1:31
    v_perm_b32 v120, v129, v128, s31
    v_accvgpr_write_b32 a0, v120
    v_perm_b32 v121, v129, v128, s32
    v_accvgpr_write_b32 a8, v121
    v_perm_b32 v122, v131, v130, s31
    v_accvgpr_write_b32 a1, v122
    v_perm_b32 v123, v131, v130, s32
    v_accvgpr_write_b32 a9, v123
    v_perm_b32 v124, v133, v132, s31
    v_accvgpr_write_b32 a2, v124
    v_perm_b32 v125, v133, v132, s32
    v_accvgpr_write_b32 a10, v125
    v_perm_b32 v126, v135, v134, s31
    v_accvgpr_write_b32 a3, v126
    v_perm_b32 v127, v135, v134, s32
    v_accvgpr_write_b32 a11, v127
    v_perm_b32 v120, v137, v136, s31
    v_accvgpr_write_b32 a4, v120
    v_perm_b32 v121, v137, v136, s32
    v_accvgpr_write_b32 a12, v121
    v_perm_b32 v122, v139, v138, s31
    v_accvgpr_write_b32 a5, v122
    v_perm_b32 v123, v139, v138, s32
    v_accvgpr_write_b32 a13, v123
    v_perm_b32 v124, v141, v140, s31
    v_accvgpr_write_b32 a6, v124
    v_perm_b32 v125, v141, v140, s32
    v_accvgpr_write_b32 a14, v125
    v_perm_b32 v126, v143, v142, s31
    v_accvgpr_write_b32 a7, v126
    v_perm_b32 v127, v143, v142, s32
    v_accvgpr_write_b32 a15, v127
    s_waitcnt lgkmcnt(0)
    s_add_u32 m0, s29, 4096
    s_mov_b32 s30, 3145728
    buffer_load_dwordx4 v164, s[12:15], s30 offen lds
    s_add_u32 m0, s29, 5120
    s_mov_b32 s30, 3211264
    buffer_load_dwordx4 v164, s[12:15], s30 offen lds
    s_add_u32 m0, s29, 6144
    s_mov_b32 s30, 3153920
    buffer_load_dwordx4 v164, s[12:15], s30 offen lds
    s_add_u32 m0, s29, 7168
    s_mov_b32 s30, 3219456
    buffer_load_dwordx4 v164, s[12:15], s30 offen lds
    s_waitcnt vmcnt(16)
    ds_read2st64_b32 v[128:129], v170 offset0:32 offset1:33
    ds_read2st64_b32 v[130:131], v170 offset0:34 offset1:35
    ds_read2st64_b32 v[132:133], v170 offset0:36 offset1:37
    ds_read2st64_b32 v[134:135], v170 offset0:38 offset1:39
    ds_read2st64_b32 v[136:137], v170 offset0:40 offset1:41
    ds_read2st64_b32 v[138:139], v170 offset0:42 offset1:43
    ds_read2st64_b32 v[140:141], v170 offset0:44 offset1:45
    ds_read2st64_b32 v[142:143], v170 offset0:46 offset1:47
    v_perm_b32 v120, v145, v144, s31
    v_accvgpr_write_b32 a16, v120
    v_perm_b32 v121, v145, v144, s32
    v_accvgpr_write_b32 a24, v121
    v_perm_b32 v122, v147, v146, s31
    v_accvgpr_write_b32 a17, v122
    v_perm_b32 v123, v147, v146, s32
    v_accvgpr_write_b32 a25, v123
    v_perm_b32 v124, v149, v148, s31
    v_accvgpr_write_b32 a18, v124
    v_perm_b32 v125, v149, v148, s32
    v_accvgpr_write_b32 a26, v125
    v_perm_b32 v126, v151, v150, s31
    v_accvgpr_write_b32 a19, v126
    v_perm_b32 v127, v151, v150, s32
    v_accvgpr_write_b32 a27, v127
    v_perm_b32 v120, v153, v152, s31
    v_accvgpr_write_b32 a20, v120
    v_perm_b32 v121, v153, v152, s32
    v_accvgpr_write_b32 a28, v121
    v_perm_b32 v122, v155, v154, s31
    v_accvgpr_write_b32 a21, v122
    v_perm_b32 v123, v155, v154, s32
    v_accvgpr_write_b32 a29, v123
    v_perm_b32 v124, v157, v156, s31
    v_accvgpr_write_b32 a22, v124
    v_perm_b32 v125, v157, v156, s32
    v_accvgpr_write_b32 a30, v125
    v_perm_b32 v126, v159, v158, s31
    v_accvgpr_write_b32 a23, v126
    v_perm_b32 v127, v159, v158, s32
    v_accvgpr_write_b32 a31, v127
    s_waitcnt lgkmcnt(0)
    s_add_u32 m0, s29, 8192
    s_mov_b32 s30, 3670016
    buffer_load_dwordx4 v164, s[12:15], s30 offen lds
    s_add_u32 m0, s29, 9216
    s_mov_b32 s30, 3735552
    buffer_load_dwordx4 v164, s[12:15], s30 offen lds
    s_add_u32 m0, s29, 10240
    s_mov_b32 s30, 3678208
    buffer_load_dwordx4 v164, s[12:15], s30 offen lds
    s_add_u32 m0, s29, 11264
    s_mov_b32 s30, 3743744
    buffer_load_dwordx4 v164, s[12:15], s30 offen lds
    s_waitcnt vmcnt(16)
    ds_read2st64_b32 v[144:145], v170 offset0:48 offset1:49
    ds_read2st64_b32 v[146:147], v170 offset0:50 offset1:51
    ds_read2st64_b32 v[148:149], v170 offset0:52 offset1:53
    ds_read2st64_b32 v[150:151], v170 offset0:54 offset1:55
    ds_read2st64_b32 v[152:153], v170 offset0:56 offset1:57
    ds_read2st64_b32 v[154:155], v170 offset0:58 offset1:59
    ds_read2st64_b32 v[156:157], v170 offset0:60 offset1:61
    ds_read2st64_b32 v[158:159], v170 offset0:62 offset1:63
    v_perm_b32 v120, v129, v128, s31
    v_accvgpr_write_b32 a32, v120
    v_perm_b32 v121, v129, v128, s32
    v_accvgpr_write_b32 a40, v121
    v_perm_b32 v122, v131, v130, s31
    v_accvgpr_write_b32 a33, v122
    v_perm_b32 v123, v131, v130, s32
    v_accvgpr_write_b32 a41, v123
    v_perm_b32 v124, v133, v132, s31
    v_accvgpr_write_b32 a34, v124
    v_perm_b32 v125, v133, v132, s32
    v_accvgpr_write_b32 a42, v125
    v_perm_b32 v126, v135, v134, s31
    v_accvgpr_write_b32 a35, v126
    v_perm_b32 v127, v135, v134, s32
    v_accvgpr_write_b32 a43, v127
    v_perm_b32 v120, v137, v136, s31
    v_accvgpr_write_b32 a36, v120
    v_perm_b32 v121, v137, v136, s32
    v_accvgpr_write_b32 a44, v121
    v_perm_b32 v122, v139, v138, s31
    v_accvgpr_write_b32 a37, v122
    v_perm_b32 v123, v139, v138, s32
    v_accvgpr_write_b32 a45, v123
    v_perm_b32 v124, v141, v140, s31
    v_accvgpr_write_b32 a38, v124
    v_perm_b32 v125, v141, v140, s32
    v_accvgpr_write_b32 a46, v125
    v_perm_b32 v126, v143, v142, s31
    v_accvgpr_write_b32 a39, v126
    v_perm_b32 v127, v143, v142, s32
    v_accvgpr_write_b32 a47, v127
    s_waitcnt lgkmcnt(0)
    s_add_u32 m0, s29, 12288
    s_mov_b32 s30, 4194304
    buffer_load_dwordx4 v164, s[12:15], s30 offen lds
    s_add_u32 m0, s29, 13312
    s_mov_b32 s30, 4259840
    buffer_load_dwordx4 v164, s[12:15], s30 offen lds
    s_add_u32 m0, s29, 14336
    s_mov_b32 s30, 4202496
    buffer_load_dwordx4 v164, s[12:15], s30 offen lds
    s_add_u32 m0, s29, 15360
    s_mov_b32 s30, 4268032
    buffer_load_dwordx4 v164, s[12:15], s30 offen lds
    s_waitcnt vmcnt(16)
    ds_read2st64_b32 v[128:129], v170 offset0:64 offset1:65
    ds_read2st64_b32 v[130:131], v170 offset0:66 offset1:67
    ds_read2st64_b32 v[132:133], v170 offset0:68 offset1:69
    ds_read2st64_b32 v[134:135], v170 offset0:70 offset1:71
    ds_read2st64_b32 v[136:137], v170 offset0:72 offset1:73
    ds_read2st64_b32 v[138:139], v170 offset0:74 offset1:75
    ds_read2st64_b32 v[140:141], v170 offset0:76 offset1:77
    ds_read2st64_b32 v[142:143], v170 offset0:78 offset1:79
    v_perm_b32 v120, v145, v144, s31
    v_accvgpr_write_b32 a48, v120
    v_perm_b32 v121, v145, v144, s32
    v_accvgpr_write_b32 a56, v121
    v_perm_b32 v122, v147, v146, s31
    v_accvgpr_write_b32 a49, v122
    v_perm_b32 v123, v147, v146, s32
    v_accvgpr_write_b32 a57, v123
    v_perm_b32 v124, v149, v148, s31
    v_accvgpr_write_b32 a50, v124
    v_perm_b32 v125, v149, v148, s32
    v_accvgpr_write_b32 a58, v125
    v_perm_b32 v126, v151, v150, s31
    v_accvgpr_write_b32 a51, v126
    v_perm_b32 v127, v151, v150, s32
    v_accvgpr_write_b32 a59, v127
    v_perm_b32 v120, v153, v152, s31
    v_accvgpr_write_b32 a52, v120
    v_perm_b32 v121, v153, v152, s32
    v_accvgpr_write_b32 a60, v121
    v_perm_b32 v122, v155, v154, s31
    v_accvgpr_write_b32 a53, v122
    v_perm_b32 v123, v155, v154, s32
    v_accvgpr_write_b32 a61, v123
    v_perm_b32 v124, v157, v156, s31
    v_accvgpr_write_b32 a54, v124
    v_perm_b32 v125, v157, v156, s32
    v_accvgpr_write_b32 a62, v125
    v_perm_b32 v126, v159, v158, s31
    v_accvgpr_write_b32 a55, v126
    v_perm_b32 v127, v159, v158, s32
    v_accvgpr_write_b32 a63, v127
    s_waitcnt lgkmcnt(0)
    s_add_u32 m0, s29, 16384
    s_mov_b32 s30, 4718592
    buffer_load_dwordx4 v164, s[12:15], s30 offen lds
    s_add_u32 m0, s29, 17408
    s_mov_b32 s30, 4784128
    buffer_load_dwordx4 v164, s[12:15], s30 offen lds
    s_add_u32 m0, s29, 18432
    s_mov_b32 s30, 4726784
    buffer_load_dwordx4 v164, s[12:15], s30 offen lds
    s_add_u32 m0, s29, 19456
    s_mov_b32 s30, 4792320
    buffer_load_dwordx4 v164, s[12:15], s30 offen lds
    s_waitcnt vmcnt(16)
    ds_read2st64_b32 v[144:145], v170 offset0:0 offset1:1
    ds_read2st64_b32 v[146:147], v170 offset0:2 offset1:3
    ds_read2st64_b32 v[148:149], v170 offset0:4 offset1:5
    ds_read2st64_b32 v[150:151], v170 offset0:6 offset1:7
    ds_read2st64_b32 v[152:153], v170 offset0:8 offset1:9
    ds_read2st64_b32 v[154:155], v170 offset0:10 offset1:11
    ds_read2st64_b32 v[156:157], v170 offset0:12 offset1:13
    ds_read2st64_b32 v[158:159], v170 offset0:14 offset1:15
    v_perm_b32 v120, v129, v128, s31
    v_accvgpr_write_b32 a64, v120
    v_perm_b32 v121, v129, v128, s32
    v_accvgpr_write_b32 a72, v121
    v_perm_b32 v122, v131, v130, s31
    v_accvgpr_write_b32 a65, v122
    v_perm_b32 v123, v131, v130, s32
    v_accvgpr_write_b32 a73, v123
    v_perm_b32 v124, v133, v132, s31
    v_accvgpr_write_b32 a66, v124
    v_perm_b32 v125, v133, v132, s32
    v_accvgpr_write_b32 a74, v125
    v_perm_b32 v126, v135, v134, s31
    v_accvgpr_write_b32 a67, v126
    v_perm_b32 v127, v135, v134, s32
    v_accvgpr_write_b32 a75, v127
    v_perm_b32 v120, v137, v136, s31
    v_accvgpr_write_b32 a68, v120
    v_perm_b32 v121, v137, v136, s32
    v_accvgpr_write_b32 a76, v121
    v_perm_b32 v122, v139, v138, s31
    v_accvgpr_write_b32 a69, v122
    v_perm_b32 v123, v139, v138, s32
    v_accvgpr_write_b32 a77, v123
    v_perm_b32 v124, v141, v140, s31
    v_accvgpr_write_b32 a70, v124
    v_perm_b32 v125, v141, v140, s32
    v_accvgpr_write_b32 a78, v125
    v_perm_b32 v126, v143, v142, s31
    v_accvgpr_write_b32 a71, v126
    v_perm_b32 v127, v143, v142, s32
    v_accvgpr_write_b32 a79, v127
    s_waitcnt lgkmcnt(0)
    s_add_u32 m0, s29, 0
    s_mov_b32 s30, 0
    buffer_load_dwordx4 v165, s[92:95], s30 offen lds
    s_add_u32 m0, s29, 1024
    s_mov_b32 s30, 64
    buffer_load_dwordx4 v165, s[92:95], s30 offen lds
    s_add_u32 m0, s29, 2048
    s_mov_b32 s30, 128
    buffer_load_dwordx4 v165, s[92:95], s30 offen lds
    s_add_u32 m0, s29, 3072
    s_mov_b32 s30, 192
    buffer_load_dwordx4 v165, s[92:95], s30 offen lds
    s_waitcnt vmcnt(16)
    ds_read2st64_b32 v[128:129], v170 offset0:16 offset1:17
    ds_read2st64_b32 v[130:131], v170 offset0:18 offset1:19
    ds_read2st64_b32 v[132:133], v170 offset0:20 offset1:21
    ds_read2st64_b32 v[134:135], v170 offset0:22 offset1:23
    ds_read2st64_b32 v[136:137], v170 offset0:24 offset1:25
    ds_read2st64_b32 v[138:139], v170 offset0:26 offset1:27
    ds_read2st64_b32 v[140:141], v170 offset0:28 offset1:29
    ds_read2st64_b32 v[142:143], v170 offset0:30 offset1:31
    v_perm_b32 v120, v145, v144, s31
    v_accvgpr_write_b32 a80, v120
    v_perm_b32 v121, v145, v144, s32
    v_accvgpr_write_b32 a88, v121
    v_perm_b32 v122, v147, v146, s31
    v_accvgpr_write_b32 a81, v122
    v_perm_b32 v123, v147, v146, s32
    v_accvgpr_write_b32 a89, v123
    v_perm_b32 v124, v149, v148, s31
    v_accvgpr_write_b32 a82, v124
    v_perm_b32 v125, v149, v148, s32
    v_accvgpr_write_b32 a90, v125
    v_perm_b32 v126, v151, v150, s31
    v_accvgpr_write_b32 a83, v126
    v_perm_b32 v127, v151, v150, s32
    v_accvgpr_write_b32 a91, v127
    v_perm_b32 v120, v153, v152, s31
    v_accvgpr_write_b32 a84, v120
    v_perm_b32 v121, v153, v152, s32
    v_accvgpr_write_b32 a92, v121
    v_perm_b32 v122, v155, v154, s31
    v_accvgpr_write_b32 a85, v122
    v_perm_b32 v123, v155, v154, s32
    v_accvgpr_write_b32 a93, v123
    v_perm_b32 v124, v157, v156, s31
    v_accvgpr_write_b32 a86, v124
    v_perm_b32 v125, v157, v156, s32
    v_accvgpr_write_b32 a94, v125
    v_perm_b32 v126, v159, v158, s31
    v_accvgpr_write_b32 a87, v126
    v_perm_b32 v127, v159, v158, s32
    v_accvgpr_write_b32 a95, v127
    s_waitcnt lgkmcnt(0)
    s_add_u32 m0, s29, 4096
    s_mov_b32 s30, 256
    buffer_load_dwordx4 v165, s[92:95], s30 offen lds
    s_add_u32 m0, s29, 5120
    s_mov_b32 s30, 20480
    buffer_load_dwordx4 v165, s[92:95], s30 offen lds
    s_add_u32 m0, s29, 6144
    s_mov_b32 s30, 20544
    buffer_load_dwordx4 v165, s[92:95], s30 offen lds
    s_add_u32 m0, s29, 7168
    s_mov_b32 s30, 20608
    buffer_load_dwordx4 v165, s[92:95], s30 offen lds
    s_waitcnt vmcnt(16)
    ds_read2st64_b32 v[144:145], v170 offset0:32 offset1:33
    ds_read2st64_b32 v[146:147], v170 offset0:34 offset1:35
    ds_read2st64_b32 v[148:149], v170 offset0:36 offset1:37
    ds_read2st64_b32 v[150:151], v170 offset0:38 offset1:39
    ds_read2st64_b32 v[152:153], v170 offset0:40 offset1:41
    ds_read2st64_b32 v[154:155], v170 offset0:42 offset1:43
    ds_read2st64_b32 v[156:157], v170 offset0:44 offset1:45
    ds_read2st64_b32 v[158:159], v170 offset0:46 offset1:47
    v_perm_b32 v120, v129, v128, s31
    v_accvgpr_write_b32 a96, v120
    v_perm_b32 v121, v129, v128, s32
    v_accvgpr_write_b32 a104, v121
    v_perm_b32 v122, v131, v130, s31
    v_accvgpr_write_b32 a97, v122
    v_perm_b32 v123, v131, v130, s32
    v_accvgpr_write_b32 a105, v123
    v_perm_b32 v124, v133, v132, s31
    v_accvgpr_write_b32 a98, v124
    v_perm_b32 v125, v133, v132, s32
    v_accvgpr_write_b32 a106, v125
    v_perm_b32 v126, v135, v134, s31
    v_accvgpr_write_b32 a99, v126
    v_perm_b32 v127, v135, v134, s32
    v_accvgpr_write_b32 a107, v127
    v_perm_b32 v120, v137, v136, s31
    v_accvgpr_write_b32 a100, v120
    v_perm_b32 v121, v137, v136, s32
    v_accvgpr_write_b32 a108, v121
    v_perm_b32 v122, v139, v138, s31
    v_accvgpr_write_b32 a101, v122
    v_perm_b32 v123, v139, v138, s32
    v_accvgpr_write_b32 a109, v123
    v_perm_b32 v124, v141, v140, s31
    v_accvgpr_write_b32 a102, v124
    v_perm_b32 v125, v141, v140, s32
    v_accvgpr_write_b32 a110, v125
    v_perm_b32 v126, v143, v142, s31
    v_accvgpr_write_b32 a103, v126
    v_perm_b32 v127, v143, v142, s32
    v_accvgpr_write_b32 a111, v127
    s_waitcnt lgkmcnt(0)
    s_add_u32 m0, s29, 8192
    s_mov_b32 s30, 20672
    buffer_load_dwordx4 v165, s[92:95], s30 offen lds
    s_add_u32 m0, s29, 9216
    s_mov_b32 s30, 20736
    buffer_load_dwordx4 v165, s[92:95], s30 offen lds
    s_add_u32 m0, s29, 10240
    s_mov_b32 s30, 40960
    buffer_load_dwordx4 v165, s[92:95], s30 offen lds
    s_add_u32 m0, s29, 11264
    s_mov_b32 s30, 41024
    buffer_load_dwordx4 v165, s[92:95], s30 offen lds
    s_waitcnt vmcnt(16)
    ds_read2st64_b32 v[128:129], v170 offset0:48 offset1:49
    ds_read2st64_b32 v[130:131], v170 offset0:50 offset1:51
    ds_read2st64_b32 v[132:133], v170 offset0:52 offset1:53
    ds_read2st64_b32 v[134:135], v170 offset0:54 offset1:55
    ds_read2st64_b32 v[136:137], v170 offset0:56 offset1:57
    ds_read2st64_b32 v[138:139], v170 offset0:58 offset1:59
    ds_read2st64_b32 v[140:141], v170 offset0:60 offset1:61
    ds_read2st64_b32 v[142:143], v170 offset0:62 offset1:63
    v_perm_b32 v120, v145, v144, s31
    v_accvgpr_write_b32 a112, v120
    v_perm_b32 v121, v145, v144, s32
    v_accvgpr_write_b32 a120, v121
    v_perm_b32 v122, v147, v146, s31
    v_accvgpr_write_b32 a113, v122
    v_perm_b32 v123, v147, v146, s32
    v_accvgpr_write_b32 a121, v123
    v_perm_b32 v124, v149, v148, s31
    v_accvgpr_write_b32 a114, v124
    v_perm_b32 v125, v149, v148, s32
    v_accvgpr_write_b32 a122, v125
    v_perm_b32 v126, v151, v150, s31
    v_accvgpr_write_b32 a115, v126
    v_perm_b32 v127, v151, v150, s32
    v_accvgpr_write_b32 a123, v127
    v_perm_b32 v120, v153, v152, s31
    v_accvgpr_write_b32 a116, v120
    v_perm_b32 v121, v153, v152, s32
    v_accvgpr_write_b32 a124, v121
    v_perm_b32 v122, v155, v154, s31
    v_accvgpr_write_b32 a117, v122
    v_perm_b32 v123, v155, v154, s32
    v_accvgpr_write_b32 a125, v123
    v_perm_b32 v124, v157, v156, s31
    v_accvgpr_write_b32 a118, v124
    v_perm_b32 v125, v157, v156, s32
    v_accvgpr_write_b32 a126, v125
    v_perm_b32 v126, v159, v158, s31
    v_accvgpr_write_b32 a119, v126
    v_perm_b32 v127, v159, v158, s32
    v_accvgpr_write_b32 a127, v127
    s_waitcnt lgkmcnt(0)
    s_add_u32 m0, s29, 12288
    s_mov_b32 s30, 41088
    buffer_load_dwordx4 v165, s[92:95], s30 offen lds
    s_add_u32 m0, s29, 13312
    s_mov_b32 s30, 41152
    buffer_load_dwordx4 v165, s[92:95], s30 offen lds
    s_add_u32 m0, s29, 14336
    s_mov_b32 s30, 41216
    buffer_load_dwordx4 v165, s[92:95], s30 offen lds
    s_add_u32 m0, s29, 15360
    s_mov_b32 s30, 61440
    buffer_load_dwordx4 v165, s[92:95], s30 offen lds
    s_waitcnt vmcnt(16)
    ds_read2st64_b32 v[144:145], v170 offset0:64 offset1:65
    ds_read2st64_b32 v[146:147], v170 offset0:66 offset1:67
    ds_read2st64_b32 v[148:149], v170 offset0:68 offset1:69
    ds_read2st64_b32 v[150:151], v170 offset0:70 offset1:71
    ds_read2st64_b32 v[152:153], v170 offset0:72 offset1:73
    ds_read2st64_b32 v[154:155], v170 offset0:74 offset1:75
    ds_read2st64_b32 v[156:157], v170 offset0:76 offset1:77
    ds_read2st64_b32 v[158:159], v170 offset0:78 offset1:79
    v_perm_b32 v120, v129, v128, s31
    v_accvgpr_write_b32 a128, v120
    v_perm_b32 v121, v129, v128, s32
    v_accvgpr_write_b32 a136, v121
    v_perm_b32 v122, v131, v130, s31
    v_accvgpr_write_b32 a129, v122
    v_perm_b32 v123, v131, v130, s32
    v_accvgpr_write_b32 a137, v123
    v_perm_b32 v124, v133, v132, s31
    v_accvgpr_write_b32 a130, v124
    v_perm_b32 v125, v133, v132, s32
    v_accvgpr_write_b32 a138, v125
    v_perm_b32 v126, v135, v134, s31
    v_accvgpr_write_b32 a131, v126
    v_perm_b32 v127, v135, v134, s32
    v_accvgpr_write_b32 a139, v127
    v_perm_b32 v120, v137, v136, s31
    v_accvgpr_write_b32 a132, v120
    v_perm_b32 v121, v137, v136, s32
    v_accvgpr_write_b32 a140, v121
    v_perm_b32 v122, v139, v138, s31
    v_accvgpr_write_b32 a133, v122
    v_perm_b32 v123, v139, v138, s32
    v_accvgpr_write_b32 a141, v123
    v_perm_b32 v124, v141, v140, s31
    v_accvgpr_write_b32 a134, v124
    v_perm_b32 v125, v141, v140, s32
    v_accvgpr_write_b32 a142, v125
    v_perm_b32 v126, v143, v142, s31
    v_accvgpr_write_b32 a135, v126
    v_perm_b32 v127, v143, v142, s32
    v_accvgpr_write_b32 a143, v127
    s_waitcnt lgkmcnt(0)
    s_add_u32 m0, s29, 16384
    s_mov_b32 s30, 61504
    buffer_load_dwordx4 v165, s[92:95], s30 offen lds
    s_add_u32 m0, s29, 17408
    s_mov_b32 s30, 61568
    buffer_load_dwordx4 v165, s[92:95], s30 offen lds
    s_add_u32 m0, s29, 18432
    s_mov_b32 s30, 61632
    buffer_load_dwordx4 v165, s[92:95], s30 offen lds
    s_add_u32 m0, s29, 19456
    s_mov_b32 s30, 61696
    buffer_load_dwordx4 v165, s[92:95], s30 offen lds
    s_waitcnt vmcnt(16)
    ds_read2st64_b32 v[128:129], v170 offset0:0 offset1:1
    ds_read2st64_b32 v[130:131], v170 offset0:2 offset1:3
    ds_read2st64_b32 v[132:133], v170 offset0:4 offset1:5
    ds_read2st64_b32 v[134:135], v170 offset0:6 offset1:7
    ds_read2st64_b32 v[136:137], v170 offset0:8 offset1:9
    ds_read2st64_b32 v[138:139], v170 offset0:10 offset1:11
    ds_read2st64_b32 v[140:141], v170 offset0:12 offset1:13
    ds_read2st64_b32 v[142:143], v170 offset0:14 offset1:15
    v_perm_b32 v120, v145, v144, s31
    v_accvgpr_write_b32 a144, v120
    v_perm_b32 v121, v145, v144, s32
    v_accvgpr_write_b32 a152, v121
    v_perm_b32 v122, v147, v146, s31
    v_accvgpr_write_b32 a145, v122
    v_perm_b32 v123, v147, v146, s32
    v_accvgpr_write_b32 a153, v123
    v_perm_b32 v124, v149, v148, s31
    v_accvgpr_write_b32 a146, v124
    v_perm_b32 v125, v149, v148, s32
    v_accvgpr_write_b32 a154, v125
    v_perm_b32 v126, v151, v150, s31
    v_accvgpr_write_b32 a147, v126
    v_perm_b32 v127, v151, v150, s32
    v_accvgpr_write_b32 a155, v127
    v_perm_b32 v120, v153, v152, s31
    v_accvgpr_write_b32 a148, v120
    v_perm_b32 v121, v153, v152, s32
    v_accvgpr_write_b32 a156, v121
    v_perm_b32 v122, v155, v154, s31
    v_accvgpr_write_b32 a149, v122
    v_perm_b32 v123, v155, v154, s32
    v_accvgpr_write_b32 a157, v123
    v_perm_b32 v124, v157, v156, s31
    v_accvgpr_write_b32 a150, v124
    v_perm_b32 v125, v157, v156, s32
    v_accvgpr_write_b32 a158, v125
    v_perm_b32 v126, v159, v158, s31
    v_accvgpr_write_b32 a151, v126
    v_perm_b32 v127, v159, v158, s32
    v_accvgpr_write_b32 a159, v127
    s_waitcnt lgkmcnt(0)
    s_add_u32 m0, s29, 0
    s_mov_b32 s30, 81920
    buffer_load_dwordx4 v165, s[92:95], s30 offen lds
    s_add_u32 m0, s29, 1024
    s_mov_b32 s30, 81984
    buffer_load_dwordx4 v165, s[92:95], s30 offen lds
    s_add_u32 m0, s29, 2048
    s_mov_b32 s30, 82048
    buffer_load_dwordx4 v165, s[92:95], s30 offen lds
    s_add_u32 m0, s29, 3072
    s_mov_b32 s30, 82112
    buffer_load_dwordx4 v165, s[92:95], s30 offen lds
    s_waitcnt vmcnt(16)
    ds_read2st64_b32 v[144:145], v170 offset0:16 offset1:17
    ds_read2st64_b32 v[146:147], v170 offset0:18 offset1:19
    ds_read2st64_b32 v[148:149], v170 offset0:20 offset1:21
    ds_read2st64_b32 v[150:151], v170 offset0:22 offset1:23
    ds_read2st64_b32 v[152:153], v170 offset0:24 offset1:25
    ds_read2st64_b32 v[154:155], v170 offset0:26 offset1:27
    ds_read2st64_b32 v[156:157], v170 offset0:28 offset1:29
    ds_read2st64_b32 v[158:159], v170 offset0:30 offset1:31
    v_perm_b32 v120, v129, v128, s31
    v_accvgpr_write_b32 a160, v120
    v_perm_b32 v121, v129, v128, s32
    v_accvgpr_write_b32 a161, v121
    v_perm_b32 v122, v131, v130, s31
    v_accvgpr_write_b32 a162, v122
    v_perm_b32 v123, v131, v130, s32
    v_accvgpr_write_b32 a163, v123
    v_perm_b32 v124, v133, v132, s31
    v_accvgpr_write_b32 a192, v124
    v_perm_b32 v125, v133, v132, s32
    v_accvgpr_write_b32 a193, v125
    v_perm_b32 v126, v135, v134, s31
    v_accvgpr_write_b32 a194, v126
    v_perm_b32 v127, v135, v134, s32
    v_accvgpr_write_b32 a195, v127
    v_perm_b32 v120, v137, v136, s31
    v_accvgpr_write_b32 a224, v120
    v_perm_b32 v121, v137, v136, s32
    v_accvgpr_write_b32 a225, v121
    v_perm_b32 v122, v139, v138, s31
    v_accvgpr_write_b32 a226, v122
    v_perm_b32 v123, v139, v138, s32
    v_accvgpr_write_b32 a227, v123
    v_perm_b32 v192, v141, v140, s31
    v_perm_b32 v193, v141, v140, s32
    v_perm_b32 v194, v143, v142, s31
    v_perm_b32 v195, v143, v142, s32
    s_waitcnt lgkmcnt(0)
    s_add_u32 m0, s29, 4096
    s_mov_b32 s30, 82176
    buffer_load_dwordx4 v165, s[92:95], s30 offen lds
    s_add_u32 m0, s29, 5120
    s_mov_b32 s30, 102400
    buffer_load_dwordx4 v165, s[92:95], s30 offen lds
    s_add_u32 m0, s29, 6144
    s_mov_b32 s30, 102464
    buffer_load_dwordx4 v165, s[92:95], s30 offen lds
    s_add_u32 m0, s29, 7168
    s_mov_b32 s30, 102528
    buffer_load_dwordx4 v165, s[92:95], s30 offen lds
    s_waitcnt vmcnt(16)
    ds_read2st64_b32 v[128:129], v170 offset0:32 offset1:33
    ds_read2st64_b32 v[130:131], v170 offset0:34 offset1:35
    ds_read2st64_b32 v[132:133], v170 offset0:36 offset1:37
    ds_read2st64_b32 v[134:135], v170 offset0:38 offset1:39
    ds_read2st64_b32 v[136:137], v170 offset0:40 offset1:41
    ds_read2st64_b32 v[138:139], v170 offset0:42 offset1:43
    ds_read2st64_b32 v[140:141], v170 offset0:44 offset1:45
    ds_read2st64_b32 v[142:143], v170 offset0:46 offset1:47
    v_perm_b32 v224, v145, v144, s31
    v_perm_b32 v225, v145, v144, s32
    v_perm_b32 v226, v147, v146, s31
    v_perm_b32 v227, v147, v146, s32
    v_perm_b32 v124, v149, v148, s31
    v_accvgpr_write_b32 a164, v124
    v_perm_b32 v125, v149, v148, s32
    v_accvgpr_write_b32 a165, v125
    v_perm_b32 v126, v151, v150, s31
    v_accvgpr_write_b32 a166, v126
    v_perm_b32 v127, v151, v150, s32
    v_accvgpr_write_b32 a167, v127
    v_perm_b32 v120, v153, v152, s31
    v_accvgpr_write_b32 a196, v120
    v_perm_b32 v121, v153, v152, s32
    v_accvgpr_write_b32 a197, v121
    v_perm_b32 v122, v155, v154, s31
    v_accvgpr_write_b32 a198, v122
    v_perm_b32 v123, v155, v154, s32
    v_accvgpr_write_b32 a199, v123
    v_perm_b32 v124, v157, v156, s31
    v_accvgpr_write_b32 a228, v124
    v_perm_b32 v125, v157, v156, s32
    v_accvgpr_write_b32 a229, v125
    v_perm_b32 v126, v159, v158, s31
    v_accvgpr_write_b32 a230, v126
    v_perm_b32 v127, v159, v158, s32
    v_accvgpr_write_b32 a231, v127
    s_waitcnt lgkmcnt(0)
    s_add_u32 m0, s29, 8192
    s_mov_b32 s30, 102592
    buffer_load_dwordx4 v165, s[92:95], s30 offen lds
    s_add_u32 m0, s29, 9216
    s_mov_b32 s30, 102656
    buffer_load_dwordx4 v165, s[92:95], s30 offen lds
    s_add_u32 m0, s29, 10240
    s_mov_b32 s30, 122880
    buffer_load_dwordx4 v165, s[92:95], s30 offen lds
    s_add_u32 m0, s29, 11264
    s_mov_b32 s30, 122944
    buffer_load_dwordx4 v165, s[92:95], s30 offen lds
    s_waitcnt vmcnt(16)
    ds_read2st64_b32 v[144:145], v170 offset0:48 offset1:49
    ds_read2st64_b32 v[146:147], v170 offset0:50 offset1:51
    ds_read2st64_b32 v[148:149], v170 offset0:52 offset1:53
    ds_read2st64_b32 v[150:151], v170 offset0:54 offset1:55
    ds_read2st64_b32 v[152:153], v170 offset0:56 offset1:57
    ds_read2st64_b32 v[154:155], v170 offset0:58 offset1:59
    ds_read2st64_b32 v[156:157], v170 offset0:60 offset1:61
    ds_read2st64_b32 v[158:159], v170 offset0:62 offset1:63
    v_perm_b32 v196, v129, v128, s31
    v_perm_b32 v197, v129, v128, s32
    v_perm_b32 v198, v131, v130, s31
    v_perm_b32 v199, v131, v130, s32
    v_perm_b32 v228, v133, v132, s31
    v_perm_b32 v229, v133, v132, s32
    v_perm_b32 v230, v135, v134, s31
    v_perm_b32 v231, v135, v134, s32
    v_perm_b32 v120, v137, v136, s31
    v_accvgpr_write_b32 a168, v120
    v_perm_b32 v121, v137, v136, s32
    v_accvgpr_write_b32 a169, v121
    v_perm_b32 v122, v139, v138, s31
    v_accvgpr_write_b32 a170, v122
    v_perm_b32 v123, v139, v138, s32
    v_accvgpr_write_b32 a171, v123
    v_perm_b32 v124, v141, v140, s31
    v_accvgpr_write_b32 a200, v124
    v_perm_b32 v125, v141, v140, s32
    v_accvgpr_write_b32 a201, v125
    v_perm_b32 v126, v143, v142, s31
    v_accvgpr_write_b32 a202, v126
    v_perm_b32 v127, v143, v142, s32
    v_accvgpr_write_b32 a203, v127
    s_waitcnt lgkmcnt(0)
    s_add_u32 m0, s29, 12288
    s_mov_b32 s30, 123008
    buffer_load_dwordx4 v165, s[92:95], s30 offen lds
    s_add_u32 m0, s29, 13312
    s_mov_b32 s30, 123072
    buffer_load_dwordx4 v165, s[92:95], s30 offen lds
    s_add_u32 m0, s29, 14336
    s_mov_b32 s30, 123136
    buffer_load_dwordx4 v165, s[92:95], s30 offen lds
    s_add_u32 m0, s29, 15360
    s_mov_b32 s30, 143360
    buffer_load_dwordx4 v165, s[92:95], s30 offen lds
    s_waitcnt vmcnt(16)
    ds_read2st64_b32 v[128:129], v170 offset0:64 offset1:65
    ds_read2st64_b32 v[130:131], v170 offset0:66 offset1:67
    ds_read2st64_b32 v[132:133], v170 offset0:68 offset1:69
    ds_read2st64_b32 v[134:135], v170 offset0:70 offset1:71
    ds_read2st64_b32 v[136:137], v170 offset0:72 offset1:73
    ds_read2st64_b32 v[138:139], v170 offset0:74 offset1:75
    ds_read2st64_b32 v[140:141], v170 offset0:76 offset1:77
    ds_read2st64_b32 v[142:143], v170 offset0:78 offset1:79
    v_perm_b32 v120, v145, v144, s31
    v_accvgpr_write_b32 a232, v120
    v_perm_b32 v121, v145, v144, s32
    v_accvgpr_write_b32 a233, v121
    v_perm_b32 v122, v147, v146, s31
    v_accvgpr_write_b32 a234, v122
    v_perm_b32 v123, v147, v146, s32
    v_accvgpr_write_b32 a235, v123
    v_perm_b32 v200, v149, v148, s31
    v_perm_b32 v201, v149, v148, s32
    v_perm_b32 v202, v151, v150, s31
    v_perm_b32 v203, v151, v150, s32
    v_perm_b32 v232, v153, v152, s31
    v_perm_b32 v233, v153, v152, s32
    v_perm_b32 v234, v155, v154, s31
    v_perm_b32 v235, v155, v154, s32
    v_perm_b32 v124, v157, v156, s31
    v_accvgpr_write_b32 a172, v124
    v_perm_b32 v125, v157, v156, s32
    v_accvgpr_write_b32 a173, v125
    v_perm_b32 v126, v159, v158, s31
    v_accvgpr_write_b32 a174, v126
    v_perm_b32 v127, v159, v158, s32
    v_accvgpr_write_b32 a175, v127
    s_waitcnt lgkmcnt(0)
    s_add_u32 m0, s29, 16384
    s_mov_b32 s30, 143424
    buffer_load_dwordx4 v165, s[92:95], s30 offen lds
    s_add_u32 m0, s29, 17408
    s_mov_b32 s30, 143488
    buffer_load_dwordx4 v165, s[92:95], s30 offen lds
    s_add_u32 m0, s29, 18432
    s_mov_b32 s30, 143552
    buffer_load_dwordx4 v165, s[92:95], s30 offen lds
    s_add_u32 m0, s29, 19456
    s_mov_b32 s30, 143616
    buffer_load_dwordx4 v165, s[92:95], s30 offen lds
    s_waitcnt vmcnt(16)
    ds_read2st64_b32 v[144:145], v170 offset0:0 offset1:1
    ds_read2st64_b32 v[146:147], v170 offset0:2 offset1:3
    ds_read2st64_b32 v[148:149], v170 offset0:4 offset1:5
    ds_read2st64_b32 v[150:151], v170 offset0:6 offset1:7
    ds_read2st64_b32 v[152:153], v170 offset0:8 offset1:9
    ds_read2st64_b32 v[154:155], v170 offset0:10 offset1:11
    ds_read2st64_b32 v[156:157], v170 offset0:12 offset1:13
    ds_read2st64_b32 v[158:159], v170 offset0:14 offset1:15
    v_perm_b32 v120, v129, v128, s31
    v_accvgpr_write_b32 a204, v120
    v_perm_b32 v121, v129, v128, s32
    v_accvgpr_write_b32 a205, v121
    v_perm_b32 v122, v131, v130, s31
    v_accvgpr_write_b32 a206, v122
    v_perm_b32 v123, v131, v130, s32
    v_accvgpr_write_b32 a207, v123
    v_perm_b32 v124, v133, v132, s31
    v_accvgpr_write_b32 a236, v124
    v_perm_b32 v125, v133, v132, s32
    v_accvgpr_write_b32 a237, v125
    v_perm_b32 v126, v135, v134, s31
    v_accvgpr_write_b32 a238, v126
    v_perm_b32 v127, v135, v134, s32
    v_accvgpr_write_b32 a239, v127
    v_perm_b32 v204, v137, v136, s31
    v_perm_b32 v205, v137, v136, s32
    v_perm_b32 v206, v139, v138, s31
    v_perm_b32 v207, v139, v138, s32
    v_perm_b32 v236, v141, v140, s31
    v_perm_b32 v237, v141, v140, s32
    v_perm_b32 v238, v143, v142, s31
    v_perm_b32 v239, v143, v142, s32
    s_waitcnt lgkmcnt(0)
    s_waitcnt vmcnt(12)
    ds_read2st64_b32 v[128:129], v170 offset0:16 offset1:17
    ds_read2st64_b32 v[130:131], v170 offset0:18 offset1:19
    ds_read2st64_b32 v[132:133], v170 offset0:20 offset1:21
    ds_read2st64_b32 v[134:135], v170 offset0:22 offset1:23
    ds_read2st64_b32 v[136:137], v170 offset0:24 offset1:25
    ds_read2st64_b32 v[138:139], v170 offset0:26 offset1:27
    ds_read2st64_b32 v[140:141], v170 offset0:28 offset1:29
    ds_read2st64_b32 v[142:143], v170 offset0:30 offset1:31
    v_perm_b32 v120, v145, v144, s31
    v_accvgpr_write_b32 a176, v120
    v_perm_b32 v121, v145, v144, s32
    v_accvgpr_write_b32 a177, v121
    v_perm_b32 v122, v147, v146, s31
    v_accvgpr_write_b32 a178, v122
    v_perm_b32 v123, v147, v146, s32
    v_accvgpr_write_b32 a179, v123
    v_perm_b32 v124, v149, v148, s31
    v_accvgpr_write_b32 a208, v124
    v_perm_b32 v125, v149, v148, s32
    v_accvgpr_write_b32 a209, v125
    v_perm_b32 v126, v151, v150, s31
    v_accvgpr_write_b32 a210, v126
    v_perm_b32 v127, v151, v150, s32
    v_accvgpr_write_b32 a211, v127
    v_perm_b32 v120, v153, v152, s31
    v_accvgpr_write_b32 a240, v120
    v_perm_b32 v121, v153, v152, s32
    v_accvgpr_write_b32 a241, v121
    v_perm_b32 v122, v155, v154, s31
    v_accvgpr_write_b32 a242, v122
    v_perm_b32 v123, v155, v154, s32
    v_accvgpr_write_b32 a243, v123
    v_perm_b32 v208, v157, v156, s31
    v_perm_b32 v209, v157, v156, s32
    v_perm_b32 v210, v159, v158, s31
    v_perm_b32 v211, v159, v158, s32
    s_waitcnt lgkmcnt(0)
    s_waitcnt vmcnt(8)
    ds_read2st64_b32 v[144:145], v170 offset0:32 offset1:33
    ds_read2st64_b32 v[146:147], v170 offset0:34 offset1:35
    ds_read2st64_b32 v[148:149], v170 offset0:36 offset1:37
    ds_read2st64_b32 v[150:151], v170 offset0:38 offset1:39
    ds_read2st64_b32 v[152:153], v170 offset0:40 offset1:41
    ds_read2st64_b32 v[154:155], v170 offset0:42 offset1:43
    ds_read2st64_b32 v[156:157], v170 offset0:44 offset1:45
    ds_read2st64_b32 v[158:159], v170 offset0:46 offset1:47
    v_perm_b32 v240, v129, v128, s31
    v_perm_b32 v241, v129, v128, s32
    v_perm_b32 v242, v131, v130, s31
    v_perm_b32 v243, v131, v130, s32
    v_perm_b32 v124, v133, v132, s31
    v_accvgpr_write_b32 a180, v124
    v_perm_b32 v125, v133, v132, s32
    v_accvgpr_write_b32 a181, v125
    v_perm_b32 v126, v135, v134, s31
    v_accvgpr_write_b32 a182, v126
    v_perm_b32 v127, v135, v134, s32
    v_accvgpr_write_b32 a183, v127
    v_perm_b32 v120, v137, v136, s31
    v_accvgpr_write_b32 a212, v120
    v_perm_b32 v121, v137, v136, s32
    v_accvgpr_write_b32 a213, v121
    v_perm_b32 v122, v139, v138, s31
    v_accvgpr_write_b32 a214, v122
    v_perm_b32 v123, v139, v138, s32
    v_accvgpr_write_b32 a215, v123
    v_perm_b32 v124, v141, v140, s31
    v_accvgpr_write_b32 a244, v124
    v_perm_b32 v125, v141, v140, s32
    v_accvgpr_write_b32 a245, v125
    v_perm_b32 v126, v143, v142, s31
    v_accvgpr_write_b32 a246, v126
    v_perm_b32 v127, v143, v142, s32
    v_accvgpr_write_b32 a247, v127
    s_waitcnt lgkmcnt(0)
    s_waitcnt vmcnt(4)
    ds_read2st64_b32 v[128:129], v170 offset0:48 offset1:49
    ds_read2st64_b32 v[130:131], v170 offset0:50 offset1:51
    ds_read2st64_b32 v[132:133], v170 offset0:52 offset1:53
    ds_read2st64_b32 v[134:135], v170 offset0:54 offset1:55
    ds_read2st64_b32 v[136:137], v170 offset0:56 offset1:57
    ds_read2st64_b32 v[138:139], v170 offset0:58 offset1:59
    ds_read2st64_b32 v[140:141], v170 offset0:60 offset1:61
    ds_read2st64_b32 v[142:143], v170 offset0:62 offset1:63
    v_perm_b32 v212, v145, v144, s31
    v_perm_b32 v213, v145, v144, s32
    v_perm_b32 v214, v147, v146, s31
    v_perm_b32 v215, v147, v146, s32
    v_perm_b32 v244, v149, v148, s31
    v_perm_b32 v245, v149, v148, s32
    v_perm_b32 v246, v151, v150, s31
    v_perm_b32 v247, v151, v150, s32
    v_perm_b32 v120, v153, v152, s31
    v_accvgpr_write_b32 a184, v120
    v_perm_b32 v121, v153, v152, s32
    v_accvgpr_write_b32 a185, v121
    v_perm_b32 v122, v155, v154, s31
    v_accvgpr_write_b32 a186, v122
    v_perm_b32 v123, v155, v154, s32
    v_accvgpr_write_b32 a187, v123
    v_perm_b32 v124, v157, v156, s31
    v_accvgpr_write_b32 a216, v124
    v_perm_b32 v125, v157, v156, s32
    v_accvgpr_write_b32 a217, v125
    v_perm_b32 v126, v159, v158, s31
    v_accvgpr_write_b32 a218, v126
    v_perm_b32 v127, v159, v158, s32
    v_accvgpr_write_b32 a219, v127
    s_waitcnt lgkmcnt(0)
    s_waitcnt vmcnt(0)
    ds_read2st64_b32 v[144:145], v170 offset0:64 offset1:65
    ds_read2st64_b32 v[146:147], v170 offset0:66 offset1:67
    ds_read2st64_b32 v[148:149], v170 offset0:68 offset1:69
    ds_read2st64_b32 v[150:151], v170 offset0:70 offset1:71
    ds_read2st64_b32 v[152:153], v170 offset0:72 offset1:73
    ds_read2st64_b32 v[154:155], v170 offset0:74 offset1:75
    ds_read2st64_b32 v[156:157], v170 offset0:76 offset1:77
    ds_read2st64_b32 v[158:159], v170 offset0:78 offset1:79
    v_perm_b32 v120, v129, v128, s31
    v_accvgpr_write_b32 a248, v120
    v_perm_b32 v121, v129, v128, s32
    v_accvgpr_write_b32 a249, v121
    v_perm_b32 v122, v131, v130, s31
    v_accvgpr_write_b32 a250, v122
    v_perm_b32 v123, v131, v130, s32
    v_accvgpr_write_b32 a251, v123
    v_perm_b32 v216, v133, v132, s31
    v_perm_b32 v217, v133, v132, s32
    v_perm_b32 v218, v135, v134, s31
    v_perm_b32 v219, v135, v134, s32
    v_perm_b32 v248, v137, v136, s31
    v_perm_b32 v249, v137, v136, s32
    v_perm_b32 v250, v139, v138, s31
    v_perm_b32 v251, v139, v138, s32
    v_perm_b32 v124, v141, v140, s31
    v_accvgpr_write_b32 a188, v124
    v_perm_b32 v125, v141, v140, s32
    v_accvgpr_write_b32 a189, v125
    v_perm_b32 v126, v143, v142, s31
    v_accvgpr_write_b32 a190, v126
    v_perm_b32 v127, v143, v142, s32
    v_accvgpr_write_b32 a191, v127
    s_waitcnt lgkmcnt(0)
    v_perm_b32 v120, v145, v144, s31
    v_accvgpr_write_b32 a220, v120
    v_perm_b32 v121, v145, v144, s32
    v_accvgpr_write_b32 a221, v121
    v_perm_b32 v122, v147, v146, s31
    v_accvgpr_write_b32 a222, v122
    v_perm_b32 v123, v147, v146, s32
    v_accvgpr_write_b32 a223, v123
    v_perm_b32 v124, v149, v148, s31
    v_accvgpr_write_b32 a252, v124
    v_perm_b32 v125, v149, v148, s32
    v_accvgpr_write_b32 a253, v125
    v_perm_b32 v126, v151, v150, s31
    v_accvgpr_write_b32 a254, v126
    v_perm_b32 v127, v151, v150, s32
    v_accvgpr_write_b32 a255, v127
    v_perm_b32 v220, v153, v152, s31
    v_perm_b32 v221, v153, v152, s32
    v_perm_b32 v222, v155, v154, s31
    v_perm_b32 v223, v155, v154, s32
    v_perm_b32 v252, v157, v156, s31
    v_perm_b32 v253, v157, v156, s32
    v_perm_b32 v254, v159, v158, s31
    v_perm_b32 v255, v159, v158, s32
    s_mov_b32 s21, 0
    v_mov_b32 v172, 40960
    s_cmp_eq_u32 s18, 0
    s_cbranch_scc0 wi_19_w
wi_19:
    buffer_load_dword v171, off, s[88:91], 0 offset:132 sc1
    s_waitcnt vmcnt(0)
wi_19_chk:
    v_readfirstlane_b32 s19, v171
    s_and_b32 s20, s19, 255
    s_cmp_eq_u32 s20, 40
    s_cbranch_scc1 wi_19_ok
    s_sleep 2
    s_add_u32 s21, s21, 1
    s_cmp_lt_u32 s21, 200000
    s_cbranch_scc1 wi_19
wi_19_ok:
    ds_write_b32 v172, v171
wi_19_w:
    s_waitcnt vmcnt(0) lgkmcnt(0)
    s_barrier
    ds_read_b32 v171, v172
    s_waitcnt lgkmcnt(0)
    v_readfirstlane_b32 s19, v171
    s_and_b32 s46, s19, 0x7000
    s_and_b32 s45, s19, 0x800
    s_and_b32 s19, s19, 0x2000
    s_xor_b32 s34, s19, 0x2000
    s_mul_i32 s20, s18, 576
    s_add_u32 s20, s20, 10240
    v_lshlrev_b32 v5, 4, v12
    v_lshl_add_u32 v5, v13, 2, v5
    v_add_u32 v5, s20, v5
    v_bfe_u32 v14, v12, 2, 1
    v_mul_u32_u24 v176, 288, v14
    v_lshl_add_u32 v176, v13, 6, v176
    v_cmp_eq_u32 vcc, 0, v14
    v_lshrrev_b32 v14, 3, v12
    v_lshl_add_u32 v176, v14, 4, v176
    v_and_b32 v14, 2, v12
    v_lshl_add_u32 v176, v14, 2, v176
    v_mov_b32 v177, 0xeeee
    v_mov_b32 v14, 0x4444
    v_cndmask_b32 v177, v177, v14, vcc
    s_mul_i32 s20, s18, 163840
    s_lshl_b32 s21, s17, 8
    s_add_u32 s20, s20, s21
    v_lshlrev_b32 v8, 4, v12
    v_add_u32 v8, s20, v8
    v_and_b32 v14, 1, v13
    v_lshl_add_u32 v9, v14, 14, v8
    v_lshrrev_b32 v14, 1, v13
    v_lshl_add_u32 v9, v14, 3, v9
    v_lshl_add_u32 v8, v13, 14, v8
    v_and_b32 v14, 1, v13
    v_mul_u32_u24 v14, 16384, v14
    v_bfe_u32 v187, v13, 1, 1
    v_mul_u32_u24 v187, 4096, v187
    v_xor_b32 v187, v187, v14
    v_xor_b32 v187, s46, v187
    v_lshl_add_u32 v187, v12, 4, v187
    v_lshl_add_u32 v187, v13, 9, v187
    s_lshr_b32 s20, s17, 4
    s_lshl_b32 s20, s20, 16
    s_and_b32 s21, s17, 15
    s_lshl_b32 s21, s21, 8
    s_add_u32 s20, s20, s21
    s_mul_i32 s21, s18, 10
    v_add3_u32 v10, s21, v13, 16
    v_and_b32 v14, 1, v10
    v_mul_u32_u24 v14, 16384, v14
    v_bfe_u32 v6, v10, 1, 1
    v_mul_u32_u24 v6, 4096, v6
    v_xor_b32 v6, v6, v14
    v_xor_b32 v6, s46, v6
    v_and_b32 v14, 16, v10
    v_lshlrev_b32 v14, 10, v14
    v_xor_b32 v6, v6, v14
    v_and_b32 v14, 32, v10
    v_lshlrev_b32 v14, 7, v14
    v_xor_b32 v6, v6, v14
    v_lshrrev_b32 v10, 2, v10
    v_lshl_add_u32 v6, v10, 17, v6
    v_lshl_add_u32 v6, v12, 4, v6
    v_add_u32 v6, s20, v6
    v_add3_u32 v10, s21, v13, 20
    v_and_b32 v14, 1, v10
    v_mul_u32_u24 v14, 16384, v14
    v_bfe_u32 v188, v10, 1, 1
    v_mul_u32_u24 v188, 4096, v188
    v_xor_b32 v188, v188, v14
    v_xor_b32 v188, s46, v188
    v_and_b32 v14, 16, v10
    v_lshlrev_b32 v14, 10, v14
    v_xor_b32 v188, v188, v14
    v_and_b32 v14, 32, v10
    v_lshlrev_b32 v14, 7, v14
    v_xor_b32 v188, v188, v14
    v_lshrrev_b32 v10, 2, v10
    v_lshl_add_u32 v188, v10, 17, v188
    v_lshl_add_u32 v188, v12, 4, v188
    v_add_u32 v188, s20, v188
    v_and_b32 v10, 1, v13
    v_add3_u32 v10, v10, s21, 24
    v_and_b32 v14, 1, v10
    v_mul_u32_u24 v14, 16384, v14
    v_bfe_u32 v7, v10, 1, 1
    v_mul_u32_u24 v7, 4096, v7
    v_xor_b32 v7, v7, v14
    v_xor_b32 v7, s46, v7
    v_and_b32 v14, 16, v10
    v_lshlrev_b32 v14, 10, v14
    v_xor_b32 v7, v7, v14
    v_and_b32 v14, 32, v10
    v_lshlrev_b32 v14, 7, v14
    v_xor_b32 v7, v7, v14
    v_lshrrev_b32 v10, 2, v10
    v_lshl_add_u32 v7, v10, 17, v7
    v_lshl_add_u32 v7, v12, 4, v7
    v_add_u32 v7, s20, v7
    v_lshrrev_b32 v14, 1, v13
    v_lshl_add_u32 v7, v14, 3, v7
    s_mov_b32 s16, 0
    s_mov_b32 s51, -1
    s_mov_b32 s24, 0
    s_mov_b32 s26, 0
    s_mov_b32 s27, 0
    s_mov_b32 s36, 8388608
    s_and_b32 s20, s2, 3
    v_mov_b32 v143, s20
    v_mov_b32 v14, v143
    v_and_b32 v15, 1, v14
    v_mul_u32_u24 v15, 16384, v15
    v_bfe_u32 v143, v14, 1, 1
    v_mul_u32_u24 v143, 4096, v143
    v_xor_b32 v143, v143, v15
    v_xor_b32 v143, s46, v143
    v_xor_b32 v143, s45, v143
    v_cmp_eq_u32 vcc, 0, v14
    v_xor_b32 v15, 22528, v143
    s_nop 0
    v_cndmask_b32 v143, v143, v15, vcc
    v_cmp_eq_u32 vcc, 1, v14
    v_xor_b32 v15, 6272, v143
    s_nop 0
    v_cndmask_b32 v143, v143, v15, vcc
    v_cmp_eq_u32 vcc, 2, v14
    v_xor_b32 v15, 18688, v143
    s_nop 0
    v_cndmask_b32 v143, v143, v15, vcc
    v_cmp_eq_u32 vcc, 3, v14
    v_xor_b32 v15, 2432, v143
    s_nop 0
    v_cndmask_b32 v143, v143, v15, vcc
    v_add_u32 v143, 1966080, v143
    s_lshl_b32 s20, s17, 1
    s_add_u32 s20, s20, 1
    s_lshl_b32 s20, s20, 7
    s_add_u32 s20, s20, 1835008
    s_add_u32 s20, s20, s19
    s_cmp_eq_u32 s18, 3
    s_cselect_b32 s20, s20, 0x40000000
    v_mov_b32 v180, s20
    v_cmp_eq_u32 vcc, 0, v1
    v_mov_b32 v15, 0x40000000
    s_nop 0
    v_cndmask_b32 v180, v15, v180, vcc
L_vo_step:
    s_cmp_eq_u32 s18, 2
    s_cbranch_scc0 L_vo_nodma
    s_and_b32 s20, s16, 3
    s_lshl_b32 s22, s20, 15
    s_add_u32 s52, s22, 32768
    s_add_u32 s53, s22, 32000
    s_add_u32 s54, s22, 31232
    s_add_u32 s55, s22, 30464
    s_add_u32 s56, s22, 33792
    s_add_u32 s57, s22, 33024
    s_add_u32 s58, s22, 32256
    s_add_u32 s59, s22, 31488
    s_add_u32 s60, s22, 34816
    s_add_u32 s61, s22, 34048
    s_sub_u32 s35, s16, 1
    s_mov_b32 s21, 0
    buffer_load_dword v182, v143, s[8:11], 0 offen sc1
    s_sleep 1
    buffer_load_dword v183, v143, s[8:11], 0 offen sc1
    s_sleep 1
    buffer_load_dword v184, v143, s[8:11], 0 offen sc1
    s_sleep 1
    buffer_load_dword v185, v143, s[8:11], 0 offen sc1
poll_20:
    s_waitcnt vmcnt(3)
    v_cmp_gt_i32 vcc, s35, v182
    s_cbranch_vccz poll_20_got
    buffer_load_dword v182, v143, s[8:11], 0 offen sc1
    s_waitcnt vmcnt(3)
    v_cmp_gt_i32 vcc, s35, v183
    s_cbranch_vccz poll_20_got
    buffer_load_dword v183, v143, s[8:11], 0 offen sc1
    s_waitcnt vmcnt(3)
    v_cmp_gt_i32 vcc, s35, v184
    s_cbranch_vccz poll_20_got
    buffer_load_dword v184, v143, s[8:11], 0 offen sc1
    s_waitcnt vmcnt(3)
    v_cmp_gt_i32 vcc, s35, v185
    s_cbranch_vccz poll_20_got
    buffer_load_dword v185, v143, s[8:11], 0 offen sc1
    s_add_u32 s21, s21, 1
    s_cmp_lt_u32 s21, 100000
    s_cbranch_scc1 poll_20
    s_mov_b32 s24, 0x7000000
poll_20_got:
    s_branch L_vo_dma
L_vo_retry:
    s_cmp_eq_u32 s18, 2
    s_cbranch_scc0 L_vo_nodma
L_vo_dma:
    s_mov_b32 m0, 0
    s_nop 0
    buffer_load_dwordx4 v187, s[8:11], s52 offen offset:0 sc1 lds
    buffer_load_dwordx4 v187, s[8:11], s53 offen offset:1024 sc1 lds
    buffer_load_dwordx4 v187, s[8:11], s54 offen offset:2048 sc1 lds
    buffer_load_dwordx4 v187, s[8:11], s55 offen offset:3072 sc1 lds
    s_mov_b32 m0, 4096
    s_nop 0
    buffer_load_dwordx4 v187, s[8:11], s56 offen offset:0 sc1 lds
    buffer_load_dwordx4 v187, s[8:11], s57 offen offset:1024 sc1 lds
    buffer_load_dwordx4 v187, s[8:11], s58 offen offset:2048 sc1 lds
    buffer_load_dwordx4 v187, s[8:11], s59 offen offset:3072 sc1 lds
    s_mov_b32 m0, 8192
    s_nop 0
    buffer_load_dwordx4 v187, s[8:11], s60 offen offset:0 sc1 lds
    buffer_load_dwordx4 v187, s[8:11], s61 offen offset:1024 sc1 lds
L_vo_nodma:
    v_mov_b32 v16, 0
    v_mov_b32 v17, 0
    v_mov_b32 v18, 0
    v_mov_b32 v19, 0
    v_mov_b32 v20, 0
    v_mov_b32 v21, 0
    v_mov_b32 v22, 0
    v_mov_b32 v23, 0
    v_mov_b32 v32, 0
    v_mov_b32 v33, 0
    v_mov_b32 v34, 0
    v_mov_b32 v35, 0
    v_mov_b32 v36, 0
    v_mov_b32 v37, 0
    v_mov_b32 v38, 0
    v_mov_b32 v39, 0
    v_mov_b32 v40, 0
    v_mov_b32 v41, 0
    v_mov_b32 v42, 0
    v_mov_b32 v43, 0
    v_mov_b32 v44, 0
    v_mov_b32 v45, 0
    v_mov_b32 v46, 0
    v_mov_b32 v47, 0
    v_mov_b32 v48, 0
    v_mov_b32 v49, 0
    v_mov_b32 v50, 0
    v_mov_b32 v51, 0
    v_mov_b32 v149, s16
    s_and_b32 s20, s16, 1
    s_lshl_b32 s28, s20, 15
    s_waitcnt vmcnt(9)
    s_barrier
    ds_read_b64_tr_b16 v[100:101], v2 offset:0
    ds_read_b64_tr_b16 v[102:103], v2 offset:512
    s_waitcnt vmcnt(7)
    s_barrier
    ds_read_b64_tr_b16 v[104:105], v2 offset:1024
    ds_read_b64_tr_b16 v[106:107], v2 offset:1536
    ds_read_b64_tr_b16 v[108:109], v2 offset:2048
    ds_read_b64_tr_b16 v[110:111], v2 offset:2560
    s_waitcnt lgkmcnt(4)
    v_smfmac_f32_16x16x64_bf16 v[16:19], v[100:103], a[0:7], v3
    s_waitcnt vmcnt(4)
    s_barrier
    ds_read_b64_tr_b16 v[112:113], v2 offset:3072
    ds_read_b64_tr_b16 v[114:115], v2 offset:3584
    v_smfmac_f32_16x16x64_bf16 v[20:23], v[100:103], a[8:15], v3
    s_waitcnt lgkmcnt(4)
    v_smfmac_f32_16x16x64_bf16 v[16:19], v[104:107], a[16:23], v3
    ds_read_b64_tr_b16 v[116:117], v2 offset:4096
    ds_read_b64_tr_b16 v[118:119], v2 offset:4608
    v_smfmac_f32_16x16x64_bf16 v[20:23], v[104:107], a[24:31], v3
    s_waitcnt lgkmcnt(4)
    v_smfmac_f32_16x16x64_bf16 v[16:19], v[108:111], a[32:39], v3
    s_waitcnt vmcnt(0)
    s_barrier
    ds_read_b64_tr_b16 v[120:121], v2 offset:5120
    ds_read_b64_tr_b16 v[122:123], v2 offset:5632
    v_smfmac_f32_16x16x64_bf16 v[20:23], v[108:111], a[40:47], v3
    s_waitcnt lgkmcnt(4)
    v_smfmac_f32_16x16x64_bf16 v[16:19], v[112:115], a[48:55], v3
    ds_read_b64_tr_b16 v[124:125], v2 offset:6144
    ds_read_b64_tr_b16 v[126:127], v2 offset:6656
    v_smfmac_f32_16x16x64_bf16 v[20:23], v[112:115], a[56:63], v3
    s_waitcnt lgkmcnt(4)
    v_smfmac_f32_16x16x64_bf16 v[16:19], v[116:119], a[64:71], v3
    ds_read_b64_tr_b16 v[128:129], v2 offset:7168
    ds_read_b64_tr_b16 v[130:131], v2 offset:7680
    v_smfmac_f32_16x16x64_bf16 v[20:23], v[116:119], a[72:79], v3
    s_waitcnt lgkmcnt(4)
    v_smfmac_f32_16x16x64_bf16 v[16:19], v[120:123], a[80:87], v3
    ds_read_b64_tr_b16 v[132:133], v2 offset:8192
    ds_read_b64_tr_b16 v[134:135], v2 offset:8704
    v_smfmac_f32_16x16x64_bf16 v[20:23], v[120:123], a[88:95], v3
    s_waitcnt lgkmcnt(4)
    v_smfmac_f32_16x16x64_bf16 v[16:19], v[124:127], a[96:103], v3
    ds_read_b64_tr_b16 v[136:137], v2 offset:9216
    ds_read_b64_tr_b16 v[138:139], v2 offset:9728
    v_smfmac_f32_16x16x64_bf16 v[20:23], v[124:127], a[104:111], v3
    s_waitcnt lgkmcnt(4)
    v_smfmac_f32_16x16x64_bf16 v[16:19], v[128:131], a[112:119], v3
    v_smfmac_f32_16x16x64_bf16 v[20:23], v[128:131], a[120:127], v3
    s_waitcnt lgkmcnt(2)
    v_smfmac_f32_16x16x64_bf16 v[16:19], v[132:135], a[128:135], v3
    v_smfmac_f32_16x16x64_bf16 v[20:23], v[132:135], a[136:143], v3
    s_waitcnt lgkmcnt(0)
    v_smfmac_f32_16x16x64_bf16 v[16:19], v[136:139], a[144:151], v3
    v_smfmac_f32_16x16x64_bf16 v[20:23], v[136:139], a[152:159], v3
    s_nop 3
    v_add_f32 v16, v16, v18
    v_add_f32 v17, v17, v19
    v_cvt_pk_bf16_f32 v18, v16, v17
    s_nop 0
    v_add_f32 v20, v20, v22
    v_add_f32 v21, v21, v23
    v_cvt_pk_bf16_f32 v19, v20, v21
    ds_write2_b32 v5, v18, v19 offset0:0 offset1:72
    v_cmp_u_f32 vcc, v16, v17
    s_cbranch_vccnz L_vo_slow
L_vo_back:
    s_add_u32 s16, s16, 1
    s_waitcnt lgkmcnt(0)
    s_barrier
    ds_read_b64_tr_b16 v[52:53], v176 offset:10240
    ds_read_b64_tr_b16 v[54:55], v176 offset:10272
    ds_read_b64_tr_b16 v[56:57], v176 offset:10816
    ds_read_b64_tr_b16 v[58:59], v176 offset:10848
    ds_read_b64_tr_b16 v[60:61], v176 offset:11392
    ds_read_b64_tr_b16 v[62:63], v176 offset:11424
    ds_read_b64_tr_b16 v[64:65], v176 offset:11968
    ds_read_b64_tr_b16 v[66:67], v176 offset:12000
    s_waitcnt lgkmcnt(6)
    v_smfmac_f32_16x16x64_bf16 v[32:35], v[52:55], a[160:167], v177
    s_waitcnt lgkmcnt(4)
    v_smfmac_f32_16x16x64_bf16 v[32:35], v[56:59], a[168:175], v177
    s_waitcnt lgkmcnt(2)
    v_smfmac_f32_16x16x64_bf16 v[32:35], v[60:63], a[176:183], v177
    s_waitcnt lgkmcnt(0)
    v_smfmac_f32_16x16x64_bf16 v[32:35], v[64:67], a[184:191], v177
    v_smfmac_f32_16x16x64_bf16 v[36:39], v[52:55], a[192:199], v177
    v_smfmac_f32_16x16x64_bf16 v[36:39], v[56:59], a[200:207], v177
    v_cvt_pk_bf16_f32 v72, v32, v33
    v_smfmac_f32_16x16x64_bf16 v[36:39], v[60:63], a[208:215], v177
    v_cvt_pk_bf16_f32 v73, v34, v35
    v_smfmac_f32_16x16x64_bf16 v[36:39], v[64:67], a[216:223], v177
    v_smfmac_f32_16x16x64_bf16 v[40:43], v[52:55], a[224:231], v177
    v_smfmac_f32_16x16x64_bf16 v[40:43], v[56:59], a[232:239], v177
    v_cvt_pk_bf16_f32 v74, v36, v37
    v_smfmac_f32_16x16x64_bf16 v[40:43], v[60:63], a[240:247], v177
    v_cvt_pk_bf16_f32 v75, v38, v39
    v_smfmac_f32_16x16x64_bf16 v[40:43], v[64:67], a[248:255], v177
    v_permlane32_swap_b32 v72, v74
    v_smfmac_f32_16x16x64_bf16 v[44:47], v[52:55], v[192:199], v177
    v_permlane32_swap_b32 v73, v75
    v_smfmac_f32_16x16x64_bf16 v[44:47], v[56:59], v[200:207], v177
    buffer_store_dwordx4 v[72:75], v6, s[8:11], s28 offen sc1
    v_cvt_pk_bf16_f32 v76, v40, v41
    v_smfmac_f32_16x16x64_bf16 v[44:47], v[60:63], v[208:215], v177
    v_cvt_pk_bf16_f32 v77, v42, v43
    v_smfmac_f32_16x16x64_bf16 v[44:47], v[64:67], v[216:223], v177
    v_smfmac_f32_16x16x64_bf16 v[48:51], v[52:55], v[224:231], v177
    v_smfmac_f32_16x16x64_bf16 v[48:51], v[56:59], v[232:239], v177
    v_cvt_pk_bf16_f32 v78, v44, v45
    v_smfmac_f32_16x16x64_bf16 v[48:51], v[60:63], v[240:247], v177
    v_cvt_pk_bf16_f32 v79, v46, v47
    v_smfmac_f32_16x16x64_bf16 v[48:51], v[64:67], v[248:255], v177
    v_permlane32_swap_b32 v76, v78
    v_permlane32_swap_b32 v77, v79
    buffer_store_dwordx4 v[76:79], v188, s[8:11], s28 offen sc1
    s_nop 0
    v_cvt_pk_bf16_f32 v80, v48, v49
    v_cvt_pk_bf16_f32 v81, v50, v51
    buffer_store_dwordx2 v[80:81], v7, s[8:11], s28 offen sc1
    s_sub_u32 s28, s16, 1
    s_and_b32 s28, s28, 63
    s_lshl_b32 s28, s28, 20
    s_add_u32 s28, s28, s36
    s_lshr_b32 s20, s28, 8
    s_xor_b32 s20, s20, s34
    s_and_b32 s20, s20, 0x2000
    s_or_b32 s28, s28, s20
    s_add_u32 s29, s28, 65536
    s_add_u32 s30, s28, 131072
    buffer_store_dwordx4 v[72:75], v8, s[4:7], s28 offen sc1
    buffer_store_dwordx4 v[76:79], v8, s[4:7], s29 offen sc1
    buffer_store_dwordx2 v[80:81], v9, s[4:7], s30 offen sc1
    s_cmp_lt_u32 s16, 64
    s_cbranch_scc1 L_vo_step
    s_waitcnt vmcnt(0)
    s_barrier
    buffer_store_dword v149, v180, s[8:11], 0 offen sc1
    s_branch L_vo_end
L_vo_slow:
    v_pk_max_u16 v140, v100, v101
    v_pk_max_u16 v140, v140, v102
    v_pk_max_u16 v140, v140, v103
    v_pk_max_u16 v140, v140, v104
    v_pk_max_u16 v140, v140, v105
    v_pk_max_u16 v140, v140, v106
    v_pk_max_u16 v140, v140, v107
    v_pk_max_u16 v140, v140, v108
    v_pk_max_u16 v140, v140, v109
    v_pk_max_u16 v140, v140, v110
    v_pk_max_u16 v140, v140, v111
    v_pk_max_u16 v140, v140, v112
    v_pk_max_u16 v140, v140, v113
    v_pk_max_u16 v140, v140, v114
    v_pk_max_u16 v140, v140, v115
    v_pk_max_u16 v140, v140, v116
    v_pk_max_u16 v140, v140, v117
    v_pk_max_u16 v140, v140, v118
    v_pk_max_u16 v140, v140, v119
    v_pk_max_u16 v140, v140, v120
    v_pk_max_u16 v140, v140, v121
    v_pk_max_u16 v140, v140, v122
    v_pk_max_u16 v140, v140, v123
    v_pk_max_u16 v140, v140, v124
    v_pk_max_u16 v140, v140, v125
    v_pk_max_u16 v140, v140, v126
    v_pk_max_u16 v140, v140, v127
    v_pk_max_u16 v140, v140, v128
    v_pk_max_u16 v140, v140, v129
    v_pk_max_u16 v140, v140, v130
    v_pk_max_u16 v140, v140, v131
    v_pk_max_u16 v140, v140, v132
    v_pk_max_u16 v140, v140, v133
    v_pk_max_u16 v140, v140, v134
    v_pk_max_u16 v140, v140, v135
    v_pk_max_u16 v140, v140, v136
    v_pk_max_u16 v140, v140, v137
    v_pk_max_u16 v140, v140, v138
    v_pk_max_u16 v140, v140, v139
    v_lshrrev_b32 v141, 16, v140
    v_max_u16 v140, v140, v141
    v_and_b32 v140, 0xffff, v140
    v_cmp_eq_u32 vcc, 0xffff, v140
    s_cbranch_vccz L_vo_back
L_vo_slow_r:
    s_add_u32 s24, s24, 1
    s_cmp_gt_u32 s24, 200000
    s_cbranch_scc1 L_vo_end
    s_waitcnt lgkmcnt(0)
    s_barrier
    s_branch L_vo_retry
L_vo_end:
    s_endpgm
L_own:
    v_and_b32 v1, 63, v0
    v_lshrrev_b32 v2, 6, v0
    s_nop 0
    v_readfirstlane_b32 s18, v2
    v_and_b32 v12, 15, v1
    v_lshrrev_b32 v13, 4, v1
    v_lshlrev_b32 v4, 4, v1
    v_mov_b32 v11, -1
    s_mov_b32 s31, 0x05040100
    s_mov_b32 s32, 0x07060302
    s_load_dwordx2 s[12:13], s[0:1], 8
    s_mov_b32 s14, 10240
    s_mov_b32 s15, 0x20000
    s_waitcnt lgkmcnt(0)
    s_lshr_b32 s21, s17, 1
    s_lshl_b32 s21, s21, 6
    s_and_b32 s22, s17, 1
    s_lshl_b32 s22, s22, 1
    s_add_u32 s21, s21, s22
    v_mul_u32_u24 v5, 2560, v13
    v_lshl_add_u32 v5, v12, 2, v5
    buffer_load_ushort v20, v5, s[12:15], s21 offen
    buffer_load_ushort v21, v5, s[12:15], s21 offen offset:1280
    s_mov_b32 s21, 0
    v_mov_b32 v172, 40960
    s_cmp_eq_u32 s18, 0
    s_cbranch_scc0 wi_21_w
wi_21:
    buffer_load_dword v171, off, s[88:91], 0 offset:128 sc1
    s_waitcnt vmcnt(0)
wi_21_chk:
    v_readfirstlane_b32 s19, v171
    s_and_b32 s20, s19, 255
    s_cmp_eq_u32 s20, 64
    s_cbranch_scc1 wi_21_ok
    s_sleep 4
    s_add_u32 s21, s21, 1
    s_cmp_lt_u32 s21, 200000
    s_cbranch_scc1 wi_21
wi_21_ok:
    ds_write_b32 v172, v171
wi_21_w:
    s_waitcnt vmcnt(0) lgkmcnt(0)
    s_barrier
    ds_read_b32 v171, v172
    s_waitcnt lgkmcnt(0)
    v_readfirstlane_b32 s19, v171
    s_cmp_gt_u32 s19, 33024
    s_cselect_b32 s19, 0x2000, 0
    s_xor_b32 s34, s19, 0x2000
    s_and_b32 s20, s17, 3
    s_lshl_b32 s23, s20, 15
    s_add_u32 s23, s23, 393216
    s_add_u32 s23, s23, s19
    s_lshr_b32 s22, s17, 2
    s_and_b32 s20, s22, 7
    s_lshl_b32 s20, s20, 8
    s_add_u32 s23, s23, s20
    s_lshr_b32 s20, s22, 3
    s_lshl_b32 s20, s20, 7
    s_add_u32 s23, s23, s20
    s_add_u32 s24, s22, 8
    s_and_b32 s20, s18, 2
    s_add_u32 s22, s22, s20
    s_mul_i32 s20, s20, 65536
    s_sub_u32 s23, s23, s20
    s_lshr_b32 s20, s17, 4
    s_add_u32 s38, s20, s22
    s_add_u32 s24, s38, 4
    s_mov_b32 s35, 0
    s_mov_b32 s36, 0
    s_mov_b32 s37, 0
    s_waitcnt vmcnt(0)
L_own_cm:
    s_lshr_b32 s20, s38, 1
    s_xor_b32 s20, s20, s38
    s_xor_b32 s20, s20, s18
    s_and_b32 s20, s20, 1
    s_and_b32 s22, s38, 3
    s_lshl_b32 s22, s22, 1
    s_or_b32 s22, s22, s20
    s_and_b32 s20, s22, 3
    s_lshl_b32 s20, s20, 11
    s_and_b32 s21, s22, 4
    s_lshl_b32 s21, s21, 12
    s_add_u32 s20, s20, s21
    s_add_u32 s20, s20, s23
    s_memtime s[26:27]
    s_waitcnt lgkmcnt(0)
    buffer_load_dword v22, off, s[8:11], s20 sc1
    s_waitcnt vmcnt(0)
    s_memtime s[28:29]
    s_waitcnt lgkmcnt(0)
    s_sub_u32 s28, s28, s26
    s_min_u32 s28, s28, 600
    s_sub_u32 s29, 0, s28
    s_bitcmp1_b32 s22, 0
    s_cselect_b32 s20, s28, s29
    s_add_u32 s35, s35, s20
    s_bitcmp1_b32 s22, 1
    s_cselect_b32 s20, s28, s29
    s_add_u32 s36, s36, s20
    s_bitcmp1_b32 s22, 2
    s_cselect_b32 s20, s28, s29
    s_add_u32 s37, s37, s20
    s_add_u32 s38, s38, 1
    s_cmp_lt_u32 s38, s24
    s_cbranch_scc1 L_own_cm
L_own_cm0:
    v_mov_b32 v24, s35
    v_mov_b32 v25, s36
    v_mov_b32 v26, s37
    s_lshl_b32 s20, s18, 4
    v_mov_b32 v22, s20
    ds_write_b96 v22, v[24:26]
    s_waitcnt lgkmcnt(0)
    s_barrier
    s_cmp_eq_u32 s18, 0
    s_cbranch_scc1 L_own_go
    s_endpgm
L_own_go:
    ds_read_b96 v[28:30], v22 offset:16
    ds_read_b96 v[32:34], v22 offset:32
    ds_read_b96 v[36:38], v22 offset:48
    s_waitcnt lgkmcnt(0)
    v_add3_u32 v24, v24, v28, v32
    v_add_u32 v24, v24, v36
    s_nop 0
    v_readfirstlane_b32 s35, v24
    v_add3_u32 v25, v25, v29, v33
    v_add_u32 v25, v25, v37
    s_nop 0
    v_readfirstlane_b32 s36, v25
    v_add3_u32 v26, v26, v30, v34
    v_add_u32 v26, v26, v38
    s_nop 0
    v_readfirstlane_b32 s37, v26
    s_lshr_b32 s37, s37, 31
    s_xor_b32 s37, s37, s17
    s_and_b32 s37, s37, 1
    s_lshr_b32 s36, s36, 31
    s_lshr_b32 s20, s17, 1
    s_xor_b32 s36, s36, s20
    s_and_b32 s36, s36, 1
    s_lshr_b32 s35, s35, 31
    s_and_b32 s20, s17, 15
    s_cselect_b32 s35, 0, s35
    s_lshl_b32 s35, s35, 8
    s_or_b32 s35, s35, s36
    s_lshl_b32 s35, s35, 8
    s_or_b32 s35, s35, s37
    s_lshl_b32 s35, s35, 8
    s_or_b32 s35, s35, 1
    v_cmp_eq_u32 vcc, 0, v1
    v_mov_b32 v22, 0x40000000
    s_nop 0
    v_cndmask_b32 v22, v22, v1, vcc
    v_mov_b32 v23, s35
    buffer_atomic_add v23, v22, s[88:91], 0 offen offset:4 sc0 sc1
    s_waitcnt vmcnt(0)
    v_readfirstlane_b32 s20, v23
    s_add_u32 s20, s20, s35
    s_and_b32 s21, s20, 255
    s_cmp_eq_u32 s21, 40
    s_cbranch_scc0 L_own_cm1
    s_or_b32 s21, s21, s19
    s_bfe_u32 s22, s20, 0x80008
    s_cmp_gt_u32 s22, 20
    s_cselect_b32 s22, 0x4000, 0
    s_or_b32 s21, s21, s22
    s_bfe_u32 s22, s20, 0x80010
    s_cmp_gt_u32 s22, 20
    s_cselect_b32 s22, 0x1000, 0
    s_or_b32 s21, s21, s22
    s_bitcmp1_b32 s20, 25
    s_cselect_b32 s22, 0x800, 0
    s_xor_b32 s22, s22, 2048
    s_or_b32 s21, s21, s22
    v_mov_b32 v23, s21
    buffer_store_dword v23, v22, s[88:91], 0 offen offset:132 sc1
L_own_cm1:
    s_mov_b32 s21, 0
wi_22:
    buffer_load_dword v171, off, s[88:91], 0 offset:132 sc1
    s_waitcnt vmcnt(0)
wi_22_chk:
    v_readfirstlane_b32 s19, v171
    s_and_b32 s20, s19, 255
    s_cmp_eq_u32 s20, 40
    s_cbranch_scc1 wi_22_ok
    s_sleep 1
    s_add_u32 s21, s21, 1
    s_cmp_lt_u32 s21, 200000
    s_cbranch_scc1 wi_22
wi_22_ok:
    s_and_b32 s46, s19, 0x7000
    s_and_b32 s45, s19, 0x800
    s_and_b32 s19, s19, 0x2000
    s_xor_b32 s34, s19, 0x2000
    v_and_b32 v3, 1, v1
    v_cmp_eq_u32 vcc, 0, v3
    v_mov_b32 v3, 0xeeee
    v_mov_b32 v5, 0x4444
    v_cndmask_b32 v3, v3, v5, vcc
    v_lshlrev_b32 v6, 2, v1
    v_mov_b32 v8, -1
    v_mov_b32 v9, -1
    v_mov_b32 v10, -1
    s_bitcmp1_b32 s17, 0
    s_cselect_b32 s21, 16384, 0
    s_bitcmp1_b32 s17, 1
    s_cselect_b32 s47, 4096, 0
    s_xor_b32 s47, s47, s21
    s_xor_b32 s47, s47, s46
    s_lshr_b32 s36, s17, 2
    s_lshl_b32 s33, s36, 17
    s_lshl_b32 s36, s36, 8
    s_add_u32 s36, s36, 32768
    s_and_b32 s20, s17, 3
    s_lshl_b32 s20, s20, 9
    s_add_u32 s36, s36, s20
    s_add_u32 s36, s36, s47
    v_lshl_or_b32 v20, v21, 16, v20
    buffer_store_dword v20, v6, s[8:11], s36 offen sc1
    s_add_u32 s33, s33, 524288
    s_lshr_b32 s20, s33, 5
    s_and_b32 s20, s20, 0x4000
    s_xor_b32 s47, s47, s20
    s_lshr_b32 s20, s33, 8
    s_and_b32 s20, s20, 0x1000
    s_xor_b32 s47, s47, s20
    s_add_u32 s33, s33, s47
    s_lshl_b32 s25, s17, 16
    s_add_u32 s25, s25, 75497472
    s_lshl_b32 s37, s17, 8
    s_add_u32 s37, s37, 335560704
    s_mov_b32 s16, 0
    s_mov_b32 s51, -1
    s_mov_b32 s24, 0
    s_mov_b32 s26, 0
    s_mov_b32 s27, 0
    s_mov_b32 s48, -1
    s_mov_b32 s49, -1
    s_mov_b32 s21, s17
    v_mov_b32 v2, v1
    v_mov_b32 v14, v2
    v_and_b32 v15, 1, v14
    v_mul_u32_u24 v15, 16384, v15
    v_bfe_u32 v2, v14, 1, 1
    v_mul_u32_u24 v2, 4096, v2
    v_xor_b32 v2, v2, v15
    v_xor_b32 v2, s46, v2
    v_xor_b32 v2, s45, v2
    v_cmp_eq_u32 vcc, 0, v14
    v_xor_b32 v15, 22528, v2
    s_nop 0
    v_cndmask_b32 v2, v2, v15, vcc
    v_cmp_eq_u32 vcc, 1, v14
    v_xor_b32 v15, 6272, v2
    s_nop 0
    v_cndmask_b32 v2, v2, v15, vcc
    v_cmp_eq_u32 vcc, 2, v14
    v_xor_b32 v15, 18688, v2
    s_nop 0
    v_cndmask_b32 v2, v2, v15, vcc
    v_cmp_eq_u32 vcc, 3, v14
    v_xor_b32 v15, 2432, v2
    s_nop 0
    v_cndmask_b32 v2, v2, v15, vcc
    s_cmp_eq_u32 s21, 0
    s_mov_b32 s20, 1966080
    s_cselect_b32 s20, s20, 0x40000000
    s_cmp_eq_u32 s18, 0
    s_cselect_b32 s20, s20, 0x40000000
    v_add_u32 v2, s20, v2
    v_cmp_gt_u32 vcc, 4, v1
    v_mov_b32 v15, 0x40000000
    s_nop 0
    v_cndmask_b32 v2, v15, v2, vcc
    s_and_b32 s20, s2, 3
    v_mov_b32 v7, s20
    v_mov_b32 v14, v7
    v_and_b32 v15, 1, v14
    v_mul_u32_u24 v15, 16384, v15
    v_bfe_u32 v7, v14, 1, 1
    v_mul_u32_u24 v7, 4096, v7
    v_xor_b32 v7, v7, v15
    v_xor_b32 v7, s46, v7
    v_xor_b32 v7, s45, v7
    v_cmp_eq_u32 vcc, 0, v14
    v_xor_b32 v15, 22528, v7
    s_nop 0
    v_cndmask_b32 v7, v7, v15, vcc
    v_cmp_eq_u32 vcc, 1, v14
    v_xor_b32 v15, 6272, v7
    s_nop 0
    v_cndmask_b32 v7, v7, v15, vcc
    v_cmp_eq_u32 vcc, 2, v14
    v_xor_b32 v15, 18688, v7
    s_nop 0
    v_cndmask_b32 v7, v7, v15, vcc
    v_cmp_eq_u32 vcc, 3, v14
    v_xor_b32 v15, 2432, v7
    s_nop 0
    v_cndmask_b32 v7, v7, v15, vcc
    v_add_u32 v7, 1933312, v7
    s_xor_b32 s20, s19, 0x2000
    s_add_u32 s20, s20, 1900544
    s_cmp_eq_u32 s17, 39
    s_cselect_b32 s20, s20, 0x40000000
    v_mov_b32 v5, s20
    v_cmp_eq_u32 vcc, 0, v1
    v_mov_b32 v15, 0x40000000
    s_nop 0
    v_cndmask_b32 v5, v15, v5, vcc
    s_xor_b32 s20, s17, 0
    s_and_b32 s20, s20, 3
    s_bitcmp1_b32 s20, 0
    s_cselect_b32 s21, 16384, 0
    s_bitcmp1_b32 s20, 1
    s_cselect_b32 s52, 4096, 0
    s_xor_b32 s52, s52, s21
    s_xor_b32 s52, s52, s46
    s_lshl_b32 s56, s20, 14
    s_lshr_b32 s60, s20, 1
    s_lshl_b32 s60, s60, 16
    s_and_b32 s20, s20, 1
    s_lshl_b32 s20, s20, 11
    s_add_u32 s60, s60, s20
    s_lshl_b32 s20, s20, 2
    s_add_u32 s56, s56, s20
    s_xor_b32 s20, s17, 1
    s_and_b32 s20, s20, 3
    s_bitcmp1_b32 s20, 0
    s_cselect_b32 s21, 16384, 0
    s_bitcmp1_b32 s20, 1
    s_cselect_b32 s53, 4096, 0
    s_xor_b32 s53, s53, s21
    s_xor_b32 s53, s53, s46
    s_lshl_b32 s57, s20, 14
    s_lshr_b32 s61, s20, 1
    s_lshl_b32 s61, s61, 16
    s_and_b32 s20, s20, 1
    s_lshl_b32 s20, s20, 11
    s_add_u32 s61, s61, s20
    s_lshl_b32 s20, s20, 2
    s_add_u32 s57, s57, s20
    s_xor_b32 s20, s17, 2
    s_and_b32 s20, s20, 3
    s_bitcmp1_b32 s20, 0
    s_cselect_b32 s21, 16384, 0
    s_bitcmp1_b32 s20, 1
    s_cselect_b32 s54, 4096, 0
    s_xor_b32 s54, s54, s21
    s_xor_b32 s54, s54, s46
    s_lshl_b32 s58, s20, 14
    s_lshr_b32 s62, s20, 1
    s_lshl_b32 s62, s62, 16
    s_and_b32 s20, s20, 1
    s_lshl_b32 s20, s20, 11
    s_add_u32 s62, s62, s20
    s_lshl_b32 s20, s20, 2
    s_add_u32 s58, s58, s20
    s_xor_b32 s20, s17, 3
    s_and_b32 s20, s20, 3
    s_bitcmp1_b32 s20, 0
    s_cselect_b32 s21, 16384, 0
    s_bitcmp1_b32 s20, 1
    s_cselect_b32 s55, 4096, 0
    s_xor_b32 s55, s55, s21
    s_xor_b32 s55, s55, s46
    s_lshl_b32 s59, s20, 14
    s_lshr_b32 s63, s20, 1
    s_lshl_b32 s63, s63, 16
    s_and_b32 s20, s20, 1
    s_lshl_b32 s20, s20, 11
    s_add_u32 s63, s63, s20
    s_lshl_b32 s20, s20, 2
    s_add_u32 s59, s59, s20
    v_and_b32 v14, 15, v1
    v_lshrrev_b32 v1, 4, v1
    v_lshlrev_b32 v1, 7, v1
    v_lshl_add_u32 v1, v14, 2, v1
    s_add_u32 s20, s19, 1867776
    v_add_u32 v1, s20, v1
    s_mov_b32 s41, 1024
L_own_step:
    s_cmp_ge_i32 s48, s16
    s_cbranch_scc1 mw_23_ok
    s_mov_b32 s21, 0
mw_23:
    buffer_load_dword v16, v1, s[8:11], 0 offen sc1
    s_waitcnt vmcnt(0)
    v_cmp_gt_i32 vcc, s16, v16
    s_cbranch_vccz mw_23_got
    s_sleep 2
    s_add_u32 s21, s21, 1
    s_cmp_lt_u32 s21, 200000
    s_cbranch_scc1 mw_23
mw_23_got:
    v_min_i32_dpp v16, v16, v16 row_ror:8 row_mask:0xf bank_mask:0xf
    s_nop 1
    v_min_i32_dpp v16, v16, v16 row_ror:4 row_mask:0xf bank_mask:0xf
    s_nop 1
    v_min_i32_dpp v16, v16, v16 row_ror:2 row_mask:0xf bank_mask:0xf
    s_nop 1
    v_min_i32_dpp v16, v16, v16 row_ror:1 row_mask:0xf bank_mask:0xf
    s_nop 0
    v_readlane_b32 s48, v16, 0
    v_readlane_b32 s20, v16, 16
    v_readlane_b32 s21, v16, 32
    s_min_i32 s48, s48, s20
    v_readlane_b32 s20, v16, 48
    s_min_i32 s48, s48, s21
    s_min_i32 s48, s48, s20
mw_23_ok:
    s_add_u32 s39, s16, 3
    s_min_u32 s39, s39, 63
    s_cmp_ge_i32 s48, s39
    s_cbranch_scc1 L_own_k0
    buffer_load_dword v24, v1, s[8:11], 0 offen sc1
L_own_k0:
    s_and_b32 s21, s16, 63
    s_mul_i32 s21, s21, 2621440
    s_add_u32 s21, s21, s25
    s_lshr_b32 s20, s21, 8
    s_xor_b32 s20, s20, s34
    s_and_b32 s20, s20, 0x2000
    s_or_b32 s21, s21, s20
    s_xor_b32 s20, s21, s56
    buffer_load_dwordx4 v[64:67], v4, s[4:7], s20 offen offset:0 sc1
    buffer_load_dwordx4 v[68:71], v4, s[4:7], s20 offen offset:1024 sc1
    buffer_load_dwordx4 v[72:75], v4, s[4:7], s20 offen offset:2048 sc1
    buffer_load_dwordx4 v[76:79], v4, s[4:7], s20 offen offset:3072 sc1
    s_add_u32 s20, s20, 4096
    buffer_load_dwordx4 v[80:83], v4, s[4:7], s20 offen offset:0 sc1
    buffer_load_dwordx4 v[84:87], v4, s[4:7], s20 offen offset:1024 sc1
    buffer_load_dwordx4 v[88:91], v4, s[4:7], s20 offen offset:2048 sc1
    buffer_load_dwordx4 v[92:95], v4, s[4:7], s20 offen offset:3072 sc1
    s_xor_b32 s20, s21, s57
    buffer_load_dwordx4 v[96:99], v4, s[4:7], s20 offen offset:0 sc1
    buffer_load_dwordx4 v[100:103], v4, s[4:7], s20 offen offset:1024 sc1
    buffer_load_dwordx4 v[104:107], v4, s[4:7], s20 offen offset:2048 sc1
    buffer_load_dwordx4 v[108:111], v4, s[4:7], s20 offen offset:3072 sc1
    s_add_u32 s20, s20, 4096
    buffer_load_dwordx4 v[112:115], v4, s[4:7], s20 offen offset:0 sc1
    buffer_load_dwordx4 v[116:119], v4, s[4:7], s20 offen offset:1024 sc1
    buffer_load_dwordx4 v[120:123], v4, s[4:7], s20 offen offset:2048 sc1
    buffer_load_dwordx4 v[124:127], v4, s[4:7], s20 offen offset:3072 sc1
    s_xor_b32 s20, s21, s58
    buffer_load_dwordx4 v[128:131], v4, s[4:7], s20 offen offset:0 sc1
    buffer_load_dwordx4 v[132:135], v4, s[4:7], s20 offen offset:1024 sc1
    buffer_load_dwordx4 v[136:139], v4, s[4:7], s20 offen offset:2048 sc1
    buffer_load_dwordx4 v[140:143], v4, s[4:7], s20 offen offset:3072 sc1
    s_add_u32 s20, s20, 4096
    buffer_load_dwordx4 v[144:147], v4, s[4:7], s20 offen offset:0 sc1
    buffer_load_dwordx4 v[148:151], v4, s[4:7], s20 offen offset:1024 sc1
    buffer_load_dwordx4 v[152:155], v4, s[4:7], s20 offen offset:2048 sc1
    buffer_load_dwordx4 v[156:159], v4, s[4:7], s20 offen offset:3072 sc1
    s_xor_b32 s20, s21, s59
    buffer_load_dwordx4 v[160:163], v4, s[4:7], s20 offen offset:0 sc1
    buffer_load_dwordx4 v[164:167], v4, s[4:7], s20 offen offset:1024 sc1
    buffer_load_dwordx4 v[168:171], v4, s[4:7], s20 offen offset:2048 sc1
    buffer_load_dwordx4 v[172:175], v4, s[4:7], s20 offen offset:3072 sc1
    s_add_u32 s20, s20, 4096
    buffer_load_dwordx4 v[176:179], v4, s[4:7], s20 offen offset:0 sc1
    buffer_load_dwordx4 v[180:183], v4, s[4:7], s20 offen offset:1024 sc1
    buffer_load_dwordx4 v[184:187], v4, s[4:7], s20 offen offset:2048 sc1
    buffer_load_dwordx4 v[188:191], v4, s[4:7], s20 offen offset:3072 sc1
    s_and_b32 s20, s16, 1
    s_lshl_b32 s28, s20, 15
    s_add_u32 s28, s28, s33
    s_add_u32 s38, s28, 65536
    s_and_b32 s20, s16, 3
    s_lshl_b32 s29, s20, 15
    s_add_u32 s29, s29, 262144
    s_lshl_b32 s30, s20, 10
    s_add_u32 s30, s30, 163840
    s_add_u32 s72, s29, s52
    s_add_u32 s73, s29, s53
    s_add_u32 s74, s29, s54
    s_add_u32 s75, s29, s55
    s_add_u32 s20, s16, 1
    s_and_b32 s20, s20, 3
    s_lshl_b32 s42, s20, 15
    s_add_u32 s42, s42, s36
    s_xor_b32 s20, s20, 2
    s_lshl_b32 s43, s20, 15
    s_add_u32 s43, s43, s36
    s_add_u32 s64, s30, s52
    s_add_u32 s68, s28, s60
    s_add_u32 s65, s30, s53
    s_add_u32 s69, s28, s61
    s_add_u32 s66, s30, s54
    s_add_u32 s70, s28, s62
    s_add_u32 s67, s30, s55
    s_add_u32 s71, s28, s63
    v_mov_b32 v0, s16
    s_cmp_ge_i32 s48, s39
    s_cbranch_scc1 L_own_known
    s_waitcnt vmcnt(32)
    v_min_i32_dpp v24, v24, v24 row_ror:8 row_mask:0xf bank_mask:0xf
    s_nop 1
    v_min_i32_dpp v24, v24, v24 row_ror:4 row_mask:0xf bank_mask:0xf
    s_nop 1
    v_min_i32_dpp v24, v24, v24 row_ror:2 row_mask:0xf bank_mask:0xf
    s_nop 1
    v_min_i32_dpp v24, v24, v24 row_ror:1 row_mask:0xf bank_mask:0xf
    s_nop 0
    v_readlane_b32 s48, v24, 0
    v_readlane_b32 s20, v24, 16
    v_readlane_b32 s21, v24, 32
    s_min_i32 s48, s48, s20
    v_readlane_b32 s20, v24, 48
    s_min_i32 s48, s48, s21
    s_min_i32 s48, s48, s20
L_own_known:
    s_waitcnt vmcnt(8)
    s_cmp_lt_u32 s16, 1
    s_cbranch_scc0 L_own_s0
    s_add_u32 s20, s19, 0
    v_lshrrev_b32 v20, 4, v4
    v_lshlrev_b32 v20, 7, v20
    v_add_u32 v20, s20, v20
    s_mov_b32 s21, 0
    buffer_load_dword v16, v20, s[8:11], 0 offen sc1
    s_sleep 1
    buffer_load_dword v17, v20, s[8:11], 0 offen sc1
    s_sleep 1
    buffer_load_dword v18, v20, s[8:11], 0 offen sc1
    s_sleep 1
    buffer_load_dword v19, v20, s[8:11], 0 offen sc1
poll_24:
    s_waitcnt vmcnt(3)
    v_cmp_gt_i32 vcc, s16, v16
    s_cbranch_vccz poll_24_got
    buffer_load_dword v16, v20, s[8:11], 0 offen sc1
    s_waitcnt vmcnt(3)
    v_cmp_gt_i32 vcc, s16, v17
    s_cbranch_vccz poll_24_got
    buffer_load_dword v17, v20, s[8:11], 0 offen sc1
    s_waitcnt vmcnt(3)
    v_cmp_gt_i32 vcc, s16, v18
    s_cbranch_vccz poll_24_got
    buffer_load_dword v18, v20, s[8:11], 0 offen sc1
    s_waitcnt vmcnt(3)
    v_cmp_gt_i32 vcc, s16, v19
    s_cbranch_vccz poll_24_got
    buffer_load_dword v19, v20, s[8:11], 0 offen sc1
    s_add_u32 s21, s21, 1
    s_cmp_lt_u32 s21, 100000
    s_cbranch_scc1 poll_24
    s_mov_b32 s24, 0x7000000
poll_24_got:
    s_branch L_own_s1
L_own_s0:
    s_mov_b32 s21, 0
    buffer_load_dword v16, v7, s[8:11], 0 offen sc1
    s_sleep 1
    s_waitcnt vmcnt(7)
    buffer_load_dword v17, v7, s[8:11], 0 offen sc1
    s_sleep 1
    s_waitcnt vmcnt(6)
    buffer_load_dword v18, v7, s[8:11], 0 offen sc1
    s_sleep 1
    s_waitcnt vmcnt(5)
    buffer_load_dword v19, v7, s[8:11], 0 offen sc1
poll_25:
    s_waitcnt vmcnt(3)
    v_cmp_gt_i32 vcc, s16, v16
    s_cbranch_vccz poll_25_got
    buffer_load_dword v16, v7, s[8:11], 0 offen sc1
    s_waitcnt vmcnt(3)
    v_cmp_gt_i32 vcc, s16, v17
    s_cbranch_vccz poll_25_got
    buffer_load_dword v17, v7, s[8:11], 0 offen sc1
    s_waitcnt vmcnt(3)
    v_cmp_gt_i32 vcc, s16, v18
    s_cbranch_vccz poll_25_got
    buffer_load_dword v18, v7, s[8:11], 0 offen sc1
    s_waitcnt vmcnt(3)
    v_cmp_gt_i32 vcc, s16, v19
    s_cbranch_vccz poll_25_got
    buffer_load_dword v19, v7, s[8:11], 0 offen sc1
    s_add_u32 s21, s21, 1
    s_cmp_lt_u32 s21, 100000
    s_cbranch_scc1 poll_25
    s_mov_b32 s24, 0x7000000
poll_25_got:
L_own_s1:
L_own_retry:
    buffer_load_dwordx4 v[32:35], v4, s[8:11], s68 offen offset:0 sc1
    buffer_load_dwordx4 v[36:39], v4, s[8:11], s68 offen offset:1024 sc1
    buffer_load_dwordx4 v[40:43], v4, s[8:11], s69 offen offset:0 sc1
    buffer_load_dwordx4 v[44:47], v4, s[8:11], s69 offen offset:1024 sc1
    buffer_load_dwordx4 v[48:51], v4, s[8:11], s70 offen offset:0 sc1
    buffer_load_dwordx4 v[52:55], v4, s[8:11], s70 offen offset:1024 sc1
    buffer_load_dwordx4 v[56:59], v4, s[8:11], s71 offen offset:0 sc1
    buffer_load_dwordx4 v[60:63], v4, s[8:11], s71 offen offset:1024 sc1
    buffer_load_dwordx4 v[192:195], v4, s[8:11], s72 offen offset:0 sc1
    buffer_load_dwordx4 v[196:199], v4, s[8:11], s72 offen offset:1024 sc1
    buffer_load_dwordx4 v[200:203], v4, s[8:11], s72 offen offset:2048 sc1
    buffer_load_dwordx4 v[204:207], v4, s[8:11], s72 offen offset:3072 sc1
    buffer_load_dwordx4 v[208:211], v4, s[8:11], s73 offen offset:0 sc1
    buffer_load_dwordx4 v[212:215], v4, s[8:11], s73 offen offset:1024 sc1
    buffer_load_dwordx4 v[216:219], v4, s[8:11], s73 offen offset:2048 sc1
    buffer_load_dwordx4 v[220:223], v4, s[8:11], s73 offen offset:3072 sc1
    buffer_load_dwordx4 v[224:227], v4, s[8:11], s74 offen offset:0 sc1
    buffer_load_dwordx4 v[228:231], v4, s[8:11], s74 offen offset:1024 sc1
    buffer_load_dwordx4 v[232:235], v4, s[8:11], s74 offen offset:2048 sc1
    buffer_load_dwordx4 v[236:239], v4, s[8:11], s74 offen offset:3072 sc1
    buffer_load_dwordx4 v[240:243], v4, s[8:11], s75 offen offset:0 sc1
    buffer_load_dwordx4 v[244:247], v4, s[8:11], s75 offen offset:1024 sc1
    buffer_load_dwordx4 v[248:251], v4, s[8:11], s75 offen offset:2048 sc1
    buffer_load_dwordx4 v[252:255], v4, s[8:11], s75 offen offset:3072 sc1
    buffer_load_dwordx4 v[16:19], v4, s[8:11], s64 offen sc1
    buffer_load_dwordx4 v[20:23], v4, s[8:11], s65 offen sc1
    buffer_load_dwordx4 v[24:27], v4, s[8:11], s66 offen sc1
    buffer_load_dwordx4 v[28:31], v4, s[8:11], s67 offen sc1
    v_mov_b32 v12, 0
    v_mov_b32 v13, 0
    v_mov_b32 v14, 0
    v_mov_b32 v15, 0
    s_waitcnt vmcnt(19)
    s_nop 0
    v_smfmac_f32_16x16x64_bf16 v[12:15], v[192:195], v[64:71], v3
    s_waitcnt vmcnt(18)
    v_smfmac_f32_16x16x64_bf16 v[12:15], v[196:199], v[72:79], v3
    s_waitcnt vmcnt(17)
    v_smfmac_f32_16x16x64_bf16 v[12:15], v[200:203], v[80:87], v3
    s_waitcnt vmcnt(16)
    v_smfmac_f32_16x16x64_bf16 v[12:15], v[204:207], v[88:95], v3
    s_waitcnt vmcnt(15)
    v_smfmac_f32_16x16x64_bf16 v[12:15], v[208:211], v[96:103], v3
    s_waitcnt vmcnt(14)
    v_smfmac_f32_16x16x64_bf16 v[12:15], v[212:215], v[104:111], v3
    s_waitcnt vmcnt(13)
    v_smfmac_f32_16x16x64_bf16 v[12:15], v[216:219], v[112:119], v3
    s_waitcnt vmcnt(12)
    buffer_store_dword v0, v2, s[8:11], s41 offen sc1
    v_smfmac_f32_16x16x64_bf16 v[12:15], v[220:223], v[120:127], v3
    s_waitcnt vmcnt(12)
    v_smfmac_f32_16x16x64_bf16 v[12:15], v[224:227], v[128:135], v3
    s_waitcnt vmcnt(11)
    v_smfmac_f32_16x16x64_bf16 v[12:15], v[228:231], v[136:143], v3
    s_waitcnt vmcnt(10)
    v_smfmac_f32_16x16x64_bf16 v[12:15], v[232:235], v[144:151], v3
    s_waitcnt vmcnt(9)
    v_smfmac_f32_16x16x64_bf16 v[12:15], v[236:239], v[152:159], v3
    s_waitcnt vmcnt(8)
    v_smfmac_f32_16x16x64_bf16 v[12:15], v[240:243], v[160:167], v3
    s_waitcnt vmcnt(7)
    v_smfmac_f32_16x16x64_bf16 v[12:15], v[244:247], v[168:175], v3
    s_waitcnt vmcnt(6)
    v_smfmac_f32_16x16x64_bf16 v[12:15], v[248:251], v[176:183], v3
    s_waitcnt vmcnt(5)
    v_smfmac_f32_16x16x64_bf16 v[12:15], v[252:255], v[184:191], v3
    s_waitcnt vmcnt(4)
    v_smfmac_f32_16x16x64_bf16 v[12:15], v[16:19], v[32:39], v3
    s_waitcnt vmcnt(3)
    v_smfmac_f32_16x16x64_bf16 v[12:15], v[20:23], v[40:47], v3
    s_waitcnt vmcnt(2)
    v_smfmac_f32_16x16x64_bf16 v[12:15], v[24:27], v[48:55], v3
    s_waitcnt vmcnt(1)
    v_smfmac_f32_16x16x64_bf16 v[12:15], v[28:31], v[56:63], v3
    s_nop 7
    v_add_f32 v12, v12, v13
    v_add_f32 v14, v14, v15
    v_cmpx_o_f32 vcc, v12, v14
    v_cvt_pk_bf16_f32 v13, v12, v14
    buffer_store_dword v13, v6, s[8:11], s42 offen sc1
    s_cmp_eq_u64 exec, -1
    s_mov_b64 exec, -1
    s_cbranch_scc0 L_own_slow
L_own_back:
    s_cmp_eq_u32 s41, 0
    s_cbranch_scc1 L_own_f0
    s_cmp_lt_u32 s16, 0
    s_cselect_b32 s41, 1024, 0
    buffer_store_dword v0, v2, s[8:11], 0 offen sc1
L_own_f0:
    buffer_store_dword v11, v6, s[8:11], s43 offen sc1
    v_mov_b32 v22, s16
    v_mov_b32 v23, s48
    buffer_store_dwordx2 v[22:23], v5, s[8:11], 0 offen sc1
    buffer_store_dwordx4 v[8:11], v4, s[8:11], s28 offen offset:0 sc1
    buffer_store_dwordx4 v[8:11], v4, s[8:11], s28 offen offset:1024 sc1
    buffer_store_dwordx4 v[8:11], v4, s[8:11], s28 offen offset:2048 sc1
    buffer_store_dwordx4 v[8:11], v4, s[8:11], s28 offen offset:3072 sc1
    buffer_store_dwordx4 v[8:11], v4, s[8:11], s38 offen offset:0 sc1
    buffer_store_dwordx4 v[8:11], v4, s[8:11], s38 offen offset:1024 sc1
    buffer_store_dwordx4 v[8:11], v4, s[8:11], s38 offen offset:2048 sc1
    buffer_store_dwordx4 v[8:11], v4, s[8:11], s38 offen offset:3072 sc1
    s_add_u32 s16, s16, 1
    s_cmp_lt_u32 s16, 63
    s_cbranch_scc1 L_own_step
    s_branch L_own_end
L_own_slow:
    v_max3_u32 v13, v16, v17, v18
    v_max_u32 v13, v13, v255
    v_max3_u32 v13, v13, v19, v20
    v_max3_u32 v13, v13, v21, v22
    v_max3_u32 v13, v13, v23, v24
    v_max3_u32 v13, v13, v25, v26
    v_max3_u32 v13, v13, v27, v28
    v_max3_u32 v13, v13, v29, v30
    v_max3_u32 v13, v13, v31, v32
    v_max3_u32 v13, v13, v33, v34
    v_max3_u32 v13, v13, v35, v36
    v_max3_u32 v13, v13, v37, v38
    v_max3_u32 v13, v13, v39, v40
    v_max3_u32 v13, v13, v41, v42
    v_max3_u32 v13, v13, v43, v44
    v_max3_u32 v13, v13, v45, v46
    v_max3_u32 v13, v13, v47, v48
    v_max3_u32 v13, v13, v49, v50
    v_max3_u32 v13, v13, v51, v52
    v_max3_u32 v13, v13, v53, v54
    v_max3_u32 v13, v13, v55, v56
    v_max3_u32 v13, v13, v57, v58
    v_max3_u32 v13, v13, v59, v60
    v_max3_u32 v13, v13, v61, v62
    v_max3_u32 v13, v13, v63, v192
    v_max3_u32 v13, v13, v193, v194
    v_max3_u32 v13, v13, v195, v196
    v_max3_u32 v13, v13, v197, v198
    v_max3_u32 v13, v13, v199, v200
    v_max3_u32 v13, v13, v201, v202
    v_max3_u32 v13, v13, v203, v204
    v_max3_u32 v13, v13, v205, v206
    v_max3_u32 v13, v13, v207, v208
    v_max3_u32 v13, v13, v209, v210
    v_max3_u32 v13, v13, v211, v212
    v_max3_u32 v13, v13, v213, v214
    v_max3_u32 v13, v13, v215, v216
    v_max3_u32 v13, v13, v217, v218
    v_max3_u32 v13, v13, v219, v220
    v_max3_u32 v13, v13, v221, v222
    v_max3_u32 v13, v13, v223, v224
    v_max3_u32 v13, v13, v225, v226
    v_max3_u32 v13, v13, v227, v228
    v_max3_u32 v13, v13, v229, v230
    v_max3_u32 v13, v13, v231, v232
    v_max3_u32 v13, v13, v233, v234
    v_max3_u32 v13, v13, v235, v236
    v_max3_u32 v13, v13, v237, v238
    v_max3_u32 v13, v13, v239, v240
    v_max3_u32 v13, v13, v241, v242
    v_max3_u32 v13, v13, v243, v244
    v_max3_u32 v13, v13, v245, v246
    v_max3_u32 v13, v13, v247, v248
    v_max3_u32 v13, v13, v249, v250
    v_max3_u32 v13, v13, v251, v252
    v_max3_u32 v13, v13, v253, v254
    v_cmp_eq_u32 vcc, -1, v13
    s_cbranch_vccnz L_own_again
    v_cvt_pk_bf16_f32 v13, v12, v14
    buffer_store_dword v13, v6, s[8:11], s42 offen sc1
    s_branch L_own_back
L_own_again:
    s_add_u32 s24, s24, 1
    s_cmp_gt_u32 s24, 200000
    s_cbranch_scc0 L_own_retry
L_own_end:
    s_endpgm
L_last:
.section .rodata,"a"
.p2align 6
.amdhsa_kernel recurrent_scan__memory_aug_recurrent_mem_tr__dense_activation_silu__prompt_kernel
  .amdhsa_next_free_vgpr 512
  .amdhsa_next_free_sgpr 102
  .amdhsa_accum_offset 256
  .amdhsa_group_segment_fixed_size 0
  .amdhsa_kernarg_size 104
  .amdhsa_user_sgpr_count 2
  .amdhsa_user_sgpr_kernarg_segment_ptr 1
  .amdhsa_system_sgpr_workgroup_id_x 1
.end_amdhsa_kernel
```
